```python
import torch

def _softmax(x, axis=-1):
    return torch.softmax(x, dim=axis)
def _gelu(x):
    return torch.nn.functional.gelu(x, approximate="tanh")
def _silu(x):
    return torch.nn.functional.silu(x)
def _sigmoid(x):
    return torch.sigmoid(x)
def _layernorm(x, axis=-1, eps=1e-5):
    m = x.mean(dim=axis, keepdim=True)
    v = x.var(dim=axis, keepdim=True, unbiased=False)
    return (x - m) / torch.sqrt(v + eps)
def _scatter_add(tgt, idx, src, axis=0):
    return tgt.clone().index_add_(axis, idx, src)
def _segment_sum(src, seg, n):
    out = torch.zeros((n,) + src.shape[1:], dtype=src.dtype)
    return out.index_add_(0, seg, src)
def _pad(x, pw):
    flat = tuple(v for pair in reversed(pw) for v in pair)
    return torch.nn.functional.pad(x, flat)

kernel_name = 'interleave_layers__mha_block__glu_gated_swiglu__prompt'

def setup_inputs():

    _w = (lambda a: (lambda t: t.to(torch.bfloat16) if t.is_floating_point() else t)(torch.as_tensor(a)))
    def _A_setup():
        B, S, D, H = 1, 2048, 512, 32
        return {
            "x": _w((lambda *s: torch.randn(*s, dtype=torch.bfloat16) * 0.05)(B, S, D)),
            "wqkv": _w((lambda *s: torch.randn(*s, dtype=torch.bfloat16) * 0.05)(D, 3 * D)),
            "wo": _w((lambda *s: torch.randn(*s, dtype=torch.bfloat16) * 0.05)(D, D)),
        }
    _A_in = _A_setup()

    def _B_setup():
        B, S, D, F = 1, 2048, 512, 1792
        return {
            "x": _w((lambda *s: torch.randn(*s, dtype=torch.bfloat16) * 0.05)(B, S, D)),
            "w1": _w((lambda *s: torch.randn(*s, dtype=torch.bfloat16) * 0.4)(D, F) * (2.0 / D) ** 0.5),
            "w3": _w((lambda *s: torch.randn(*s, dtype=torch.bfloat16) * 0.4)(D, F) * (2.0 / D) ** 0.5),
            "w2": _w((lambda *s: torch.randn(*s, dtype=torch.bfloat16) * 0.4)(F, D) * (2.0 / F) ** 0.5),
        }
    _B_in = _B_setup()

    return {
        "A_x": _A_in["x"],
        "A_wqkv": _A_in["wqkv"],
        "A_wo": _A_in["wo"],
        "B_x": _B_in["x"],
        "B_w1": _B_in["w1"],
        "B_w3": _B_in["w3"],
        "B_w2": _B_in["w2"],
    }

def reference(A_x, A_wqkv, A_wo, B_x, B_w1, B_w3, B_w2):
    def _A_ref(x, wqkv, wo):
        B, S, D = x.shape
        H = 32
        Dh = D // H
        qkv = (lambda x, *d: x.permute(*d))((x @ wqkv).reshape(B, S, 3, H, Dh), 2, 0, 3, 1, 4)
        q, k, v = qkv[0], qkv[1], qkv[2]
        scores = torch.einsum("bhqd,bhkd->bhqk", q, k) * (Dh ** -0.5)
        p = _softmax(scores, axis=-1)
        o = torch.einsum("bhqk,bhkd->bhqd", p, v)
        return (lambda x, *d: x.permute(*d))(o, 0, 2, 1, 3).reshape(B, S, D) @ wo

    def _B_ref(x, w1, w3, w2):
        gate = torch.einsum("bsd,df->bsf", x, w1)
        up = torch.einsum("bsd,df->bsf", x, w3)
        h = _silu(gate) * up
        out = torch.einsum("bsf,fd->bsd", h, w2)
        return out

    x = A_x
    x = x + _A_ref(_layernorm(x, axis=-1), A_wqkv, A_wo)
    x = x + _B_ref(_layernorm(x, axis=-1), B_w1, B_w3, B_w2)
    x = x + _A_ref(_layernorm(x, axis=-1), A_wqkv, A_wo)
    x = x + _B_ref(_layernorm(x, axis=-1), B_w1, B_w3, B_w2)
    return x
```

```asm
; @launch grid=(256,1,1) block=(256,1,1) lds=163840
.amdgcn_target "amdgcn-amd-amdhsa--gfx950"
.text
.globl interleave_layers__mha_block__glu_gated_swiglu__prompt_kernel
.p2align 8
.type interleave_layers__mha_block__glu_gated_swiglu__prompt_kernel,@function
interleave_layers__mha_block__glu_gated_swiglu__prompt_kernel:
  s_cmp_ge_u32 s2, 256
  s_cbranch_scc1 L_exit
  s_load_dwordx16 s[64:79], s[0:1], 0
  s_load_dwordx4 s[80:83], s[0:1], 64
  v_lshrrev_b32 v4, 6, v0
  v_and_b32 v5, 63, v0
  v_readfirstlane_b32 s38, v4
  v_lshlrev_b32 v1, 2, v5
  v_lshlrev_b32 v0, 4, v5
  s_and_b32 s36, s2, 7
  s_lshr_b32 s37, s2, 3
  s_and_b32 s40, s37, 15
  s_xor_b32 s40, s40, 0
  s_lshr_b32 s48, s37, 4
  s_lshl_b32 s48, s48, 2
  s_add_u32 s48, s48, s38
  s_lshl_b32 s49, s36, 3
  s_add_u32 s39, s49, s48
  s_getpc_b64 s[4:5]
L_pc:
  s_lshl_b32 s56, s37, 2
  s_add_u32 s56, s56, s38
  s_and_b32 s56, s56, 15
  s_lshl_b32 s56, s56, 13
  v_lshrrev_b32 v6, 4, v0
  v_lshl_add_u32 v6, v6, 7, s56
  v_min_u32 v6, L_end-L_pc-4, v6
  global_load_dword v255, v6, s[4:5]
  v_lshrrev_b32 v4, 4, v0
  v_lshrrev_b32 v6, 3, v4
  v_lshlrev_b32 v224, 10, v6
  v_lshrrev_b32 v6, 1, v6
  v_and_b32 v7, 7, v4
  v_xor_b32 v6, v6, v7
  v_lshl_add_u32 v224, v6, 4, v224
  v_xor_b32 v225, 64, v224
  s_lshl_b32 s48, s39, 15
  s_lshr_b32 s49, s40, 1
  s_lshl_b32 s54, s38, 14
  s_lshl_b32 s6, s40, 6
  s_mul_i32 s7, s38, 3072
  s_add_u32 s7, s7, 65536
  v_add_u32 v6, 0, v4
  v_mul_u32_u24 v7, 0x1556, v6
  v_lshrrev_b32 v7, 16, v7
  v_mul_u32_u24 v232, 12, v7
  v_sub_u32 v6, v6, v232
  v_mul_u32_u24 v232, 3072, v7
  v_lshrrev_b32 v7, 2, v6
  v_lshl_add_u32 v232, v7, 10, v232
  v_and_b32 v6, 3, v6
  v_lshl_add_u32 v232, v6, 4, v232
  v_add_u32 v6, 64, v4
  v_mul_u32_u24 v7, 0x1556, v6
  v_lshrrev_b32 v7, 16, v7
  v_mul_u32_u24 v233, 12, v7
  v_sub_u32 v6, v6, v233
  v_mul_u32_u24 v233, 3072, v7
  v_lshrrev_b32 v7, 2, v6
  v_lshl_add_u32 v233, v7, 10, v233
  v_and_b32 v6, 3, v6
  v_lshl_add_u32 v233, v6, 4, v233
  v_add_u32 v6, 128, v4
  v_mul_u32_u24 v7, 0x1556, v6
  v_lshrrev_b32 v7, 16, v7
  v_mul_u32_u24 v234, 12, v7
  v_sub_u32 v6, v6, v234
  v_mul_u32_u24 v234, 3072, v7
  v_lshrrev_b32 v7, 2, v6
  v_lshl_add_u32 v234, v7, 10, v234
  v_and_b32 v6, 3, v6
  v_lshl_add_u32 v234, v6, 4, v234
  s_waitcnt lgkmcnt(0)
  s_mov_b32 s12, s64
  s_mov_b32 s13, s65
  s_mov_b32 s14, 2097152
  s_mov_b32 s15, 0x20000
  s_mov_b32 s24, s66
  s_mov_b32 s25, s67
  s_mov_b32 s26, 1572864
  s_mov_b32 s27, 0x20000
  s_lshl_b32 s50, s37, 2
  s_add_u32 s50, s50, s38
  s_mul_i32 s51, s50, 12288
  s_lshl_b32 s50, s50, 11
  s_lshl_b32 s52, s36, 18
  s_add_u32 s50, s50, s52
  v_lshlrev_b32 v254, 3, v0
  v_and_b32 v253, 0x780, v254
  buffer_load_dword v255, v253, s[12:15], s50 offen
  v_lshrrev_b32 v252, 6, v0
  v_min_u32 v252, 11, v252
  v_lshlrev_b32 v252, 10, v252
  buffer_load_dword v255, v252, s[24:27], s51 offen offset:384
  s_lshl_b32 s51, s2, 2
  s_add_u32 s51, s51, s38
  s_mul_i32 s51, s51, 1536
  buffer_load_dword v255, v253, s[24:27], s51 offen
  s_add_u32 s50, s49, 0
  s_and_b32 s50, s50, 7
  s_lshl_b32 s3, s50, 7
  s_add_u32 s3, s3, s48
  s_add_u32 s53, s54, 0
  s_mov_b32 m0, s53
  s_nop 0
  buffer_load_dwordx4 v224, s[12:15], s3 offen lds
  s_add_u32 s53, s54, 1024
  s_mov_b32 m0, s53
  s_add_u32 s3, s3, 8192
  buffer_load_dwordx4 v225, s[12:15], s3 offen lds
  s_add_u32 s53, s54, 2048
  s_mov_b32 m0, s53
  s_add_u32 s3, s3, 8192
  buffer_load_dwordx4 v224, s[12:15], s3 offen lds
  s_add_u32 s53, s54, 3072
  s_mov_b32 m0, s53
  s_add_u32 s3, s3, 8192
  buffer_load_dwordx4 v225, s[12:15], s3 offen lds
  s_add_u32 s50, s49, 0
  s_and_b32 s50, s50, 7
  s_lshl_b32 s50, s50, 2
  s_add_u32 s50, s50, s38
  s_mul_i32 s3, s50, 49152
  s_add_u32 s3, s3, s6
  s_add_u32 s53, s7, 0
  s_mov_b32 m0, s53
  s_nop 0
  buffer_load_dwordx4 v232, s[24:27], s3 offen lds
  s_add_u32 s53, s7, 1024
  s_mov_b32 m0, s53
  s_nop 0
  buffer_load_dwordx4 v233, s[24:27], s3 offen lds
  s_add_u32 s53, s7, 2048
  s_mov_b32 m0, s53
  s_nop 0
  buffer_load_dwordx4 v234, s[24:27], s3 offen lds
  s_mov_b32 s8, s82
  s_mov_b32 s9, s83
  s_mov_b32 s10, 268435456
  s_mov_b32 s11, 0x20000
  s_mov_b32 s20, s80
  s_mov_b32 s21, s81
  s_mov_b32 s22, 256
  s_mov_b32 s23, 0x20000
  s_cmp_lt_u32 s2, 8
  s_cbranch_scc0 L_zf_1
  v_mov_b32 v248, 0
  v_mov_b32 v249, 0
  v_mov_b32 v250, 0
  v_mov_b32 v251, 0
  s_lshl_b32 s50, s2, 2
  s_add_u32 s50, s50, s38
  s_mul_i32 s50, s50, 3072
  buffer_store_dwordx4 v[248:251], v0, s[8:11], s50 offen sc1
  buffer_store_dwordx4 v[248:251], v0, s[8:11], s50 offen offset:1024 sc1
  buffer_store_dwordx4 v[248:251], v0, s[8:11], s50 offen offset:2048 sc1
L_zf_1:
  s_and_b32 s44, s37, 7
  s_lshr_b32 s50, s37, 3
  s_lshl_b32 s50, s50, 1
  s_lshl_b32 s51, s36, 3
  s_add_u32 s50, s50, s51
  s_lshr_b32 s51, s38, 1
  s_add_u32 s41, s50, s51
  s_xor_b32 s42, s41, 1
  s_and_b32 s43, s38, 1
  s_mov_b32 s47, 0xffff0000
  s_mov_b32 s60, 0x0000ffff
  s_mov_b32 s61, 0x0000ffff
  s_mov_b32 s45, 1
  s_and_b32 s50, s39, 7
  v_mov_b32 v3, 0
  s_lshl_b32 s52, s36, 4
  s_add_u32 s52, s52, s40
  s_lshl_b32 s52, s52, 7
  s_lshl_b32 s53, s50, 2
  s_add_u32 s52, s52, s53
  s_add_u32 s52, s52, 0
  v_writelane_b32 v3, s52, 0
  s_lshl_b32 s52, s40, 3
  s_add_u32 s52, s52, s36
  s_lshl_b32 s52, s52, 7
  s_add_u32 s52, s52, s53
  s_add_u32 s52, s52, 65536
  v_writelane_b32 v3, s52, 1
  s_lshl_b32 s52, s36, 2
  s_add_u32 s52, s52, s38
  s_lshl_b32 s52, s52, 2
  s_lshr_b32 s53, s37, 3
  s_add_u32 s52, s52, s53
  s_lshl_b32 s52, s52, 7
  s_lshl_b32 s53, s44, 2
  s_add_u32 s52, s52, s53
  s_add_u32 s52, s52, 16384
  v_writelane_b32 v3, s52, 2
  s_lshl_b32 s52, s41, 7
  s_lshl_b32 s53, s44, 1
  s_add_u32 s53, s53, s43
  s_lshl_b32 s53, s53, 2
  s_add_u32 s52, s52, s53
  s_add_u32 s53, s52, 49152
  v_writelane_b32 v3, s53, 3
  s_add_u32 s53, s52, 57344
  v_writelane_b32 v3, s53, 5
  s_lshr_b32 s52, s39, 1
  s_lshl_b32 s52, s52, 2
  s_lshr_b32 s53, s40, 2
  s_add_u32 s52, s52, s53
  s_lshl_b32 s52, s52, 7
  s_and_b32 s53, s39, 1
  s_lshl_b32 s53, s53, 2
  s_and_b32 s55, s40, 3
  s_add_u32 s53, s53, s55
  s_lshl_b32 s53, s53, 2
  s_add_u32 s52, s52, s53
  s_add_u32 s52, s52, 32768
  v_writelane_b32 v3, s52, 4
  s_lshr_b32 s52, s2, 2
  s_lshl_b32 s52, s52, 7
  s_and_b32 s53, s2, 3
  s_lshl_b32 s53, s53, 2
  s_add_u32 s52, s52, s53
  s_add_u32 s52, s52, 81920
  v_writelane_b32 v3, s52, 6
  s_lshl_b32 s52, s36, 5
  s_add_u32 s52, s52, s37
  s_lshl_b32 s52, s52, 2
  s_add_u32 s52, s52, 90112
  v_writelane_b32 v3, s52, 7
  v_and_b32 v6, 31, v4
  v_lshrrev_b32 v7, 5, v4
  v_bfe_u32 v5, v4, 1, 3
  v_xor_b32 v5, v5, v7
  v_lshlrev_b32 v5, 4, v5
  v_lshl_add_u32 v5, v6, 7, v5
  v_add_u32 v5, s54, v5
  s_add_u32 s50, s38, 0
  s_and_b32 s50, s50, 3
  s_lshl_b32 s50, s50, 5
  v_xor_b32 v226, s50, v5
  s_add_u32 s50, s38, 1
  s_and_b32 s50, s50, 3
  s_lshl_b32 s50, s50, 5
  v_xor_b32 v227, s50, v5
  s_add_u32 s50, s38, 2
  s_and_b32 s50, s50, 3
  s_lshl_b32 s50, s50, 5
  v_xor_b32 v228, s50, v5
  s_add_u32 s50, s38, 3
  s_and_b32 s50, s50, 3
  s_lshl_b32 s50, s50, 5
  v_xor_b32 v229, s50, v5
  v_lshrrev_b32 v6, 5, v4
  v_lshlrev_b32 v6, 3, v6
  v_bfe_u32 v7, v4, 2, 2
  v_add_u32 v6, v6, v7
  v_mul_u32_u24 v5, 192, v6
  v_bfe_u32 v7, v4, 4, 1
  v_lshl_add_u32 v5, v7, 5, v5
  v_and_b32 v7, 1, v4
  v_lshl_add_u32 v5, v7, 4, v5
  v_bfe_u32 v7, v4, 1, 1
  v_lshl_add_u32 v5, v7, 3, v5
  s_add_u32 s50, s38, 0
  s_and_b32 s50, s50, 3
  s_mul_i32 s50, s50, 3072
  s_add_u32 s50, s50, 65536
  v_add_u32 v236, s50, v5
  s_add_u32 s50, s38, 1
  s_and_b32 s50, s50, 3
  s_mul_i32 s50, s50, 3072
  s_add_u32 s50, s50, 65536
  v_add_u32 v237, s50, v5
  s_add_u32 s50, s38, 2
  s_and_b32 s50, s50, 3
  s_mul_i32 s50, s50, 3072
  s_add_u32 s50, s50, 65536
  v_add_u32 v238, s50, v5
  s_add_u32 s50, s38, 3
  s_and_b32 s50, s50, 3
  s_mul_i32 s50, s50, 3072
  s_add_u32 s50, s50, 65536
  v_add_u32 v239, s50, v5
  v_mov_b32 v5, 0x3f803f80
  v_accvgpr_write_b32 a48, v5
  v_accvgpr_write_b32 a49, v5
  v_accvgpr_write_b32 a50, v5
  v_accvgpr_write_b32 a51, v5
  v_lshrrev_b32 v4, 4, v0
  v_and_b32 v6, 0x33, v4
  v_bfe_u32 v7, v4, 2, 1
  v_lshl_add_u32 v6, v7, 3, v6
  v_bfe_u32 v7, v4, 3, 1
  v_lshl_add_u32 v6, v7, 2, v6
  v_lshlrev_b32 v242, 4, v6
  v_bfe_u32 v6, v4, 4, 1
  v_lshlrev_b32 v243, 17, v6
  v_lshrrev_b32 v6, 5, v4
  v_lshl_add_u32 v243, v6, 8, v243
  v_and_b32 v6, 15, v4
  v_lshl_add_u32 v243, v6, 4, v243
  s_mov_b32 s55, s2
  s_cmp_ge_u32 s55, 224
  s_cbranch_scc1 L_rl_2
  s_mov_b32 s28, s72
  s_mov_b32 s29, s73
  s_mov_b32 s30, 1835008
  s_mov_b32 s31, 0x20000
  s_mov_b32 s32, s74
  s_mov_b32 s33, s75
  s_mov_b32 s34, 1835008
  s_mov_b32 s35, 0x20000
  s_mov_b32 s57, 3584
  s_lshr_b32 s50, s55, 3
  s_and_b32 s51, s55, 7
  s_lshl_b32 s52, s51, 2
  s_add_u32 s52, s52, s38
  s_mul_i32 s58, s52, 57344
  s_lshl_b32 s52, s50, 7
  s_add_u32 s58, s58, s52
  s_lshl_b32 s50, s50, 2
  s_add_u32 s50, s50, s38
  s_lshl_b32 s62, s50, 10
  s_add_u32 s62, s62, 9699328
  s_mul_i32 s52, s50, 9363
  s_lshr_b32 s52, s52, 16
  s_mul_i32 s53, s52, 7
  s_sub_u32 s53, s50, s53
  s_mul_i32 s64, s52, 229376
  s_add_u32 s64, s64, 4194304
  s_mov_b32 s52, 0
  s_mov_b32 s65, 4096
  s_cmp_ge_u32 s53, 4
  s_cselect_b32 s52, 4, s52
  s_cselect_b32 s65, 2048, s65
  s_cmp_ge_u32 s53, 6
  s_cselect_b32 s52, 6, s52
  s_cselect_b32 s65, 1024, s65
  s_mul_i32 s50, s52, 31
  s_add_u32 s50, s50, s53
  s_lshl_b32 s50, s50, 10
  s_add_u32 s64, s64, s50
  s_mov_b32 s56, 8192
  s_lshl_b32 s59, s38, 5
  s_lshl_b32 s50, s65, 2
  s_mul_i32 s50, s50, s51
  s_add_u32 s64, s64, s50
  s_and_b32 s50, s51, 4
  s_lshl_b32 s50, s50, 7
  s_add_u32 s62, s62, s50
  s_and_b32 s50, s51, 3
  s_lshl_b32 s50, s50, 2
  s_add_u32 s62, s62, s50
  s_mov_b32 s50, 0
  s_mov_b32 s51, 0
  s_branch L_rl_3
L_rl_2:
  s_mov_b32 s28, s68
  s_mov_b32 s29, s69
  s_mov_b32 s30, 524288
  s_mov_b32 s31, 0x20000
  s_mov_b32 s32, s68
  s_mov_b32 s33, s69
  s_mov_b32 s34, 523776
  s_mov_b32 s35, 0x20000
  s_add_u32 s32, s32, 512
  s_addc_u32 s33, s33, 0
  s_mov_b32 s57, 1024
  s_sub_u32 s50, s55, 224
  s_lshl_b32 s58, s50, 14
  s_lshr_b32 s51, s38, 1
  s_lshl_b32 s59, s51, 13
  s_mul_i32 s51, s51, 128
  s_add_u32 s51, s51, s50
  s_lshl_b32 s64, s51, 11
  s_and_b32 s51, s38, 1
  s_lshl_b32 s52, s51, 10
  s_add_u32 s64, s64, s52
  s_add_u32 s64, s64, 3670016
  s_mov_b32 s65, 65536
  s_lshl_b32 s52, s51, 6
  s_add_u32 s59, s59, s52
  s_mov_b32 s56, 32
  s_lshl_b32 s62, s55, 2
  s_add_u32 s62, s62, s38
  s_and_b32 s62, s62, 63
  s_lshl_b32 s62, s62, 10
  s_add_u32 s62, s62, 9895936
  s_mov_b32 s50, 3
  s_mov_b32 s51, s38
L_rl_3:
  v_lshrrev_b32 v244, 7, v0
  v_and_b32 v6, s50, v244
  v_xor_b32 v6, s51, v6
  v_mul_lo_u32 v244, v244, s57
  v_lshl_add_u32 v244, v6, 7, v244
  v_and_b32 v246, 0x70, v0
  v_add3_u32 v244, v244, v246, s58
  s_lshl_b32 s4, s57, 3
  s_add_u32 s59, s59, 131072
  v_bfe_u32 v246, v0, 8, 1
  v_mul_lo_u32 v246, v246, s56
  v_add_u32 v246, s59, v246
  v_lshrrev_b32 v6, 9, v0
  v_lshl_add_u32 v246, v6, 10, v246
  v_bfe_u32 v6, v0, 6, 2
  v_lshl_add_u32 v246, v6, 7, v246
  v_and_b32 v6, s50, v6
  v_lshl_add_u32 v246, v6, 11, v246
  v_and_b32 v6, 16, v0
  v_add_u32 v246, v6, v246
  v_bfe_u32 v6, v0, 5, 1
  v_lshl_add_u32 v246, v6, 3, v246
  v_add_u32 v248, s4, v244
  s_mov_b32 s50, s37
  s_cmp_gt_u32 s37, 0
  s_subb_u32 s50, s50, 0
  s_cmp_gt_u32 s37, 6
  s_subb_u32 s50, s50, 0
  s_cmp_gt_u32 s37, 7
  s_subb_u32 s50, s50, 0
  s_cmp_gt_u32 s37, 16
  s_subb_u32 s50, s50, 0
  s_cmp_gt_u32 s37, 22
  s_subb_u32 s50, s50, 0
  s_cmp_gt_u32 s37, 23
  s_subb_u32 s50, s50, 0
  s_lshl_b32 s55, s50, 3
  s_add_u32 s55, s55, s36
  s_min_u32 s55, s55, 207
  s_cmp_lt_u32 s55, 112
  s_cbranch_scc1 L_rl_7
  s_mov_b32 s80, s66
  s_mov_b32 s81, s67
  s_mov_b32 s82, 1572864
  s_mov_b32 s83, 0x20000
  s_mov_b32 s16, s66
  s_mov_b32 s17, s67
  s_mov_b32 s18, 1572736
  s_mov_b32 s19, 0x20000
  s_add_u32 s16, s16, 128
  s_addc_u32 s17, s17, 0
  s_mov_b32 s57, 3072
  s_sub_u32 s50, s55, 112
  s_and_b32 s51, s50, 7
  s_lshr_b32 s50, s50, 3
  s_lshl_b32 s52, s51, 2
  s_add_u32 s52, s52, s38
  s_mul_i32 s58, s52, 49152
  s_lshl_b32 s52, s50, 8
  s_add_u32 s58, s58, s52
  s_lshl_b32 s50, s50, 2
  s_add_u32 s50, s50, s38
  s_lshl_b32 s63, s50, 10
  s_add_u32 s63, s63, 9830400
  s_and_b32 s52, s50, 15
  s_mul_i32 s70, s52, 98304
  s_lshr_b32 s52, s50, 4
  s_lshl_b32 s52, s52, 10
  s_add_u32 s70, s70, s52
  s_add_u32 s70, s70, 2097152
  s_mov_b32 s71, 3072
  s_mov_b32 s56, 32
  s_lshr_b32 s59, s38, 1
  s_lshl_b32 s59, s59, 13
  s_and_b32 s52, s38, 1
  s_lshl_b32 s52, s52, 6
  s_add_u32 s59, s59, s52
  s_lshl_b32 s50, s71, 2
  s_mul_i32 s50, s50, s51
  s_add_u32 s70, s70, s50
  s_and_b32 s50, s51, 4
  s_lshl_b32 s50, s50, 7
  s_add_u32 s63, s63, s50
  s_and_b32 s50, s51, 3
  s_lshl_b32 s50, s50, 2
  s_add_u32 s63, s63, s50
  s_mov_b32 s50, 0
  s_mov_b32 s51, 0
  s_branch L_rl_8
L_rl_7:
  s_mov_b32 s80, s76
  s_mov_b32 s81, s77
  s_mov_b32 s82, 1835008
  s_mov_b32 s83, 0x20000
  s_mov_b32 s16, s76
  s_mov_b32 s17, s77
  s_mov_b32 s18, 1834496
  s_mov_b32 s19, 0x20000
  s_add_u32 s16, s16, 512
  s_addc_u32 s17, s17, 0
  s_mov_b32 s57, 1024
  s_sub_u32 s50, s55, 0
  s_lshl_b32 s58, s50, 14
  s_lshr_b32 s51, s38, 1
  s_lshl_b32 s59, s51, 13
  s_mul_i32 s51, s51, 448
  s_add_u32 s51, s51, s50
  s_lshl_b32 s70, s51, 11
  s_and_b32 s51, s38, 1
  s_lshl_b32 s52, s51, 10
  s_add_u32 s70, s70, s52
  s_add_u32 s70, s70, 7864320
  s_mov_b32 s71, 229376
  s_lshl_b32 s52, s51, 6
  s_add_u32 s59, s59, s52
  s_mov_b32 s56, 32
  s_lshl_b32 s63, s55, 2
  s_add_u32 s63, s63, s38
  s_and_b32 s63, s63, 63
  s_lshl_b32 s63, s63, 10
  s_add_u32 s63, s63, 9895936
  s_mov_b32 s50, 3
  s_mov_b32 s51, s38
L_rl_8:
  v_lshrrev_b32 v245, 7, v0
  v_and_b32 v6, s50, v245
  v_xor_b32 v6, s51, v6
  v_mul_lo_u32 v245, v245, s57
  v_lshl_add_u32 v245, v6, 7, v245
  v_and_b32 v247, 0x70, v0
  v_add3_u32 v245, v245, v247, s58
  s_lshl_b32 s5, s57, 3
  s_add_u32 s59, s59, 147456
  v_bfe_u32 v247, v0, 8, 1
  v_mul_lo_u32 v247, v247, s56
  v_add_u32 v247, s59, v247
  v_lshrrev_b32 v6, 9, v0
  v_lshl_add_u32 v247, v6, 10, v247
  v_bfe_u32 v6, v0, 6, 2
  v_lshl_add_u32 v247, v6, 7, v247
  v_and_b32 v6, s50, v6
  v_lshl_add_u32 v247, v6, 11, v247
  v_and_b32 v6, 16, v0
  v_add_u32 v247, v6, v247
  v_bfe_u32 v6, v0, 5, 1
  v_lshl_add_u32 v247, v6, 3, v247
  v_add_u32 v249, s5, v245
  s_lshr_b32 s50, 0xc100c1, s37
  s_and_b32 s50, s50, 1
  s_cselect_b32 s82, 0, s82
  s_cselect_b32 s18, 0, s18
  s_cselect_b32 s70, 0x10000000, s70
  s_cselect_b32 s63, 0x10000000, s63
  s_add_u32 s50, s49, 1
  s_and_b32 s50, s50, 7
  s_lshl_b32 s3, s50, 7
  s_add_u32 s3, s3, s48
  s_add_u32 s53, s54, 4096
  s_mov_b32 m0, s53
  s_nop 0
  buffer_load_dwordx4 v224, s[12:15], s3 offen lds
  s_add_u32 s53, s54, 5120
  s_mov_b32 m0, s53
  s_add_u32 s3, s3, 8192
  buffer_load_dwordx4 v225, s[12:15], s3 offen lds
  s_add_u32 s53, s54, 6144
  s_mov_b32 m0, s53
  s_add_u32 s3, s3, 8192
  buffer_load_dwordx4 v224, s[12:15], s3 offen lds
  s_add_u32 s53, s54, 7168
  s_mov_b32 m0, s53
  s_add_u32 s3, s3, 8192
  buffer_load_dwordx4 v225, s[12:15], s3 offen lds
  s_add_u32 s50, s49, 1
  s_and_b32 s50, s50, 7
  s_lshl_b32 s50, s50, 2
  s_add_u32 s50, s50, s38
  s_mul_i32 s3, s50, 49152
  s_add_u32 s3, s3, s6
  s_add_u32 s53, s7, 12288
  s_mov_b32 m0, s53
  s_nop 0
  buffer_load_dwordx4 v232, s[24:27], s3 offen lds
  s_add_u32 s53, s7, 13312
  s_mov_b32 m0, s53
  s_nop 0
  buffer_load_dwordx4 v233, s[24:27], s3 offen lds
  s_add_u32 s53, s7, 14336
  s_mov_b32 m0, s53
  s_nop 0
  buffer_load_dwordx4 v234, s[24:27], s3 offen lds
  s_add_u32 s50, s49, 2
  s_and_b32 s50, s50, 7
  s_lshl_b32 s3, s50, 7
  s_add_u32 s3, s3, s48
  s_add_u32 s53, s54, 8192
  s_mov_b32 m0, s53
  s_nop 0
  buffer_load_dwordx4 v224, s[12:15], s3 offen lds
  s_add_u32 s53, s54, 9216
  s_mov_b32 m0, s53
  s_add_u32 s3, s3, 8192
  buffer_load_dwordx4 v225, s[12:15], s3 offen lds
  s_add_u32 s53, s54, 10240
  s_mov_b32 m0, s53
  s_add_u32 s3, s3, 8192
  buffer_load_dwordx4 v224, s[12:15], s3 offen lds
  s_add_u32 s53, s54, 11264
  s_mov_b32 m0, s53
  s_add_u32 s3, s3, 8192
  buffer_load_dwordx4 v225, s[12:15], s3 offen lds
  s_add_u32 s50, s49, 2
  s_and_b32 s50, s50, 7
  s_lshl_b32 s50, s50, 2
  s_add_u32 s50, s50, s38
  s_mul_i32 s3, s50, 49152
  s_add_u32 s3, s3, s6
  s_add_u32 s53, s7, 24576
  s_mov_b32 m0, s53
  s_nop 0
  buffer_load_dwordx4 v232, s[24:27], s3 offen lds
  s_add_u32 s53, s7, 25600
  s_mov_b32 m0, s53
  s_nop 0
  buffer_load_dwordx4 v233, s[24:27], s3 offen lds
  s_add_u32 s53, s7, 26624
  s_mov_b32 m0, s53
  s_nop 0
  buffer_load_dwordx4 v234, s[24:27], s3 offen lds
  s_waitcnt vmcnt(17)
  ds_read_b128 v[16:19], v226 offset:0
  ds_read_b128 v[20:23], v227 offset:0
  ds_read_b128 v[24:27], v228 offset:0
  ds_read_b128 v[28:31], v229 offset:0
  s_waitcnt vmcnt(14)
  s_barrier
  ds_read_b64_tr_b16 a[224:225], v236 offset:64
  ds_read_b64_tr_b16 a[226:227], v236 offset:832
  ds_read_b64_tr_b16 a[228:229], v236 offset:128
  ds_read_b64_tr_b16 a[230:231], v236 offset:896
  ds_read_b64_tr_b16 a[232:233], v236 offset:0
  ds_read_b64_tr_b16 a[234:235], v236 offset:768
  ds_read_b64_tr_b16 a[236:237], v237 offset:64
  ds_read_b64_tr_b16 a[238:239], v237 offset:832
  ds_read_b64_tr_b16 a[240:241], v237 offset:128
  ds_read_b64_tr_b16 a[242:243], v237 offset:896
  s_waitcnt lgkmcnt(10)
  s_waitcnt lgkmcnt(4)
  v_mfma_f32_32x32x16_bf16 v[160:175], a[224:227], v[16:19], 0
  ds_read_b64_tr_b16 a[244:245], v237 offset:0
  ds_read_b64_tr_b16 a[246:247], v237 offset:768
  s_waitcnt vmcnt(10)
  ds_read_b128 v[32:35], v226 offset:4096
  ds_read_b128 v[36:39], v227 offset:4096
  v_mfma_f32_4x4x4_16b_bf16 a[0:3], a[48:49], a[224:225], 0
  v_mfma_f32_4x4x4_16b_bf16 a[4:7], a[48:49], a[226:227], 0
  v_mfma_f32_32x32x16_bf16 v[176:191], v[16:19], a[228:231], 0
  ds_read_b64_tr_b16 a[248:249], v238 offset:64
  ds_read_b64_tr_b16 a[250:251], v238 offset:832
  ds_read_b128 v[40:43], v228 offset:4096
  ds_read_b128 v[44:47], v229 offset:4096
  v_mfma_f32_4x4x4_16b_bf16 a[8:11], a[48:49], a[228:229], 0
  v_mfma_f32_4x4x4_16b_bf16 a[12:15], a[48:49], a[230:231], 0
  v_mfma_f32_32x32x16_bf16 v[144:159], a[232:235], v[16:19], 0
  ds_read_b64_tr_b16 a[252:253], v238 offset:128
  ds_read_b64_tr_b16 a[254:255], v238 offset:896
  s_cmp_lt_u32 s2, 8
  s_cbranch_scc0 L_hs_12
  s_lshl_b32 s57, s2, 2
  s_add_u32 s57, s57, s38
  s_lshl_b32 s57, s57, 2
  v_mov_b32 v5, 1
  v_mov_b32 v6, s57
  s_mov_b64 exec, 1
  buffer_store_dword v5, v6, s[20:23], 0 offen sc1
  s_mov_b64 exec, -1
L_hs_12:
  s_add_u32 s50, s49, 3
  s_and_b32 s50, s50, 7
  s_lshl_b32 s3, s50, 7
  s_add_u32 s3, s3, s48
  s_add_u32 s53, s54, 12288
  s_mov_b32 m0, s53
  s_nop 0
  buffer_load_dwordx4 v224, s[12:15], s3 offen lds
  v_mfma_f32_4x4x4_16b_bf16 a[16:19], a[48:49], a[232:233], 0
  v_mfma_f32_4x4x4_16b_bf16 a[20:23], a[48:49], a[234:235], 0
  v_mfma_f32_4x4x4_16b_bf16 v[192:195], a[48:49], v[16:17], 0
  v_mfma_f32_4x4x4_16b_bf16 v[208:211], v[16:17], v[16:17], 0
  v_mfma_f32_4x4x4_16b_bf16 v[196:199], a[48:49], v[18:19], 0
  v_mfma_f32_4x4x4_16b_bf16 v[212:215], v[18:19], v[18:19], 0
  s_waitcnt lgkmcnt(8)
  v_mfma_f32_32x32x16_bf16 v[160:175], a[236:239], v[20:23], v[160:175]
  ds_read_b64_tr_b16 a[224:225], v238 offset:0
  ds_read_b64_tr_b16 a[226:227], v238 offset:768
  s_add_u32 s53, s54, 13312
  s_mov_b32 m0, s53
  s_add_u32 s3, s3, 8192
  buffer_load_dwordx4 v225, s[12:15], s3 offen lds
  s_add_u32 s53, s54, 14336
  s_mov_b32 m0, s53
  s_add_u32 s3, s3, 8192
  buffer_load_dwordx4 v224, s[12:15], s3 offen lds
  v_mfma_f32_32x32x16_bf16 v[176:191], v[20:23], a[240:243], v[176:191]
  ds_read_b64_tr_b16 a[228:229], v239 offset:64
  ds_read_b64_tr_b16 a[230:231], v239 offset:832
  s_add_u32 s53, s54, 15360
  s_mov_b32 m0, s53
  s_add_u32 s3, s3, 8192
  buffer_load_dwordx4 v225, s[12:15], s3 offen lds
  s_add_u32 s50, s49, 3
  s_and_b32 s50, s50, 7
  s_lshl_b32 s50, s50, 2
  s_add_u32 s50, s50, s38
  s_mul_i32 s3, s50, 49152
  s_add_u32 s3, s3, s6
  s_add_u32 s53, s7, 36864
  s_mov_b32 m0, s53
  s_nop 0
  buffer_load_dwordx4 v232, s[24:27], s3 offen lds
  v_mfma_f32_32x32x16_bf16 v[144:159], a[244:247], v[20:23], v[144:159]
  ds_read_b64_tr_b16 a[232:233], v239 offset:128
  ds_read_b64_tr_b16 a[234:235], v239 offset:896
  s_add_u32 s53, s7, 37888
  s_mov_b32 m0, s53
  s_nop 0
  buffer_load_dwordx4 v233, s[24:27], s3 offen lds
  s_add_u32 s53, s7, 38912
  s_mov_b32 m0, s53
  s_nop 0
  buffer_load_dwordx4 v234, s[24:27], s3 offen lds
  v_mfma_f32_4x4x4_16b_bf16 v[192:195], a[48:49], v[20:21], v[192:195]
  v_mfma_f32_4x4x4_16b_bf16 v[208:211], v[20:21], v[20:21], v[208:211]
  v_mfma_f32_4x4x4_16b_bf16 v[196:199], a[48:49], v[22:23], v[196:199]
  v_mfma_f32_4x4x4_16b_bf16 v[212:215], v[22:23], v[22:23], v[212:215]
  s_waitcnt lgkmcnt(4)
  v_mfma_f32_32x32x16_bf16 v[160:175], a[248:251], v[24:27], v[160:175]
  ds_read_b64_tr_b16 a[236:237], v239 offset:0
  ds_read_b64_tr_b16 a[238:239], v239 offset:768
  v_mfma_f32_32x32x16_bf16 v[176:191], v[24:27], a[252:255], v[176:191]
  s_waitcnt vmcnt(14)
  s_barrier
  ds_read_b64_tr_b16 a[240:241], v236 offset:12352
  ds_read_b64_tr_b16 a[242:243], v236 offset:13120
  v_mfma_f32_32x32x16_bf16 v[144:159], a[224:227], v[24:27], v[144:159]
  ds_read_b64_tr_b16 a[244:245], v236 offset:12416
  ds_read_b64_tr_b16 a[246:247], v236 offset:13184
  v_mfma_f32_4x4x4_16b_bf16 v[192:195], a[48:49], v[24:25], v[192:195]
  v_mfma_f32_4x4x4_16b_bf16 v[208:211], v[24:25], v[24:25], v[208:211]
  v_mfma_f32_4x4x4_16b_bf16 v[196:199], a[48:49], v[26:27], v[196:199]
  v_mfma_f32_4x4x4_16b_bf16 v[212:215], v[26:27], v[26:27], v[212:215]
  s_waitcnt lgkmcnt(4)
  v_mfma_f32_32x32x16_bf16 v[160:175], a[228:231], v[28:31], v[160:175]
  ds_read_b64_tr_b16 a[248:249], v236 offset:12288
  ds_read_b64_tr_b16 a[250:251], v236 offset:13056
  v_mfma_f32_32x32x16_bf16 v[176:191], v[28:31], a[232:235], v[176:191]
  ds_read_b64_tr_b16 a[252:253], v237 offset:12352
  ds_read_b64_tr_b16 a[254:255], v237 offset:13120
  v_mfma_f32_32x32x16_bf16 v[144:159], a[236:239], v[28:31], v[144:159]
  ds_read_b64_tr_b16 a[224:225], v237 offset:12416
  ds_read_b64_tr_b16 a[226:227], v237 offset:13184
  v_mfma_f32_4x4x4_16b_bf16 v[192:195], a[48:49], v[28:29], v[192:195]
  v_mfma_f32_4x4x4_16b_bf16 v[208:211], v[28:29], v[28:29], v[208:211]
  v_mfma_f32_4x4x4_16b_bf16 v[196:199], a[48:49], v[30:31], v[196:199]
  v_mfma_f32_4x4x4_16b_bf16 v[212:215], v[30:31], v[30:31], v[212:215]
  s_waitcnt lgkmcnt(4)
  v_mfma_f32_32x32x16_bf16 v[160:175], a[240:243], v[32:35], v[160:175]
  ds_read_b64_tr_b16 a[228:229], v237 offset:12288
  ds_read_b64_tr_b16 a[230:231], v237 offset:13056
  s_add_u32 s50, s49, 4
  s_and_b32 s50, s50, 7
  s_lshl_b32 s3, s50, 7
  s_add_u32 s3, s3, s48
  s_add_u32 s53, s54, 0
  s_mov_b32 m0, s53
  s_nop 0
  buffer_load_dwordx4 v224, s[12:15], s3 offen lds
  s_add_u32 s53, s54, 1024
  s_mov_b32 m0, s53
  s_add_u32 s3, s3, 8192
  buffer_load_dwordx4 v225, s[12:15], s3 offen lds
  v_mfma_f32_4x4x4_16b_bf16 a[0:3], a[48:49], a[240:241], a[0:3]
  v_mfma_f32_4x4x4_16b_bf16 a[4:7], a[48:49], a[242:243], a[4:7]
  v_mfma_f32_32x32x16_bf16 v[176:191], v[32:35], a[244:247], v[176:191]
  ds_read_b64_tr_b16 a[232:233], v238 offset:12352
  ds_read_b64_tr_b16 a[234:235], v238 offset:13120
  s_add_u32 s53, s54, 2048
  s_mov_b32 m0, s53
  s_add_u32 s3, s3, 8192
  buffer_load_dwordx4 v224, s[12:15], s3 offen lds
  s_add_u32 s53, s54, 3072
  s_mov_b32 m0, s53
  s_add_u32 s3, s3, 8192
  buffer_load_dwordx4 v225, s[12:15], s3 offen lds
  v_mfma_f32_4x4x4_16b_bf16 a[8:11], a[48:49], a[244:245], a[8:11]
  v_mfma_f32_4x4x4_16b_bf16 a[12:15], a[48:49], a[246:247], a[12:15]
  v_mfma_f32_32x32x16_bf16 v[144:159], a[248:251], v[32:35], v[144:159]
  ds_read_b64_tr_b16 a[236:237], v238 offset:12416
  ds_read_b64_tr_b16 a[238:239], v238 offset:13184
  s_add_u32 s50, s49, 4
  s_and_b32 s50, s50, 7
  s_lshl_b32 s50, s50, 2
  s_add_u32 s50, s50, s38
  s_mul_i32 s3, s50, 49152
  s_add_u32 s3, s3, s6
  s_add_u32 s53, s7, 49152
  s_mov_b32 m0, s53
  s_nop 0
  buffer_load_dwordx4 v232, s[24:27], s3 offen lds
  s_add_u32 s53, s7, 50176
  s_mov_b32 m0, s53
  s_nop 0
  buffer_load_dwordx4 v233, s[24:27], s3 offen lds
  v_mfma_f32_4x4x4_16b_bf16 a[16:19], a[48:49], a[248:249], a[16:19]
  v_mfma_f32_4x4x4_16b_bf16 a[20:23], a[48:49], a[250:251], a[20:23]
  v_mfma_f32_4x4x4_16b_bf16 v[192:195], a[48:49], v[32:33], v[192:195]
  v_mfma_f32_4x4x4_16b_bf16 v[208:211], v[32:33], v[32:33], v[208:211]
  v_mfma_f32_4x4x4_16b_bf16 v[196:199], a[48:49], v[34:35], v[196:199]
  v_mfma_f32_4x4x4_16b_bf16 v[212:215], v[34:35], v[34:35], v[212:215]
  s_waitcnt lgkmcnt(4)
  v_mfma_f32_32x32x16_bf16 v[160:175], a[252:255], v[36:39], v[160:175]
  ds_read_b64_tr_b16 a[240:241], v238 offset:12288
  ds_read_b64_tr_b16 a[242:243], v238 offset:13056
  s_add_u32 s53, s7, 51200
  s_mov_b32 m0, s53
  s_nop 0
  buffer_load_dwordx4 v234, s[24:27], s3 offen lds
  s_waitcnt vmcnt(17)
  ds_read_b128 v[48:51], v226 offset:8192
  v_mfma_f32_32x32x16_bf16 v[176:191], v[36:39], a[224:227], v[176:191]
  ds_read_b64_tr_b16 a[244:245], v239 offset:12352
  ds_read_b64_tr_b16 a[246:247], v239 offset:13120
  ds_read_b128 v[52:55], v227 offset:8192
  ds_read_b128 v[56:59], v228 offset:8192
  v_mfma_f32_32x32x16_bf16 v[144:159], a[228:231], v[36:39], v[144:159]
  ds_read_b64_tr_b16 a[248:249], v239 offset:12416
  ds_read_b64_tr_b16 a[250:251], v239 offset:13184
  ds_read_b128 v[60:63], v229 offset:8192
  s_lshl_b32 s53, s38, 11
  s_add_u32 s53, s53, 131072
  s_mov_b32 m0, s53
  s_nop 0
  buffer_load_dwordx4 v244, s[28:31], 0 offen lds
  v_mfma_f32_4x4x4_16b_bf16 v[192:195], a[48:49], v[36:37], v[192:195]
  v_mfma_f32_4x4x4_16b_bf16 v[208:211], v[36:37], v[36:37], v[208:211]
  v_mfma_f32_4x4x4_16b_bf16 v[196:199], a[48:49], v[38:39], v[196:199]
  v_mfma_f32_4x4x4_16b_bf16 v[212:215], v[38:39], v[38:39], v[212:215]
  s_waitcnt lgkmcnt(8)
  v_mfma_f32_32x32x16_bf16 v[160:175], a[232:235], v[40:43], v[160:175]
  ds_read_b64_tr_b16 a[252:253], v239 offset:12288
  ds_read_b64_tr_b16 a[254:255], v239 offset:13056
  s_lshl_b32 s53, s38, 11
  s_add_u32 s53, s53, 132096
  s_mov_b32 m0, s53
  s_nop 0
  buffer_load_dwordx4 v248, s[28:31], 0 offen lds
  s_lshl_b32 s53, s38, 11
  s_add_u32 s53, s53, 139264
  s_mov_b32 m0, s53
  s_nop 0
  buffer_load_dwordx4 v244, s[32:35], 0 offen lds
  v_mfma_f32_32x32x16_bf16 v[176:191], v[40:43], a[236:239], v[176:191]
  s_waitcnt vmcnt(17)
  s_barrier
  ds_read_b64_tr_b16 a[224:225], v236 offset:24640
  ds_read_b64_tr_b16 a[226:227], v236 offset:25408
  s_lshl_b32 s53, s38, 11
  s_add_u32 s53, s53, 140288
  s_mov_b32 m0, s53
  s_nop 0
  buffer_load_dwordx4 v248, s[32:35], 0 offen lds
  v_mfma_f32_32x32x16_bf16 v[144:159], a[240:243], v[40:43], v[144:159]
  ds_read_b64_tr_b16 a[228:229], v236 offset:24704
  ds_read_b64_tr_b16 a[230:231], v236 offset:25472
  v_mfma_f32_4x4x4_16b_bf16 v[192:195], a[48:49], v[40:41], v[192:195]
  v_mfma_f32_4x4x4_16b_bf16 v[208:211], v[40:41], v[40:41], v[208:211]
  v_mfma_f32_4x4x4_16b_bf16 v[196:199], a[48:49], v[42:43], v[196:199]
  v_mfma_f32_4x4x4_16b_bf16 v[212:215], v[42:43], v[42:43], v[212:215]
  s_waitcnt lgkmcnt(4)
  v_mfma_f32_32x32x16_bf16 v[160:175], a[244:247], v[44:47], v[160:175]
  ds_read_b64_tr_b16 a[232:233], v236 offset:24576
  ds_read_b64_tr_b16 a[234:235], v236 offset:25344
  v_mfma_f32_32x32x16_bf16 v[176:191], v[44:47], a[248:251], v[176:191]
  ds_read_b64_tr_b16 a[236:237], v237 offset:24640
  ds_read_b64_tr_b16 a[238:239], v237 offset:25408
  v_mfma_f32_32x32x16_bf16 v[144:159], a[252:255], v[44:47], v[144:159]
  ds_read_b64_tr_b16 a[240:241], v237 offset:24704
  ds_read_b64_tr_b16 a[242:243], v237 offset:25472
  v_mfma_f32_4x4x4_16b_bf16 v[192:195], a[48:49], v[44:45], v[192:195]
  v_mfma_f32_4x4x4_16b_bf16 v[208:211], v[44:45], v[44:45], v[208:211]
  v_mfma_f32_4x4x4_16b_bf16 v[196:199], a[48:49], v[46:47], v[196:199]
  v_mfma_f32_4x4x4_16b_bf16 v[212:215], v[46:47], v[46:47], v[212:215]
  s_waitcnt lgkmcnt(4)
  v_mfma_f32_32x32x16_bf16 v[160:175], a[224:227], v[48:51], v[160:175]
  ds_read_b64_tr_b16 a[244:245], v237 offset:24576
  ds_read_b64_tr_b16 a[246:247], v237 offset:25344
  s_add_u32 s50, s49, 5
  s_and_b32 s50, s50, 7
  s_lshl_b32 s3, s50, 7
  s_add_u32 s3, s3, s48
  s_add_u32 s53, s54, 4096
  s_mov_b32 m0, s53
  s_nop 0
  buffer_load_dwordx4 v224, s[12:15], s3 offen lds
  s_add_u32 s53, s54, 5120
  s_mov_b32 m0, s53
  s_add_u32 s3, s3, 8192
  buffer_load_dwordx4 v225, s[12:15], s3 offen lds
  v_mfma_f32_4x4x4_16b_bf16 a[0:3], a[48:49], a[224:225], a[0:3]
  v_mfma_f32_4x4x4_16b_bf16 a[4:7], a[48:49], a[226:227], a[4:7]
  v_mfma_f32_32x32x16_bf16 v[176:191], v[48:51], a[228:231], v[176:191]
  ds_read_b64_tr_b16 a[248:249], v238 offset:24640
  ds_read_b64_tr_b16 a[250:251], v238 offset:25408
  s_add_u32 s53, s54, 6144
  s_mov_b32 m0, s53
  s_add_u32 s3, s3, 8192
  buffer_load_dwordx4 v224, s[12:15], s3 offen lds
  s_add_u32 s53, s54, 7168
  s_mov_b32 m0, s53
  s_add_u32 s3, s3, 8192
  buffer_load_dwordx4 v225, s[12:15], s3 offen lds
  v_mfma_f32_4x4x4_16b_bf16 a[8:11], a[48:49], a[228:229], a[8:11]
  v_mfma_f32_4x4x4_16b_bf16 a[12:15], a[48:49], a[230:231], a[12:15]
  v_mfma_f32_32x32x16_bf16 v[144:159], a[232:235], v[48:51], v[144:159]
  ds_read_b64_tr_b16 a[252:253], v238 offset:24704
  ds_read_b64_tr_b16 a[254:255], v238 offset:25472
  s_add_u32 s50, s49, 5
  s_and_b32 s50, s50, 7
  s_lshl_b32 s50, s50, 2
  s_add_u32 s50, s50, s38
  s_mul_i32 s3, s50, 49152
  s_add_u32 s3, s3, s6
  s_add_u32 s53, s7, 0
  s_mov_b32 m0, s53
  s_nop 0
  buffer_load_dwordx4 v232, s[24:27], s3 offen lds
  s_add_u32 s53, s7, 1024
  s_mov_b32 m0, s53
  s_nop 0
  buffer_load_dwordx4 v233, s[24:27], s3 offen lds
  v_mfma_f32_4x4x4_16b_bf16 a[16:19], a[48:49], a[232:233], a[16:19]
  v_mfma_f32_4x4x4_16b_bf16 a[20:23], a[48:49], a[234:235], a[20:23]
  v_mfma_f32_4x4x4_16b_bf16 v[192:195], a[48:49], v[48:49], v[192:195]
  v_mfma_f32_4x4x4_16b_bf16 v[208:211], v[48:49], v[48:49], v[208:211]
  v_mfma_f32_4x4x4_16b_bf16 v[196:199], a[48:49], v[50:51], v[196:199]
  v_mfma_f32_4x4x4_16b_bf16 v[212:215], v[50:51], v[50:51], v[212:215]
  s_waitcnt lgkmcnt(4)
  v_mfma_f32_32x32x16_bf16 v[160:175], a[236:239], v[52:55], v[160:175]
  ds_read_b64_tr_b16 a[224:225], v238 offset:24576
  ds_read_b64_tr_b16 a[226:227], v238 offset:25344
  s_add_u32 s53, s7, 2048
  s_mov_b32 m0, s53
  s_nop 0
  buffer_load_dwordx4 v234, s[24:27], s3 offen lds
  s_waitcnt vmcnt(21)
  ds_read_b128 v[64:67], v226 offset:12288
  v_mfma_f32_32x32x16_bf16 v[176:191], v[52:55], a[240:243], v[176:191]
  ds_read_b64_tr_b16 a[228:229], v239 offset:24640
  ds_read_b64_tr_b16 a[230:231], v239 offset:25408
  ds_read_b128 v[68:71], v227 offset:12288
  ds_read_b128 v[72:75], v228 offset:12288
  v_mfma_f32_32x32x16_bf16 v[144:159], a[244:247], v[52:55], v[144:159]
  ds_read_b64_tr_b16 a[232:233], v239 offset:24704
  ds_read_b64_tr_b16 a[234:235], v239 offset:25472
  ds_read_b128 v[76:79], v229 offset:12288
  s_lshl_b32 s53, s38, 11
  s_add_u32 s53, s53, 147456
  s_mov_b32 m0, s53
  s_nop 0
  buffer_load_dwordx4 v245, s[80:83], 0 offen lds
  v_mfma_f32_4x4x4_16b_bf16 v[192:195], a[48:49], v[52:53], v[192:195]
  v_mfma_f32_4x4x4_16b_bf16 v[208:211], v[52:53], v[52:53], v[208:211]
  v_mfma_f32_4x4x4_16b_bf16 v[196:199], a[48:49], v[54:55], v[196:199]
  v_mfma_f32_4x4x4_16b_bf16 v[212:215], v[54:55], v[54:55], v[212:215]
  s_waitcnt lgkmcnt(8)
  v_mfma_f32_32x32x16_bf16 v[160:175], a[248:251], v[56:59], v[160:175]
  ds_read_b64_tr_b16 a[236:237], v239 offset:24576
  ds_read_b64_tr_b16 a[238:239], v239 offset:25344
  s_lshl_b32 s53, s38, 11
  s_add_u32 s53, s53, 148480
  s_mov_b32 m0, s53
  s_nop 0
  buffer_load_dwordx4 v249, s[80:83], 0 offen lds
  s_lshl_b32 s53, s38, 11
  s_add_u32 s53, s53, 155648
  s_mov_b32 m0, s53
  s_nop 0
  buffer_load_dwordx4 v245, s[16:19], 0 offen lds
  v_mfma_f32_32x32x16_bf16 v[176:191], v[56:59], a[252:255], v[176:191]
  s_waitcnt vmcnt(21)
  s_barrier
  ds_read_b64_tr_b16 a[240:241], v236 offset:36928
  ds_read_b64_tr_b16 a[242:243], v236 offset:37696
  s_lshl_b32 s53, s38, 11
  s_add_u32 s53, s53, 156672
  s_mov_b32 m0, s53
  s_nop 0
  buffer_load_dwordx4 v249, s[16:19], 0 offen lds
  v_mfma_f32_32x32x16_bf16 v[144:159], a[224:227], v[56:59], v[144:159]
  ds_read_b64_tr_b16 a[244:245], v236 offset:36992
  ds_read_b64_tr_b16 a[246:247], v236 offset:37760
  v_mfma_f32_4x4x4_16b_bf16 v[192:195], a[48:49], v[56:57], v[192:195]
  v_mfma_f32_4x4x4_16b_bf16 v[208:211], v[56:57], v[56:57], v[208:211]
  v_mfma_f32_4x4x4_16b_bf16 v[196:199], a[48:49], v[58:59], v[196:199]
  v_mfma_f32_4x4x4_16b_bf16 v[212:215], v[58:59], v[58:59], v[212:215]
  s_waitcnt lgkmcnt(4)
  v_mfma_f32_32x32x16_bf16 v[160:175], a[228:231], v[60:63], v[160:175]
  ds_read_b64_tr_b16 a[248:249], v236 offset:36864
  ds_read_b64_tr_b16 a[250:251], v236 offset:37632
  v_mfma_f32_32x32x16_bf16 v[176:191], v[60:63], a[232:235], v[176:191]
  ds_read_b64_tr_b16 a[252:253], v237 offset:36928
  ds_read_b64_tr_b16 a[254:255], v237 offset:37696
  v_mfma_f32_32x32x16_bf16 v[144:159], a[236:239], v[60:63], v[144:159]
  ds_read_b64_tr_b16 a[224:225], v237 offset:36992
  ds_read_b64_tr_b16 a[226:227], v237 offset:37760
  v_mfma_f32_4x4x4_16b_bf16 v[192:195], a[48:49], v[60:61], v[192:195]
  v_mfma_f32_4x4x4_16b_bf16 v[208:211], v[60:61], v[60:61], v[208:211]
  v_mfma_f32_4x4x4_16b_bf16 v[196:199], a[48:49], v[62:63], v[196:199]
  v_mfma_f32_4x4x4_16b_bf16 v[212:215], v[62:63], v[62:63], v[212:215]
  s_waitcnt lgkmcnt(4)
  v_mfma_f32_32x32x16_bf16 v[160:175], a[240:243], v[64:67], v[160:175]
  ds_read_b64_tr_b16 a[228:229], v237 offset:36864
  ds_read_b64_tr_b16 a[230:231], v237 offset:37632
  v_and_b32 v254, 0x7c, v1
  buffer_load_dword v5, v254, s[20:23], 0 offen sc1
  s_add_u32 s50, s49, 6
  s_and_b32 s50, s50, 7
  s_lshl_b32 s3, s50, 7
  s_add_u32 s3, s3, s48
  s_add_u32 s53, s54, 8192
  s_mov_b32 m0, s53
  s_nop 0
  buffer_load_dwordx4 v224, s[12:15], s3 offen lds
  v_mfma_f32_4x4x4_16b_bf16 a[0:3], a[48:49], a[240:241], a[0:3]
  v_mfma_f32_4x4x4_16b_bf16 a[4:7], a[48:49], a[242:243], a[4:7]
  v_mfma_f32_32x32x16_bf16 v[176:191], v[64:67], a[244:247], v[176:191]
  ds_read_b64_tr_b16 a[232:233], v238 offset:36928
  ds_read_b64_tr_b16 a[234:235], v238 offset:37696
  s_add_u32 s53, s54, 9216
  s_mov_b32 m0, s53
  s_add_u32 s3, s3, 8192
  buffer_load_dwordx4 v225, s[12:15], s3 offen lds
  s_add_u32 s53, s54, 10240
  s_mov_b32 m0, s53
  s_add_u32 s3, s3, 8192
  buffer_load_dwordx4 v224, s[12:15], s3 offen lds
  v_mfma_f32_4x4x4_16b_bf16 a[8:11], a[48:49], a[244:245], a[8:11]
  v_mfma_f32_4x4x4_16b_bf16 a[12:15], a[48:49], a[246:247], a[12:15]
  v_mfma_f32_32x32x16_bf16 v[144:159], a[248:251], v[64:67], v[144:159]
  ds_read_b64_tr_b16 a[236:237], v238 offset:36992
  ds_read_b64_tr_b16 a[238:239], v238 offset:37760
  s_add_u32 s53, s54, 11264
  s_mov_b32 m0, s53
  s_add_u32 s3, s3, 8192
  buffer_load_dwordx4 v225, s[12:15], s3 offen lds
  s_add_u32 s50, s49, 6
  s_and_b32 s50, s50, 7
  s_lshl_b32 s50, s50, 2
  s_add_u32 s50, s50, s38
  s_mul_i32 s3, s50, 49152
  s_add_u32 s3, s3, s6
  s_add_u32 s53, s7, 12288
  s_mov_b32 m0, s53
  s_nop 0
  buffer_load_dwordx4 v232, s[24:27], s3 offen lds
  v_mfma_f32_4x4x4_16b_bf16 a[16:19], a[48:49], a[248:249], a[16:19]
  v_mfma_f32_4x4x4_16b_bf16 a[20:23], a[48:49], a[250:251], a[20:23]
  v_mfma_f32_4x4x4_16b_bf16 v[192:195], a[48:49], v[64:65], v[192:195]
  v_mfma_f32_4x4x4_16b_bf16 v[208:211], v[64:65], v[64:65], v[208:211]
  v_mfma_f32_4x4x4_16b_bf16 v[196:199], a[48:49], v[66:67], v[196:199]
  v_mfma_f32_4x4x4_16b_bf16 v[212:215], v[66:67], v[66:67], v[212:215]
  s_waitcnt lgkmcnt(4)
  v_mfma_f32_32x32x16_bf16 v[160:175], a[252:255], v[68:71], v[160:175]
  ds_read_b64_tr_b16 a[240:241], v238 offset:36864
  ds_read_b64_tr_b16 a[242:243], v238 offset:37632
  s_add_u32 s53, s7, 13312
  s_mov_b32 m0, s53
  s_nop 0
  buffer_load_dwordx4 v233, s[24:27], s3 offen lds
  s_add_u32 s53, s7, 14336
  s_mov_b32 m0, s53
  s_nop 0
  buffer_load_dwordx4 v234, s[24:27], s3 offen lds
  v_mfma_f32_32x32x16_bf16 v[176:191], v[68:71], a[224:227], v[176:191]
  ds_read_b64_tr_b16 a[244:245], v239 offset:36928
  ds_read_b64_tr_b16 a[246:247], v239 offset:37696
  s_waitcnt vmcnt(26)
  ds_read_b128 v[80:83], v226 offset:0
  ds_read_b128 v[84:87], v227 offset:0
  v_mfma_f32_32x32x16_bf16 v[144:159], a[228:231], v[68:71], v[144:159]
  ds_read_b64_tr_b16 a[248:249], v239 offset:36992
  ds_read_b64_tr_b16 a[250:251], v239 offset:37760
  ds_read_b128 v[88:91], v228 offset:0
  ds_read_b128 v[92:95], v229 offset:0
  v_mfma_f32_4x4x4_16b_bf16 v[192:195], a[48:49], v[68:69], v[192:195]
  v_mfma_f32_4x4x4_16b_bf16 v[208:211], v[68:69], v[68:69], v[208:211]
  v_mfma_f32_4x4x4_16b_bf16 v[196:199], a[48:49], v[70:71], v[196:199]
  v_mfma_f32_4x4x4_16b_bf16 v[212:215], v[70:71], v[70:71], v[212:215]
  s_waitcnt lgkmcnt(8)
  v_mfma_f32_32x32x16_bf16 v[160:175], a[232:235], v[72:75], v[160:175]
  ds_read_b64_tr_b16 a[252:253], v239 offset:36864
  ds_read_b64_tr_b16 a[254:255], v239 offset:37632
  v_mfma_f32_32x32x16_bf16 v[176:191], v[72:75], a[236:239], v[176:191]
  s_waitcnt vmcnt(23)
  s_waitcnt vmcnt(19)
  s_barrier
  ds_read_b64_tr_b16 a[224:225], v236 offset:49216
  ds_read_b64_tr_b16 a[226:227], v236 offset:49984
  v_mfma_f32_32x32x16_bf16 v[144:159], a[240:243], v[72:75], v[144:159]
  ds_read_b64_tr_b16 a[228:229], v236 offset:49280
  ds_read_b64_tr_b16 a[230:231], v236 offset:50048
  v_mfma_f32_4x4x4_16b_bf16 v[192:195], a[48:49], v[72:73], v[192:195]
  v_mfma_f32_4x4x4_16b_bf16 v[208:211], v[72:73], v[72:73], v[208:211]
  v_mfma_f32_4x4x4_16b_bf16 v[196:199], a[48:49], v[74:75], v[196:199]
  v_mfma_f32_4x4x4_16b_bf16 v[212:215], v[74:75], v[74:75], v[212:215]
  s_waitcnt lgkmcnt(4)
  v_mfma_f32_32x32x16_bf16 v[160:175], a[244:247], v[76:79], v[160:175]
  ds_read_b64_tr_b16 a[232:233], v236 offset:49152
  ds_read_b64_tr_b16 a[234:235], v236 offset:49920
  v_mfma_f32_32x32x16_bf16 v[176:191], v[76:79], a[248:251], v[176:191]
  ds_read_b64_tr_b16 a[236:237], v237 offset:49216
  ds_read_b64_tr_b16 a[238:239], v237 offset:49984
  v_mfma_f32_32x32x16_bf16 v[144:159], a[252:255], v[76:79], v[144:159]
  ds_read_b64_tr_b16 a[240:241], v237 offset:49280
  ds_read_b64_tr_b16 a[242:243], v237 offset:50048
  v_mfma_f32_4x4x4_16b_bf16 v[192:195], a[48:49], v[76:77], v[192:195]
  v_mfma_f32_4x4x4_16b_bf16 v[208:211], v[76:77], v[76:77], v[208:211]
  v_mfma_f32_4x4x4_16b_bf16 v[196:199], a[48:49], v[78:79], v[196:199]
  v_mfma_f32_4x4x4_16b_bf16 v[212:215], v[78:79], v[78:79], v[212:215]
  s_waitcnt lgkmcnt(4)
  v_mfma_f32_32x32x16_bf16 v[160:175], a[224:227], v[80:83], v[160:175]
  ds_read_b64_tr_b16 a[244:245], v237 offset:49152
  ds_read_b64_tr_b16 a[246:247], v237 offset:49920
  s_add_u32 s50, s49, 7
  s_and_b32 s50, s50, 7
  s_lshl_b32 s3, s50, 7
  s_add_u32 s3, s3, s48
  s_add_u32 s53, s54, 12288
  s_mov_b32 m0, s53
  s_nop 0
  buffer_load_dwordx4 v224, s[12:15], s3 offen lds
  s_add_u32 s53, s54, 13312
  s_mov_b32 m0, s53
  s_add_u32 s3, s3, 8192
  buffer_load_dwordx4 v225, s[12:15], s3 offen lds
  v_mfma_f32_4x4x4_16b_bf16 a[0:3], a[48:49], a[224:225], a[0:3]
  v_mfma_f32_4x4x4_16b_bf16 a[4:7], a[48:49], a[226:227], a[4:7]
  v_mfma_f32_32x32x16_bf16 v[176:191], v[80:83], a[228:231], v[176:191]
  ds_read_b64_tr_b16 a[248:249], v238 offset:49216
  ds_read_b64_tr_b16 a[250:251], v238 offset:49984
  s_add_u32 s53, s54, 14336
  s_mov_b32 m0, s53
  s_add_u32 s3, s3, 8192
  buffer_load_dwordx4 v224, s[12:15], s3 offen lds
  s_add_u32 s53, s54, 15360
  s_mov_b32 m0, s53
  s_add_u32 s3, s3, 8192
  buffer_load_dwordx4 v225, s[12:15], s3 offen lds
  v_mfma_f32_4x4x4_16b_bf16 a[8:11], a[48:49], a[228:229], a[8:11]
  v_mfma_f32_4x4x4_16b_bf16 a[12:15], a[48:49], a[230:231], a[12:15]
  v_mfma_f32_32x32x16_bf16 v[144:159], a[232:235], v[80:83], v[144:159]
  ds_read_b64_tr_b16 a[252:253], v238 offset:49280
  ds_read_b64_tr_b16 a[254:255], v238 offset:50048
  s_add_u32 s50, s49, 7
  s_and_b32 s50, s50, 7
  s_lshl_b32 s50, s50, 2
  s_add_u32 s50, s50, s38
  s_mul_i32 s3, s50, 49152
  s_add_u32 s3, s3, s6
  s_add_u32 s53, s7, 24576
  s_mov_b32 m0, s53
  s_nop 0
  buffer_load_dwordx4 v232, s[24:27], s3 offen lds
  s_add_u32 s53, s7, 25600
  s_mov_b32 m0, s53
  s_nop 0
  buffer_load_dwordx4 v233, s[24:27], s3 offen lds
  v_mfma_f32_4x4x4_16b_bf16 a[16:19], a[48:49], a[232:233], a[16:19]
  v_mfma_f32_4x4x4_16b_bf16 a[20:23], a[48:49], a[234:235], a[20:23]
  v_mfma_f32_4x4x4_16b_bf16 v[192:195], a[48:49], v[80:81], v[192:195]
  v_mfma_f32_4x4x4_16b_bf16 v[208:211], v[80:81], v[80:81], v[208:211]
  v_mfma_f32_4x4x4_16b_bf16 v[196:199], a[48:49], v[82:83], v[196:199]
  v_mfma_f32_4x4x4_16b_bf16 v[212:215], v[82:83], v[82:83], v[212:215]
  s_waitcnt lgkmcnt(4)
  v_mfma_f32_32x32x16_bf16 v[160:175], a[236:239], v[84:87], v[160:175]
  ds_read_b64_tr_b16 a[224:225], v238 offset:49152
  ds_read_b64_tr_b16 a[226:227], v238 offset:49920
  s_add_u32 s53, s7, 26624
  s_mov_b32 m0, s53
  s_nop 0
  buffer_load_dwordx4 v234, s[24:27], s3 offen lds
  s_waitcnt vmcnt(22)
  ds_read_b128 v[96:99], v226 offset:4096
  v_mfma_f32_32x32x16_bf16 v[176:191], v[84:87], a[240:243], v[176:191]
  ds_read_b64_tr_b16 a[228:229], v239 offset:49216
  ds_read_b64_tr_b16 a[230:231], v239 offset:49984
  ds_read_b128 v[100:103], v227 offset:4096
  ds_read_b128 v[104:107], v228 offset:4096
  v_mfma_f32_32x32x16_bf16 v[144:159], a[244:247], v[84:87], v[144:159]
  ds_read_b64_tr_b16 a[232:233], v239 offset:49280
  ds_read_b64_tr_b16 a[234:235], v239 offset:50048
  ds_read_b128 v[108:111], v229 offset:4096
  ds_read_b64_tr_b16 v[216:217], v246
  ds_read_b64_tr_b16 v[218:219], v246 offset:512
  v_mfma_f32_4x4x4_16b_bf16 v[192:195], a[48:49], v[84:85], v[192:195]
  v_mfma_f32_4x4x4_16b_bf16 v[208:211], v[84:85], v[84:85], v[208:211]
  v_mfma_f32_4x4x4_16b_bf16 v[196:199], a[48:49], v[86:87], v[196:199]
  v_mfma_f32_4x4x4_16b_bf16 v[212:215], v[86:87], v[86:87], v[212:215]
  s_waitcnt lgkmcnt(10)
  v_mfma_f32_32x32x16_bf16 v[160:175], a[248:251], v[88:91], v[160:175]
  ds_read_b64_tr_b16 a[236:237], v239 offset:49152
  ds_read_b64_tr_b16 a[238:239], v239 offset:49920
  v_mfma_f32_32x32x16_bf16 v[176:191], v[88:91], a[252:255], v[176:191]
  s_waitcnt vmcnt(19)
  s_waitcnt vmcnt(15)
  s_barrier
  ds_read_b64_tr_b16 a[240:241], v236 offset:64
  ds_read_b64_tr_b16 a[242:243], v236 offset:832
  s_waitcnt lgkmcnt(4)
  buffer_store_dwordx4 v[216:219], v0, s[8:11], s64 offen sc1
  s_add_u32 s64, s64, s65
  v_mfma_f32_32x32x16_bf16 a[52:67], a[48:51], v[216:219], 0
  v_mfma_f32_32x32x16_bf16 v[144:159], a[224:227], v[88:91], v[144:159]
  ds_read_b64_tr_b16 a[244:245], v236 offset:128
  ds_read_b64_tr_b16 a[246:247], v236 offset:896
  v_xor_b32 v246, 2048, v246
  ds_read_b64_tr_b16 v[216:217], v246
  ds_read_b64_tr_b16 v[218:219], v246 offset:512
  v_mfma_f32_4x4x4_16b_bf16 v[192:195], a[48:49], v[88:89], v[192:195]
  v_mfma_f32_4x4x4_16b_bf16 v[208:211], v[88:89], v[88:89], v[208:211]
  v_mfma_f32_4x4x4_16b_bf16 v[196:199], a[48:49], v[90:91], v[196:199]
  v_mfma_f32_4x4x4_16b_bf16 v[212:215], v[90:91], v[90:91], v[212:215]
  s_waitcnt lgkmcnt(6)
  v_mfma_f32_32x32x16_bf16 v[160:175], a[228:231], v[92:95], v[160:175]
  ds_read_b64_tr_b16 a[248:249], v236 offset:0
  ds_read_b64_tr_b16 a[250:251], v236 offset:768
  s_waitcnt lgkmcnt(2)
  buffer_store_dwordx4 v[216:219], v0, s[8:11], s64 offen sc1
  s_add_u32 s64, s64, s65
  v_mfma_f32_32x32x16_bf16 v[176:191], v[92:95], a[232:235], v[176:191]
  ds_read_b64_tr_b16 a[252:253], v237 offset:64
  ds_read_b64_tr_b16 a[254:255], v237 offset:832
  v_mfma_f32_32x32x16_bf16 a[52:67], a[48:51], v[216:219], a[52:67]
  v_xor_b32 v246, 6144, v246
  ds_read_b64_tr_b16 v[216:217], v246
  ds_read_b64_tr_b16 v[218:219], v246 offset:512
  v_mfma_f32_32x32x16_bf16 v[144:159], a[236:239], v[92:95], v[144:159]
  ds_read_b64_tr_b16 a[224:225], v237 offset:128
  ds_read_b64_tr_b16 a[226:227], v237 offset:896
  v_mfma_f32_4x4x4_16b_bf16 v[192:195], a[48:49], v[92:93], v[192:195]
  v_mfma_f32_4x4x4_16b_bf16 v[208:211], v[92:93], v[92:93], v[208:211]
  v_mfma_f32_4x4x4_16b_bf16 v[196:199], a[48:49], v[94:95], v[196:199]
  v_mfma_f32_4x4x4_16b_bf16 v[212:215], v[94:95], v[94:95], v[212:215]
  s_waitcnt lgkmcnt(2)
  buffer_store_dwordx4 v[216:219], v0, s[8:11], s64 offen sc1
  s_add_u32 s64, s64, s65
  v_mfma_f32_32x32x16_bf16 a[52:67], a[48:51], v[216:219], a[52:67]
  v_xor_b32 v246, 2048, v246
  ds_read_b64_tr_b16 v[216:217], v246
  ds_read_b64_tr_b16 v[218:219], v246 offset:512
  s_waitcnt lgkmcnt(0)
  buffer_store_dwordx4 v[216:219], v0, s[8:11], s64 offen sc1
  s_add_u32 s64, s64, s65
  v_mfma_f32_32x32x16_bf16 a[52:67], a[48:51], v[216:219], a[52:67]
  s_nop 11
  v_accvgpr_read_b32 v254, a52
  v_and_b32 v231, 0x1f0, v0
  v_cvt_pk_bf16_f32 v255, v254, v254
  v_lshlrev_b32 v255, 16, v255
  v_sub_f32 v255, v254, v255
  v_cvt_pk_bf16_f32 v255, v254, v255
  buffer_store_dword v255, v231, s[8:11], s62 offen sc1
  s_waitcnt vmcnt(19)
  v_cmp_eq_u32 vcc, 0, v5
  s_nop 0
  s_cbranch_vccnz L_lslow_13
L_ljoin_14:
  v_mfma_f32_32x32x16_bf16 v[160:175], a[240:243], v[96:99], v[160:175]
  ds_read_b64_tr_b16 a[228:229], v237 offset:0
  ds_read_b64_tr_b16 a[230:231], v237 offset:768
  s_waitcnt vmcnt(15)
  ds_read_b128 v[112:115], v226 offset:8192
  ds_read_b128 v[116:119], v227 offset:8192
  v_mfma_f32_4x4x4_16b_bf16 a[0:3], a[48:49], a[240:241], a[0:3]
  v_mfma_f32_4x4x4_16b_bf16 a[4:7], a[48:49], a[242:243], a[4:7]
  v_mfma_f32_32x32x16_bf16 v[176:191], v[96:99], a[244:247], v[176:191]
  ds_read_b64_tr_b16 a[232:233], v238 offset:64
  ds_read_b64_tr_b16 a[234:235], v238 offset:832
  ds_read_b128 v[120:123], v228 offset:8192
  ds_read_b128 v[124:127], v229 offset:8192
  v_mfma_f32_4x4x4_16b_bf16 a[8:11], a[48:49], a[244:245], a[8:11]
  v_mfma_f32_4x4x4_16b_bf16 a[12:15], a[48:49], a[246:247], a[12:15]
  v_mfma_f32_32x32x16_bf16 v[144:159], a[248:251], v[96:99], v[144:159]
  ds_read_b64_tr_b16 a[236:237], v238 offset:128
  ds_read_b64_tr_b16 a[238:239], v238 offset:896
  ds_read_b64_tr_b16 v[216:217], v247
  ds_read_b64_tr_b16 v[218:219], v247 offset:512
  v_mfma_f32_4x4x4_16b_bf16 a[16:19], a[48:49], a[248:249], a[16:19]
  v_mfma_f32_4x4x4_16b_bf16 a[20:23], a[48:49], a[250:251], a[20:23]
  v_mfma_f32_4x4x4_16b_bf16 v[192:195], a[48:49], v[96:97], v[192:195]
  v_mfma_f32_4x4x4_16b_bf16 v[208:211], v[96:97], v[96:97], v[208:211]
  v_mfma_f32_4x4x4_16b_bf16 v[196:199], a[48:49], v[98:99], v[196:199]
  v_mfma_f32_4x4x4_16b_bf16 v[212:215], v[98:99], v[98:99], v[212:215]
  s_waitcnt lgkmcnt(10)
  v_mfma_f32_32x32x16_bf16 v[160:175], a[252:255], v[100:103], v[160:175]
  ds_read_b64_tr_b16 a[240:241], v238 offset:0
  ds_read_b64_tr_b16 a[242:243], v238 offset:768
  s_waitcnt lgkmcnt(2)
  buffer_store_dwordx4 v[216:219], v0, s[8:11], s70 offen sc1
  s_add_u32 s70, s70, s71
  v_mfma_f32_32x32x16_bf16 v[176:191], v[100:103], a[224:227], v[176:191]
  ds_read_b64_tr_b16 a[244:245], v239 offset:64
  ds_read_b64_tr_b16 a[246:247], v239 offset:832
  v_mfma_f32_32x32x16_bf16 a[52:67], a[48:51], v[216:219], 0
  v_xor_b32 v247, 2048, v247
  ds_read_b64_tr_b16 v[216:217], v247
  ds_read_b64_tr_b16 v[218:219], v247 offset:512
  v_mfma_f32_32x32x16_bf16 v[144:159], a[228:231], v[100:103], v[144:159]
  ds_read_b64_tr_b16 a[248:249], v239 offset:128
  ds_read_b64_tr_b16 a[250:251], v239 offset:896
  v_mfma_f32_4x4x4_16b_bf16 v[192:195], a[48:49], v[100:101], v[192:195]
  v_mfma_f32_4x4x4_16b_bf16 v[208:211], v[100:101], v[100:101], v[208:211]
  v_mfma_f32_4x4x4_16b_bf16 v[196:199], a[48:49], v[102:103], v[196:199]
  v_mfma_f32_4x4x4_16b_bf16 v[212:215], v[102:103], v[102:103], v[212:215]
  s_waitcnt lgkmcnt(6)
  v_mfma_f32_32x32x16_bf16 v[160:175], a[232:235], v[104:107], v[160:175]
  ds_read_b64_tr_b16 a[252:253], v239 offset:0
  ds_read_b64_tr_b16 a[254:255], v239 offset:768
  s_waitcnt lgkmcnt(4)
  buffer_store_dwordx4 v[216:219], v0, s[8:11], s70 offen sc1
  s_add_u32 s70, s70, s71
  v_mfma_f32_32x32x16_bf16 a[52:67], a[48:51], v[216:219], a[52:67]
  v_mfma_f32_32x32x16_bf16 v[176:191], v[104:107], a[236:239], v[176:191]
  s_waitcnt vmcnt(14)
  s_barrier
  ds_read_b64_tr_b16 a[224:225], v236 offset:12352
  ds_read_b64_tr_b16 a[226:227], v236 offset:13120
  v_xor_b32 v247, 6144, v247
  ds_read_b64_tr_b16 v[216:217], v247
  ds_read_b64_tr_b16 v[218:219], v247 offset:512
  v_mfma_f32_32x32x16_bf16 v[144:159], a[240:243], v[104:107], v[144:159]
  ds_read_b64_tr_b16 a[228:229], v236 offset:12416
  ds_read_b64_tr_b16 a[230:231], v236 offset:13184
  s_waitcnt lgkmcnt(2)
  buffer_store_dwordx4 v[216:219], v0, s[8:11], s70 offen sc1
  s_add_u32 s70, s70, s71
  v_mfma_f32_4x4x4_16b_bf16 v[192:195], a[48:49], v[104:105], v[192:195]
  v_mfma_f32_4x4x4_16b_bf16 v[208:211], v[104:105], v[104:105], v[208:211]
  v_mfma_f32_4x4x4_16b_bf16 v[196:199], a[48:49], v[106:107], v[196:199]
  v_mfma_f32_4x4x4_16b_bf16 v[212:215], v[106:107], v[106:107], v[212:215]
  v_mfma_f32_32x32x16_bf16 v[160:175], a[244:247], v[108:111], v[160:175]
  ds_read_b64_tr_b16 a[232:233], v236 offset:12288
  ds_read_b64_tr_b16 a[234:235], v236 offset:13056
  v_mfma_f32_32x32x16_bf16 a[52:67], a[48:51], v[216:219], a[52:67]
  v_xor_b32 v247, 2048, v247
  ds_read_b64_tr_b16 v[216:217], v247
  ds_read_b64_tr_b16 v[218:219], v247 offset:512
  v_mfma_f32_32x32x16_bf16 v[176:191], v[108:111], a[248:251], v[176:191]
  ds_read_b64_tr_b16 a[236:237], v237 offset:12352
  ds_read_b64_tr_b16 a[238:239], v237 offset:13120
  v_mfma_f32_32x32x16_bf16 v[144:159], a[252:255], v[108:111], v[144:159]
  ds_read_b64_tr_b16 a[240:241], v237 offset:12416
  ds_read_b64_tr_b16 a[242:243], v237 offset:13184
  s_waitcnt lgkmcnt(4)
  buffer_store_dwordx4 v[216:219], v0, s[8:11], s70 offen sc1
  s_add_u32 s70, s70, s71
  v_mfma_f32_32x32x16_bf16 a[52:67], a[48:51], v[216:219], a[52:67]
  v_mfma_f32_4x4x4_16b_bf16 v[192:195], a[48:49], v[108:109], v[192:195]
  v_mfma_f32_4x4x4_16b_bf16 v[208:211], v[108:109], v[108:109], v[208:211]
  v_mfma_f32_4x4x4_16b_bf16 v[196:199], a[48:49], v[110:111], v[196:199]
  v_mfma_f32_4x4x4_16b_bf16 v[212:215], v[110:111], v[110:111], v[212:215]
  s_nop 7
  v_accvgpr_read_b32 v254, a52
  v_and_b32 v231, 0x1f0, v0
  v_cvt_pk_bf16_f32 v255, v254, v254
  v_lshlrev_b32 v255, 16, v255
  v_sub_f32 v255, v254, v255
  v_cvt_pk_bf16_f32 v255, v254, v255
  buffer_store_dword v255, v231, s[8:11], s63 offen sc1
  v_mfma_f32_32x32x16_bf16 v[160:175], a[224:227], v[112:115], v[160:175]
  ds_read_b64_tr_b16 a[244:245], v237 offset:12288
  ds_read_b64_tr_b16 a[246:247], v237 offset:13056
  s_waitcnt vmcnt(13)
  ds_read_b128 v[128:131], v226 offset:12288
  ds_read_b128 v[132:135], v227 offset:12288
  v_mfma_f32_4x4x4_16b_bf16 a[0:3], a[48:49], a[224:225], a[0:3]
  v_mfma_f32_4x4x4_16b_bf16 a[4:7], a[48:49], a[226:227], a[4:7]
  v_mfma_f32_32x32x16_bf16 v[176:191], v[112:115], a[228:231], v[176:191]
  ds_read_b64_tr_b16 a[248:249], v238 offset:12352
  ds_read_b64_tr_b16 a[250:251], v238 offset:13120
  ds_read_b128 v[136:139], v228 offset:12288
  ds_read_b128 v[140:143], v229 offset:12288
  v_mfma_f32_4x4x4_16b_bf16 a[8:11], a[48:49], a[228:229], a[8:11]
  v_mfma_f32_4x4x4_16b_bf16 a[12:15], a[48:49], a[230:231], a[12:15]
  v_mfma_f32_32x32x16_bf16 v[144:159], a[232:235], v[112:115], v[144:159]
  ds_read_b64_tr_b16 a[252:253], v238 offset:12416
  ds_read_b64_tr_b16 a[254:255], v238 offset:13184
  s_lshl_b32 s59, s40, 7
  s_add_u32 s59, s59, s39
  v_mfma_f32_4x4x4_16b_bf16 a[16:19], a[48:49], a[232:233], a[16:19]
  v_mfma_f32_4x4x4_16b_bf16 a[20:23], a[48:49], a[234:235], a[20:23]
  v_mfma_f32_4x4x4_16b_bf16 v[192:195], a[48:49], v[112:113], v[192:195]
  v_mfma_f32_4x4x4_16b_bf16 v[208:211], v[112:113], v[112:113], v[208:211]
  v_mfma_f32_4x4x4_16b_bf16 v[196:199], a[48:49], v[114:115], v[196:199]
  v_mfma_f32_4x4x4_16b_bf16 v[212:215], v[114:115], v[114:115], v[212:215]
  s_waitcnt lgkmcnt(8)
  v_mfma_f32_32x32x16_bf16 v[160:175], a[236:239], v[116:119], v[160:175]
  ds_read_b64_tr_b16 a[224:225], v238 offset:12288
  ds_read_b64_tr_b16 a[226:227], v238 offset:13056
  s_lshl_b32 s55, s59, 11
  s_add_u32 s55, s55, 23068672
  v_mfma_f32_32x32x16_bf16 v[176:191], v[116:119], a[240:243], v[176:191]
  ds_read_b64_tr_b16 a[228:229], v239 offset:12352
  ds_read_b64_tr_b16 a[230:231], v239 offset:13120
  s_add_u32 s56, s55, 0x20000
  s_lshl_b32 s57, s39, 4
  v_mfma_f32_32x32x16_bf16 v[144:159], a[244:247], v[116:119], v[144:159]
  ds_read_b64_tr_b16 a[232:233], v239 offset:12416
  ds_read_b64_tr_b16 a[234:235], v239 offset:13184
  s_add_u32 s57, s57, s40
  s_lshl_b32 s57, s57, 11
  v_mfma_f32_4x4x4_16b_bf16 v[192:195], a[48:49], v[116:117], v[192:195]
  v_mfma_f32_4x4x4_16b_bf16 v[208:211], v[116:117], v[116:117], v[208:211]
  v_mfma_f32_4x4x4_16b_bf16 v[196:199], a[48:49], v[118:119], v[196:199]
  v_mfma_f32_4x4x4_16b_bf16 v[212:215], v[118:119], v[118:119], v[212:215]
  s_waitcnt lgkmcnt(4)
  v_mfma_f32_32x32x16_bf16 v[160:175], a[248:251], v[120:123], v[160:175]
  ds_read_b64_tr_b16 a[236:237], v239 offset:12288
  ds_read_b64_tr_b16 a[238:239], v239 offset:13056
  s_add_u32 s57, s57, 10485760
  v_mfma_f32_32x32x16_bf16 v[176:191], v[120:123], a[252:255], v[176:191]
  s_waitcnt vmcnt(10)
  s_barrier
  ds_read_b64_tr_b16 a[240:241], v236 offset:24640
  ds_read_b64_tr_b16 a[242:243], v236 offset:25408
  v_mfma_f32_32x32x16_bf16 v[144:159], a[224:227], v[120:123], v[144:159]
  ds_read_b64_tr_b16 a[244:245], v236 offset:24704
  ds_read_b64_tr_b16 a[246:247], v236 offset:25472
  v_mfma_f32_4x4x4_16b_bf16 v[192:195], a[48:49], v[120:121], v[192:195]
  v_mfma_f32_4x4x4_16b_bf16 v[208:211], v[120:121], v[120:121], v[208:211]
  v_mfma_f32_4x4x4_16b_bf16 v[196:199], a[48:49], v[122:123], v[196:199]
  v_mfma_f32_4x4x4_16b_bf16 v[212:215], v[122:123], v[122:123], v[212:215]
  s_waitcnt lgkmcnt(4)
  v_mfma_f32_32x32x16_bf16 v[160:175], a[228:231], v[124:127], v[160:175]
  ds_read_b64_tr_b16 a[248:249], v236 offset:24576
  ds_read_b64_tr_b16 a[250:251], v236 offset:25344
  v_mfma_f32_32x32x16_bf16 v[176:191], v[124:127], a[232:235], v[176:191]
  ds_read_b64_tr_b16 a[252:253], v237 offset:24640
  ds_read_b64_tr_b16 a[254:255], v237 offset:25408
  v_mfma_f32_32x32x16_bf16 v[144:159], a[236:239], v[124:127], v[144:159]
  ds_read_b64_tr_b16 a[224:225], v237 offset:24704
  ds_read_b64_tr_b16 a[226:227], v237 offset:25472
  v_mfma_f32_4x4x4_16b_bf16 v[192:195], a[48:49], v[124:125], v[192:195]
  v_mfma_f32_4x4x4_16b_bf16 v[208:211], v[124:125], v[124:125], v[208:211]
  v_mfma_f32_4x4x4_16b_bf16 v[196:199], a[48:49], v[126:127], v[196:199]
  v_mfma_f32_4x4x4_16b_bf16 v[212:215], v[126:127], v[126:127], v[212:215]
  v_mfma_f32_4x4x4_16b_bf16 v[192:195], a[48:49], v[128:129], v[192:195]
  v_mfma_f32_4x4x4_16b_bf16 v[208:211], v[128:129], v[128:129], v[208:211]
  v_mfma_f32_4x4x4_16b_bf16 v[196:199], a[48:49], v[130:131], v[196:199]
  v_mfma_f32_4x4x4_16b_bf16 v[212:215], v[130:131], v[130:131], v[212:215]
  v_mfma_f32_4x4x4_16b_bf16 v[192:195], a[48:49], v[132:133], v[192:195]
  v_mfma_f32_4x4x4_16b_bf16 v[208:211], v[132:133], v[132:133], v[208:211]
  v_mfma_f32_4x4x4_16b_bf16 v[196:199], a[48:49], v[134:135], v[196:199]
  v_mfma_f32_4x4x4_16b_bf16 v[212:215], v[134:135], v[134:135], v[212:215]
  v_mfma_f32_4x4x4_16b_bf16 v[192:195], a[48:49], v[136:137], v[192:195]
  v_mfma_f32_4x4x4_16b_bf16 v[208:211], v[136:137], v[136:137], v[208:211]
  v_mfma_f32_4x4x4_16b_bf16 v[196:199], a[48:49], v[138:139], v[196:199]
  v_mfma_f32_4x4x4_16b_bf16 v[212:215], v[138:139], v[138:139], v[212:215]
  v_mfma_f32_4x4x4_16b_bf16 v[192:195], a[48:49], v[140:141], v[192:195]
  v_mfma_f32_4x4x4_16b_bf16 v[208:211], v[140:141], v[140:141], v[208:211]
  v_mfma_f32_4x4x4_16b_bf16 v[196:199], a[48:49], v[142:143], v[196:199]
  v_mfma_f32_4x4x4_16b_bf16 v[212:215], v[142:143], v[142:143], v[212:215]
  s_waitcnt lgkmcnt(4)
  v_mfma_f32_32x32x16_bf16 v[160:175], a[240:243], v[128:131], v[160:175]
  ds_read_b64_tr_b16 a[228:229], v237 offset:24576
  ds_read_b64_tr_b16 a[230:231], v237 offset:25344
  v_mfma_f32_4x4x4_16b_bf16 a[0:3], a[48:49], a[240:241], a[0:3]
  v_mfma_f32_4x4x4_16b_bf16 a[4:7], a[48:49], a[242:243], a[4:7]
  v_mfma_f32_32x32x16_bf16 v[176:191], v[128:131], a[244:247], v[176:191]
  ds_read_b64_tr_b16 a[232:233], v238 offset:24640
  ds_read_b64_tr_b16 a[234:235], v238 offset:25408
  v_mfma_f32_4x4x4_16b_bf16 a[8:11], a[48:49], a[244:245], a[8:11]
  v_mfma_f32_4x4x4_16b_bf16 a[12:15], a[48:49], a[246:247], a[12:15]
  v_mfma_f32_32x32x16_bf16 v[144:159], a[248:251], v[128:131], v[144:159]
  ds_read_b64_tr_b16 a[236:237], v238 offset:24704
  ds_read_b64_tr_b16 a[238:239], v238 offset:25472
  v_add_f32 v192, v192, v196
  v_add_f32 v208, v208, v212
  v_add_f32 v209, v209, v213
  v_add_f32 v210, v210, v214
  v_add_f32 v211, v211, v215
  v_mfma_f32_4x4x4_16b_bf16 a[16:19], a[48:49], a[248:249], a[16:19]
  v_mfma_f32_4x4x4_16b_bf16 a[20:23], a[48:49], a[250:251], a[20:23]
  s_waitcnt lgkmcnt(4)
  v_mfma_f32_32x32x16_bf16 v[160:175], a[252:255], v[132:135], v[160:175]
  ds_read_b64_tr_b16 a[240:241], v238 offset:24576
  ds_read_b64_tr_b16 a[242:243], v238 offset:25344
  s_mov_b32 s50, 0xaaaaaaaa
  s_mov_b32 s51, 0xaaaaaaaa
  v_cndmask_b32 v208, v208, v209, s[50:51]
  v_cndmask_b32 v210, v210, v211, s[50:51]
  s_mov_b32 s50, 0xcccccccc
  v_mfma_f32_32x32x16_bf16 v[176:191], v[132:135], a[224:227], v[176:191]
  ds_read_b64_tr_b16 a[244:245], v239 offset:24640
  ds_read_b64_tr_b16 a[246:247], v239 offset:25408
  s_mov_b32 s51, 0xcccccccc
  v_cndmask_b32 v208, v208, v210, s[50:51]
  s_nop 1
  v_permlane32_swap_b32 v192, v208
  v_add_f32 v192, v192, v208
  v_mfma_f32_32x32x16_bf16 v[144:159], a[228:231], v[132:135], v[144:159]
  ds_read_b64_tr_b16 a[248:249], v239 offset:24704
  ds_read_b64_tr_b16 a[250:251], v239 offset:25472
  v_mov_b32 v208, v192
  s_nop 1
  v_permlane32_swap_b32 v192, v208
  v_mul_f32 v192, 0xbb000000, v192
  v_mul_f32 v208, 0x3b000000, v208
  s_lshl_b32 s52, s38, 2
  s_add_u32 s52, s52, 8192
  v_add_u32 v253, s52, v0
  v_accvgpr_read_b32 v6, a0
  v_accvgpr_read_b32 v254, a4
  v_add_f32 v6, v6, v254
  v_cvt_pk_bf16_f32 v254, v6, v6
  v_lshlrev_b32 v254, 16, v254
  v_sub_f32 v254, v6, v254
  v_cvt_pk_bf16_f32 v254, v6, v254
  ds_write_b32 v253, v254 offset:0
  v_accvgpr_read_b32 v6, a8
  v_accvgpr_read_b32 v254, a12
  v_add_f32 v6, v6, v254
  v_cvt_pk_bf16_f32 v254, v6, v6
  v_lshlrev_b32 v254, 16, v254
  v_sub_f32 v254, v6, v254
  v_cvt_pk_bf16_f32 v254, v6, v254
  ds_write_b32 v253, v254 offset:1024
  v_accvgpr_read_b32 v6, a16
  v_accvgpr_read_b32 v254, a20
  v_add_f32 v6, v6, v254
  v_cvt_pk_bf16_f32 v254, v6, v6
  v_lshlrev_b32 v254, 16, v254
  v_sub_f32 v254, v6, v254
  v_cvt_pk_bf16_f32 v254, v6, v254
  ds_write_b32 v253, v254 offset:2048
  s_waitcnt lgkmcnt(7)
  v_mfma_f32_32x32x16_bf16 v[160:175], a[232:235], v[136:139], v[160:175]
  ds_read_b64_tr_b16 a[252:253], v239 offset:24576
  ds_read_b64_tr_b16 a[254:255], v239 offset:25344
  v_fma_f32 v208, -v192, v192, v208
  v_max_f32 v208, 0, v208
  v_cvt_pk_bf16_f32 v208, v208, v208
  v_lshlrev_b32 v208, 16, v208
  v_add_f32 v208, 0x3727c5ac, v208
  v_mfma_f32_32x32x16_bf16 v[176:191], v[136:139], a[236:239], v[176:191]
  v_cvt_pk_bf16_f32 v208, v208, v208
  v_lshlrev_b32 v208, 16, v208
  v_sqrt_f32 v208, v208
  v_cvt_pk_bf16_f32 v220, v192, v192
  v_mfma_f32_32x32x16_bf16 v[144:159], a[240:243], v[136:139], v[144:159]
  v_cvt_pk_bf16_f32 v208, v208, v208
  v_lshlrev_b32 v208, 16, v208
  v_rcp_f32 v240, v208
  v_mul_f32 v241, v208, v208
  s_waitcnt lgkmcnt(0)
  v_mfma_f32_32x32x16_bf16 v[160:175], a[244:247], v[140:143], v[160:175]
  v_mov_b32 v221, v220
  v_mov_b32 v222, v220
  v_mov_b32 v223, v220
  s_add_u32 s50, s54, 12288
  v_and_b32 v4, 0x7c, v1
  v_mfma_f32_32x32x16_bf16 v[176:191], v[140:143], a[248:251], v[176:191]
  v_add_u32 v4, s50, v4
  ds_write_b32 v4, v240
  v_lshrrev_b32 v4, 9, v0
  v_lshlrev_b32 v4, 4, v4
  v_add_u32 v4, s50, v4
  v_mfma_f32_32x32x16_bf16 v[144:159], a[252:255], v[140:143], v[144:159]
  v_mul_f32 v252, 0x3eb8aa3b, v240
  ds_read_b128 v[192:195], v4 offset:0
  ds_read_b128 v[196:199], v4 offset:32
  ds_read_b128 v[200:203], v4 offset:64
  ds_read_b128 v[204:207], v4 offset:96
  s_waitcnt lgkmcnt(0)
  s_barrier
  ds_read_b128 v[208:211], v0 offset:8192
  ds_read_b128 v[212:215], v0 offset:9216
  ds_read_b128 v[232:235], v0 offset:10240
  s_waitcnt lgkmcnt(2)
  v_mfma_f32_32x32x16_bf16 v[160:175], v[208:211], v[220:223], v[160:175]
  s_waitcnt lgkmcnt(1)
  v_mfma_f32_32x32x16_bf16 v[176:191], v[220:223], v[212:215], v[176:191]
  s_waitcnt lgkmcnt(0)
  v_mfma_f32_32x32x16_bf16 v[144:159], v[232:235], v[220:223], v[144:159]
  s_nop 7
  v_mul_f32 v160, v240, v160
  v_mul_f32 v161, v240, v161
  v_mul_f32 v162, v240, v162
  v_mul_f32 v163, v240, v163
  v_mul_f32 v164, v240, v164
  v_mul_f32 v165, v240, v165
  v_mul_f32 v166, v240, v166
  v_mul_f32 v167, v240, v167
  v_cvt_pk_bf16_f32 v208, v160, v161
  v_cvt_pk_bf16_f32 v209, v162, v163
  v_cvt_pk_bf16_f32 v210, v164, v165
  v_cvt_pk_bf16_f32 v211, v166, v167
  buffer_store_dwordx4 v[208:211], v242, s[8:11], s55 offen sc1
  v_mul_f32 v168, v240, v168
  v_mul_f32 v169, v240, v169
  v_mul_f32 v170, v240, v170
  v_mul_f32 v171, v240, v171
  v_mul_f32 v172, v240, v172
  v_mul_f32 v173, v240, v173
  v_mul_f32 v174, v240, v174
  v_mul_f32 v175, v240, v175
  v_cvt_pk_bf16_f32 v212, v168, v169
  v_cvt_pk_bf16_f32 v213, v170, v171
  v_cvt_pk_bf16_f32 v214, v172, v173
  v_cvt_pk_bf16_f32 v215, v174, v175
  buffer_store_dwordx4 v[212:215], v242, s[8:11], s56 offen sc1
  v_mul_f32 v176, v192, v176
  v_mul_f32 v177, v193, v177
  v_mul_f32 v178, v194, v178
  v_mul_f32 v179, v195, v179
  v_mul_f32 v180, v196, v180
  v_mul_f32 v181, v197, v181
  v_mul_f32 v182, v198, v182
  v_mul_f32 v183, v199, v183
  v_cvt_pk_bf16_f32 v216, v176, v177
  v_cvt_pk_bf16_f32 v217, v178, v179
  v_cvt_pk_bf16_f32 v218, v180, v181
  v_cvt_pk_bf16_f32 v219, v182, v183
  buffer_store_dwordx4 v[216:219], v243, s[8:11], s55 offen offset:1024 sc1
  v_mul_f32 v184, v200, v184
  v_mul_f32 v185, v201, v185
  v_mul_f32 v186, v202, v186
  v_mul_f32 v187, v203, v187
  v_mul_f32 v188, v204, v188
  v_mul_f32 v189, v205, v189
  v_mul_f32 v190, v206, v190
  v_mul_f32 v191, v207, v191
  v_cvt_pk_bf16_f32 v220, v184, v185
  v_cvt_pk_bf16_f32 v221, v186, v187
  v_cvt_pk_bf16_f32 v222, v188, v189
  v_cvt_pk_bf16_f32 v223, v190, v191
  buffer_store_dwordx4 v[220:223], v243, s[8:11], s55 offen offset:1536 sc1
  v_mul_f32 v144, v252, v144
  v_mul_f32 v145, v252, v145
  v_mul_f32 v146, v252, v146
  v_mul_f32 v147, v252, v147
  v_mul_f32 v148, v252, v148
  v_mul_f32 v149, v252, v149
  v_mul_f32 v150, v252, v150
  v_mul_f32 v151, v252, v151
  v_cvt_pk_bf16_f32 v224, v144, v145
  v_cvt_pk_bf16_f32 v225, v146, v147
  v_cvt_pk_bf16_f32 v226, v148, v149
  v_cvt_pk_bf16_f32 v227, v150, v151
  buffer_store_dwordx4 v[224:227], v0, s[8:11], s57 offen sc1
  v_mul_f32 v152, v252, v152
  v_mul_f32 v153, v252, v153
  v_mul_f32 v154, v252, v154
  v_mul_f32 v155, v252, v155
  v_mul_f32 v156, v252, v156
  v_mul_f32 v157, v252, v157
  v_mul_f32 v158, v252, v158
  v_mul_f32 v159, v252, v159
  v_cvt_pk_bf16_f32 v228, v152, v153
  v_cvt_pk_bf16_f32 v229, v154, v155
  v_cvt_pk_bf16_f32 v230, v156, v157
  v_cvt_pk_bf16_f32 v231, v158, v159
  buffer_store_dwordx4 v[228:231], v0, s[8:11], s57 offen offset:1024 sc1
  v_mov_b32 v4, 0x3f803f80
  s_mov_b32 s48, 0x110000
  s_mov_b32 s49, 0x110000
  v_cndmask_b32 v2, 0, v4, s[48:49]
  v_mov_b32 v212, v2
  v_mov_b32 v213, v2
  v_mov_b32 v214, v2
  v_mov_b32 v215, v2
  v_mov_b32 v216, v2
  v_mov_b32 v217, v2
  v_mov_b32 v218, v2
  v_mov_b32 v219, v2
  v_lshrrev_b32 v4, 9, v0
  v_lshlrev_b32 v252, 8, v4
  v_and_b32 v4, 0xf0, v0
  v_add_u32 v252, v252, v4
  v_and_b32 v4, 28, v1
  s_lshl_b32 s48, s36, 4
  s_lshr_b32 s49, s37, 1
  s_add_u32 s48, s48, s49
  s_lshl_b32 s48, s48, 7
  s_add_u32 s48, s48, 0
  s_lshl_b32 s7, s49, 10
  s_lshl_b32 s50, s38, 3
  s_add_u32 s7, s7, s50
  s_add_u32 s7, s7, 65536
  s_lshl_b32 s50, s38, 1
  s_lshl_b32 s6, s37, 6
  s_add_u32 s6, s6, s50
  s_lshl_b32 s6, s6, 11
  s_add_u32 s6, s6, 23068672
  s_lshl_b32 s51, s36, 8
  s_add_u32 s51, s51, s37
  s_lshl_b32 s51, s51, 10
  s_add_u32 s51, s51, 10485760
  s_add_u32 s52, s50, 2
  s_and_b32 s52, s52, 7
  s_lshl_b32 s52, s52, 15
  s_add_u32 s52, s52, s51
  s_add_u32 s53, s50, 3
  s_and_b32 s53, s53, 7
  s_lshl_b32 s53, s53, 15
  s_add_u32 s53, s53, s51
  s_add_u32 s54, s50, 4
  s_and_b32 s54, s54, 7
  s_lshl_b32 s54, s54, 15
  s_add_u32 s54, s54, s51
  s_add_u32 s55, s50, 5
  s_and_b32 s55, s55, 7
  s_lshl_b32 s55, s55, 15
  s_add_u32 s55, s55, s51
  s_add_u32 s56, s50, 6
  s_and_b32 s56, s56, 7
  s_lshl_b32 s56, s56, 15
  s_add_u32 s56, s56, s51
  s_add_u32 s57, s50, 7
  s_and_b32 s57, s57, 7
  s_lshl_b32 s57, s57, 15
  s_add_u32 s57, s57, s51
  s_add_u32 s58, s50, 8
  s_and_b32 s58, s58, 7
  s_lshl_b32 s58, s58, 15
  s_add_u32 s58, s58, s51
  s_add_u32 s59, s50, 9
  s_and_b32 s59, s59, 7
  s_lshl_b32 s59, s59, 15
  s_add_u32 s59, s59, s51
  s_lshl_b32 s3, s36, 14
  s_add_u32 s3, s3, s6
  s_waitcnt vmcnt(0)
  s_and_b32 s48, s7, 0xfffffc00
  s_lshl_b32 s4, s36, 7
  s_add_u32 s48, s48, s4
  s_barrier
  s_cmp_eq_u32 s38, 3
  s_cbranch_scc0 L_b3_16
  v_readlane_b32 s49, v3, 1
  v_mov_b32 v5, 1
  s_mov_b64 exec, 15
  s_sub_u32 s49, s49, 12
  s_nop 1
  buffer_store_dword v5, v1, s[8:11], s49 offen sc1
  s_mov_b64 exec, -1
L_b3_16:
  s_cmp_eq_u32 s38, 2
  s_cbranch_scc0 L_b2_18
  v_mov_b32 v5, 1
  s_mov_b64 exec, 64
  buffer_store_dword v5, v3, s[8:11], 0 offen sc1
  s_mov_b64 exec, -1
L_b2_18:
  s_cmp_eq_u32 s38, 0
  s_cbranch_scc0 L_b0_17
  s_mov_b32 s46, 2097152
L_poll_19:
  buffer_load_dword v5, v4, s[8:11], s48 offen sc1
  s_sub_u32 s46, s46, 1
  s_cbranch_scc1 L_exit
  s_waitcnt vmcnt(0)
  v_cmp_gt_u32 vcc, 1, v5
  s_nop 0
  s_cbranch_vccnz L_poll_19
L_b0_17:
  s_barrier
  buffer_load_dwordx4 v[208:211], v0, s[8:11], s3 offen sc1
  buffer_load_dwordx4 v[144:147], v0, s[8:11], s52 offen sc1
  buffer_load_dwordx4 v[148:151], v0, s[8:11], s53 offen sc1
  s_mov_b64 exec, s[60:61]
  buffer_load_dwordx4 v[212:215], v252, s[8:11], s3 offen offset:1024 sc1
  buffer_load_dwordx4 v[216:219], v252, s[8:11], s3 offen offset:1536 sc1
  s_mov_b64 exec, -1
  buffer_load_dwordx4 v[152:155], v0, s[8:11], s54 offen sc1
  buffer_load_dwordx4 v[156:159], v0, s[8:11], s55 offen sc1
  v_mov_b32 v224, v2
  v_mov_b32 v225, v2
  v_mov_b32 v226, v2
  v_mov_b32 v227, v2
  v_mov_b32 v228, v2
  v_mov_b32 v229, v2
  v_mov_b32 v230, v2
  v_mov_b32 v231, v2
  v_mov_b32 v236, v2
  v_mov_b32 v237, v2
  v_mov_b32 v238, v2
  v_mov_b32 v239, v2
  v_mov_b32 v240, v2
  v_mov_b32 v241, v2
  v_mov_b32 v242, v2
  v_mov_b32 v243, v2
  v_mov_b32 v2, 0xdddddddd
  v_pk_mov_b32 v[16:17], 0, 0
  v_pk_mov_b32 v[18:19], 0, 0
  v_pk_mov_b32 v[20:21], 0, 0
  v_pk_mov_b32 v[22:23], 0, 0
  v_pk_mov_b32 v[24:25], 0, 0
  v_pk_mov_b32 v[26:27], 0, 0
  v_pk_mov_b32 v[28:29], 0, 0
  v_pk_mov_b32 v[30:31], 0, 0
  v_pk_mov_b32 v[32:33], 0, 0
  v_pk_mov_b32 v[34:35], 0, 0
  v_pk_mov_b32 v[36:37], 0, 0
  v_pk_mov_b32 v[38:39], 0, 0
  v_pk_mov_b32 v[40:41], 0, 0
  v_pk_mov_b32 v[42:43], 0, 0
  v_pk_mov_b32 v[44:45], 0, 0
  v_pk_mov_b32 v[46:47], 0, 0
  v_pk_mov_b32 v[48:49], 0, 0
  v_pk_mov_b32 v[50:51], 0, 0
  v_pk_mov_b32 v[52:53], 0, 0
  v_pk_mov_b32 v[54:55], 0, 0
  v_pk_mov_b32 v[56:57], 0, 0
  v_pk_mov_b32 v[58:59], 0, 0
  v_pk_mov_b32 v[60:61], 0, 0
  v_pk_mov_b32 v[62:63], 0, 0
  v_pk_mov_b32 v[64:65], 0, 0
  v_pk_mov_b32 v[66:67], 0, 0
  v_pk_mov_b32 v[68:69], 0, 0
  v_pk_mov_b32 v[70:71], 0, 0
  v_pk_mov_b32 v[72:73], 0, 0
  v_pk_mov_b32 v[74:75], 0, 0
  v_pk_mov_b32 v[76:77], 0, 0
  v_pk_mov_b32 v[78:79], 0, 0
  v_pk_mov_b32 v[80:81], 0, 0
  v_pk_mov_b32 v[82:83], 0, 0
  v_pk_mov_b32 v[84:85], 0, 0
  v_pk_mov_b32 v[86:87], 0, 0
  v_pk_mov_b32 v[88:89], 0, 0
  v_pk_mov_b32 v[90:91], 0, 0
  v_pk_mov_b32 v[92:93], 0, 0
  v_pk_mov_b32 v[94:95], 0, 0
  v_pk_mov_b32 v[96:97], 0, 0
  v_pk_mov_b32 v[98:99], 0, 0
  v_pk_mov_b32 v[100:101], 0, 0
  v_pk_mov_b32 v[102:103], 0, 0
  v_pk_mov_b32 v[104:105], 0, 0
  v_pk_mov_b32 v[106:107], 0, 0
  v_pk_mov_b32 v[108:109], 0, 0
  v_pk_mov_b32 v[110:111], 0, 0
  v_pk_mov_b32 v[112:113], 0, 0
  v_pk_mov_b32 v[114:115], 0, 0
  v_pk_mov_b32 v[116:117], 0, 0
  v_pk_mov_b32 v[118:119], 0, 0
  v_pk_mov_b32 v[120:121], 0, 0
  v_pk_mov_b32 v[122:123], 0, 0
  v_pk_mov_b32 v[124:125], 0, 0
  v_pk_mov_b32 v[126:127], 0, 0
  v_pk_mov_b32 v[128:129], 0, 0
  v_pk_mov_b32 v[130:131], 0, 0
  v_pk_mov_b32 v[132:133], 0, 0
  v_pk_mov_b32 v[134:135], 0, 0
  v_pk_mov_b32 v[136:137], 0, 0
  v_pk_mov_b32 v[138:139], 0, 0
  v_pk_mov_b32 v[140:141], 0, 0
  v_pk_mov_b32 v[142:143], 0, 0
  v_bfe_u32 v4, v0, 5, 3
  v_add_u32 v4, s36, v4
  v_and_b32 v4, 7, v4
  v_lshlrev_b32 v253, 7, v4
  v_bfe_u32 v4, v0, 4, 1
  v_lshl_add_u32 v253, v4, 2, v253
  s_waitcnt vmcnt(5)
  v_mfma_f32_32x32x16_bf16 v[176:191], v[208:211], v[144:147], 0
  s_nop 11
  v_exp_f32 v176, v176
  v_exp_f32 v177, v177
  buffer_load_dwordx4 v[160:163], v0, s[8:11], s56 offen sc1
  s_waitcnt vmcnt(5)
  v_exp_f32 v178, v178
  v_exp_f32 v179, v179
  v_exp_f32 v180, v180
  v_mfma_f32_32x32x16_bf16 v[192:207], v[208:211], v[148:151], 0
  s_waitcnt vmcnt(3)
  v_exp_f32 v181, v181
  v_exp_f32 v182, v182
  v_exp_f32 v183, v183
  v_exp_f32 v184, v184
  v_exp_f32 v185, v185
  v_smfmac_f32_32x32x32_bf16 v[16:31], v[212:215], v[176:183], v2
  buffer_load_dwordx4 v[164:167], v0, s[8:11], s57 offen sc1
  v_exp_f32 v186, v186
  v_exp_f32 v187, v187
  v_exp_f32 v188, v188
  v_exp_f32 v189, v189
  v_exp_f32 v190, v190
  v_exp_f32 v191, v191
  v_exp_f32 v192, v192
  v_exp_f32 v193, v193
  v_smfmac_f32_32x32x32_bf16 v[16:31], v[216:219], v[184:191], v2
  buffer_load_dwordx4 v[168:171], v0, s[8:11], s58 offen sc1
  s_waitcnt vmcnt(4)
  v_exp_f32 v194, v194
  v_exp_f32 v195, v195
  v_exp_f32 v196, v196
  v_mfma_f32_32x32x16_bf16 v[176:191], v[208:211], v[152:155], 0
  v_exp_f32 v197, v197
  v_exp_f32 v198, v198
  v_exp_f32 v199, v199
  v_exp_f32 v200, v200
  v_exp_f32 v201, v201
  v_smfmac_f32_32x32x32_bf16 v[32:47], v[212:215], v[192:199], v2
  buffer_load_dwordx4 v[172:175], v0, s[8:11], s59 offen sc1
  v_exp_f32 v202, v202
  v_exp_f32 v203, v203
  v_exp_f32 v204, v204
  v_exp_f32 v205, v205
  v_exp_f32 v206, v206
  v_exp_f32 v207, v207
  v_exp_f32 v176, v176
  v_exp_f32 v177, v177
  v_smfmac_f32_32x32x32_bf16 v[32:47], v[216:219], v[200:207], v2
  buffer_load_dwordx4 v[220:223], v0, s[8:11], s3 offen offset:2048 sc1
  s_waitcnt vmcnt(5)
  v_exp_f32 v178, v178
  v_exp_f32 v179, v179
  v_exp_f32 v180, v180
  v_mfma_f32_32x32x16_bf16 v[192:207], v[208:211], v[156:159], 0
  v_exp_f32 v181, v181
  v_exp_f32 v182, v182
  v_exp_f32 v183, v183
  v_exp_f32 v184, v184
  v_exp_f32 v185, v185
  v_smfmac_f32_32x32x32_bf16 v[48:63], v[212:215], v[176:183], v2
  s_mov_b64 exec, s[60:61]
  buffer_load_dwordx4 v[224:227], v252, s[8:11], s3 offen offset:3072 sc1
  buffer_load_dwordx4 v[228:231], v252, s[8:11], s3 offen offset:3584 sc1
  s_mov_b64 exec, -1
  v_exp_f32 v186, v186
  v_exp_f32 v187, v187
  v_exp_f32 v188, v188
  v_exp_f32 v189, v189
  v_exp_f32 v190, v190
  v_exp_f32 v191, v191
  v_exp_f32 v192, v192
  v_exp_f32 v193, v193
  v_smfmac_f32_32x32x32_bf16 v[48:63], v[216:219], v[184:191], v2
  s_waitcnt vmcnt(6)
  v_exp_f32 v194, v194
  v_exp_f32 v195, v195
  v_exp_f32 v196, v196
  v_mfma_f32_32x32x16_bf16 v[176:191], v[208:211], v[160:163], 0
  v_exp_f32 v197, v197
  v_exp_f32 v198, v198
  v_exp_f32 v199, v199
  v_exp_f32 v200, v200
  v_exp_f32 v201, v201
  v_smfmac_f32_32x32x32_bf16 v[64:79], v[212:215], v[192:199], v2
  v_exp_f32 v202, v202
  v_exp_f32 v203, v203
  v_exp_f32 v204, v204
  v_exp_f32 v205, v205
  v_exp_f32 v206, v206
  v_exp_f32 v207, v207
  v_exp_f32 v176, v176
  v_exp_f32 v177, v177
  v_smfmac_f32_32x32x32_bf16 v[64:79], v[216:219], v[200:207], v2
  s_waitcnt vmcnt(5)
  v_exp_f32 v178, v178
  v_exp_f32 v179, v179
  v_exp_f32 v180, v180
  v_mfma_f32_32x32x16_bf16 v[192:207], v[208:211], v[164:167], 0
  v_exp_f32 v181, v181
  v_exp_f32 v182, v182
  v_exp_f32 v183, v183
  v_exp_f32 v184, v184
  v_exp_f32 v185, v185
  v_smfmac_f32_32x32x32_bf16 v[80:95], v[212:215], v[176:183], v2
  buffer_load_dword v249, v253, s[8:11], s7 offen sc1
  v_exp_f32 v186, v186
  v_exp_f32 v187, v187
  v_exp_f32 v188, v188
  v_exp_f32 v189, v189
  v_exp_f32 v190, v190
  v_exp_f32 v191, v191
  v_exp_f32 v192, v192
  v_exp_f32 v193, v193
  v_smfmac_f32_32x32x32_bf16 v[80:95], v[216:219], v[184:191], v2
  s_waitcnt vmcnt(5)
  v_exp_f32 v194, v194
  v_exp_f32 v195, v195
  v_exp_f32 v196, v196
  v_mfma_f32_32x32x16_bf16 v[176:191], v[208:211], v[168:171], 0
  v_exp_f32 v197, v197
  v_exp_f32 v198, v198
  v_exp_f32 v199, v199
  v_exp_f32 v200, v200
  v_exp_f32 v201, v201
  v_smfmac_f32_32x32x32_bf16 v[96:111], v[212:215], v[192:199], v2
  v_exp_f32 v202, v202
  v_exp_f32 v203, v203
  v_exp_f32 v204, v204
  v_exp_f32 v205, v205
  v_exp_f32 v206, v206
  v_exp_f32 v207, v207
  v_exp_f32 v176, v176
  v_exp_f32 v177, v177
  v_smfmac_f32_32x32x32_bf16 v[96:111], v[216:219], v[200:207], v2
  s_waitcnt vmcnt(4)
  v_exp_f32 v178, v178
  v_exp_f32 v179, v179
  v_exp_f32 v180, v180
  v_mfma_f32_32x32x16_bf16 v[192:207], v[208:211], v[172:175], 0
  v_exp_f32 v181, v181
  v_exp_f32 v182, v182
  v_exp_f32 v183, v183
  v_exp_f32 v184, v184
  v_exp_f32 v185, v185
  v_smfmac_f32_32x32x32_bf16 v[112:127], v[212:215], v[176:183], v2
  v_exp_f32 v186, v186
  v_exp_f32 v187, v187
  v_exp_f32 v188, v188
  v_exp_f32 v189, v189
  v_exp_f32 v190, v190
  v_exp_f32 v191, v191
  v_exp_f32 v192, v192
  v_exp_f32 v193, v193
  v_smfmac_f32_32x32x32_bf16 v[112:127], v[216:219], v[184:191], v2
  s_waitcnt vmcnt(1)
  v_exp_f32 v194, v194
  v_exp_f32 v195, v195
  v_exp_f32 v196, v196
  v_mfma_f32_32x32x16_bf16 v[176:191], v[220:223], v[144:147], 0
  s_waitcnt vmcnt(0)
  v_cmp_gt_u32 s[100:101], 1, v249
  v_exp_f32 v197, v197
  v_exp_f32 v198, v198
  v_exp_f32 v199, v199
  v_exp_f32 v200, v200
  v_exp_f32 v201, v201
  v_smfmac_f32_32x32x32_bf16 v[128:143], v[212:215], v[192:199], v2
  s_and_b32 s46, s100, 12
  s_cbranch_scc1 L_gslow_21
L_gjoin_22:
  v_exp_f32 v202, v202
  v_exp_f32 v203, v203
  v_exp_f32 v204, v204
  v_exp_f32 v205, v205
  v_exp_f32 v206, v206
  v_exp_f32 v207, v207
  v_exp_f32 v176, v176
  v_exp_f32 v177, v177
  v_smfmac_f32_32x32x32_bf16 v[128:143], v[216:219], v[200:207], v2
  s_add_u32 s3, s36, 1
  s_and_b32 s3, s3, 7
  s_cmp_eq_u32 s38, 0
  s_cbranch_scc0 L_xs_24
  s_getreg_b32 s59, hwreg(HW_REG_XCC_ID, 0, 4)
  s_or_b32 s59, s59, 0x80
  v_mov_b32 v5, s59
  s_mov_b64 exec, 0x80
  buffer_store_dword v5, v3, s[8:11], 0 offen sc1
  s_mov_b64 exec, -1
L_xs_24:
  v_exp_f32 v178, v178
  v_exp_f32 v179, v179
  v_exp_f32 v180, v180
  v_mfma_f32_32x32x16_bf16 v[192:207], v[220:223], v[148:151], 0
  s_lshl_b32 s3, s3, 14
  s_add_u32 s3, s3, s6
  v_exp_f32 v181, v181
  v_exp_f32 v182, v182
  v_exp_f32 v183, v183
  v_exp_f32 v184, v184
  v_exp_f32 v185, v185
  v_smfmac_f32_32x32x32_bf16 v[16:31], v[224:227], v[176:183], v2
  buffer_load_dwordx4 v[232:235], v0, s[8:11], s3 offen sc1
  v_exp_f32 v186, v186
  v_exp_f32 v187, v187
  v_exp_f32 v188, v188
  v_exp_f32 v189, v189
  v_exp_f32 v190, v190
  v_exp_f32 v191, v191
  v_exp_f32 v192, v192
  v_exp_f32 v193, v193
  v_smfmac_f32_32x32x32_bf16 v[16:31], v[228:231], v[184:191], v2
  s_mov_b64 exec, s[60:61]
  buffer_load_dwordx4 v[236:239], v252, s[8:11], s3 offen offset:1024 sc1
  buffer_load_dwordx4 v[240:243], v252, s[8:11], s3 offen offset:1536 sc1
  s_mov_b64 exec, -1
  v_exp_f32 v194, v194
  v_exp_f32 v195, v195
  v_exp_f32 v196, v196
  v_mfma_f32_32x32x16_bf16 v[176:191], v[220:223], v[152:155], 0
  v_exp_f32 v197, v197
  v_exp_f32 v198, v198
  v_exp_f32 v199, v199
  v_exp_f32 v200, v200
  v_exp_f32 v201, v201
  v_smfmac_f32_32x32x32_bf16 v[32:47], v[224:227], v[192:199], v2
  v_bfe_u32 v250, v0, 4, 5
  v_lshlrev_b32 v250, 10, v250
  v_exp_f32 v202, v202
  v_exp_f32 v203, v203
  v_exp_f32 v204, v204
  v_exp_f32 v205, v205
  v_exp_f32 v206, v206
  v_exp_f32 v207, v207
  v_exp_f32 v176, v176
  v_exp_f32 v177, v177
  v_smfmac_f32_32x32x32_bf16 v[32:47], v[228:231], v[200:207], v2
  buffer_load_dwordx4 v[208:211], v0, s[8:11], s3 offen offset:2048 sc1
  v_exp_f32 v178, v178
  v_exp_f32 v179, v179
  v_exp_f32 v180, v180
  v_mfma_f32_32x32x16_bf16 v[192:207], v[220:223], v[156:159], 0
  v_exp_f32 v181, v181
  v_exp_f32 v182, v182
  v_exp_f32 v183, v183
  v_exp_f32 v184, v184
  v_exp_f32 v185, v185
  v_smfmac_f32_32x32x32_bf16 v[48:63], v[224:227], v[176:183], v2
  s_mov_b64 exec, s[60:61]
  buffer_load_dwordx4 v[212:215], v252, s[8:11], s3 offen offset:3072 sc1
  buffer_load_dwordx4 v[216:219], v252, s[8:11], s3 offen offset:3584 sc1
  s_mov_b64 exec, -1
  v_exp_f32 v186, v186
  v_exp_f32 v187, v187
  v_exp_f32 v188, v188
  v_exp_f32 v189, v189
  v_exp_f32 v190, v190
  v_exp_f32 v191, v191
  v_exp_f32 v192, v192
  v_exp_f32 v193, v193
  v_smfmac_f32_32x32x32_bf16 v[48:63], v[228:231], v[184:191], v2
  v_lshrrev_b32 v251, 9, v0
  v_lshl_add_u32 v250, v251, 4, v250
  v_exp_f32 v194, v194
  v_exp_f32 v195, v195
  v_exp_f32 v196, v196
  v_mfma_f32_32x32x16_bf16 v[176:191], v[220:223], v[160:163], 0
  v_exp_f32 v197, v197
  v_exp_f32 v198, v198
  v_exp_f32 v199, v199
  v_exp_f32 v200, v200
  v_exp_f32 v201, v201
  v_smfmac_f32_32x32x32_bf16 v[64:79], v[224:227], v[192:199], v2
  s_lshl_b32 s48, s44, 1
  s_add_u32 s48, s48, s43
  v_exp_f32 v202, v202
  v_exp_f32 v203, v203
  v_exp_f32 v204, v204
  v_exp_f32 v205, v205
  v_exp_f32 v206, v206
  v_exp_f32 v207, v207
  v_exp_f32 v176, v176
  v_exp_f32 v177, v177
  v_smfmac_f32_32x32x32_bf16 v[64:79], v[228:231], v[200:207], v2
  s_lshl_b32 s48, s48, 6
  s_lshl_b32 s49, s41, 15
  v_exp_f32 v178, v178
  v_exp_f32 v179, v179
  v_exp_f32 v180, v180
  v_mfma_f32_32x32x16_bf16 v[192:207], v[220:223], v[164:167], 0
  v_exp_f32 v181, v181
  v_exp_f32 v182, v182
  v_exp_f32 v183, v183
  v_exp_f32 v184, v184
  v_exp_f32 v185, v185
  v_smfmac_f32_32x32x32_bf16 v[80:95], v[224:227], v[176:183], v2
  s_add_u32 s48, s48, s49
  v_exp_f32 v186, v186
  v_exp_f32 v187, v187
  v_exp_f32 v188, v188
  v_exp_f32 v189, v189
  v_exp_f32 v190, v190
  v_exp_f32 v191, v191
  v_exp_f32 v192, v192
  v_exp_f32 v193, v193
  v_smfmac_f32_32x32x32_bf16 v[80:95], v[228:231], v[184:191], v2
  buffer_load_dwordx4 v[8:11], v250, s[12:15], s48 offen
  v_exp_f32 v194, v194
  v_exp_f32 v195, v195
  v_exp_f32 v196, v196
  v_mfma_f32_32x32x16_bf16 v[176:191], v[220:223], v[168:171], 0
  v_exp_f32 v197, v197
  v_exp_f32 v198, v198
  v_exp_f32 v199, v199
  v_exp_f32 v200, v200
  v_exp_f32 v201, v201
  v_smfmac_f32_32x32x32_bf16 v[96:111], v[224:227], v[192:199], v2
  buffer_load_dwordx4 v[12:15], v250, s[12:15], s48 offen offset:32
  v_exp_f32 v202, v202
  v_exp_f32 v203, v203
  v_exp_f32 v204, v204
  v_exp_f32 v205, v205
  v_exp_f32 v206, v206
  v_exp_f32 v207, v207
  v_exp_f32 v176, v176
  v_exp_f32 v177, v177
  v_smfmac_f32_32x32x32_bf16 v[96:111], v[228:231], v[200:207], v2
  s_and_b32 s46, s100, 48
  s_cbranch_scc1 L_gslow_25
L_gjoin_26:
  v_exp_f32 v178, v178
  v_exp_f32 v179, v179
  v_exp_f32 v180, v180
  v_mfma_f32_32x32x16_bf16 v[192:207], v[220:223], v[172:175], 0
  v_exp_f32 v181, v181
  v_exp_f32 v182, v182
  v_exp_f32 v183, v183
  v_exp_f32 v184, v184
  v_exp_f32 v185, v185
  v_smfmac_f32_32x32x32_bf16 v[112:127], v[224:227], v[176:183], v2
  s_add_u32 s3, s36, 2
  s_and_b32 s3, s3, 7
  v_exp_f32 v186, v186
  v_exp_f32 v187, v187
  v_exp_f32 v188, v188
  v_exp_f32 v189, v189
  v_exp_f32 v190, v190
  v_exp_f32 v191, v191
  v_exp_f32 v192, v192
  v_exp_f32 v193, v193
  v_smfmac_f32_32x32x32_bf16 v[112:127], v[228:231], v[184:191], v2
  s_waitcnt vmcnt(5)
  v_exp_f32 v194, v194
  v_exp_f32 v195, v195
  v_exp_f32 v196, v196
  v_mfma_f32_32x32x16_bf16 v[176:191], v[232:235], v[144:147], 0
  v_exp_f32 v197, v197
  v_exp_f32 v198, v198
  v_exp_f32 v199, v199
  v_exp_f32 v200, v200
  v_exp_f32 v201, v201
  v_smfmac_f32_32x32x32_bf16 v[128:143], v[224:227], v[192:199], v2
  s_lshl_b32 s3, s3, 14
  s_add_u32 s3, s3, s6
  v_exp_f32 v202, v202
  v_exp_f32 v203, v203
  v_exp_f32 v204, v204
  v_exp_f32 v205, v205
  v_exp_f32 v206, v206
  v_exp_f32 v207, v207
  v_exp_f32 v176, v176
  v_exp_f32 v177, v177
  v_smfmac_f32_32x32x32_bf16 v[128:143], v[228:231], v[200:207], v2
  buffer_load_dwordx4 v[220:223], v0, s[8:11], s3 offen sc1
  s_mov_b32 s58, 81920
  v_lshlrev_b32 v248, 3, v0
  buffer_load_dwordx4 v[244:247], v248, s[8:11], s58 offen sc1
  v_exp_f32 v178, v178
  v_exp_f32 v179, v179
  v_exp_f32 v180, v180
  v_mfma_f32_32x32x16_bf16 v[192:207], v[232:235], v[148:151], 0
  v_exp_f32 v181, v181
  v_exp_f32 v182, v182
  v_exp_f32 v183, v183
  v_exp_f32 v184, v184
  v_exp_f32 v185, v185
  v_smfmac_f32_32x32x32_bf16 v[16:31], v[236:239], v[176:183], v2
  s_mov_b64 exec, s[60:61]
  buffer_load_dwordx4 v[224:227], v252, s[8:11], s3 offen offset:1024 sc1
  buffer_load_dwordx4 v[228:231], v252, s[8:11], s3 offen offset:1536 sc1
  s_mov_b64 exec, -1
  v_exp_f32 v186, v186
  v_exp_f32 v187, v187
  v_exp_f32 v188, v188
  v_exp_f32 v189, v189
  v_exp_f32 v190, v190
  v_exp_f32 v191, v191
  v_exp_f32 v192, v192
  v_exp_f32 v193, v193
  v_smfmac_f32_32x32x32_bf16 v[16:31], v[240:243], v[184:191], v2
  s_getpc_b64 s[4:5]
L_pc_28:
  s_lshl_b32 s46, s37, 2
  s_add_u32 s46, s46, s38
  s_and_b32 s46, s46, 7
  s_lshl_b32 s46, s46, 11
  s_add_u32 s46, s46, 1024
  v_lshrrev_b32 v6, 6, v0
  v_lshl_add_u32 v6, v6, 7, s46
  v_min_u32 v6, L_end-L_pc_28-4, v6
  global_load_dword v255, v6, s[4:5]
  v_exp_f32 v194, v194
  v_exp_f32 v195, v195
  v_exp_f32 v196, v196
  v_mfma_f32_32x32x16_bf16 v[176:191], v[232:235], v[152:155], 0
  v_exp_f32 v197, v197
  v_exp_f32 v198, v198
  v_exp_f32 v199, v199
  v_exp_f32 v200, v200
  v_exp_f32 v201, v201
  v_smfmac_f32_32x32x32_bf16 v[32:47], v[236:239], v[192:199], v2
  v_exp_f32 v202, v202
  v_exp_f32 v203, v203
  v_exp_f32 v204, v204
  v_exp_f32 v205, v205
  v_exp_f32 v206, v206
  v_exp_f32 v207, v207
  v_exp_f32 v176, v176
  v_exp_f32 v177, v177
  v_smfmac_f32_32x32x32_bf16 v[32:47], v[240:243], v[200:207], v2
  v_exp_f32 v178, v178
  v_exp_f32 v179, v179
  v_exp_f32 v180, v180
  v_mfma_f32_32x32x16_bf16 v[192:207], v[232:235], v[156:159], 0
  v_exp_f32 v181, v181
  v_exp_f32 v182, v182
  v_exp_f32 v183, v183
  v_exp_f32 v184, v184
  v_exp_f32 v185, v185
  v_smfmac_f32_32x32x32_bf16 v[48:63], v[236:239], v[176:183], v2
  v_exp_f32 v186, v186
  v_exp_f32 v187, v187
  v_exp_f32 v188, v188
  v_exp_f32 v189, v189
  v_exp_f32 v190, v190
  v_exp_f32 v191, v191
  v_exp_f32 v192, v192
  v_exp_f32 v193, v193
  v_smfmac_f32_32x32x32_bf16 v[48:63], v[240:243], v[184:191], v2
  v_exp_f32 v194, v194
  v_exp_f32 v195, v195
  v_exp_f32 v196, v196
  v_mfma_f32_32x32x16_bf16 v[176:191], v[232:235], v[160:163], 0
  v_exp_f32 v197, v197
  v_exp_f32 v198, v198
  v_exp_f32 v199, v199
  v_exp_f32 v200, v200
  v_exp_f32 v201, v201
  v_smfmac_f32_32x32x32_bf16 v[64:79], v[236:239], v[192:199], v2
  v_exp_f32 v202, v202
  v_exp_f32 v203, v203
  v_exp_f32 v204, v204
  v_exp_f32 v205, v205
  v_exp_f32 v206, v206
  v_exp_f32 v207, v207
  v_exp_f32 v176, v176
  v_exp_f32 v177, v177
  v_smfmac_f32_32x32x32_bf16 v[64:79], v[240:243], v[200:207], v2
  v_exp_f32 v178, v178
  v_exp_f32 v179, v179
  v_exp_f32 v180, v180
  v_mfma_f32_32x32x16_bf16 v[192:207], v[232:235], v[164:167], 0
  v_exp_f32 v181, v181
  v_exp_f32 v182, v182
  v_exp_f32 v183, v183
  v_exp_f32 v184, v184
  v_exp_f32 v185, v185
  v_smfmac_f32_32x32x32_bf16 v[80:95], v[236:239], v[176:183], v2
  v_exp_f32 v186, v186
  v_exp_f32 v187, v187
  v_exp_f32 v188, v188
  v_exp_f32 v189, v189
  v_exp_f32 v190, v190
  v_exp_f32 v191, v191
  v_exp_f32 v192, v192
  v_exp_f32 v193, v193
  v_smfmac_f32_32x32x32_bf16 v[80:95], v[240:243], v[184:191], v2
  s_waitcnt vmcnt(3)
  v_min_u32 v244, v244, v245
  v_min3_u32 v244, v244, v246, v247
  v_cmp_gt_u32 vcc, 1, v244
  s_nop 0
  s_cbranch_vccnz L_lslow_29
L_ljoin_30:
  v_exp_f32 v194, v194
  v_exp_f32 v195, v195
  v_exp_f32 v196, v196
  v_mfma_f32_32x32x16_bf16 v[176:191], v[232:235], v[168:171], 0
  v_exp_f32 v197, v197
  v_exp_f32 v198, v198
  v_exp_f32 v199, v199
  v_exp_f32 v200, v200
  v_exp_f32 v201, v201
  v_smfmac_f32_32x32x32_bf16 v[96:111], v[236:239], v[192:199], v2
  v_exp_f32 v202, v202
  v_exp_f32 v203, v203
  v_exp_f32 v204, v204
  v_exp_f32 v205, v205
  v_exp_f32 v206, v206
  v_exp_f32 v207, v207
  v_exp_f32 v176, v176
  v_exp_f32 v177, v177
  v_smfmac_f32_32x32x32_bf16 v[96:111], v[240:243], v[200:207], v2
  s_mul_i32 s58, s40, 229376
  s_add_u32 s58, s58, 4194304
  v_exp_f32 v178, v178
  v_exp_f32 v179, v179
  v_exp_f32 v180, v180
  v_mfma_f32_32x32x16_bf16 v[192:207], v[232:235], v[172:175], 0
  v_exp_f32 v181, v181
  v_exp_f32 v182, v182
  v_exp_f32 v183, v183
  v_exp_f32 v184, v184
  v_exp_f32 v185, v185
  v_smfmac_f32_32x32x32_bf16 v[112:127], v[236:239], v[176:183], v2
  v_exp_f32 v186, v186
  v_exp_f32 v187, v187
  v_exp_f32 v188, v188
  v_exp_f32 v189, v189
  v_exp_f32 v190, v190
  v_exp_f32 v191, v191
  v_exp_f32 v192, v192
  v_exp_f32 v193, v193
  v_smfmac_f32_32x32x32_bf16 v[112:127], v[240:243], v[184:191], v2
  v_exp_f32 v194, v194
  v_exp_f32 v195, v195
  v_exp_f32 v196, v196
  v_mfma_f32_32x32x16_bf16 v[176:191], v[208:211], v[144:147], 0
  s_mul_i32 s56, s38, 26624
  s_add_u32 s57, s56, s58
  v_exp_f32 v197, v197
  v_exp_f32 v198, v198
  v_exp_f32 v199, v199
  v_exp_f32 v200, v200
  v_exp_f32 v201, v201
  v_smfmac_f32_32x32x32_bf16 v[128:143], v[236:239], v[192:199], v2
  s_add_u32 s57, s57, 0
  s_add_u32 s56, s56, 0
  v_exp_f32 v202, v202
  v_exp_f32 v203, v203
  v_exp_f32 v204, v204
  v_exp_f32 v205, v205
  v_exp_f32 v206, v206
  v_exp_f32 v207, v207
  v_exp_f32 v176, v176
  v_exp_f32 v177, v177
  v_smfmac_f32_32x32x32_bf16 v[128:143], v[240:243], v[200:207], v2
  buffer_load_dwordx4 v[232:235], v0, s[8:11], s3 offen offset:2048 sc1
  v_exp_f32 v178, v178
  v_exp_f32 v179, v179
  v_exp_f32 v180, v180
  v_mfma_f32_32x32x16_bf16 v[192:207], v[208:211], v[148:151], 0
  s_mov_b32 m0, s56
  s_nop 0
  buffer_load_dwordx4 v0, s[8:11], s57 offen sc1 lds
  v_exp_f32 v181, v181
  v_exp_f32 v182, v182
  v_exp_f32 v183, v183
  v_exp_f32 v184, v184
  v_exp_f32 v185, v185
  v_smfmac_f32_32x32x32_bf16 v[16:31], v[212:215], v[176:183], v2
  s_mov_b64 exec, s[60:61]
  buffer_load_dwordx4 v[236:239], v252, s[8:11], s3 offen offset:3072 sc1
  buffer_load_dwordx4 v[240:243], v252, s[8:11], s3 offen offset:3584 sc1
  s_mov_b64 exec, -1
  v_exp_f32 v186, v186
  v_exp_f32 v187, v187
  v_exp_f32 v188, v188
  v_exp_f32 v189, v189
  v_exp_f32 v190, v190
  v_exp_f32 v191, v191
  v_exp_f32 v192, v192
  v_exp_f32 v193, v193
  v_smfmac_f32_32x32x32_bf16 v[16:31], v[216:219], v[184:191], v2
  buffer_load_dwordx4 v0, s[8:11], s57 offen offset:1024 sc1 lds
  v_exp_f32 v194, v194
  v_exp_f32 v195, v195
  v_exp_f32 v196, v196
  v_mfma_f32_32x32x16_bf16 v[176:191], v[208:211], v[152:155], 0
  buffer_load_dwordx4 v0, s[8:11], s57 offen offset:2048 sc1 lds
  v_exp_f32 v197, v197
  v_exp_f32 v198, v198
  v_exp_f32 v199, v199
  v_exp_f32 v200, v200
  v_exp_f32 v201, v201
  v_smfmac_f32_32x32x32_bf16 v[32:47], v[212:215], v[192:199], v2
  v_exp_f32 v202, v202
  v_exp_f32 v203, v203
  v_exp_f32 v204, v204
  v_exp_f32 v205, v205
  v_exp_f32 v206, v206
  v_exp_f32 v207, v207
  v_exp_f32 v176, v176
  v_exp_f32 v177, v177
  v_smfmac_f32_32x32x32_bf16 v[32:47], v[216:219], v[200:207], v2
  buffer_load_dwordx4 v0, s[8:11], s57 offen offset:3072 sc1 lds
  v_exp_f32 v178, v178
  v_exp_f32 v179, v179
  v_exp_f32 v180, v180
  v_mfma_f32_32x32x16_bf16 v[192:207], v[208:211], v[156:159], 0
  v_exp_f32 v181, v181
  v_exp_f32 v182, v182
  v_exp_f32 v183, v183
  v_exp_f32 v184, v184
  v_exp_f32 v185, v185
  v_smfmac_f32_32x32x32_bf16 v[48:63], v[212:215], v[176:183], v2
  v_exp_f32 v186, v186
  v_exp_f32 v187, v187
  v_exp_f32 v188, v188
  v_exp_f32 v189, v189
  v_exp_f32 v190, v190
  v_exp_f32 v191, v191
  v_exp_f32 v192, v192
  v_exp_f32 v193, v193
  v_smfmac_f32_32x32x32_bf16 v[48:63], v[216:219], v[184:191], v2
  s_add_u32 s56, s56, 4096
  s_add_u32 s57, s57, 4096
  v_exp_f32 v194, v194
  v_exp_f32 v195, v195
  v_exp_f32 v196, v196
  v_mfma_f32_32x32x16_bf16 v[176:191], v[208:211], v[160:163], 0
  s_mov_b32 m0, s56
  s_nop 0
  buffer_load_dwordx4 v0, s[8:11], s57 offen sc1 lds
  v_exp_f32 v197, v197
  v_exp_f32 v198, v198
  v_exp_f32 v199, v199
  v_exp_f32 v200, v200
  v_exp_f32 v201, v201
  v_smfmac_f32_32x32x32_bf16 v[64:79], v[212:215], v[192:199], v2
  v_exp_f32 v202, v202
  v_exp_f32 v203, v203
  v_exp_f32 v204, v204
  v_exp_f32 v205, v205
  v_exp_f32 v206, v206
  v_exp_f32 v207, v207
  v_exp_f32 v176, v176
  v_exp_f32 v177, v177
  v_smfmac_f32_32x32x32_bf16 v[64:79], v[216:219], v[200:207], v2
  buffer_load_dwordx4 v0, s[8:11], s57 offen offset:1024 sc1 lds
  v_exp_f32 v178, v178
  v_exp_f32 v179, v179
  v_exp_f32 v180, v180
  v_mfma_f32_32x32x16_bf16 v[192:207], v[208:211], v[164:167], 0
  v_exp_f32 v181, v181
  v_exp_f32 v182, v182
  v_exp_f32 v183, v183
  v_exp_f32 v184, v184
  v_exp_f32 v185, v185
  v_smfmac_f32_32x32x32_bf16 v[80:95], v[212:215], v[176:183], v2
  v_exp_f32 v186, v186
  v_exp_f32 v187, v187
  v_exp_f32 v188, v188
  v_exp_f32 v189, v189
  v_exp_f32 v190, v190
  v_exp_f32 v191, v191
  v_exp_f32 v192, v192
  v_exp_f32 v193, v193
  v_smfmac_f32_32x32x32_bf16 v[80:95], v[216:219], v[184:191], v2
  buffer_load_dwordx4 v0, s[8:11], s57 offen offset:2048 sc1 lds
  v_exp_f32 v194, v194
  v_exp_f32 v195, v195
  v_exp_f32 v196, v196
  v_mfma_f32_32x32x16_bf16 v[176:191], v[208:211], v[168:171], 0
  v_exp_f32 v197, v197
  v_exp_f32 v198, v198
  v_exp_f32 v199, v199
  v_exp_f32 v200, v200
  v_exp_f32 v201, v201
  v_smfmac_f32_32x32x32_bf16 v[96:111], v[212:215], v[192:199], v2
  v_exp_f32 v202, v202
  v_exp_f32 v203, v203
  v_exp_f32 v204, v204
  v_exp_f32 v205, v205
  v_exp_f32 v206, v206
  v_exp_f32 v207, v207
  v_exp_f32 v176, v176
  v_exp_f32 v177, v177
  v_smfmac_f32_32x32x32_bf16 v[96:111], v[216:219], v[200:207], v2
  s_and_b32 s46, s100, 192
  s_cbranch_scc1 L_gslow_32
L_gjoin_33:
  v_exp_f32 v178, v178
  v_exp_f32 v179, v179
  v_exp_f32 v180, v180
  v_mfma_f32_32x32x16_bf16 v[192:207], v[208:211], v[172:175], 0
  buffer_load_dwordx4 v0, s[8:11], s57 offen offset:3072 sc1 lds
  v_exp_f32 v181, v181
  v_exp_f32 v182, v182
  v_exp_f32 v183, v183
  v_exp_f32 v184, v184
  v_exp_f32 v185, v185
  v_smfmac_f32_32x32x32_bf16 v[112:127], v[212:215], v[176:183], v2
  s_add_u32 s3, s36, 3
  s_and_b32 s3, s3, 7
  v_exp_f32 v186, v186
  v_exp_f32 v187, v187
  v_exp_f32 v188, v188
  v_exp_f32 v189, v189
  v_exp_f32 v190, v190
  v_exp_f32 v191, v191
  v_exp_f32 v192, v192
  v_exp_f32 v193, v193
  v_smfmac_f32_32x32x32_bf16 v[112:127], v[216:219], v[184:191], v2
  s_waitcnt vmcnt(12)
  v_exp_f32 v194, v194
  v_exp_f32 v195, v195
  v_exp_f32 v196, v196
  v_mfma_f32_32x32x16_bf16 v[176:191], v[220:223], v[144:147], 0
  s_add_u32 s56, s56, 4096
  s_add_u32 s57, s57, 4096
  v_exp_f32 v197, v197
  v_exp_f32 v198, v198
  v_exp_f32 v199, v199
  v_exp_f32 v200, v200
  v_exp_f32 v201, v201
  v_smfmac_f32_32x32x32_bf16 v[128:143], v[212:215], v[192:199], v2
  s_lshl_b32 s3, s3, 14
  s_add_u32 s3, s3, s6
  v_exp_f32 v202, v202
  v_exp_f32 v203, v203
  v_exp_f32 v204, v204
  v_exp_f32 v205, v205
  v_exp_f32 v206, v206
  v_exp_f32 v207, v207
  v_exp_f32 v176, v176
  v_exp_f32 v177, v177
  v_smfmac_f32_32x32x32_bf16 v[128:143], v[216:219], v[200:207], v2
  buffer_load_dwordx4 v[208:211], v0, s[8:11], s3 offen sc1
  v_exp_f32 v178, v178
  v_exp_f32 v179, v179
  v_exp_f32 v180, v180
  v_mfma_f32_32x32x16_bf16 v[192:207], v[220:223], v[148:151], 0
  s_mov_b32 m0, s56
  s_nop 0
  buffer_load_dwordx4 v0, s[8:11], s57 offen sc1 lds
  v_exp_f32 v181, v181
  v_exp_f32 v182, v182
  v_exp_f32 v183, v183
  v_exp_f32 v184, v184
  v_exp_f32 v185, v185
  v_smfmac_f32_32x32x32_bf16 v[16:31], v[224:227], v[176:183], v2
  s_mov_b64 exec, s[60:61]
  buffer_load_dwordx4 v[212:215], v252, s[8:11], s3 offen offset:1024 sc1
  buffer_load_dwordx4 v[216:219], v252, s[8:11], s3 offen offset:1536 sc1
  s_mov_b64 exec, -1
  v_exp_f32 v186, v186
  v_exp_f32 v187, v187
  v_exp_f32 v188, v188
  v_exp_f32 v189, v189
  v_exp_f32 v190, v190
  v_exp_f32 v191, v191
  v_exp_f32 v192, v192
  v_exp_f32 v193, v193
  v_smfmac_f32_32x32x32_bf16 v[16:31], v[228:231], v[184:191], v2
  buffer_load_dwordx4 v0, s[8:11], s57 offen offset:1024 sc1 lds
  v_exp_f32 v194, v194
  v_exp_f32 v195, v195
  v_exp_f32 v196, v196
  v_mfma_f32_32x32x16_bf16 v[176:191], v[220:223], v[152:155], 0
  buffer_load_dwordx4 v0, s[8:11], s57 offen offset:2048 sc1 lds
  v_exp_f32 v197, v197
  v_exp_f32 v198, v198
  v_exp_f32 v199, v199
  v_exp_f32 v200, v200
  v_exp_f32 v201, v201
  v_smfmac_f32_32x32x32_bf16 v[32:47], v[224:227], v[192:199], v2
  v_exp_f32 v202, v202
  v_exp_f32 v203, v203
  v_exp_f32 v204, v204
  v_exp_f32 v205, v205
  v_exp_f32 v206, v206
  v_exp_f32 v207, v207
  v_exp_f32 v176, v176
  v_exp_f32 v177, v177
  v_smfmac_f32_32x32x32_bf16 v[32:47], v[228:231], v[200:207], v2
  buffer_load_dwordx4 v0, s[8:11], s57 offen offset:3072 sc1 lds
  v_exp_f32 v178, v178
  v_exp_f32 v179, v179
  v_exp_f32 v180, v180
  v_mfma_f32_32x32x16_bf16 v[192:207], v[220:223], v[156:159], 0
  v_exp_f32 v181, v181
  v_exp_f32 v182, v182
  v_exp_f32 v183, v183
  v_exp_f32 v184, v184
  v_exp_f32 v185, v185
  v_smfmac_f32_32x32x32_bf16 v[48:63], v[224:227], v[176:183], v2
  v_exp_f32 v186, v186
  v_exp_f32 v187, v187
  v_exp_f32 v188, v188
  v_exp_f32 v189, v189
  v_exp_f32 v190, v190
  v_exp_f32 v191, v191
  v_exp_f32 v192, v192
  v_exp_f32 v193, v193
  v_smfmac_f32_32x32x32_bf16 v[48:63], v[228:231], v[184:191], v2
  s_add_u32 s56, s56, 4096
  s_add_u32 s57, s57, 4096
  v_exp_f32 v194, v194
  v_exp_f32 v195, v195
  v_exp_f32 v196, v196
  v_mfma_f32_32x32x16_bf16 v[176:191], v[220:223], v[160:163], 0
  s_mov_b32 m0, s56
  s_nop 0
  buffer_load_dwordx4 v0, s[8:11], s57 offen sc1 lds
  v_exp_f32 v197, v197
  v_exp_f32 v198, v198
  v_exp_f32 v199, v199
  v_exp_f32 v200, v200
  v_exp_f32 v201, v201
  v_smfmac_f32_32x32x32_bf16 v[64:79], v[224:227], v[192:199], v2
  v_exp_f32 v202, v202
  v_exp_f32 v203, v203
  v_exp_f32 v204, v204
  v_exp_f32 v205, v205
  v_exp_f32 v206, v206
  v_exp_f32 v207, v207
  v_exp_f32 v176, v176
  v_exp_f32 v177, v177
  v_smfmac_f32_32x32x32_bf16 v[64:79], v[228:231], v[200:207], v2
  buffer_load_dwordx4 v0, s[8:11], s57 offen offset:1024 sc1 lds
  v_exp_f32 v178, v178
  v_exp_f32 v179, v179
  v_exp_f32 v180, v180
  v_mfma_f32_32x32x16_bf16 v[192:207], v[220:223], v[164:167], 0
  v_exp_f32 v181, v181
  v_exp_f32 v182, v182
  v_exp_f32 v183, v183
  v_exp_f32 v184, v184
  v_exp_f32 v185, v185
  v_smfmac_f32_32x32x32_bf16 v[80:95], v[224:227], v[176:183], v2
  v_exp_f32 v186, v186
  v_exp_f32 v187, v187
  v_exp_f32 v188, v188
  v_exp_f32 v189, v189
  v_exp_f32 v190, v190
  v_exp_f32 v191, v191
  v_exp_f32 v192, v192
  v_exp_f32 v193, v193
  v_smfmac_f32_32x32x32_bf16 v[80:95], v[228:231], v[184:191], v2
  buffer_load_dwordx4 v0, s[8:11], s57 offen offset:2048 sc1 lds
  v_exp_f32 v194, v194
  v_exp_f32 v195, v195
  v_exp_f32 v196, v196
  v_mfma_f32_32x32x16_bf16 v[176:191], v[220:223], v[168:171], 0
  v_exp_f32 v197, v197
  v_exp_f32 v198, v198
  v_exp_f32 v199, v199
  v_exp_f32 v200, v200
  v_exp_f32 v201, v201
  v_smfmac_f32_32x32x32_bf16 v[96:111], v[224:227], v[192:199], v2
  v_exp_f32 v202, v202
  v_exp_f32 v203, v203
  v_exp_f32 v204, v204
  v_exp_f32 v205, v205
  v_exp_f32 v206, v206
  v_exp_f32 v207, v207
  v_exp_f32 v176, v176
  v_exp_f32 v177, v177
  v_smfmac_f32_32x32x32_bf16 v[96:111], v[228:231], v[200:207], v2
  buffer_load_dwordx4 v0, s[8:11], s57 offen offset:3072 sc1 lds
  v_exp_f32 v178, v178
  v_exp_f32 v179, v179
  v_exp_f32 v180, v180
  v_mfma_f32_32x32x16_bf16 v[192:207], v[220:223], v[172:175], 0
  v_exp_f32 v181, v181
  v_exp_f32 v182, v182
  v_exp_f32 v183, v183
  v_exp_f32 v184, v184
  v_exp_f32 v185, v185
  v_smfmac_f32_32x32x32_bf16 v[112:127], v[224:227], v[176:183], v2
  v_exp_f32 v186, v186
  v_exp_f32 v187, v187
  v_exp_f32 v188, v188
  v_exp_f32 v189, v189
  v_exp_f32 v190, v190
  v_exp_f32 v191, v191
  v_exp_f32 v192, v192
  v_exp_f32 v193, v193
  v_smfmac_f32_32x32x32_bf16 v[112:127], v[228:231], v[184:191], v2
  s_waitcnt vmcnt(18)
  v_exp_f32 v194, v194
  v_exp_f32 v195, v195
  v_exp_f32 v196, v196
  v_mfma_f32_32x32x16_bf16 v[176:191], v[232:235], v[144:147], 0
  s_add_u32 s56, s56, 4096
  s_add_u32 s57, s57, 4096
  v_exp_f32 v197, v197
  v_exp_f32 v198, v198
  v_exp_f32 v199, v199
  v_exp_f32 v200, v200
  v_exp_f32 v201, v201
  v_smfmac_f32_32x32x32_bf16 v[128:143], v[224:227], v[192:199], v2
  s_mov_b32 m0, s56
  s_nop 0
  buffer_load_dwordx4 v0, s[8:11], s57 offen sc1 lds
  v_exp_f32 v202, v202
  v_exp_f32 v203, v203
  v_exp_f32 v204, v204
  v_exp_f32 v205, v205
  v_exp_f32 v206, v206
  v_exp_f32 v207, v207
  v_exp_f32 v176, v176
  v_exp_f32 v177, v177
  v_smfmac_f32_32x32x32_bf16 v[128:143], v[228:231], v[200:207], v2
  buffer_load_dwordx4 v[220:223], v0, s[8:11], s3 offen offset:2048 sc1
  v_exp_f32 v178, v178
  v_exp_f32 v179, v179
  v_exp_f32 v180, v180
  v_mfma_f32_32x32x16_bf16 v[192:207], v[232:235], v[148:151], 0
  buffer_load_dwordx4 v0, s[8:11], s57 offen offset:1024 sc1 lds
  v_exp_f32 v181, v181
  v_exp_f32 v182, v182
  v_exp_f32 v183, v183
  v_exp_f32 v184, v184
  v_exp_f32 v185, v185
  v_smfmac_f32_32x32x32_bf16 v[16:31], v[236:239], v[176:183], v2
  s_mov_b64 exec, s[60:61]
  buffer_load_dwordx4 v[224:227], v252, s[8:11], s3 offen offset:3072 sc1
  buffer_load_dwordx4 v[228:231], v252, s[8:11], s3 offen offset:3584 sc1
  s_mov_b64 exec, -1
  v_exp_f32 v186, v186
  v_exp_f32 v187, v187
  v_exp_f32 v188, v188
  v_exp_f32 v189, v189
  v_exp_f32 v190, v190
  v_exp_f32 v191, v191
  v_exp_f32 v192, v192
  v_exp_f32 v193, v193
  v_smfmac_f32_32x32x32_bf16 v[16:31], v[240:243], v[184:191], v2
  buffer_load_dwordx4 v0, s[8:11], s57 offen offset:2048 sc1 lds
  v_exp_f32 v194, v194
  v_exp_f32 v195, v195
  v_exp_f32 v196, v196
  v_mfma_f32_32x32x16_bf16 v[176:191], v[232:235], v[152:155], 0
  v_exp_f32 v197, v197
  v_exp_f32 v198, v198
  v_exp_f32 v199, v199
  v_exp_f32 v200, v200
  v_exp_f32 v201, v201
  v_smfmac_f32_32x32x32_bf16 v[32:47], v[236:239], v[192:199], v2
  v_exp_f32 v202, v202
  v_exp_f32 v203, v203
  v_exp_f32 v204, v204
  v_exp_f32 v205, v205
  v_exp_f32 v206, v206
  v_exp_f32 v207, v207
  v_exp_f32 v176, v176
  v_exp_f32 v177, v177
  v_smfmac_f32_32x32x32_bf16 v[32:47], v[240:243], v[200:207], v2
  buffer_load_dwordx4 v0, s[8:11], s57 offen offset:3072 sc1 lds
  v_exp_f32 v178, v178
  v_exp_f32 v179, v179
  v_exp_f32 v180, v180
  v_mfma_f32_32x32x16_bf16 v[192:207], v[232:235], v[156:159], 0
  v_exp_f32 v181, v181
  v_exp_f32 v182, v182
  v_exp_f32 v183, v183
  v_exp_f32 v184, v184
  v_exp_f32 v185, v185
  v_smfmac_f32_32x32x32_bf16 v[48:63], v[236:239], v[176:183], v2
  v_exp_f32 v186, v186
  v_exp_f32 v187, v187
  v_exp_f32 v188, v188
  v_exp_f32 v189, v189
  v_exp_f32 v190, v190
  v_exp_f32 v191, v191
  v_exp_f32 v192, v192
  v_exp_f32 v193, v193
  v_smfmac_f32_32x32x32_bf16 v[48:63], v[240:243], v[184:191], v2
  s_add_u32 s56, s56, 4096
  s_add_u32 s57, s57, 4096
  v_exp_f32 v194, v194
  v_exp_f32 v195, v195
  v_exp_f32 v196, v196
  v_mfma_f32_32x32x16_bf16 v[176:191], v[232:235], v[160:163], 0
  s_mov_b32 m0, s56
  s_nop 0
  buffer_load_dwordx4 v0, s[8:11], s57 offen sc1 lds
  v_exp_f32 v197, v197
  v_exp_f32 v198, v198
  v_exp_f32 v199, v199
  v_exp_f32 v200, v200
  v_exp_f32 v201, v201
  v_smfmac_f32_32x32x32_bf16 v[64:79], v[236:239], v[192:199], v2
  v_exp_f32 v202, v202
  v_exp_f32 v203, v203
  v_exp_f32 v204, v204
  v_exp_f32 v205, v205
  v_exp_f32 v206, v206
  v_exp_f32 v207, v207
  v_exp_f32 v176, v176
  v_exp_f32 v177, v177
  v_smfmac_f32_32x32x32_bf16 v[64:79], v[240:243], v[200:207], v2
  buffer_load_dwordx4 v0, s[8:11], s57 offen offset:1024 sc1 lds
  v_exp_f32 v178, v178
  v_exp_f32 v179, v179
  v_exp_f32 v180, v180
  v_mfma_f32_32x32x16_bf16 v[192:207], v[232:235], v[164:167], 0
  v_exp_f32 v181, v181
  v_exp_f32 v182, v182
  v_exp_f32 v183, v183
  v_exp_f32 v184, v184
  v_exp_f32 v185, v185
  v_smfmac_f32_32x32x32_bf16 v[80:95], v[236:239], v[176:183], v2
  v_exp_f32 v186, v186
  v_exp_f32 v187, v187
  v_exp_f32 v188, v188
  v_exp_f32 v189, v189
  v_exp_f32 v190, v190
  v_exp_f32 v191, v191
  v_exp_f32 v192, v192
  v_exp_f32 v193, v193
  v_smfmac_f32_32x32x32_bf16 v[80:95], v[240:243], v[184:191], v2
  buffer_load_dwordx4 v0, s[8:11], s57 offen offset:2048 sc1 lds
  v_exp_f32 v194, v194
  v_exp_f32 v195, v195
  v_exp_f32 v196, v196
  v_mfma_f32_32x32x16_bf16 v[176:191], v[232:235], v[168:171], 0
  v_exp_f32 v197, v197
  v_exp_f32 v198, v198
  v_exp_f32 v199, v199
  v_exp_f32 v200, v200
  v_exp_f32 v201, v201
  v_smfmac_f32_32x32x32_bf16 v[96:111], v[236:239], v[192:199], v2
  v_exp_f32 v202, v202
  v_exp_f32 v203, v203
  v_exp_f32 v204, v204
  v_exp_f32 v205, v205
  v_exp_f32 v206, v206
  v_exp_f32 v207, v207
  v_exp_f32 v176, v176
  v_exp_f32 v177, v177
  v_smfmac_f32_32x32x32_bf16 v[96:111], v[240:243], v[200:207], v2
  s_and_b32 s46, s100, 768
  s_cbranch_scc1 L_gslow_35
L_gjoin_36:
  v_exp_f32 v178, v178
  v_exp_f32 v179, v179
  v_exp_f32 v180, v180
  v_mfma_f32_32x32x16_bf16 v[192:207], v[232:235], v[172:175], 0
  buffer_load_dwordx4 v0, s[8:11], s57 offen offset:3072 sc1 lds
  v_exp_f32 v181, v181
  v_exp_f32 v182, v182
  v_exp_f32 v183, v183
  v_exp_f32 v184, v184
  v_exp_f32 v185, v185
  v_smfmac_f32_32x32x32_bf16 v[112:127], v[236:239], v[176:183], v2
  s_add_u32 s3, s36, 4
  s_and_b32 s3, s3, 7
  v_exp_f32 v186, v186
  v_exp_f32 v187, v187
  v_exp_f32 v188, v188
  v_exp_f32 v189, v189
  v_exp_f32 v190, v190
  v_exp_f32 v191, v191
  v_exp_f32 v192, v192
  v_exp_f32 v193, v193
  v_smfmac_f32_32x32x32_bf16 v[112:127], v[240:243], v[184:191], v2
  s_waitcnt vmcnt(18)
  v_exp_f32 v194, v194
  v_exp_f32 v195, v195
  v_exp_f32 v196, v196
  v_mfma_f32_32x32x16_bf16 v[176:191], v[208:211], v[144:147], 0
  s_add_u32 s56, s56, 4096
  s_add_u32 s57, s57, 4096
  v_exp_f32 v197, v197
  v_exp_f32 v198, v198
  v_exp_f32 v199, v199
  v_exp_f32 v200, v200
  v_exp_f32 v201, v201
  v_smfmac_f32_32x32x32_bf16 v[128:143], v[236:239], v[192:199], v2
  s_lshl_b32 s3, s3, 14
  s_add_u32 s3, s3, s6
  v_exp_f32 v202, v202
  v_exp_f32 v203, v203
  v_exp_f32 v204, v204
  v_exp_f32 v205, v205
  v_exp_f32 v206, v206
  v_exp_f32 v207, v207
  v_exp_f32 v176, v176
  v_exp_f32 v177, v177
  v_smfmac_f32_32x32x32_bf16 v[128:143], v[240:243], v[200:207], v2
  buffer_load_dwordx4 v[232:235], v0, s[8:11], s3 offen sc1
  v_exp_f32 v178, v178
  v_exp_f32 v179, v179
  v_exp_f32 v180, v180
  v_mfma_f32_32x32x16_bf16 v[192:207], v[208:211], v[148:151], 0
  s_mov_b32 m0, s56
  s_nop 0
  buffer_load_dwordx4 v0, s[8:11], s57 offen sc1 lds
  v_exp_f32 v181, v181
  v_exp_f32 v182, v182
  v_exp_f32 v183, v183
  v_exp_f32 v184, v184
  v_exp_f32 v185, v185
  v_smfmac_f32_32x32x32_bf16 v[16:31], v[212:215], v[176:183], v2
  s_mov_b64 exec, s[60:61]
  buffer_load_dwordx4 v[236:239], v252, s[8:11], s3 offen offset:1024 sc1
  buffer_load_dwordx4 v[240:243], v252, s[8:11], s3 offen offset:1536 sc1
  s_mov_b64 exec, -1
  v_exp_f32 v186, v186
  v_exp_f32 v187, v187
  v_exp_f32 v188, v188
  v_exp_f32 v189, v189
  v_exp_f32 v190, v190
  v_exp_f32 v191, v191
  v_exp_f32 v192, v192
  v_exp_f32 v193, v193
  v_smfmac_f32_32x32x32_bf16 v[16:31], v[216:219], v[184:191], v2
  buffer_load_dwordx4 v0, s[8:11], s57 offen offset:1024 sc1 lds
  v_exp_f32 v194, v194
  v_exp_f32 v195, v195
  v_exp_f32 v196, v196
  v_mfma_f32_32x32x16_bf16 v[176:191], v[208:211], v[152:155], 0
  s_mul_i32 s56, s44, 229376
  s_mul_i32 s57, s38, 57344
  v_exp_f32 v197, v197
  v_exp_f32 v198, v198
  v_exp_f32 v199, v199
  v_exp_f32 v200, v200
  v_exp_f32 v201, v201
  v_smfmac_f32_32x32x32_bf16 v[32:47], v[212:215], v[192:199], v2
  s_add_u32 s56, s56, s57
  s_add_u32 s56, s56, 7864320
  v_exp_f32 v202, v202
  v_exp_f32 v203, v203
  v_exp_f32 v204, v204
  v_exp_f32 v205, v205
  v_exp_f32 v206, v206
  v_exp_f32 v207, v207
  v_exp_f32 v176, v176
  v_exp_f32 v177, v177
  v_smfmac_f32_32x32x32_bf16 v[32:47], v[216:219], v[200:207], v2
  s_lshl_b32 s57, s43, 10
  s_add_u32 s56, s56, s57
  v_exp_f32 v178, v178
  v_exp_f32 v179, v179
  v_exp_f32 v180, v180
  v_mfma_f32_32x32x16_bf16 v[192:207], v[208:211], v[156:159], 0
  s_xor_b32 s57, s56, 1024
  v_exp_f32 v181, v181
  v_exp_f32 v182, v182
  v_exp_f32 v183, v183
  v_exp_f32 v184, v184
  v_exp_f32 v185, v185
  v_smfmac_f32_32x32x32_bf16 v[48:63], v[212:215], v[176:183], v2
  buffer_load_dwordx4 a[0:3], v0, s[8:11], s56 offen sc1
  v_exp_f32 v186, v186
  v_exp_f32 v187, v187
  v_exp_f32 v188, v188
  v_exp_f32 v189, v189
  v_exp_f32 v190, v190
  v_exp_f32 v191, v191
  v_exp_f32 v192, v192
  v_exp_f32 v193, v193
  v_smfmac_f32_32x32x32_bf16 v[48:63], v[216:219], v[184:191], v2
  buffer_load_dwordx4 a[4:7], v0, s[8:11], s57 offen sc1
  v_exp_f32 v194, v194
  v_exp_f32 v195, v195
  v_exp_f32 v196, v196
  v_mfma_f32_32x32x16_bf16 v[176:191], v[208:211], v[160:163], 0
  buffer_load_dwordx4 a[8:11], v0, s[8:11], s56 offen offset:2048 sc1
  v_exp_f32 v197, v197
  v_exp_f32 v198, v198
  v_exp_f32 v199, v199
  v_exp_f32 v200, v200
  v_exp_f32 v201, v201
  v_smfmac_f32_32x32x32_bf16 v[64:79], v[212:215], v[192:199], v2
  buffer_load_dwordx4 a[12:15], v0, s[8:11], s57 offen offset:2048 sc1
  v_exp_f32 v202, v202
  v_exp_f32 v203, v203
  v_exp_f32 v204, v204
  v_exp_f32 v205, v205
  v_exp_f32 v206, v206
  v_exp_f32 v207, v207
  v_exp_f32 v176, v176
  v_exp_f32 v177, v177
  v_smfmac_f32_32x32x32_bf16 v[64:79], v[216:219], v[200:207], v2
  s_add_u32 s56, s56, 4096
  s_add_u32 s57, s57, 4096
  buffer_load_dwordx4 a[16:19], v0, s[8:11], s56 offen sc1
  v_exp_f32 v178, v178
  v_exp_f32 v179, v179
  v_exp_f32 v180, v180
  v_mfma_f32_32x32x16_bf16 v[192:207], v[208:211], v[164:167], 0
  buffer_load_dwordx4 a[20:23], v0, s[8:11], s57 offen sc1
  v_exp_f32 v181, v181
  v_exp_f32 v182, v182
  v_exp_f32 v183, v183
  v_exp_f32 v184, v184
  v_exp_f32 v185, v185
  v_smfmac_f32_32x32x32_bf16 v[80:95], v[212:215], v[176:183], v2
  buffer_load_dwordx4 a[24:27], v0, s[8:11], s56 offen offset:2048 sc1
  v_exp_f32 v186, v186
  v_exp_f32 v187, v187
  v_exp_f32 v188, v188
  v_exp_f32 v189, v189
  v_exp_f32 v190, v190
  v_exp_f32 v191, v191
  v_exp_f32 v192, v192
  v_exp_f32 v193, v193
  v_smfmac_f32_32x32x32_bf16 v[80:95], v[216:219], v[184:191], v2
  buffer_load_dwordx4 a[28:31], v0, s[8:11], s57 offen offset:2048 sc1
  v_exp_f32 v194, v194
  v_exp_f32 v195, v195
  v_exp_f32 v196, v196
  v_mfma_f32_32x32x16_bf16 v[176:191], v[208:211], v[168:171], 0
  v_exp_f32 v197, v197
  v_exp_f32 v198, v198
  v_exp_f32 v199, v199
  v_exp_f32 v200, v200
  v_exp_f32 v201, v201
  v_smfmac_f32_32x32x32_bf16 v[96:111], v[212:215], v[192:199], v2
  s_add_u32 s56, s56, 4096
  s_add_u32 s57, s57, 4096
  buffer_load_dwordx4 a[32:35], v0, s[8:11], s56 offen sc1
  v_exp_f32 v202, v202
  v_exp_f32 v203, v203
  v_exp_f32 v204, v204
  v_exp_f32 v205, v205
  v_exp_f32 v206, v206
  v_exp_f32 v207, v207
  v_exp_f32 v176, v176
  v_exp_f32 v177, v177
  v_smfmac_f32_32x32x32_bf16 v[96:111], v[216:219], v[200:207], v2
  buffer_load_dwordx4 a[36:39], v0, s[8:11], s57 offen sc1
  v_exp_f32 v178, v178
  v_exp_f32 v179, v179
  v_exp_f32 v180, v180
  v_mfma_f32_32x32x16_bf16 v[192:207], v[208:211], v[172:175], 0
  v_exp_f32 v181, v181
  v_exp_f32 v182, v182
  v_exp_f32 v183, v183
  v_exp_f32 v184, v184
  v_exp_f32 v185, v185
  v_smfmac_f32_32x32x32_bf16 v[112:127], v[212:215], v[176:183], v2
  buffer_load_dwordx4 a[40:43], v0, s[8:11], s56 offen offset:2048 sc1
  v_exp_f32 v186, v186
  v_exp_f32 v187, v187
  v_exp_f32 v188, v188
  v_exp_f32 v189, v189
  v_exp_f32 v190, v190
  v_exp_f32 v191, v191
  v_exp_f32 v192, v192
  v_exp_f32 v193, v193
  v_smfmac_f32_32x32x32_bf16 v[112:127], v[216:219], v[184:191], v2
  s_waitcnt vmcnt(22)
  v_exp_f32 v194, v194
  v_exp_f32 v195, v195
  v_exp_f32 v196, v196
  v_mfma_f32_32x32x16_bf16 v[176:191], v[220:223], v[144:147], 0
  buffer_load_dwordx4 a[44:47], v0, s[8:11], s57 offen offset:2048 sc1
  v_exp_f32 v197, v197
  v_exp_f32 v198, v198
  v_exp_f32 v199, v199
  v_exp_f32 v200, v200
  v_exp_f32 v201, v201
  v_smfmac_f32_32x32x32_bf16 v[128:143], v[212:215], v[192:199], v2
  s_add_u32 s56, s56, 4096
  s_add_u32 s57, s57, 4096
  buffer_load_dwordx4 a[48:51], v0, s[8:11], s56 offen sc1
  v_exp_f32 v202, v202
  v_exp_f32 v203, v203
  v_exp_f32 v204, v204
  v_exp_f32 v205, v205
  v_exp_f32 v206, v206
  v_exp_f32 v207, v207
  v_exp_f32 v176, v176
  v_exp_f32 v177, v177
  v_smfmac_f32_32x32x32_bf16 v[128:143], v[216:219], v[200:207], v2
  buffer_load_dwordx4 v[208:211], v0, s[8:11], s3 offen offset:2048 sc1
  v_exp_f32 v178, v178
  v_exp_f32 v179, v179
  v_exp_f32 v180, v180
  v_mfma_f32_32x32x16_bf16 v[192:207], v[220:223], v[148:151], 0
  buffer_load_dwordx4 a[52:55], v0, s[8:11], s57 offen sc1
  v_exp_f32 v181, v181
  v_exp_f32 v182, v182
  v_exp_f32 v183, v183
  v_exp_f32 v184, v184
  v_exp_f32 v185, v185
  v_smfmac_f32_32x32x32_bf16 v[16:31], v[224:227], v[176:183], v2
  s_mov_b64 exec, s[60:61]
  buffer_load_dwordx4 v[212:215], v252, s[8:11], s3 offen offset:3072 sc1
  buffer_load_dwordx4 v[216:219], v252, s[8:11], s3 offen offset:3584 sc1
  s_mov_b64 exec, -1
  v_exp_f32 v186, v186
  v_exp_f32 v187, v187
  v_exp_f32 v188, v188
  v_exp_f32 v189, v189
  v_exp_f32 v190, v190
  v_exp_f32 v191, v191
  v_exp_f32 v192, v192
  v_exp_f32 v193, v193
  v_smfmac_f32_32x32x32_bf16 v[16:31], v[228:231], v[184:191], v2
  buffer_load_dwordx4 a[56:59], v0, s[8:11], s56 offen offset:2048 sc1
  v_exp_f32 v194, v194
  v_exp_f32 v195, v195
  v_exp_f32 v196, v196
  v_mfma_f32_32x32x16_bf16 v[176:191], v[220:223], v[152:155], 0
  buffer_load_dwordx4 a[60:63], v0, s[8:11], s57 offen offset:2048 sc1
  v_exp_f32 v197, v197
  v_exp_f32 v198, v198
  v_exp_f32 v199, v199
  v_exp_f32 v200, v200
  v_exp_f32 v201, v201
  v_smfmac_f32_32x32x32_bf16 v[32:47], v[224:227], v[192:199], v2
  v_exp_f32 v202, v202
  v_exp_f32 v203, v203
  v_exp_f32 v204, v204
  v_exp_f32 v205, v205
  v_exp_f32 v206, v206
  v_exp_f32 v207, v207
  v_exp_f32 v176, v176
  v_exp_f32 v177, v177
  v_smfmac_f32_32x32x32_bf16 v[32:47], v[228:231], v[200:207], v2
  s_add_u32 s56, s56, 4096
  s_add_u32 s57, s57, 4096
  buffer_load_dwordx4 a[64:67], v0, s[8:11], s56 offen sc1
  v_exp_f32 v178, v178
  v_exp_f32 v179, v179
  v_exp_f32 v180, v180
  v_mfma_f32_32x32x16_bf16 v[192:207], v[220:223], v[156:159], 0
  buffer_load_dwordx4 a[68:71], v0, s[8:11], s57 offen sc1
  v_exp_f32 v181, v181
  v_exp_f32 v182, v182
  v_exp_f32 v183, v183
  v_exp_f32 v184, v184
  v_exp_f32 v185, v185
  v_smfmac_f32_32x32x32_bf16 v[48:63], v[224:227], v[176:183], v2
  v_exp_f32 v186, v186
  v_exp_f32 v187, v187
  v_exp_f32 v188, v188
  v_exp_f32 v189, v189
  v_exp_f32 v190, v190
  v_exp_f32 v191, v191
  v_exp_f32 v192, v192
  v_exp_f32 v193, v193
  v_smfmac_f32_32x32x32_bf16 v[48:63], v[228:231], v[184:191], v2
  buffer_load_dwordx4 a[72:75], v0, s[8:11], s56 offen offset:2048 sc1
  v_exp_f32 v194, v194
  v_exp_f32 v195, v195
  v_exp_f32 v196, v196
  v_mfma_f32_32x32x16_bf16 v[176:191], v[220:223], v[160:163], 0
  buffer_load_dwordx4 a[76:79], v0, s[8:11], s57 offen offset:2048 sc1
  v_exp_f32 v197, v197
  v_exp_f32 v198, v198
  v_exp_f32 v199, v199
  v_exp_f32 v200, v200
  v_exp_f32 v201, v201
  v_smfmac_f32_32x32x32_bf16 v[64:79], v[224:227], v[192:199], v2
  v_exp_f32 v202, v202
  v_exp_f32 v203, v203
  v_exp_f32 v204, v204
  v_exp_f32 v205, v205
  v_exp_f32 v206, v206
  v_exp_f32 v207, v207
  v_exp_f32 v176, v176
  v_exp_f32 v177, v177
  v_smfmac_f32_32x32x32_bf16 v[64:79], v[228:231], v[200:207], v2
  s_add_u32 s56, s56, 4096
  s_add_u32 s57, s57, 4096
  buffer_load_dwordx4 a[80:83], v0, s[8:11], s56 offen sc1
  v_exp_f32 v178, v178
  v_exp_f32 v179, v179
  v_exp_f32 v180, v180
  v_mfma_f32_32x32x16_bf16 v[192:207], v[220:223], v[164:167], 0
  v_exp_f32 v181, v181
  v_exp_f32 v182, v182
  v_exp_f32 v183, v183
  v_exp_f32 v184, v184
  v_exp_f32 v185, v185
  v_smfmac_f32_32x32x32_bf16 v[80:95], v[224:227], v[176:183], v2
  buffer_load_dwordx4 a[84:87], v0, s[8:11], s57 offen sc1
  v_exp_f32 v186, v186
  v_exp_f32 v187, v187
  v_exp_f32 v188, v188
  v_exp_f32 v189, v189
  v_exp_f32 v190, v190
  v_exp_f32 v191, v191
  v_exp_f32 v192, v192
  v_exp_f32 v193, v193
  v_smfmac_f32_32x32x32_bf16 v[80:95], v[228:231], v[184:191], v2
  buffer_load_dwordx4 a[88:91], v0, s[8:11], s56 offen offset:2048 sc1
  v_exp_f32 v194, v194
  v_exp_f32 v195, v195
  v_exp_f32 v196, v196
  v_mfma_f32_32x32x16_bf16 v[176:191], v[220:223], v[168:171], 0
  v_exp_f32 v197, v197
  v_exp_f32 v198, v198
  v_exp_f32 v199, v199
  v_exp_f32 v200, v200
  v_exp_f32 v201, v201
  v_smfmac_f32_32x32x32_bf16 v[96:111], v[224:227], v[192:199], v2
  buffer_load_dwordx4 a[92:95], v0, s[8:11], s57 offen offset:2048 sc1
  v_exp_f32 v202, v202
  v_exp_f32 v203, v203
  v_exp_f32 v204, v204
  v_exp_f32 v205, v205
  v_exp_f32 v206, v206
  v_exp_f32 v207, v207
  v_exp_f32 v176, v176
  v_exp_f32 v177, v177
  v_smfmac_f32_32x32x32_bf16 v[96:111], v[228:231], v[200:207], v2
  s_and_b32 s46, s100, 3072
  s_cbranch_scc1 L_gslow_38
L_gjoin_39:
  v_exp_f32 v178, v178
  v_exp_f32 v179, v179
  v_exp_f32 v180, v180
  v_mfma_f32_32x32x16_bf16 v[192:207], v[220:223], v[172:175], 0
  s_add_u32 s56, s56, 4096
  s_add_u32 s57, s57, 4096
  buffer_load_dwordx4 a[96:99], v0, s[8:11], s56 offen sc1
  v_exp_f32 v181, v181
  v_exp_f32 v182, v182
  v_exp_f32 v183, v183
  v_exp_f32 v184, v184
  v_exp_f32 v185, v185
  v_smfmac_f32_32x32x32_bf16 v[112:127], v[224:227], v[176:183], v2
  s_add_u32 s3, s36, 5
  s_and_b32 s3, s3, 7
  v_exp_f32 v186, v186
  v_exp_f32 v187, v187
  v_exp_f32 v188, v188
  v_exp_f32 v189, v189
  v_exp_f32 v190, v190
  v_exp_f32 v191, v191
  v_exp_f32 v192, v192
  v_exp_f32 v193, v193
  v_smfmac_f32_32x32x32_bf16 v[112:127], v[228:231], v[184:191], v2
  s_waitcnt vmcnt(29)
  v_exp_f32 v194, v194
  v_exp_f32 v195, v195
  v_exp_f32 v196, v196
  v_mfma_f32_32x32x16_bf16 v[176:191], v[232:235], v[144:147], 0
  buffer_load_dwordx4 a[100:103], v0, s[8:11], s57 offen sc1
  v_exp_f32 v197, v197
  v_exp_f32 v198, v198
  v_exp_f32 v199, v199
  v_exp_f32 v200, v200
  v_exp_f32 v201, v201
  v_smfmac_f32_32x32x32_bf16 v[128:143], v[224:227], v[192:199], v2
  s_lshl_b32 s3, s3, 14
  s_add_u32 s3, s3, s6
  v_exp_f32 v202, v202
  v_exp_f32 v203, v203
  v_exp_f32 v204, v204
  v_exp_f32 v205, v205
  v_exp_f32 v206, v206
  v_exp_f32 v207, v207
  v_exp_f32 v176, v176
  v_exp_f32 v177, v177
  v_smfmac_f32_32x32x32_bf16 v[128:143], v[228:231], v[200:207], v2
  buffer_load_dwordx4 v[220:223], v0, s[8:11], s3 offen sc1
  v_exp_f32 v178, v178
  v_exp_f32 v179, v179
  v_exp_f32 v180, v180
  v_mfma_f32_32x32x16_bf16 v[192:207], v[232:235], v[148:151], 0
  buffer_load_dwordx4 a[104:107], v0, s[8:11], s56 offen offset:2048 sc1
  v_exp_f32 v181, v181
  v_exp_f32 v182, v182
  v_exp_f32 v183, v183
  v_exp_f32 v184, v184
  v_exp_f32 v185, v185
  v_smfmac_f32_32x32x32_bf16 v[16:31], v[236:239], v[176:183], v2
  s_mov_b64 exec, s[60:61]
  buffer_load_dwordx4 v[224:227], v252, s[8:11], s3 offen offset:1024 sc1
  buffer_load_dwordx4 v[228:231], v252, s[8:11], s3 offen offset:1536 sc1
  s_mov_b64 exec, -1
  v_exp_f32 v186, v186
  v_exp_f32 v187, v187
  v_exp_f32 v188, v188
  v_exp_f32 v189, v189
  v_exp_f32 v190, v190
  v_exp_f32 v191, v191
  v_exp_f32 v192, v192
  v_exp_f32 v193, v193
  v_smfmac_f32_32x32x32_bf16 v[16:31], v[240:243], v[184:191], v2
  buffer_load_dwordx4 a[108:111], v0, s[8:11], s57 offen offset:2048 sc1
  v_exp_f32 v194, v194
  v_exp_f32 v195, v195
  v_exp_f32 v196, v196
  v_mfma_f32_32x32x16_bf16 v[176:191], v[232:235], v[152:155], 0
  s_add_u32 s56, s56, 4096
  s_add_u32 s57, s57, 4096
  buffer_load_dwordx4 a[112:115], v0, s[8:11], s56 offen sc1
  v_exp_f32 v197, v197
  v_exp_f32 v198, v198
  v_exp_f32 v199, v199
  v_exp_f32 v200, v200
  v_exp_f32 v201, v201
  v_smfmac_f32_32x32x32_bf16 v[32:47], v[236:239], v[192:199], v2
  buffer_load_dwordx4 a[116:119], v0, s[8:11], s57 offen sc1
  v_exp_f32 v202, v202
  v_exp_f32 v203, v203
  v_exp_f32 v204, v204
  v_exp_f32 v205, v205
  v_exp_f32 v206, v206
  v_exp_f32 v207, v207
  v_exp_f32 v176, v176
  v_exp_f32 v177, v177
  v_smfmac_f32_32x32x32_bf16 v[32:47], v[240:243], v[200:207], v2
  buffer_load_dwordx4 a[120:123], v0, s[8:11], s56 offen offset:2048 sc1
  v_exp_f32 v178, v178
  v_exp_f32 v179, v179
  v_exp_f32 v180, v180
  v_mfma_f32_32x32x16_bf16 v[192:207], v[232:235], v[156:159], 0
  buffer_load_dwordx4 a[124:127], v0, s[8:11], s57 offen offset:2048 sc1
  v_exp_f32 v181, v181
  v_exp_f32 v182, v182
  v_exp_f32 v183, v183
  v_exp_f32 v184, v184
  v_exp_f32 v185, v185
  v_smfmac_f32_32x32x32_bf16 v[48:63], v[236:239], v[176:183], v2
  s_add_u32 s56, s56, 4096
  s_add_u32 s57, s57, 4096
  buffer_load_dwordx4 a[128:131], v0, s[8:11], s56 offen sc1
  v_exp_f32 v186, v186
  v_exp_f32 v187, v187
  v_exp_f32 v188, v188
  v_exp_f32 v189, v189
  v_exp_f32 v190, v190
  v_exp_f32 v191, v191
  v_exp_f32 v192, v192
  v_exp_f32 v193, v193
  v_smfmac_f32_32x32x32_bf16 v[48:63], v[240:243], v[184:191], v2
  buffer_load_dwordx4 a[132:135], v0, s[8:11], s57 offen sc1
  v_exp_f32 v194, v194
  v_exp_f32 v195, v195
  v_exp_f32 v196, v196
  v_mfma_f32_32x32x16_bf16 v[176:191], v[232:235], v[160:163], 0
  buffer_load_dwordx4 a[136:139], v0, s[8:11], s56 offen offset:2048 sc1
  v_exp_f32 v197, v197
  v_exp_f32 v198, v198
  v_exp_f32 v199, v199
  v_exp_f32 v200, v200
  v_exp_f32 v201, v201
  v_smfmac_f32_32x32x32_bf16 v[64:79], v[236:239], v[192:199], v2
  v_exp_f32 v202, v202
  v_exp_f32 v203, v203
  v_exp_f32 v204, v204
  v_exp_f32 v205, v205
  v_exp_f32 v206, v206
  v_exp_f32 v207, v207
  v_exp_f32 v176, v176
  v_exp_f32 v177, v177
  v_smfmac_f32_32x32x32_bf16 v[64:79], v[240:243], v[200:207], v2
  buffer_load_dwordx4 a[140:143], v0, s[8:11], s57 offen offset:2048 sc1
  v_exp_f32 v178, v178
  v_exp_f32 v179, v179
  v_exp_f32 v180, v180
  v_mfma_f32_32x32x16_bf16 v[192:207], v[232:235], v[164:167], 0
  v_exp_f32 v181, v181
  v_exp_f32 v182, v182
  v_exp_f32 v183, v183
  v_exp_f32 v184, v184
  v_exp_f32 v185, v185
  v_smfmac_f32_32x32x32_bf16 v[80:95], v[236:239], v[176:183], v2
  s_add_u32 s56, s56, 4096
  s_add_u32 s57, s57, 4096
  buffer_load_dwordx4 a[144:147], v0, s[8:11], s56 offen sc1
  v_exp_f32 v186, v186
  v_exp_f32 v187, v187
  v_exp_f32 v188, v188
  v_exp_f32 v189, v189
  v_exp_f32 v190, v190
  v_exp_f32 v191, v191
  v_exp_f32 v192, v192
  v_exp_f32 v193, v193
  v_smfmac_f32_32x32x32_bf16 v[80:95], v[240:243], v[184:191], v2
  buffer_load_dwordx4 a[148:151], v0, s[8:11], s57 offen sc1
  v_exp_f32 v194, v194
  v_exp_f32 v195, v195
  v_exp_f32 v196, v196
  v_mfma_f32_32x32x16_bf16 v[176:191], v[232:235], v[168:171], 0
  v_exp_f32 v197, v197
  v_exp_f32 v198, v198
  v_exp_f32 v199, v199
  v_exp_f32 v200, v200
  v_exp_f32 v201, v201
  v_smfmac_f32_32x32x32_bf16 v[96:111], v[236:239], v[192:199], v2
  buffer_load_dwordx4 a[152:155], v0, s[8:11], s56 offen offset:2048 sc1
  v_exp_f32 v202, v202
  v_exp_f32 v203, v203
  v_exp_f32 v204, v204
  v_exp_f32 v205, v205
  v_exp_f32 v206, v206
  v_exp_f32 v207, v207
  v_exp_f32 v176, v176
  v_exp_f32 v177, v177
  v_smfmac_f32_32x32x32_bf16 v[96:111], v[240:243], v[200:207], v2
  buffer_load_dwordx4 a[156:159], v0, s[8:11], s57 offen offset:2048 sc1
  v_exp_f32 v178, v178
  v_exp_f32 v179, v179
  v_exp_f32 v180, v180
  v_mfma_f32_32x32x16_bf16 v[192:207], v[232:235], v[172:175], 0
  v_exp_f32 v181, v181
  v_exp_f32 v182, v182
  v_exp_f32 v183, v183
  v_exp_f32 v184, v184
  v_exp_f32 v185, v185
  v_smfmac_f32_32x32x32_bf16 v[112:127], v[236:239], v[176:183], v2
  s_add_u32 s56, s56, 4096
  s_add_u32 s57, s57, 4096
  buffer_load_dwordx4 a[160:163], v0, s[8:11], s56 offen sc1
  v_exp_f32 v186, v186
  v_exp_f32 v187, v187
  v_exp_f32 v188, v188
  v_exp_f32 v189, v189
  v_exp_f32 v190, v190
  v_exp_f32 v191, v191
  v_exp_f32 v192, v192
  v_exp_f32 v193, v193
  v_smfmac_f32_32x32x32_bf16 v[112:127], v[240:243], v[184:191], v2
  s_waitcnt vmcnt(30)
  v_exp_f32 v194, v194
  v_exp_f32 v195, v195
  v_exp_f32 v196, v196
  v_mfma_f32_32x32x16_bf16 v[176:191], v[208:211], v[144:147], 0
  buffer_load_dwordx4 a[164:167], v0, s[8:11], s57 offen sc1
  v_exp_f32 v197, v197
  v_exp_f32 v198, v198
  v_exp_f32 v199, v199
  v_exp_f32 v200, v200
  v_exp_f32 v201, v201
  v_smfmac_f32_32x32x32_bf16 v[128:143], v[236:239], v[192:199], v2
  buffer_load_dwordx4 a[168:171], v0, s[8:11], s56 offen offset:2048 sc1
  v_exp_f32 v202, v202
  v_exp_f32 v203, v203
  v_exp_f32 v204, v204
  v_exp_f32 v205, v205
  v_exp_f32 v206, v206
  v_exp_f32 v207, v207
  v_exp_f32 v176, v176
  v_exp_f32 v177, v177
  v_smfmac_f32_32x32x32_bf16 v[128:143], v[240:243], v[200:207], v2
  buffer_load_dwordx4 v[232:235], v0, s[8:11], s3 offen offset:2048 sc1
  v_exp_f32 v178, v178
  v_exp_f32 v179, v179
  v_exp_f32 v180, v180
  v_mfma_f32_32x32x16_bf16 v[192:207], v[208:211], v[148:151], 0
  buffer_load_dwordx4 a[172:175], v0, s[8:11], s57 offen offset:2048 sc1
  v_exp_f32 v181, v181
  v_exp_f32 v182, v182
  v_exp_f32 v183, v183
  v_exp_f32 v184, v184
  v_exp_f32 v185, v185
  v_smfmac_f32_32x32x32_bf16 v[16:31], v[212:215], v[176:183], v2
  s_mov_b64 exec, s[60:61]
  buffer_load_dwordx4 v[236:239], v252, s[8:11], s3 offen offset:3072 sc1
  buffer_load_dwordx4 v[240:243], v252, s[8:11], s3 offen offset:3584 sc1
  s_mov_b64 exec, -1
  v_exp_f32 v186, v186
  v_exp_f32 v187, v187
  v_exp_f32 v188, v188
  v_exp_f32 v189, v189
  v_exp_f32 v190, v190
  v_exp_f32 v191, v191
  v_exp_f32 v192, v192
  v_exp_f32 v193, v193
  v_smfmac_f32_32x32x32_bf16 v[16:31], v[216:219], v[184:191], v2
  s_add_u32 s56, s56, 4096
  s_add_u32 s57, s57, 4096
  buffer_load_dwordx4 a[176:179], v0, s[8:11], s56 offen sc1
  v_exp_f32 v194, v194
  v_exp_f32 v195, v195
  v_exp_f32 v196, v196
  v_mfma_f32_32x32x16_bf16 v[176:191], v[208:211], v[152:155], 0
  buffer_load_dwordx4 a[180:183], v0, s[8:11], s57 offen sc1
  v_exp_f32 v197, v197
  v_exp_f32 v198, v198
  v_exp_f32 v199, v199
  v_exp_f32 v200, v200
  v_exp_f32 v201, v201
  v_smfmac_f32_32x32x32_bf16 v[32:47], v[212:215], v[192:199], v2
  v_exp_f32 v202, v202
  v_exp_f32 v203, v203
  v_exp_f32 v204, v204
  v_exp_f32 v205, v205
  v_exp_f32 v206, v206
  v_exp_f32 v207, v207
  v_exp_f32 v176, v176
  v_exp_f32 v177, v177
  v_smfmac_f32_32x32x32_bf16 v[32:47], v[216:219], v[200:207], v2
  buffer_load_dwordx4 a[184:187], v0, s[8:11], s56 offen offset:2048 sc1
  v_exp_f32 v178, v178
  v_exp_f32 v179, v179
  v_exp_f32 v180, v180
  v_mfma_f32_32x32x16_bf16 v[192:207], v[208:211], v[156:159], 0
  buffer_load_dwordx4 a[188:191], v0, s[8:11], s57 offen offset:2048 sc1
  v_exp_f32 v181, v181
  v_exp_f32 v182, v182
  v_exp_f32 v183, v183
  v_exp_f32 v184, v184
  v_exp_f32 v185, v185
  v_smfmac_f32_32x32x32_bf16 v[48:63], v[212:215], v[176:183], v2
  v_exp_f32 v186, v186
  v_exp_f32 v187, v187
  v_exp_f32 v188, v188
  v_exp_f32 v189, v189
  v_exp_f32 v190, v190
  v_exp_f32 v191, v191
  v_exp_f32 v192, v192
  v_exp_f32 v193, v193
  v_smfmac_f32_32x32x32_bf16 v[48:63], v[216:219], v[184:191], v2
  s_add_u32 s56, s56, 4096
  s_add_u32 s57, s57, 4096
  buffer_load_dwordx4 a[192:195], v0, s[8:11], s56 offen sc1
  v_exp_f32 v194, v194
  v_exp_f32 v195, v195
  v_exp_f32 v196, v196
  v_mfma_f32_32x32x16_bf16 v[176:191], v[208:211], v[160:163], 0
  buffer_load_dwordx4 a[196:199], v0, s[8:11], s57 offen sc1
  v_exp_f32 v197, v197
  v_exp_f32 v198, v198
  v_exp_f32 v199, v199
  v_exp_f32 v200, v200
  v_exp_f32 v201, v201
  v_smfmac_f32_32x32x32_bf16 v[64:79], v[212:215], v[192:199], v2
  v_exp_f32 v202, v202
  v_exp_f32 v203, v203
  v_exp_f32 v204, v204
  v_exp_f32 v205, v205
  v_exp_f32 v206, v206
  v_exp_f32 v207, v207
  v_exp_f32 v176, v176
  v_exp_f32 v177, v177
  v_smfmac_f32_32x32x32_bf16 v[64:79], v[216:219], v[200:207], v2
  buffer_load_dwordx4 a[200:203], v0, s[8:11], s56 offen offset:2048 sc1
  v_exp_f32 v178, v178
  v_exp_f32 v179, v179
  v_exp_f32 v180, v180
  v_mfma_f32_32x32x16_bf16 v[192:207], v[208:211], v[164:167], 0
  v_exp_f32 v181, v181
  v_exp_f32 v182, v182
  v_exp_f32 v183, v183
  v_exp_f32 v184, v184
  v_exp_f32 v185, v185
  v_smfmac_f32_32x32x32_bf16 v[80:95], v[212:215], v[176:183], v2
  buffer_load_dwordx4 a[204:207], v0, s[8:11], s57 offen offset:2048 sc1
  v_exp_f32 v186, v186
  v_exp_f32 v187, v187
  v_exp_f32 v188, v188
  v_exp_f32 v189, v189
  v_exp_f32 v190, v190
  v_exp_f32 v191, v191
  v_exp_f32 v192, v192
  v_exp_f32 v193, v193
  v_smfmac_f32_32x32x32_bf16 v[80:95], v[216:219], v[184:191], v2
  s_add_u32 s56, s56, 4096
  s_add_u32 s57, s57, 4096
  buffer_load_dwordx4 a[208:211], v0, s[8:11], s56 offen sc1
  v_exp_f32 v194, v194
  v_exp_f32 v195, v195
  v_exp_f32 v196, v196
  v_mfma_f32_32x32x16_bf16 v[176:191], v[208:211], v[168:171], 0
  v_exp_f32 v197, v197
  v_exp_f32 v198, v198
  v_exp_f32 v199, v199
  v_exp_f32 v200, v200
  v_exp_f32 v201, v201
  v_smfmac_f32_32x32x32_bf16 v[96:111], v[212:215], v[192:199], v2
  buffer_load_dwordx4 a[212:215], v0, s[8:11], s57 offen sc1
  v_exp_f32 v202, v202
  v_exp_f32 v203, v203
  v_exp_f32 v204, v204
  v_exp_f32 v205, v205
  v_exp_f32 v206, v206
  v_exp_f32 v207, v207
  v_exp_f32 v176, v176
  v_exp_f32 v177, v177
  v_smfmac_f32_32x32x32_bf16 v[96:111], v[216:219], v[200:207], v2
  s_and_b32 s46, s100, 12288
  s_cbranch_scc1 L_gslow_41
L_gjoin_42:
  v_exp_f32 v178, v178
  v_exp_f32 v179, v179
  v_exp_f32 v180, v180
  v_mfma_f32_32x32x16_bf16 v[192:207], v[208:211], v[172:175], 0
  buffer_load_dwordx4 a[216:219], v0, s[8:11], s56 offen offset:2048 sc1
  v_exp_f32 v181, v181
  v_exp_f32 v182, v182
  v_exp_f32 v183, v183
  v_exp_f32 v184, v184
  v_exp_f32 v185, v185
  v_smfmac_f32_32x32x32_bf16 v[112:127], v[212:215], v[176:183], v2
  s_add_u32 s3, s36, 6
  s_and_b32 s3, s3, 7
  v_exp_f32 v186, v186
  v_exp_f32 v187, v187
  v_exp_f32 v188, v188
  v_exp_f32 v189, v189
  v_exp_f32 v190, v190
  v_exp_f32 v191, v191
  v_exp_f32 v192, v192
  v_exp_f32 v193, v193
  v_smfmac_f32_32x32x32_bf16 v[112:127], v[216:219], v[184:191], v2
  s_waitcnt vmcnt(31)
  v_exp_f32 v194, v194
  v_exp_f32 v195, v195
  v_exp_f32 v196, v196
  v_mfma_f32_32x32x16_bf16 v[176:191], v[220:223], v[144:147], 0
  buffer_load_dwordx4 a[220:223], v0, s[8:11], s57 offen offset:2048 sc1
  v_exp_f32 v197, v197
  v_exp_f32 v198, v198
  v_exp_f32 v199, v199
  v_exp_f32 v200, v200
  v_exp_f32 v201, v201
  v_smfmac_f32_32x32x32_bf16 v[128:143], v[212:215], v[192:199], v2
  s_lshl_b32 s3, s3, 14
  s_add_u32 s3, s3, s6
  v_exp_f32 v202, v202
  v_exp_f32 v203, v203
  v_exp_f32 v204, v204
  v_exp_f32 v205, v205
  v_exp_f32 v206, v206
  v_exp_f32 v207, v207
  v_exp_f32 v176, v176
  v_exp_f32 v177, v177
  v_smfmac_f32_32x32x32_bf16 v[128:143], v[216:219], v[200:207], v2
  buffer_load_dwordx4 v[208:211], v0, s[8:11], s3 offen sc1
  v_exp_f32 v178, v178
  v_exp_f32 v179, v179
  v_exp_f32 v180, v180
  v_mfma_f32_32x32x16_bf16 v[192:207], v[220:223], v[148:151], 0
  v_and_b32 v254, 0x3c0, v0
  v_lshlrev_b32 v254, 1, v254
  v_exp_f32 v181, v181
  v_exp_f32 v182, v182
  v_exp_f32 v183, v183
  v_exp_f32 v184, v184
  v_exp_f32 v185, v185
  v_smfmac_f32_32x32x32_bf16 v[16:31], v[224:227], v[176:183], v2
  s_mov_b64 exec, s[60:61]
  buffer_load_dwordx4 v[212:215], v252, s[8:11], s3 offen offset:1024 sc1
  buffer_load_dwordx4 v[216:219], v252, s[8:11], s3 offen offset:1536 sc1
  s_mov_b64 exec, -1
  v_exp_f32 v186, v186
  v_exp_f32 v187, v187
  v_exp_f32 v188, v188
  v_exp_f32 v189, v189
  v_exp_f32 v190, v190
  v_exp_f32 v191, v191
  v_exp_f32 v192, v192
  v_exp_f32 v193, v193
  v_smfmac_f32_32x32x32_bf16 v[16:31], v[228:231], v[184:191], v2
  s_mul_i32 s52, s40, 7168
  s_lshl_b32 s53, s38, 11
  v_exp_f32 v194, v194
  v_exp_f32 v195, v195
  v_exp_f32 v196, v196
  v_mfma_f32_32x32x16_bf16 v[176:191], v[220:223], v[152:155], 0
  s_add_u32 s52, s52, s53
  s_add_u32 s52, s52, 9699328
  v_exp_f32 v197, v197
  v_exp_f32 v198, v198
  v_exp_f32 v199, v199
  v_exp_f32 v200, v200
  v_exp_f32 v201, v201
  v_smfmac_f32_32x32x32_bf16 v[32:47], v[224:227], v[192:199], v2
  buffer_load_dword v255, v254, s[8:11], s52 offen sc1
  v_exp_f32 v202, v202
  v_exp_f32 v203, v203
  v_exp_f32 v204, v204
  v_exp_f32 v205, v205
  v_exp_f32 v206, v206
  v_exp_f32 v207, v207
  v_exp_f32 v176, v176
  v_exp_f32 v177, v177
  v_smfmac_f32_32x32x32_bf16 v[32:47], v[228:231], v[200:207], v2
  s_mul_i32 s52, s39, 114688
  s_mul_i32 s53, s40, 7168
  v_exp_f32 v178, v178
  v_exp_f32 v179, v179
  v_exp_f32 v180, v180
  v_mfma_f32_32x32x16_bf16 v[192:207], v[220:223], v[156:159], 0
  s_add_u32 s52, s52, s53
  s_add_u32 s52, s52, 14680064
  v_exp_f32 v181, v181
  v_exp_f32 v182, v182
  v_exp_f32 v183, v183
  v_exp_f32 v184, v184
  v_exp_f32 v185, v185
  v_smfmac_f32_32x32x32_bf16 v[48:63], v[224:227], v[176:183], v2
  buffer_load_dword v255, v254, s[8:11], s52 offen sc1
  v_exp_f32 v186, v186
  v_exp_f32 v187, v187
  v_exp_f32 v188, v188
  v_exp_f32 v189, v189
  v_exp_f32 v190, v190
  v_exp_f32 v191, v191
  v_exp_f32 v192, v192
  v_exp_f32 v193, v193
  v_smfmac_f32_32x32x32_bf16 v[48:63], v[228:231], v[184:191], v2
  v_exp_f32 v194, v194
  v_exp_f32 v195, v195
  v_exp_f32 v196, v196
  v_mfma_f32_32x32x16_bf16 v[176:191], v[220:223], v[160:163], 0
  v_exp_f32 v197, v197
  v_exp_f32 v198, v198
  v_exp_f32 v199, v199
  v_exp_f32 v200, v200
  v_exp_f32 v201, v201
  v_smfmac_f32_32x32x32_bf16 v[64:79], v[224:227], v[192:199], v2
  v_exp_f32 v202, v202
  v_exp_f32 v203, v203
  v_exp_f32 v204, v204
  v_exp_f32 v205, v205
  v_exp_f32 v206, v206
  v_exp_f32 v207, v207
  v_exp_f32 v176, v176
  v_exp_f32 v177, v177
  v_smfmac_f32_32x32x32_bf16 v[64:79], v[228:231], v[200:207], v2
  v_exp_f32 v178, v178
  v_exp_f32 v179, v179
  v_exp_f32 v180, v180
  v_mfma_f32_32x32x16_bf16 v[192:207], v[220:223], v[164:167], 0
  v_exp_f32 v181, v181
  v_exp_f32 v182, v182
  v_exp_f32 v183, v183
  v_exp_f32 v184, v184
  v_exp_f32 v185, v185
  v_smfmac_f32_32x32x32_bf16 v[80:95], v[224:227], v[176:183], v2
  buffer_load_dword v255, v254, s[8:11], s52 offen offset:2048 sc1
  v_exp_f32 v186, v186
  v_exp_f32 v187, v187
  v_exp_f32 v188, v188
  v_exp_f32 v189, v189
  v_exp_f32 v190, v190
  v_exp_f32 v191, v191
  v_exp_f32 v192, v192
  v_exp_f32 v193, v193
  v_smfmac_f32_32x32x32_bf16 v[80:95], v[228:231], v[184:191], v2
  v_exp_f32 v194, v194
  v_exp_f32 v195, v195
  v_exp_f32 v196, v196
  v_mfma_f32_32x32x16_bf16 v[176:191], v[220:223], v[168:171], 0
  v_exp_f32 v197, v197
  v_exp_f32 v198, v198
  v_exp_f32 v199, v199
  v_exp_f32 v200, v200
  v_exp_f32 v201, v201
  v_smfmac_f32_32x32x32_bf16 v[96:111], v[224:227], v[192:199], v2
  v_exp_f32 v202, v202
  v_exp_f32 v203, v203
  v_exp_f32 v204, v204
  v_exp_f32 v205, v205
  v_exp_f32 v206, v206
  v_exp_f32 v207, v207
  v_exp_f32 v176, v176
  v_exp_f32 v177, v177
  v_smfmac_f32_32x32x32_bf16 v[96:111], v[228:231], v[200:207], v2
  v_exp_f32 v178, v178
  v_exp_f32 v179, v179
  v_exp_f32 v180, v180
  v_mfma_f32_32x32x16_bf16 v[192:207], v[220:223], v[172:175], 0
  v_exp_f32 v181, v181
  v_exp_f32 v182, v182
  v_exp_f32 v183, v183
  v_exp_f32 v184, v184
  v_exp_f32 v185, v185
  v_smfmac_f32_32x32x32_bf16 v[112:127], v[224:227], v[176:183], v2
  v_exp_f32 v186, v186
  v_exp_f32 v187, v187
  v_exp_f32 v188, v188
  v_exp_f32 v189, v189
  v_exp_f32 v190, v190
  v_exp_f32 v191, v191
  v_exp_f32 v192, v192
  v_exp_f32 v193, v193
  v_smfmac_f32_32x32x32_bf16 v[112:127], v[228:231], v[184:191], v2
  s_waitcnt vmcnt(18)
  v_exp_f32 v194, v194
  v_exp_f32 v195, v195
  v_exp_f32 v196, v196
  v_mfma_f32_32x32x16_bf16 v[176:191], v[232:235], v[144:147], 0
  v_exp_f32 v197, v197
  v_exp_f32 v198, v198
  v_exp_f32 v199, v199
  v_exp_f32 v200, v200
  v_exp_f32 v201, v201
  v_smfmac_f32_32x32x32_bf16 v[128:143], v[224:227], v[192:199], v2
  v_exp_f32 v202, v202
  v_exp_f32 v203, v203
  v_exp_f32 v204, v204
  v_exp_f32 v205, v205
  v_exp_f32 v206, v206
  v_exp_f32 v207, v207
  v_exp_f32 v176, v176
  v_exp_f32 v177, v177
  v_smfmac_f32_32x32x32_bf16 v[128:143], v[228:231], v[200:207], v2
  buffer_load_dwordx4 v[220:223], v0, s[8:11], s3 offen offset:2048 sc1
  v_exp_f32 v178, v178
  v_exp_f32 v179, v179
  v_exp_f32 v180, v180
  v_mfma_f32_32x32x16_bf16 v[192:207], v[232:235], v[148:151], 0
  s_add_u32 s52, s52, 4096
  buffer_load_dword v255, v254, s[8:11], s52 offen sc1
  v_exp_f32 v181, v181
  v_exp_f32 v182, v182
  v_exp_f32 v183, v183
  v_exp_f32 v184, v184
  v_exp_f32 v185, v185
  v_smfmac_f32_32x32x32_bf16 v[16:31], v[236:239], v[176:183], v2
  s_mov_b64 exec, s[60:61]
  buffer_load_dwordx4 v[224:227], v252, s[8:11], s3 offen offset:3072 sc1
  buffer_load_dwordx4 v[228:231], v252, s[8:11], s3 offen offset:3584 sc1
  s_mov_b64 exec, -1
  v_exp_f32 v186, v186
  v_exp_f32 v187, v187
  v_exp_f32 v188, v188
  v_exp_f32 v189, v189
  v_exp_f32 v190, v190
  v_exp_f32 v191, v191
  v_exp_f32 v192, v192
  v_exp_f32 v193, v193
  v_smfmac_f32_32x32x32_bf16 v[16:31], v[240:243], v[184:191], v2
  v_exp_f32 v194, v194
  v_exp_f32 v195, v195
  v_exp_f32 v196, v196
  v_mfma_f32_32x32x16_bf16 v[176:191], v[232:235], v[152:155], 0
  v_exp_f32 v197, v197
  v_exp_f32 v198, v198
  v_exp_f32 v199, v199
  v_exp_f32 v200, v200
  v_exp_f32 v201, v201
  v_smfmac_f32_32x32x32_bf16 v[32:47], v[236:239], v[192:199], v2
  v_exp_f32 v202, v202
  v_exp_f32 v203, v203
  v_exp_f32 v204, v204
  v_exp_f32 v205, v205
  v_exp_f32 v206, v206
  v_exp_f32 v207, v207
  v_exp_f32 v176, v176
  v_exp_f32 v177, v177
  v_smfmac_f32_32x32x32_bf16 v[32:47], v[240:243], v[200:207], v2
  v_exp_f32 v178, v178
  v_exp_f32 v179, v179
  v_exp_f32 v180, v180
  v_mfma_f32_32x32x16_bf16 v[192:207], v[232:235], v[156:159], 0
  v_exp_f32 v181, v181
  v_exp_f32 v182, v182
  v_exp_f32 v183, v183
  v_exp_f32 v184, v184
  v_exp_f32 v185, v185
  v_smfmac_f32_32x32x32_bf16 v[48:63], v[236:239], v[176:183], v2
  v_exp_f32 v186, v186
  v_exp_f32 v187, v187
  v_exp_f32 v188, v188
  v_exp_f32 v189, v189
  v_exp_f32 v190, v190
  v_exp_f32 v191, v191
  v_exp_f32 v192, v192
  v_exp_f32 v193, v193
  v_smfmac_f32_32x32x32_bf16 v[48:63], v[240:243], v[184:191], v2
  buffer_load_dword v255, v254, s[8:11], s52 offen offset:2048 sc1
  v_exp_f32 v194, v194
  v_exp_f32 v195, v195
  v_exp_f32 v196, v196
  v_mfma_f32_32x32x16_bf16 v[176:191], v[232:235], v[160:163], 0
  v_exp_f32 v197, v197
  v_exp_f32 v198, v198
  v_exp_f32 v199, v199
  v_exp_f32 v200, v200
  v_exp_f32 v201, v201
  v_smfmac_f32_32x32x32_bf16 v[64:79], v[236:239], v[192:199], v2
  v_exp_f32 v202, v202
  v_exp_f32 v203, v203
  v_exp_f32 v204, v204
  v_exp_f32 v205, v205
  v_exp_f32 v206, v206
  v_exp_f32 v207, v207
  v_exp_f32 v176, v176
  v_exp_f32 v177, v177
  v_smfmac_f32_32x32x32_bf16 v[64:79], v[240:243], v[200:207], v2
  v_exp_f32 v178, v178
  v_exp_f32 v179, v179
  v_exp_f32 v180, v180
  v_mfma_f32_32x32x16_bf16 v[192:207], v[232:235], v[164:167], 0
  v_exp_f32 v181, v181
  v_exp_f32 v182, v182
  v_exp_f32 v183, v183
  v_exp_f32 v184, v184
  v_exp_f32 v185, v185
  v_smfmac_f32_32x32x32_bf16 v[80:95], v[236:239], v[176:183], v2
  v_exp_f32 v186, v186
  v_exp_f32 v187, v187
  v_exp_f32 v188, v188
  v_exp_f32 v189, v189
  v_exp_f32 v190, v190
  v_exp_f32 v191, v191
  v_exp_f32 v192, v192
  v_exp_f32 v193, v193
  v_smfmac_f32_32x32x32_bf16 v[80:95], v[240:243], v[184:191], v2
  v_exp_f32 v194, v194
  v_exp_f32 v195, v195
  v_exp_f32 v196, v196
  v_mfma_f32_32x32x16_bf16 v[176:191], v[232:235], v[168:171], 0
  v_exp_f32 v197, v197
  v_exp_f32 v198, v198
  v_exp_f32 v199, v199
  v_exp_f32 v200, v200
  v_exp_f32 v201, v201
  v_smfmac_f32_32x32x32_bf16 v[96:111], v[236:239], v[192:199], v2
  v_exp_f32 v202, v202
  v_exp_f32 v203, v203
  v_exp_f32 v204, v204
  v_exp_f32 v205, v205
  v_exp_f32 v206, v206
  v_exp_f32 v207, v207
  v_exp_f32 v176, v176
  v_exp_f32 v177, v177
  v_smfmac_f32_32x32x32_bf16 v[96:111], v[240:243], v[200:207], v2
  s_and_b32 s46, s100, 49152
  s_cbranch_scc1 L_gslow_44
L_gjoin_45:
  v_exp_f32 v178, v178
  v_exp_f32 v179, v179
  v_exp_f32 v180, v180
  v_mfma_f32_32x32x16_bf16 v[192:207], v[232:235], v[172:175], 0
  s_lshl_b32 s52, s41, 4
  s_lshl_b32 s53, s44, 1
  v_exp_f32 v181, v181
  v_exp_f32 v182, v182
  v_exp_f32 v183, v183
  v_exp_f32 v184, v184
  v_exp_f32 v185, v185
  v_smfmac_f32_32x32x32_bf16 v[112:127], v[236:239], v[176:183], v2
  s_add_u32 s3, s36, 7
  s_and_b32 s3, s3, 7
  v_exp_f32 v186, v186
  v_exp_f32 v187, v187
  v_exp_f32 v188, v188
  v_exp_f32 v189, v189
  v_exp_f32 v190, v190
  v_exp_f32 v191, v191
  v_exp_f32 v192, v192
  v_exp_f32 v193, v193
  v_smfmac_f32_32x32x32_bf16 v[112:127], v[240:243], v[184:191], v2
  s_waitcnt vmcnt(8)
  v_exp_f32 v194, v194
  v_exp_f32 v195, v195
  v_exp_f32 v196, v196
  v_mfma_f32_32x32x16_bf16 v[176:191], v[208:211], v[144:147], 0
  s_add_u32 s52, s52, s53
  s_add_u32 s52, s52, s43
  v_exp_f32 v197, v197
  v_exp_f32 v198, v198
  v_exp_f32 v199, v199
  v_exp_f32 v200, v200
  v_exp_f32 v201, v201
  v_smfmac_f32_32x32x32_bf16 v[128:143], v[236:239], v[192:199], v2
  s_lshl_b32 s3, s3, 14
  s_add_u32 s3, s3, s6
  v_exp_f32 v202, v202
  v_exp_f32 v203, v203
  v_exp_f32 v204, v204
  v_exp_f32 v205, v205
  v_exp_f32 v206, v206
  v_exp_f32 v207, v207
  v_exp_f32 v176, v176
  v_exp_f32 v177, v177
  v_smfmac_f32_32x32x32_bf16 v[128:143], v[240:243], v[200:207], v2
  buffer_load_dwordx4 v[232:235], v0, s[8:11], s3 offen sc1
  v_exp_f32 v178, v178
  v_exp_f32 v179, v179
  v_exp_f32 v180, v180
  v_mfma_f32_32x32x16_bf16 v[192:207], v[208:211], v[148:151], 0
  s_lshl_b32 s52, s52, 11
  s_add_u32 s52, s52, 12582912
  v_exp_f32 v181, v181
  v_exp_f32 v182, v182
  v_exp_f32 v183, v183
  v_exp_f32 v184, v184
  v_exp_f32 v185, v185
  v_smfmac_f32_32x32x32_bf16 v[16:31], v[212:215], v[176:183], v2
  s_mov_b64 exec, s[60:61]
  buffer_load_dwordx4 v[236:239], v252, s[8:11], s3 offen offset:1024 sc1
  buffer_load_dwordx4 v[240:243], v252, s[8:11], s3 offen offset:1536 sc1
  s_mov_b64 exec, -1
  v_exp_f32 v186, v186
  v_exp_f32 v187, v187
  v_exp_f32 v188, v188
  v_exp_f32 v189, v189
  v_exp_f32 v190, v190
  v_exp_f32 v191, v191
  v_exp_f32 v192, v192
  v_exp_f32 v193, v193
  v_smfmac_f32_32x32x32_bf16 v[16:31], v[216:219], v[184:191], v2
  buffer_load_dword v255, v254, s[8:11], s52 offen sc1
  v_exp_f32 v194, v194
  v_exp_f32 v195, v195
  v_exp_f32 v196, v196
  v_mfma_f32_32x32x16_bf16 v[176:191], v[208:211], v[152:155], 0
  v_exp_f32 v197, v197
  v_exp_f32 v198, v198
  v_exp_f32 v199, v199
  v_exp_f32 v200, v200
  v_exp_f32 v201, v201
  v_smfmac_f32_32x32x32_bf16 v[32:47], v[212:215], v[192:199], v2
  v_exp_f32 v202, v202
  v_exp_f32 v203, v203
  v_exp_f32 v204, v204
  v_exp_f32 v205, v205
  v_exp_f32 v206, v206
  v_exp_f32 v207, v207
  v_exp_f32 v176, v176
  v_exp_f32 v177, v177
  v_smfmac_f32_32x32x32_bf16 v[32:47], v[216:219], v[200:207], v2
  v_exp_f32 v178, v178
  v_exp_f32 v179, v179
  v_exp_f32 v180, v180
  v_mfma_f32_32x32x16_bf16 v[192:207], v[208:211], v[156:159], 0
  s_lshl_b32 s52, s41, 2
  s_lshr_b32 s53, s44, 1
  v_exp_f32 v181, v181
  v_exp_f32 v182, v182
  v_exp_f32 v183, v183
  v_exp_f32 v184, v184
  v_exp_f32 v185, v185
  v_smfmac_f32_32x32x32_bf16 v[48:63], v[212:215], v[176:183], v2
  s_add_u32 s52, s52, s53
  s_lshl_b32 s52, s52, 10
  v_exp_f32 v186, v186
  v_exp_f32 v187, v187
  v_exp_f32 v188, v188
  v_exp_f32 v189, v189
  v_exp_f32 v190, v190
  v_exp_f32 v191, v191
  v_exp_f32 v192, v192
  v_exp_f32 v193, v193
  v_smfmac_f32_32x32x32_bf16 v[48:63], v[216:219], v[184:191], v2
  s_add_u32 s52, s52, 1048576
  v_exp_f32 v194, v194
  v_exp_f32 v195, v195
  v_exp_f32 v196, v196
  v_mfma_f32_32x32x16_bf16 v[176:191], v[208:211], v[160:163], 0
  buffer_load_dword v255, v254, s[8:11], s52 offen sc1
  v_exp_f32 v197, v197
  v_exp_f32 v198, v198
  v_exp_f32 v199, v199
  v_exp_f32 v200, v200
  v_exp_f32 v201, v201
  v_smfmac_f32_32x32x32_bf16 v[64:79], v[212:215], v[192:199], v2
  s_lshl_b32 s52, s36, 2
  s_add_u32 s52, s52, s38
  v_exp_f32 v202, v202
  v_exp_f32 v203, v203
  v_exp_f32 v204, v204
  v_exp_f32 v205, v205
  v_exp_f32 v206, v206
  v_exp_f32 v207, v207
  v_exp_f32 v176, v176
  v_exp_f32 v177, v177
  v_smfmac_f32_32x32x32_bf16 v[64:79], v[216:219], v[200:207], v2
  s_lshl_b32 s52, s52, 6
  s_add_u32 s52, s52, s37
  v_exp_f32 v178, v178
  v_exp_f32 v179, v179
  v_exp_f32 v180, v180
  v_mfma_f32_32x32x16_bf16 v[192:207], v[208:211], v[164:167], 0
  v_and_b32 v7, 0x7c, v1
  s_lshl_b32 s55, s36, 7
  s_add_u32 s55, s55, 90112
  buffer_load_dword v6, v7, s[8:11], s55 offen sc1
  v_exp_f32 v181, v181
  v_exp_f32 v182, v182
  v_exp_f32 v183, v183
  v_exp_f32 v184, v184
  v_exp_f32 v185, v185
  v_smfmac_f32_32x32x32_bf16 v[80:95], v[212:215], v[176:183], v2
  s_lshl_b32 s52, s52, 10
  s_add_u32 s52, s52, 10485760
  v_exp_f32 v186, v186
  v_exp_f32 v187, v187
  v_exp_f32 v188, v188
  v_exp_f32 v189, v189
  v_exp_f32 v190, v190
  v_exp_f32 v191, v191
  v_exp_f32 v192, v192
  v_exp_f32 v193, v193
  v_smfmac_f32_32x32x32_bf16 v[80:95], v[216:219], v[184:191], v2
  buffer_load_dword v255, v254, s[8:11], s52 offen sc1
  v_exp_f32 v194, v194
  v_exp_f32 v195, v195
  v_exp_f32 v196, v196
  v_mfma_f32_32x32x16_bf16 v[176:191], v[208:211], v[168:171], 0
  s_add_u32 s52, s52, 32768
  v_exp_f32 v197, v197
  v_exp_f32 v198, v198
  v_exp_f32 v199, v199
  v_exp_f32 v200, v200
  v_exp_f32 v201, v201
  v_smfmac_f32_32x32x32_bf16 v[96:111], v[212:215], v[192:199], v2
  buffer_load_dword v255, v254, s[8:11], s52 offen sc1
  v_exp_f32 v202, v202
  v_exp_f32 v203, v203
  v_exp_f32 v204, v204
  v_exp_f32 v205, v205
  v_exp_f32 v206, v206
  v_exp_f32 v207, v207
  v_exp_f32 v176, v176
  v_exp_f32 v177, v177
  v_smfmac_f32_32x32x32_bf16 v[96:111], v[216:219], v[200:207], v2
  v_exp_f32 v178, v178
  v_exp_f32 v179, v179
  v_exp_f32 v180, v180
  v_mfma_f32_32x32x16_bf16 v[192:207], v[208:211], v[172:175], 0
  v_exp_f32 v181, v181
  v_exp_f32 v182, v182
  v_exp_f32 v183, v183
  v_exp_f32 v184, v184
  v_exp_f32 v185, v185
  v_smfmac_f32_32x32x32_bf16 v[112:127], v[212:215], v[176:183], v2
  v_exp_f32 v186, v186
  v_exp_f32 v187, v187
  v_exp_f32 v188, v188
  v_exp_f32 v189, v189
  v_exp_f32 v190, v190
  v_exp_f32 v191, v191
  v_exp_f32 v192, v192
  v_exp_f32 v193, v193
  v_smfmac_f32_32x32x32_bf16 v[112:127], v[216:219], v[184:191], v2
  s_waitcnt vmcnt(9)
  v_exp_f32 v194, v194
  v_exp_f32 v195, v195
  v_exp_f32 v196, v196
  v_mfma_f32_32x32x16_bf16 v[176:191], v[220:223], v[144:147], 0
  s_lshl_b32 s56, s44, 16
  s_lshl_b32 s57, s38, 14
  v_exp_f32 v197, v197
  v_exp_f32 v198, v198
  v_exp_f32 v199, v199
  v_exp_f32 v200, v200
  v_exp_f32 v201, v201
  v_smfmac_f32_32x32x32_bf16 v[128:143], v[212:215], v[192:199], v2
  s_add_u32 s56, s56, s57
  s_lshl_b32 s57, s43, 10
  v_exp_f32 v202, v202
  v_exp_f32 v203, v203
  v_exp_f32 v204, v204
  v_exp_f32 v205, v205
  v_exp_f32 v206, v206
  v_exp_f32 v207, v207
  v_exp_f32 v176, v176
  v_exp_f32 v177, v177
  v_smfmac_f32_32x32x32_bf16 v[128:143], v[216:219], v[200:207], v2
  buffer_load_dwordx4 v[208:211], v0, s[8:11], s3 offen offset:2048 sc1
  v_exp_f32 v178, v178
  v_exp_f32 v179, v179
  v_exp_f32 v180, v180
  v_mfma_f32_32x32x16_bf16 v[192:207], v[220:223], v[148:151], 0
  s_add_u32 s56, s56, s57
  s_add_u32 s56, s56, 3670016
  v_exp_f32 v181, v181
  v_exp_f32 v182, v182
  v_exp_f32 v183, v183
  v_exp_f32 v184, v184
  v_exp_f32 v185, v185
  v_smfmac_f32_32x32x32_bf16 v[16:31], v[224:227], v[176:183], v2
  s_mov_b64 exec, s[60:61]
  buffer_load_dwordx4 v[212:215], v252, s[8:11], s3 offen offset:3072 sc1
  buffer_load_dwordx4 v[216:219], v252, s[8:11], s3 offen offset:3584 sc1
  s_mov_b64 exec, -1
  v_exp_f32 v186, v186
  v_exp_f32 v187, v187
  v_exp_f32 v188, v188
  v_exp_f32 v189, v189
  v_exp_f32 v190, v190
  v_exp_f32 v191, v191
  v_exp_f32 v192, v192
  v_exp_f32 v193, v193
  v_smfmac_f32_32x32x32_bf16 v[16:31], v[228:231], v[184:191], v2
  s_xor_b32 s57, s56, 1024
  v_exp_f32 v194, v194
  v_exp_f32 v195, v195
  v_exp_f32 v196, v196
  v_mfma_f32_32x32x16_bf16 v[176:191], v[220:223], v[152:155], 0
  s_waitcnt vmcnt(5)
  v_cmp_eq_u32 vcc, 0, v6
  s_nop 0
  s_cbranch_vccnz L_lslow_47
L_ljoin_48:
  v_readfirstlane_b32 s55, v6
  s_nop 1
  v_cmp_ne_u32 vcc, s55, v6
  s_nop 1
  s_cmp_lg_u64 vcc, 0
  s_cselect_b32 s45, 1, 0
  v_exp_f32 v197, v197
  v_exp_f32 v198, v198
  v_exp_f32 v199, v199
  v_exp_f32 v200, v200
  v_exp_f32 v201, v201
  v_smfmac_f32_32x32x32_bf16 v[32:47], v[224:227], v[192:199], v2
  buffer_load_dwordx4 a[224:227], v0, s[8:11], s56 offen sc1
  v_exp_f32 v202, v202
  v_exp_f32 v203, v203
  v_exp_f32 v204, v204
  v_exp_f32 v205, v205
  v_exp_f32 v206, v206
  v_exp_f32 v207, v207
  v_exp_f32 v176, v176
  v_exp_f32 v177, v177
  v_smfmac_f32_32x32x32_bf16 v[32:47], v[228:231], v[200:207], v2
  buffer_load_dwordx4 a[228:231], v0, s[8:11], s57 offen sc1
  v_exp_f32 v178, v178
  v_exp_f32 v179, v179
  v_exp_f32 v180, v180
  v_mfma_f32_32x32x16_bf16 v[192:207], v[220:223], v[156:159], 0
  buffer_load_dwordx4 a[232:235], v0, s[8:11], s56 offen offset:2048 sc1
  v_exp_f32 v181, v181
  v_exp_f32 v182, v182
  v_exp_f32 v183, v183
  v_exp_f32 v184, v184
  v_exp_f32 v185, v185
  v_smfmac_f32_32x32x32_bf16 v[48:63], v[224:227], v[176:183], v2
  buffer_load_dwordx4 a[236:239], v0, s[8:11], s57 offen offset:2048 sc1
  v_exp_f32 v186, v186
  v_exp_f32 v187, v187
  v_exp_f32 v188, v188
  v_exp_f32 v189, v189
  v_exp_f32 v190, v190
  v_exp_f32 v191, v191
  v_exp_f32 v192, v192
  v_exp_f32 v193, v193
  v_smfmac_f32_32x32x32_bf16 v[48:63], v[228:231], v[184:191], v2
  s_add_u32 s56, s56, 4096
  s_add_u32 s57, s57, 4096
  buffer_load_dwordx4 a[240:243], v0, s[8:11], s56 offen sc1
  v_exp_f32 v194, v194
  v_exp_f32 v195, v195
  v_exp_f32 v196, v196
  v_mfma_f32_32x32x16_bf16 v[176:191], v[220:223], v[160:163], 0
  buffer_load_dwordx4 a[244:247], v0, s[8:11], s57 offen sc1
  v_exp_f32 v197, v197
  v_exp_f32 v198, v198
  v_exp_f32 v199, v199
  v_exp_f32 v200, v200
  v_exp_f32 v201, v201
  v_smfmac_f32_32x32x32_bf16 v[64:79], v[224:227], v[192:199], v2
  buffer_load_dwordx4 a[248:251], v0, s[8:11], s56 offen offset:2048 sc1
  v_exp_f32 v202, v202
  v_exp_f32 v203, v203
  v_exp_f32 v204, v204
  v_exp_f32 v205, v205
  v_exp_f32 v206, v206
  v_exp_f32 v207, v207
  v_exp_f32 v176, v176
  v_exp_f32 v177, v177
  v_smfmac_f32_32x32x32_bf16 v[64:79], v[228:231], v[200:207], v2
  buffer_load_dwordx4 a[252:255], v0, s[8:11], s57 offen offset:2048 sc1
  v_exp_f32 v178, v178
  v_exp_f32 v179, v179
  v_exp_f32 v180, v180
  v_mfma_f32_32x32x16_bf16 v[192:207], v[220:223], v[164:167], 0
  v_exp_f32 v181, v181
  v_exp_f32 v182, v182
  v_exp_f32 v183, v183
  v_exp_f32 v184, v184
  v_exp_f32 v185, v185
  v_smfmac_f32_32x32x32_bf16 v[80:95], v[224:227], v[176:183], v2
  v_exp_f32 v186, v186
  v_exp_f32 v187, v187
  v_exp_f32 v188, v188
  v_exp_f32 v189, v189
  v_exp_f32 v190, v190
  v_exp_f32 v191, v191
  v_exp_f32 v192, v192
  v_exp_f32 v193, v193
  v_smfmac_f32_32x32x32_bf16 v[80:95], v[228:231], v[184:191], v2
  v_exp_f32 v194, v194
  v_exp_f32 v195, v195
  v_exp_f32 v196, v196
  v_mfma_f32_32x32x16_bf16 v[176:191], v[220:223], v[168:171], 0
  v_exp_f32 v197, v197
  v_exp_f32 v198, v198
  v_exp_f32 v199, v199
  v_exp_f32 v200, v200
  v_exp_f32 v201, v201
  v_smfmac_f32_32x32x32_bf16 v[96:111], v[224:227], v[192:199], v2
  v_exp_f32 v202, v202
  v_exp_f32 v203, v203
  v_exp_f32 v204, v204
  v_exp_f32 v205, v205
  v_exp_f32 v206, v206
  v_exp_f32 v207, v207
  v_exp_f32 v176, v176
  v_exp_f32 v177, v177
  v_smfmac_f32_32x32x32_bf16 v[96:111], v[228:231], v[200:207], v2
  s_getpc_b64 s[4:5]
L_pc_50:
  s_lshl_b32 s46, s37, 2
  s_add_u32 s46, s46, s38
  s_and_b32 s46, s46, 7
  s_lshl_b32 s46, s46, 11
  s_add_u32 s46, s46, 512
  v_lshrrev_b32 v6, 6, v0
  v_lshl_add_u32 v6, v6, 7, s46
  v_min_u32 v6, L_end-L_pc_50-4, v6
  global_load_dword v255, v6, s[4:5]
  v_exp_f32 v178, v178
  v_exp_f32 v179, v179
  v_exp_f32 v180, v180
  v_mfma_f32_32x32x16_bf16 v[192:207], v[220:223], v[172:175], 0
  v_exp_f32 v181, v181
  v_exp_f32 v182, v182
  v_exp_f32 v183, v183
  v_exp_f32 v184, v184
  v_exp_f32 v185, v185
  v_smfmac_f32_32x32x32_bf16 v[112:127], v[224:227], v[176:183], v2
  v_exp_f32 v186, v186
  v_exp_f32 v187, v187
  v_exp_f32 v188, v188
  v_exp_f32 v189, v189
  v_exp_f32 v190, v190
  v_exp_f32 v191, v191
  v_exp_f32 v192, v192
  v_exp_f32 v193, v193
  v_smfmac_f32_32x32x32_bf16 v[112:127], v[228:231], v[184:191], v2
  v_exp_f32 v194, v194
  v_exp_f32 v195, v195
  v_exp_f32 v196, v196
  v_mfma_f32_32x32x16_bf16 v[176:191], v[232:235], v[144:147], 0
  v_exp_f32 v197, v197
  v_exp_f32 v198, v198
  v_exp_f32 v199, v199
  v_exp_f32 v200, v200
  v_exp_f32 v201, v201
  v_smfmac_f32_32x32x32_bf16 v[128:143], v[224:227], v[192:199], v2
  v_exp_f32 v202, v202
  v_exp_f32 v203, v203
  v_exp_f32 v204, v204
  v_exp_f32 v205, v205
  v_exp_f32 v206, v206
  v_exp_f32 v207, v207
  v_exp_f32 v176, v176
  v_exp_f32 v177, v177
  v_smfmac_f32_32x32x32_bf16 v[128:143], v[228:231], v[200:207], v2
  s_waitcnt vmcnt(9)
  v_exp_f32 v178, v178
  v_exp_f32 v179, v179
  v_exp_f32 v180, v180
  v_mfma_f32_32x32x16_bf16 v[192:207], v[208:211], v[144:147], 0
  s_add_u32 s48, s38, 1
  s_and_b32 s48, s48, 3
  v_exp_f32 v181, v181
  v_exp_f32 v182, v182
  v_exp_f32 v183, v183
  v_exp_f32 v184, v184
  v_exp_f32 v185, v185
  v_smfmac_f32_32x32x32_bf16 v[16:31], v[236:239], v[176:183], v2
  s_mul_i32 s48, s48, 6
  s_add_u32 s48, s48, 0
  v_exp_f32 v186, v186
  v_exp_f32 v187, v187
  v_exp_f32 v188, v188
  v_exp_f32 v189, v189
  v_exp_f32 v190, v190
  v_exp_f32 v191, v191
  v_exp_f32 v192, v192
  v_exp_f32 v193, v193
  v_smfmac_f32_32x32x32_bf16 v[16:31], v[240:243], v[184:191], v2
  s_add_u32 s56, s56, 4096
  s_add_u32 s57, s57, 4096
  buffer_load_dwordx4 v[220:223], v0, s[8:11], s56 offen sc1
  v_exp_f32 v194, v194
  v_exp_f32 v195, v195
  v_exp_f32 v196, v196
  v_mfma_f32_32x32x16_bf16 v[176:191], v[232:235], v[148:151], 0
  buffer_load_dwordx4 v[224:227], v0, s[8:11], s57 offen sc1
  v_exp_f32 v197, v197
  v_exp_f32 v198, v198
  v_exp_f32 v199, v199
  v_exp_f32 v200, v200
  v_exp_f32 v201, v201
  v_smfmac_f32_32x32x32_bf16 v[16:31], v[212:215], v[192:199], v2
  buffer_load_dwordx4 v[228:231], v0, s[8:11], s56 offen offset:2048 sc1
  v_exp_f32 v202, v202
  v_exp_f32 v203, v203
  v_exp_f32 v204, v204
  v_exp_f32 v205, v205
  v_exp_f32 v206, v206
  v_exp_f32 v207, v207
  v_exp_f32 v176, v176
  v_exp_f32 v177, v177
  v_smfmac_f32_32x32x32_bf16 v[16:31], v[216:219], v[200:207], v2
  s_lshl_b32 s49, s48, 11
  s_add_u32 s49, s49, 106496
  v_add_u32 v4, s49, v0
  v_exp_f32 v178, v178
  v_exp_f32 v179, v179
  v_exp_f32 v180, v180
  v_mfma_f32_32x32x16_bf16 v[192:207], v[208:211], v[148:151], 0
  buffer_load_dwordx4 v[244:247], v0, s[8:11], s57 offen offset:2048 sc1
  v_exp_f32 v181, v181
  v_exp_f32 v182, v182
  v_exp_f32 v183, v183
  v_exp_f32 v184, v184
  v_exp_f32 v185, v185
  v_smfmac_f32_32x32x32_bf16 v[32:47], v[236:239], v[176:183], v2
  s_lshl_b32 s49, s48, 8
  s_add_u32 s49, s49, 155648
  v_add_u32 v6, s49, v1
  v_exp_f32 v186, v186
  v_exp_f32 v187, v187
  v_exp_f32 v188, v188
  v_exp_f32 v189, v189
  v_exp_f32 v190, v190
  v_exp_f32 v191, v191
  v_exp_f32 v192, v192
  v_exp_f32 v193, v193
  v_smfmac_f32_32x32x32_bf16 v[32:47], v[240:243], v[184:191], v2
  ds_write_b128 v4, v[16:19] offset:0
  v_exp_f32 v194, v194
  v_exp_f32 v195, v195
  v_exp_f32 v196, v196
  v_mfma_f32_32x32x16_bf16 v[176:191], v[232:235], v[152:155], 0
  ds_write_b32 v6, v24 offset:0
  v_exp_f32 v197, v197
  v_exp_f32 v198, v198
  v_exp_f32 v199, v199
  v_exp_f32 v200, v200
  v_exp_f32 v201, v201
  v_smfmac_f32_32x32x32_bf16 v[32:47], v[212:215], v[192:199], v2
  ds_write_b128 v4, v[20:23] offset:1024
  v_exp_f32 v202, v202
  v_exp_f32 v203, v203
  v_exp_f32 v204, v204
  v_exp_f32 v205, v205
  v_exp_f32 v206, v206
  v_exp_f32 v207, v207
  v_exp_f32 v176, v176
  v_exp_f32 v177, v177
  v_smfmac_f32_32x32x32_bf16 v[32:47], v[216:219], v[200:207], v2
  s_add_u32 s56, s56, 4096
  s_add_u32 s57, s57, 4096
  buffer_load_dwordx4 v[248:251], v0, s[8:11], s56 offen sc1
  v_exp_f32 v178, v178
  v_exp_f32 v179, v179
  v_exp_f32 v180, v180
  v_mfma_f32_32x32x16_bf16 v[192:207], v[208:211], v[152:155], 0
  s_add_u32 s48, s38, 2
  s_and_b32 s48, s48, 3
  v_exp_f32 v181, v181
  v_exp_f32 v182, v182
  v_exp_f32 v183, v183
  v_exp_f32 v184, v184
  v_exp_f32 v185, v185
  v_smfmac_f32_32x32x32_bf16 v[48:63], v[236:239], v[176:183], v2
  s_mul_i32 s48, s48, 6
  s_add_u32 s48, s48, 2
  v_exp_f32 v186, v186
  v_exp_f32 v187, v187
  v_exp_f32 v188, v188
  v_exp_f32 v189, v189
  v_exp_f32 v190, v190
  v_exp_f32 v191, v191
  v_exp_f32 v192, v192
  v_exp_f32 v193, v193
  v_smfmac_f32_32x32x32_bf16 v[48:63], v[240:243], v[184:191], v2
  ds_write_b128 v4, v[32:35] offset:2048
  v_exp_f32 v194, v194
  v_exp_f32 v195, v195
  v_exp_f32 v196, v196
  v_mfma_f32_32x32x16_bf16 v[176:191], v[232:235], v[156:159], 0
  ds_write_b32 v6, v40 offset:256
  v_exp_f32 v197, v197
  v_exp_f32 v198, v198
  v_exp_f32 v199, v199
  v_exp_f32 v200, v200
  v_exp_f32 v201, v201
  v_smfmac_f32_32x32x32_bf16 v[48:63], v[212:215], v[192:199], v2
  ds_write_b128 v4, v[36:39] offset:3072
  v_exp_f32 v202, v202
  v_exp_f32 v203, v203
  v_exp_f32 v204, v204
  v_exp_f32 v205, v205
  v_exp_f32 v206, v206
  v_exp_f32 v207, v207
  v_exp_f32 v176, v176
  v_exp_f32 v177, v177
  v_smfmac_f32_32x32x32_bf16 v[48:63], v[216:219], v[200:207], v2
  s_lshl_b32 s49, s48, 11
  s_add_u32 s49, s49, 106496
  v_add_u32 v5, s49, v0
  v_exp_f32 v178, v178
  v_exp_f32 v179, v179
  v_exp_f32 v180, v180
  v_mfma_f32_32x32x16_bf16 v[192:207], v[208:211], v[156:159], 0
  buffer_load_dwordx4 v[144:147], v0, s[8:11], s57 offen sc1
  v_exp_f32 v181, v181
  v_exp_f32 v182, v182
  v_exp_f32 v183, v183
  v_exp_f32 v184, v184
  v_exp_f32 v185, v185
  v_smfmac_f32_32x32x32_bf16 v[64:79], v[236:239], v[176:183], v2
  s_lshl_b32 s49, s48, 8
  s_add_u32 s49, s49, 155648
  v_add_u32 v7, s49, v1
  v_exp_f32 v186, v186
  v_exp_f32 v187, v187
  v_exp_f32 v188, v188
  v_exp_f32 v189, v189
  v_exp_f32 v190, v190
  v_exp_f32 v191, v191
  v_exp_f32 v192, v192
  v_exp_f32 v193, v193
  v_smfmac_f32_32x32x32_bf16 v[64:79], v[240:243], v[184:191], v2
  ds_write_b128 v5, v[48:51] offset:0
  v_exp_f32 v194, v194
  v_exp_f32 v195, v195
  v_exp_f32 v196, v196
  v_mfma_f32_32x32x16_bf16 v[176:191], v[232:235], v[160:163], 0
  ds_write_b32 v7, v56 offset:0
  v_exp_f32 v197, v197
  v_exp_f32 v198, v198
  v_exp_f32 v199, v199
  v_exp_f32 v200, v200
  v_exp_f32 v201, v201
  v_smfmac_f32_32x32x32_bf16 v[64:79], v[212:215], v[192:199], v2
  ds_write_b128 v5, v[52:55] offset:1024
  v_exp_f32 v202, v202
  v_exp_f32 v203, v203
  v_exp_f32 v204, v204
  v_exp_f32 v205, v205
  v_exp_f32 v206, v206
  v_exp_f32 v207, v207
  v_exp_f32 v176, v176
  v_exp_f32 v177, v177
  v_smfmac_f32_32x32x32_bf16 v[64:79], v[216:219], v[200:207], v2
  buffer_load_dwordx4 v[148:151], v0, s[8:11], s56 offen offset:2048 sc1
  v_exp_f32 v178, v178
  v_exp_f32 v179, v179
  v_exp_f32 v180, v180
  v_mfma_f32_32x32x16_bf16 v[192:207], v[208:211], v[160:163], 0
  s_add_u32 s48, s38, 3
  s_and_b32 s48, s48, 3
  v_exp_f32 v181, v181
  v_exp_f32 v182, v182
  v_exp_f32 v183, v183
  v_exp_f32 v184, v184
  v_exp_f32 v185, v185
  v_smfmac_f32_32x32x32_bf16 v[80:95], v[236:239], v[176:183], v2
  s_mul_i32 s48, s48, 6
  s_add_u32 s48, s48, 4
  v_exp_f32 v186, v186
  v_exp_f32 v187, v187
  v_exp_f32 v188, v188
  v_exp_f32 v189, v189
  v_exp_f32 v190, v190
  v_exp_f32 v191, v191
  v_exp_f32 v192, v192
  v_exp_f32 v193, v193
  v_smfmac_f32_32x32x32_bf16 v[80:95], v[240:243], v[184:191], v2
  ds_write_b128 v5, v[64:67] offset:2048
  v_exp_f32 v194, v194
  v_exp_f32 v195, v195
  v_exp_f32 v196, v196
  v_mfma_f32_32x32x16_bf16 v[176:191], v[232:235], v[164:167], 0
  ds_write_b32 v7, v72 offset:256
  v_exp_f32 v197, v197
  v_exp_f32 v198, v198
  v_exp_f32 v199, v199
  v_exp_f32 v200, v200
  v_exp_f32 v201, v201
  v_smfmac_f32_32x32x32_bf16 v[80:95], v[212:215], v[192:199], v2
  ds_write_b128 v5, v[68:71] offset:3072
  v_exp_f32 v202, v202
  v_exp_f32 v203, v203
  v_exp_f32 v204, v204
  v_exp_f32 v205, v205
  v_exp_f32 v206, v206
  v_exp_f32 v207, v207
  v_exp_f32 v176, v176
  v_exp_f32 v177, v177
  v_smfmac_f32_32x32x32_bf16 v[80:95], v[216:219], v[200:207], v2
  s_lshl_b32 s49, s48, 11
  s_add_u32 s49, s49, 106496
  v_add_u32 v4, s49, v0
  v_exp_f32 v178, v178
  v_exp_f32 v179, v179
  v_exp_f32 v180, v180
  v_mfma_f32_32x32x16_bf16 v[192:207], v[208:211], v[164:167], 0
  buffer_load_dwordx4 v[152:155], v0, s[8:11], s57 offen offset:2048 sc1
  v_exp_f32 v181, v181
  v_exp_f32 v182, v182
  v_exp_f32 v183, v183
  v_exp_f32 v184, v184
  v_exp_f32 v185, v185
  v_smfmac_f32_32x32x32_bf16 v[96:111], v[236:239], v[176:183], v2
  s_lshl_b32 s49, s48, 8
  s_add_u32 s49, s49, 155648
  v_add_u32 v6, s49, v1
  v_exp_f32 v186, v186
  v_exp_f32 v187, v187
  v_exp_f32 v188, v188
  v_exp_f32 v189, v189
  v_exp_f32 v190, v190
  v_exp_f32 v191, v191
  v_exp_f32 v192, v192
  v_exp_f32 v193, v193
  v_smfmac_f32_32x32x32_bf16 v[96:111], v[240:243], v[184:191], v2
  ds_write_b128 v4, v[80:83] offset:0
  v_exp_f32 v194, v194
  v_exp_f32 v195, v195
  v_exp_f32 v196, v196
  v_mfma_f32_32x32x16_bf16 v[176:191], v[232:235], v[168:171], 0
  ds_write_b32 v6, v88 offset:0
  v_exp_f32 v197, v197
  v_exp_f32 v198, v198
  v_exp_f32 v199, v199
  v_exp_f32 v200, v200
  v_exp_f32 v201, v201
  v_smfmac_f32_32x32x32_bf16 v[96:111], v[212:215], v[192:199], v2
  ds_write_b128 v4, v[84:87] offset:1024
  v_exp_f32 v202, v202
  v_exp_f32 v203, v203
  v_exp_f32 v204, v204
  v_exp_f32 v205, v205
  v_exp_f32 v206, v206
  v_exp_f32 v207, v207
  v_exp_f32 v176, v176
  v_exp_f32 v177, v177
  v_smfmac_f32_32x32x32_bf16 v[96:111], v[216:219], v[200:207], v2
  s_mul_i32 s48, s38, 6
  s_lshl_b32 s49, s48, 11
  s_add_u32 s49, s49, 106496
  v_add_u32 v5, s49, v0
  s_lshl_b32 s49, s48, 8
  s_add_u32 s49, s49, 155648
  v_add_u32 v7, s49, v1
  v_exp_f32 v178, v178
  v_exp_f32 v179, v179
  v_exp_f32 v180, v180
  v_mfma_f32_32x32x16_bf16 v[192:207], v[232:235], v[172:175], 0
  v_exp_f32 v181, v181
  v_exp_f32 v182, v182
  v_exp_f32 v183, v183
  v_exp_f32 v184, v184
  v_exp_f32 v185, v185
  v_smfmac_f32_32x32x32_bf16 v[112:127], v[236:239], v[176:183], v2
  s_lshl_b32 s48, s36, 3
  s_lshl_b32 s49, s38, 1
  s_add_u32 s48, s48, s49
  s_lshl_b32 s48, s48, 5
  s_add_u32 s48, s48, s37
  s_lshl_b32 s48, s48, 10
  s_add_u32 s48, s48, 10485760
  s_add_u32 s49, s48, 32768
  v_exp_f32 v186, v186
  v_exp_f32 v187, v187
  v_exp_f32 v188, v188
  v_exp_f32 v189, v189
  v_exp_f32 v190, v190
  v_exp_f32 v191, v191
  v_exp_f32 v192, v192
  v_exp_f32 v193, v193
  v_smfmac_f32_32x32x32_bf16 v[112:127], v[240:243], v[184:191], v2
  ds_write_b128 v4, v[96:99] offset:2048
  v_exp_f32 v194, v194
  v_exp_f32 v195, v195
  v_exp_f32 v196, v196
  v_mfma_f32_32x32x16_bf16 v[176:191], v[208:211], v[168:171], 0
  ds_write_b32 v6, v104 offset:256
  v_exp_f32 v197, v197
  v_exp_f32 v198, v198
  v_exp_f32 v199, v199
  v_exp_f32 v200, v200
  v_exp_f32 v201, v201
  v_smfmac_f32_32x32x32_bf16 v[128:143], v[236:239], v[192:199], v2
  ds_write_b128 v4, v[100:103] offset:3072
  v_exp_f32 v202, v202
  v_exp_f32 v203, v203
  v_exp_f32 v204, v204
  v_exp_f32 v205, v205
  v_exp_f32 v206, v206
  v_exp_f32 v207, v207
  v_exp_f32 v176, v176
  v_exp_f32 v177, v177
  v_smfmac_f32_32x32x32_bf16 v[128:143], v[240:243], v[200:207], v2
  s_waitcnt lgkmcnt(0)
  s_barrier
  v_exp_f32 v178, v178
  v_exp_f32 v179, v179
  v_exp_f32 v180, v180
  v_mfma_f32_32x32x16_bf16 v[192:207], v[208:211], v[172:175], 0
  ds_read_b128 v[16:19], v5 offset:0
  ds_read_b128 v[20:23], v5 offset:1024
  ds_read_b32 v24, v7 offset:0
  v_exp_f32 v181, v181
  v_exp_f32 v182, v182
  v_exp_f32 v183, v183
  v_exp_f32 v184, v184
  v_exp_f32 v185, v185
  v_smfmac_f32_32x32x32_bf16 v[112:127], v[212:215], v[176:183], v2
  ds_read_b128 v[26:29], v5 offset:4096
  ds_read_b128 v[30:33], v5 offset:5120
  ds_read_b32 v34, v7 offset:512
  ds_read_b128 v[36:39], v5 offset:8192
  ds_read_b128 v[40:43], v5 offset:9216
  ds_read_b32 v44, v7 offset:1024
  v_exp_f32 v186, v186
  v_exp_f32 v187, v187
  v_exp_f32 v188, v188
  v_exp_f32 v189, v189
  v_exp_f32 v190, v190
  v_exp_f32 v191, v191
  v_exp_f32 v192, v192
  v_exp_f32 v193, v193
  v_smfmac_f32_32x32x32_bf16 v[112:127], v[216:219], v[184:191], v2
  ds_read_b128 v[46:49], v5 offset:2048
  ds_read_b128 v[50:53], v5 offset:3072
  ds_read_b32 v54, v7 offset:256
  ds_read_b128 v[56:59], v5 offset:6144
  ds_read_b128 v[60:63], v5 offset:7168
  ds_read_b32 v64, v7 offset:768
  v_exp_f32 v194, v194
  v_exp_f32 v195, v195
  v_exp_f32 v196, v196
  ds_read_b128 v[66:69], v5 offset:10240
  ds_read_b128 v[70:73], v5 offset:11264
  ds_read_b32 v74, v7 offset:1280
  v_exp_f32 v197, v197
  v_exp_f32 v198, v198
  v_exp_f32 v199, v199
  v_exp_f32 v200, v200
  v_exp_f32 v201, v201
  v_smfmac_f32_32x32x32_bf16 v[128:143], v[212:215], v[192:199], v2
  v_exp_f32 v202, v202
  v_exp_f32 v203, v203
  v_exp_f32 v204, v204
  v_exp_f32 v205, v205
  v_exp_f32 v206, v206
  v_exp_f32 v207, v207
  s_nop 1
  v_smfmac_f32_32x32x32_bf16 v[128:143], v[216:219], v[200:207], v2
  s_waitcnt lgkmcnt(9)
  v_add_f32 v120, v120, v24
  v_pk_add_f32 v[112:113], v[112:113], v[16:17]
  v_pk_add_f32 v[114:115], v[114:115], v[18:19]
  v_pk_add_f32 v[116:117], v[116:117], v[20:21]
  v_pk_add_f32 v[118:119], v[118:119], v[22:23]
  v_add_f32 v120, v120, v34
  v_pk_add_f32 v[112:113], v[112:113], v[26:27]
  v_pk_add_f32 v[114:115], v[114:115], v[28:29]
  v_pk_add_f32 v[116:117], v[116:117], v[30:31]
  v_pk_add_f32 v[118:119], v[118:119], v[32:33]
  v_add_f32 v120, v120, v44
  v_pk_add_f32 v[112:113], v[112:113], v[36:37]
  v_pk_add_f32 v[114:115], v[114:115], v[38:39]
  v_pk_add_f32 v[116:117], v[116:117], v[40:41]
  v_pk_add_f32 v[118:119], v[118:119], v[42:43]
  v_rcp_f32 v122, v120
  s_nop 0
  v_pk_mul_f32 v[112:113], v[112:113], v[122:123] op_sel_hi:[1,0]
  v_pk_mul_f32 v[114:115], v[114:115], v[122:123] op_sel_hi:[1,0]
  v_pk_mul_f32 v[116:117], v[116:117], v[122:123] op_sel_hi:[1,0]
  v_pk_mul_f32 v[118:119], v[118:119], v[122:123] op_sel_hi:[1,0]
  v_cvt_pk_bf16_f32 v124, v112, v113
  v_cvt_pk_bf16_f32 v125, v114, v115
  v_cvt_pk_bf16_f32 v126, v116, v117
  v_cvt_pk_bf16_f32 v127, v118, v119
  buffer_store_dwordx4 v[124:127], v0, s[8:11], s48 offen
  s_waitcnt lgkmcnt(0)
  v_add_f32 v54, v54, v64
  v_pk_add_f32 v[46:47], v[46:47], v[56:57]
  v_pk_add_f32 v[48:49], v[48:49], v[58:59]
  v_pk_add_f32 v[50:51], v[50:51], v[60:61]
  v_pk_add_f32 v[52:53], v[52:53], v[62:63]
  v_add_f32 v54, v54, v74
  v_pk_add_f32 v[46:47], v[46:47], v[66:67]
  v_pk_add_f32 v[48:49], v[48:49], v[68:69]
  v_pk_add_f32 v[50:51], v[50:51], v[70:71]
  v_pk_add_f32 v[52:53], v[52:53], v[72:73]
  v_add_f32 v136, v136, v54
  v_pk_add_f32 v[128:129], v[128:129], v[46:47]
  v_pk_add_f32 v[130:131], v[130:131], v[48:49]
  v_pk_add_f32 v[132:133], v[132:133], v[50:51]
  v_pk_add_f32 v[134:135], v[134:135], v[52:53]
  v_rcp_f32 v138, v136
  s_nop 0
  v_pk_mul_f32 v[128:129], v[128:129], v[138:139] op_sel_hi:[1,0]
  v_pk_mul_f32 v[130:131], v[130:131], v[138:139] op_sel_hi:[1,0]
  v_pk_mul_f32 v[132:133], v[132:133], v[138:139] op_sel_hi:[1,0]
  v_pk_mul_f32 v[134:135], v[134:135], v[138:139] op_sel_hi:[1,0]
  v_cvt_pk_bf16_f32 v140, v128, v129
  v_cvt_pk_bf16_f32 v141, v130, v131
  v_cvt_pk_bf16_f32 v142, v132, v133
  v_cvt_pk_bf16_f32 v143, v134, v135
  buffer_store_dwordx4 v[140:143], v0, s[8:11], s49 offen
  v_maximum3_f32 v18, abs(v112), abs(v113), abs(v114)
  v_maximum3_f32 v18, abs(v115), abs(v116), v18
  v_maximum3_f32 v18, abs(v117), abs(v118), v18
  v_maximum3_f32 v19, abs(v128), abs(v129), abs(v130)
  v_maximum3_f32 v19, abs(v131), abs(v132), v19
  v_maximum3_f32 v19, abs(v133), abs(v134), v19
  v_maximum3_f32 v18, abs(v119), abs(v135), v18
  v_minimum3_f32 v16, v120, v136, v136
  v_maximum3_f32 v17, v120, v136, v136
  v_maximum3_f32 v18, v18, v19, v19
  s_mov_b32 s50, 0x1f800000
  s_mov_b32 s51, 0x7b800000
  s_mov_b32 s52, 0x7f7fffff
  v_cmp_nle_f32 vcc, s50, v16
  v_cmp_nge_f32 s[54:55], s51, v17
  v_cmp_nge_f32 s[58:59], s52, v18
  s_nop 0
  s_or_b64 vcc, vcc, s[54:55]
  s_or_b64 vcc, vcc, s[58:59]
  s_cbranch_scc1 L_fb_51
L_fbj_52:
  v_and_b32 v4, 28, v1
  s_lshl_b32 s50, s36, 2
  s_lshr_b32 s51, s37, 3
  s_add_u32 s50, s50, s51
  s_lshl_b32 s50, s50, 2
  s_add_u32 s50, s50, s38
  s_lshl_b32 s50, s50, 7
  s_add_u32 s50, s50, 16384
  s_lshl_b32 s51, s42, 15
  s_lshl_b32 s52, s38, 13
  s_add_u32 s51, s51, s52
  s_add_u32 s51, s51, 10485760
  s_xor_b32 s52, s51, 32768
  s_waitcnt vmcnt(0)
  v_mov_b32 v5, 1
  s_cmp_lg_u32 s45, 0
  s_cbranch_scc1 L_slow_55
  s_mov_b64 exec, 4
  buffer_store_dword v5, v3, s[8:11], 0 offen
  s_mov_b64 exec, -1
L_join_56:
  s_barrier
  s_mul_i32 s54, s38, 12288
  s_add_u32 s54, s54, 106496
  v_add_u32 v6, s54, v0
  v_lshlrev_b32 v128, 16, v8
  v_and_b32 v129, s47, v8
  v_lshlrev_b32 v130, 16, v9
  v_and_b32 v131, s47, v9
  v_lshlrev_b32 v132, 16, v10
  v_and_b32 v133, s47, v10
  v_lshlrev_b32 v134, 16, v11
  v_and_b32 v135, s47, v11
  v_lshlrev_b32 v136, 16, v12
  v_and_b32 v137, s47, v12
  v_lshlrev_b32 v138, 16, v13
  v_and_b32 v139, s47, v13
  v_lshlrev_b32 v140, 16, v14
  v_and_b32 v141, s47, v14
  v_lshlrev_b32 v142, 16, v15
  v_and_b32 v143, s47, v15
  s_lshl_b32 s48, s44, 1
  s_add_u32 s48, s48, s43
  v_mov_b32 v7, 0x3f803f80
  s_lshl_b32 s55, s41, 15
  s_lshl_b32 s56, s48, 11
  s_add_u32 s55, s55, s56
  s_add_u32 s55, s55, 12582912
  s_lshl_b32 s56, s41, 12
  s_lshr_b32 s57, s48, 2
  s_lshl_b32 s57, s57, 10
  s_add_u32 s56, s56, s57
  s_and_b32 s57, s48, 3
  s_lshl_b32 s57, s57, 2
  s_add_u32 s56, s56, s57
  s_add_u32 s56, s56, 1048576
  s_mov_b32 s46, 2097152
L_poll_57:
  buffer_load_dword v5, v4, s[8:11], s50 offen sc1
  s_sub_u32 s46, s46, 1
  s_cbranch_scc1 L_exit
  s_waitcnt vmcnt(0)
  v_cmp_gt_u32 vcc, 1, v5
  s_nop 0
  s_cbranch_vccnz L_poll_57
  s_cmp_lg_u32 s45, 0
  s_cbranch_scc1 L_slow_58
L_join_59:
  buffer_load_dwordx4 v[208:211], v0, s[8:11], s51 offen sc1
  buffer_load_dwordx4 v[212:215], v0, s[8:11], s51 offen offset:1024 sc1
  buffer_load_dwordx4 v[216:219], v0, s[8:11], s51 offen offset:2048 sc1
  buffer_load_dwordx4 v[156:159], v0, s[8:11], s51 offen offset:3072 sc1
  s_add_u32 s51, s51, 4096
  buffer_load_dwordx4 v[160:163], v0, s[8:11], s51 offen sc1
  buffer_load_dwordx4 v[164:167], v0, s[8:11], s51 offen offset:1024 sc1
  buffer_load_dwordx4 v[168:171], v0, s[8:11], s51 offen offset:2048 sc1
  buffer_load_dwordx4 v[172:175], v0, s[8:11], s51 offen offset:3072 sc1
  buffer_load_dwordx4 v[176:179], v0, s[8:11], s52 offen sc1
  buffer_load_dwordx4 v[180:183], v0, s[8:11], s52 offen offset:1024 sc1
  s_waitcnt vmcnt(9)
  v_mfma_f32_32x32x16_bf16 v[64:79], a[228:231], v[208:211], 0
  v_mfma_f32_32x32x16_bf16 v[48:63], a[224:227], v[208:211], 0
  buffer_load_dwordx4 v[184:187], v0, s[8:11], s52 offen offset:2048 sc1
  s_waitcnt vmcnt(9)
  v_mfma_f32_32x32x16_bf16 v[64:79], a[236:239], v[212:215], v[64:79]
  v_mfma_f32_32x32x16_bf16 v[48:63], a[232:235], v[212:215], v[48:63]
  buffer_load_dwordx4 v[188:191], v0, s[8:11], s52 offen offset:3072 sc1
  s_waitcnt vmcnt(9)
  v_mfma_f32_32x32x16_bf16 v[64:79], a[244:247], v[216:219], v[64:79]
  v_mfma_f32_32x32x16_bf16 v[48:63], a[240:243], v[216:219], v[48:63]
  s_add_u32 s52, s52, 4096
  buffer_load_dwordx4 v[192:195], v0, s[8:11], s52 offen sc1
  s_waitcnt vmcnt(9)
  v_mfma_f32_32x32x16_bf16 v[64:79], a[252:255], v[156:159], v[64:79]
  v_mfma_f32_32x32x16_bf16 v[48:63], a[248:251], v[156:159], v[48:63]
  buffer_load_dwordx4 v[196:199], v0, s[8:11], s52 offen offset:1024 sc1
  s_waitcnt vmcnt(9)
  v_mfma_f32_32x32x16_bf16 v[64:79], v[224:227], v[160:163], v[64:79]
  v_mfma_f32_32x32x16_bf16 v[48:63], v[220:223], v[160:163], v[48:63]
  buffer_load_dwordx4 v[200:203], v0, s[8:11], s52 offen offset:2048 sc1
  s_waitcnt vmcnt(9)
  v_mfma_f32_32x32x16_bf16 v[64:79], v[244:247], v[164:167], v[64:79]
  v_mfma_f32_32x32x16_bf16 v[48:63], v[228:231], v[164:167], v[48:63]
  buffer_load_dwordx4 v[204:207], v0, s[8:11], s52 offen offset:3072 sc1
  s_waitcnt vmcnt(9)
  v_mfma_f32_32x32x16_bf16 v[64:79], v[144:147], v[168:171], v[64:79]
  v_mfma_f32_32x32x16_bf16 v[48:63], v[248:251], v[168:171], v[48:63]
  s_mul_i32 s57, s40, 7168
  s_add_u32 s57, s57, 9699328
  s_add_u32 s58, s57, 4096
  s_waitcnt vmcnt(8)
  v_mfma_f32_32x32x16_bf16 v[64:79], v[152:155], v[172:175], v[64:79]
  v_mfma_f32_32x32x16_bf16 v[48:63], v[148:151], v[172:175], v[48:63]
  buffer_load_dwordx4 v[208:211], v0, s[8:11], s57 offen sc1
  s_waitcnt vmcnt(8)
  v_mfma_f32_32x32x16_bf16 v[32:47], a[228:231], v[176:179], 0
  buffer_load_dwordx4 v[212:215], v0, s[8:11], s57 offen offset:1024 sc1
  s_xor_b32 s54, s38, 3
  s_mul_i32 s54, s54, 12288
  s_add_u32 s54, s54, 114688
  v_add_u32 v4, s54, v0
  s_waitcnt vmcnt(8)
  v_mfma_f32_32x32x16_bf16 v[32:47], a[236:239], v[180:183], v[32:47]
  buffer_load_dwordx4 v[216:219], v0, s[8:11], s57 offen offset:2048 sc1
  s_waitcnt vmcnt(8)
  v_mfma_f32_32x32x16_bf16 v[32:47], a[244:247], v[184:187], v[32:47]
  buffer_load_dwordx4 v[252:255], v0, s[8:11], s58 offen offset:2048 sc1
  ds_write_b128 v4, v[64:67] offset:0
  ds_write_b128 v4, v[68:71] offset:1024
  s_waitcnt vmcnt(8)
  v_mfma_f32_32x32x16_bf16 v[32:47], a[252:255], v[188:191], v[32:47]
  s_mul_i32 s59, s40, 229376
  s_add_u32 s59, s59, 4194304
  ds_write_b128 v4, v[72:75] offset:2048
  ds_write_b128 v4, v[76:79] offset:3072
  s_waitcnt vmcnt(7)
  v_mfma_f32_32x32x16_bf16 v[32:47], v[224:227], v[192:195], v[32:47]
  s_mul_i32 s57, s38, 2048
  s_add_u32 s58, s57, s59
  s_xor_b32 s54, s38, 2
  s_mul_i32 s54, s54, 12288
  s_add_u32 s54, s54, 110592
  v_add_u32 v4, s54, v0
  s_waitcnt vmcnt(6)
  v_mfma_f32_32x32x16_bf16 v[32:47], v[244:247], v[196:199], v[32:47]
  s_add_u32 s58, s58, 155648
  s_add_u32 s57, s57, 155648
  ds_write_b128 v4, v[48:51] offset:0
  ds_write_b128 v4, v[52:55] offset:1024
  s_waitcnt vmcnt(5)
  v_mfma_f32_32x32x16_bf16 v[32:47], v[144:147], v[200:203], v[32:47]
  s_mov_b32 m0, s57
  s_nop 0
  buffer_load_dwordx4 v0, s[8:11], s58 offen sc1 lds
  ds_write_b128 v4, v[56:59] offset:2048
  ds_write_b128 v4, v[60:63] offset:3072
  s_waitcnt vmcnt(5)
  v_mfma_f32_32x32x16_bf16 v[32:47], v[152:155], v[204:207], v[32:47]
  buffer_load_dwordx4 v0, s[8:11], s58 offen offset:1024 sc1 lds
  v_mfma_f32_32x32x16_bf16 v[16:31], a[224:227], v[176:179], 0
  s_xor_b32 s54, s38, 1
  s_mul_i32 s54, s54, 12288
  s_add_u32 s54, s54, 106496
  v_add_u32 v4, s54, v0
  v_mfma_f32_32x32x16_bf16 v[16:31], a[232:235], v[180:183], v[16:31]
  s_nop 4
  ds_write_b128 v4, v[32:35] offset:0
  v_mfma_f32_32x32x16_bf16 v[16:31], a[240:243], v[184:187], v[16:31]
  ds_write_b128 v4, v[36:39] offset:1024
  ds_write_b128 v4, v[40:43] offset:2048
  ds_write_b128 v4, v[44:47] offset:3072
  v_mfma_f32_32x32x16_bf16 v[16:31], a[248:251], v[188:191], v[16:31]
  s_waitcnt lgkmcnt(0)
  s_barrier
  ds_read_b128 v[80:83], v6 offset:8192
  ds_read_b128 v[84:87], v6 offset:9216
  v_mfma_f32_32x32x16_bf16 v[16:31], v[220:223], v[192:195], v[16:31]
  ds_read_b128 v[88:91], v6 offset:10240
  ds_read_b128 v[92:95], v6 offset:11264
  ds_read_b128 v[96:99], v6 offset:4096
  v_mfma_f32_32x32x16_bf16 v[16:31], v[228:231], v[196:199], v[16:31]
  ds_read_b128 v[100:103], v6 offset:5120
  ds_read_b128 v[104:107], v6 offset:6144
  ds_read_b128 v[108:111], v6 offset:7168
  v_mfma_f32_32x32x16_bf16 v[16:31], v[248:251], v[200:203], v[16:31]
  ds_read_b128 v[112:115], v6 offset:0
  ds_read_b128 v[116:119], v6 offset:1024
  ds_read_b128 v[120:123], v6 offset:2048
  v_mfma_f32_32x32x16_bf16 v[16:31], v[148:151], v[204:207], v[16:31]
  ds_read_b128 v[124:127], v6 offset:3072
  s_waitcnt lgkmcnt(11)
  v_pk_add_f32 v[128:129], v[128:129], v[80:81]
  v_pk_add_f32 v[130:131], v[130:131], v[82:83]
  s_waitcnt lgkmcnt(10)
  v_pk_add_f32 v[132:133], v[132:133], v[84:85]
  v_pk_add_f32 v[134:135], v[134:135], v[86:87]
  s_waitcnt lgkmcnt(9)
  v_pk_add_f32 v[136:137], v[136:137], v[88:89]
  v_pk_add_f32 v[138:139], v[138:139], v[90:91]
  s_waitcnt lgkmcnt(8)
  v_pk_add_f32 v[140:141], v[140:141], v[92:93]
  v_pk_add_f32 v[142:143], v[142:143], v[94:95]
  s_waitcnt lgkmcnt(7)
  v_pk_add_f32 v[128:129], v[128:129], v[96:97]
  v_pk_add_f32 v[130:131], v[130:131], v[98:99]
  s_waitcnt lgkmcnt(6)
  v_pk_add_f32 v[132:133], v[132:133], v[100:101]
  v_pk_add_f32 v[134:135], v[134:135], v[102:103]
  s_waitcnt lgkmcnt(5)
  v_pk_add_f32 v[136:137], v[136:137], v[104:105]
  v_pk_add_f32 v[138:139], v[138:139], v[106:107]
  s_waitcnt lgkmcnt(4)
  v_pk_add_f32 v[140:141], v[140:141], v[108:109]
  v_pk_add_f32 v[142:143], v[142:143], v[110:111]
  s_waitcnt lgkmcnt(3)
  v_pk_add_f32 v[128:129], v[128:129], v[112:113]
  v_pk_add_f32 v[130:131], v[130:131], v[114:115]
  s_waitcnt lgkmcnt(2)
  v_pk_add_f32 v[132:133], v[132:133], v[116:117]
  v_pk_add_f32 v[134:135], v[134:135], v[118:119]
  s_waitcnt lgkmcnt(1)
  v_pk_add_f32 v[136:137], v[136:137], v[120:121]
  v_pk_add_f32 v[138:139], v[138:139], v[122:123]
  s_waitcnt lgkmcnt(0)
  v_pk_add_f32 v[140:141], v[140:141], v[124:125]
  v_pk_add_f32 v[142:143], v[142:143], v[126:127]
  v_pk_add_f32 v[16:17], v[16:17], v[128:129]
  v_pk_add_f32 v[18:19], v[18:19], v[130:131]
  v_pk_add_f32 v[20:21], v[20:21], v[132:133]
  v_pk_add_f32 v[22:23], v[22:23], v[134:135]
  v_cvt_pk_bf16_f32 v8, v16, v17
  v_cvt_pk_bf16_f32 v9, v18, v19
  v_cvt_pk_bf16_f32 v10, v20, v21
  v_cvt_pk_bf16_f32 v11, v22, v23
  buffer_store_dwordx4 v[8:11], v0, s[8:11], s55 offen
  v_pk_add_f32 v[24:25], v[24:25], v[136:137]
  v_pk_add_f32 v[26:27], v[26:27], v[138:139]
  v_pk_add_f32 v[28:29], v[28:29], v[140:141]
  v_pk_add_f32 v[30:31], v[30:31], v[142:143]
  v_cvt_pk_bf16_f32 v12, v24, v25
  v_cvt_pk_bf16_f32 v13, v26, v27
  v_cvt_pk_bf16_f32 v14, v28, v29
  v_cvt_pk_bf16_f32 v15, v30, v31
  buffer_store_dwordx4 v[12:15], v0, s[8:11], s55 offen offset:1024
  v_mov_b32 v128, 0
  v_mov_b32 v129, 0
  v_mov_b32 v130, 0
  v_mov_b32 v131, 0
  v_dot2c_f32_bf16 v128, v8, v7
  v_dot2c_f32_bf16 v130, v8, v8
  v_dot2c_f32_bf16 v129, v9, v7
  v_dot2c_f32_bf16 v131, v9, v9
  v_dot2c_f32_bf16 v128, v10, v7
  v_dot2c_f32_bf16 v130, v10, v10
  v_dot2c_f32_bf16 v129, v11, v7
  v_dot2c_f32_bf16 v131, v11, v11
  v_dot2c_f32_bf16 v128, v12, v7
  v_dot2c_f32_bf16 v130, v12, v12
  v_dot2c_f32_bf16 v129, v13, v7
  v_dot2c_f32_bf16 v131, v13, v13
  v_dot2c_f32_bf16 v128, v14, v7
  v_dot2c_f32_bf16 v130, v14, v14
  v_dot2c_f32_bf16 v129, v15, v7
  v_dot2c_f32_bf16 v131, v15, v15
  s_nop 1
  v_add_f32 v128, v128, v129
  v_add_f32 v130, v130, v131
  s_nop 1
  v_permlane32_swap_b32 v128, v130
  v_add_f32 v128, v128, v130
  s_cmp_lg_u32 s45, 0
  s_cbranch_scc1 L_slow_61
  buffer_store_dword v128, v0, s[8:11], s56 offen
L_join_62:
  v_and_b32 v4, 60, v1
  s_lshl_b32 s50, s39, 7
  s_add_u32 s50, s50, 49152
  v_add_u32 v240, 0x10000, v0
  v_add_u32 v241, 0x20000, v0
  s_mul_i32 s59, s40, 229376
  s_add_u32 s59, s59, 4194304
  s_mul_i32 s51, s40, 7168
  s_mul_i32 s6, s39, 114688
  s_add_u32 s6, s6, s51
  s_add_u32 s6, s6, 14680064
  s_add_u32 s7, s6, 4096
  s_add_u32 s51, s51, 9699328
  s_add_u32 s3, s51, 4096
  s_waitcnt vmcnt(0)
  v_mov_b32 v5, 1
  s_cmp_lg_u32 s45, 0
  s_cbranch_scc1 L_slow_63
  s_mov_b64 exec, 8
  buffer_store_dword v5, v3, s[8:11], 0 offen
  s_mov_b64 exec, -1
L_join_64:
  s_barrier
  ds_read_b128 a[224:227], v0 offset:0
  ds_read_b128 a[228:231], v0 offset:1024
  ds_read_b128 a[232:235], v0 offset:2048
  ds_read_b128 a[236:239], v0 offset:3072
  ds_read_b128 a[240:243], v0 offset:4096
  ds_read_b128 a[244:247], v0 offset:5120
  ds_read_b128 a[248:251], v0 offset:6144
  s_lshl_b32 s48, s39, 12
  s_add_u32 s48, s48, 1048576
  s_lshl_b32 s49, s39, 15
  s_add_u32 s49, s49, 12582912
  s_mov_b32 s46, 2097152
L_poll_65:
  buffer_load_dword v5, v4, s[8:11], s50 offen sc1
  s_sub_u32 s46, s46, 1
  s_cbranch_scc1 L_exit
  s_waitcnt vmcnt(0)
  v_cmp_gt_u32 vcc, 1, v5
  s_nop 0
  s_cbranch_vccnz L_poll_65
  s_cmp_lg_u32 s45, 0
  s_cbranch_scc1 L_slow_66
L_join_67:
  buffer_load_dwordx4 v[16:19], v0, s[8:11], s49 offen sc1
  buffer_load_dwordx4 v[20:23], v0, s[8:11], s49 offen offset:1024 sc1
  buffer_load_dwordx4 v[24:27], v0, s[8:11], s49 offen offset:2048 sc1
  buffer_load_dwordx4 v[28:31], v0, s[8:11], s49 offen offset:3072 sc1
  s_add_u32 s49, s49, 4096
  buffer_load_dwordx4 v[32:35], v0, s[8:11], s49 offen sc1
  buffer_load_dwordx4 v[36:39], v0, s[8:11], s49 offen offset:1024 sc1
  s_waitcnt vmcnt(5)
  s_waitcnt lgkmcnt(3)
  v_mfma_f32_32x32x16_bf16 v[144:159], a[224:227], v[16:19], 0
  ds_read_b128 a[252:255], v0 offset:7168
  buffer_load_dwordx4 v[40:43], v0, s[8:11], s49 offen offset:2048 sc1
  v_mfma_f32_32x32x16_bf16 v[160:175], a[228:231], v[16:19], 0
  ds_read_b128 a[224:227], v0 offset:8192
  v_mfma_f32_32x32x16_bf16 v[176:191], a[232:235], v[16:19], 0
  ds_read_b128 a[228:231], v0 offset:9216
  buffer_load_dwordx4 v[44:47], v0, s[8:11], s49 offen offset:3072 sc1
  v_mfma_f32_32x32x16_bf16 v[192:207], a[236:239], v[16:19], 0
  ds_read_b128 a[232:235], v0 offset:10240
  s_waitcnt vmcnt(6)
  s_waitcnt lgkmcnt(3)
  v_mfma_f32_32x32x16_bf16 v[144:159], a[240:243], v[20:23], v[144:159]
  ds_read_b128 a[236:239], v0 offset:11264
  s_add_u32 s49, s49, 4096
  buffer_load_dwordx4 v[48:51], v0, s[8:11], s49 offen sc1
  v_mfma_f32_32x32x16_bf16 v[160:175], a[244:247], v[20:23], v[160:175]
  ds_read_b128 a[240:243], v0 offset:12288
  v_mfma_f32_32x32x16_bf16 v[176:191], a[248:251], v[20:23], v[176:191]
  ds_read_b128 a[244:247], v0 offset:13312
  buffer_load_dwordx4 v[52:55], v0, s[8:11], s49 offen offset:1024 sc1
  v_mfma_f32_32x32x16_bf16 v[192:207], a[252:255], v[20:23], v[192:207]
  ds_read_b128 a[248:251], v0 offset:14336
  s_waitcnt vmcnt(7)
  s_waitcnt lgkmcnt(3)
  v_mfma_f32_32x32x16_bf16 v[144:159], a[224:227], v[24:27], v[144:159]
  ds_read_b128 a[252:255], v0 offset:15360
  buffer_load_dwordx4 v[56:59], v0, s[8:11], s49 offen offset:2048 sc1
  v_mfma_f32_32x32x16_bf16 v[160:175], a[228:231], v[24:27], v[160:175]
  ds_read_b128 a[224:227], v0 offset:16384
  v_mfma_f32_32x32x16_bf16 v[176:191], a[232:235], v[24:27], v[176:191]
  ds_read_b128 a[228:231], v0 offset:17408
  buffer_load_dwordx4 v[60:63], v0, s[8:11], s49 offen offset:3072 sc1
  v_mfma_f32_32x32x16_bf16 v[192:207], a[236:239], v[24:27], v[192:207]
  ds_read_b128 a[232:235], v0 offset:18432
  s_waitcnt vmcnt(8)
  s_waitcnt lgkmcnt(3)
  v_mfma_f32_32x32x16_bf16 v[144:159], a[240:243], v[28:31], v[144:159]
  ds_read_b128 a[236:239], v0 offset:19456
  buffer_load_dwordx4 v[224:227], v0, s[8:11], s48 offen sc1
  v_mfma_f32_32x32x16_bf16 v[160:175], a[244:247], v[28:31], v[160:175]
  ds_read_b128 a[240:243], v0 offset:20480
  v_mfma_f32_32x32x16_bf16 v[176:191], a[248:251], v[28:31], v[176:191]
  ds_read_b128 a[244:247], v0 offset:21504
  buffer_load_dwordx4 v[228:231], v0, s[8:11], s48 offen offset:1024 sc1
  v_mfma_f32_32x32x16_bf16 v[192:207], a[252:255], v[28:31], v[192:207]
  ds_read_b128 a[248:251], v0 offset:22528
  s_waitcnt vmcnt(9)
  s_waitcnt lgkmcnt(3)
  v_mfma_f32_32x32x16_bf16 v[144:159], a[224:227], v[32:35], v[144:159]
  ds_read_b128 a[252:255], v0 offset:23552
  buffer_load_dwordx4 v[232:235], v0, s[8:11], s48 offen offset:2048 sc1
  v_mfma_f32_32x32x16_bf16 v[160:175], a[228:231], v[32:35], v[160:175]
  ds_read_b128 a[224:227], v0 offset:24576
  v_mfma_f32_32x32x16_bf16 v[176:191], a[232:235], v[32:35], v[176:191]
  ds_read_b128 a[228:231], v0 offset:25600
  buffer_load_dwordx4 v[236:239], v0, s[8:11], s48 offen offset:3072 sc1
  v_mfma_f32_32x32x16_bf16 v[192:207], a[236:239], v[32:35], v[192:207]
  ds_read_b128 a[232:235], v0 offset:26624
  s_waitcnt vmcnt(10)
  s_waitcnt lgkmcnt(3)
  v_mfma_f32_32x32x16_bf16 v[144:159], a[240:243], v[36:39], v[144:159]
  ds_read_b128 a[236:239], v0 offset:27648
  s_add_u32 s49, s49, 4096
  buffer_load_dwordx4 v[64:67], v0, s[8:11], s49 offen sc1
  v_mfma_f32_32x32x16_bf16 v[160:175], a[244:247], v[36:39], v[160:175]
  ds_read_b128 a[240:243], v0 offset:28672
  v_mfma_f32_32x32x16_bf16 v[176:191], a[248:251], v[36:39], v[176:191]
  ds_read_b128 a[244:247], v0 offset:29696
  buffer_load_dwordx4 v[68:71], v0, s[8:11], s49 offen offset:1024 sc1
  v_mfma_f32_32x32x16_bf16 v[192:207], a[252:255], v[36:39], v[192:207]
  ds_read_b128 a[248:251], v0 offset:30720
  s_waitcnt vmcnt(11)
  s_waitcnt lgkmcnt(3)
  v_mfma_f32_32x32x16_bf16 v[144:159], a[224:227], v[40:43], v[144:159]
  ds_read_b128 a[252:255], v0 offset:31744
  buffer_load_dwordx4 v[72:75], v0, s[8:11], s49 offen offset:2048 sc1
  v_mfma_f32_32x32x16_bf16 v[160:175], a[228:231], v[40:43], v[160:175]
  ds_read_b128 a[224:227], v0 offset:32768
  v_mfma_f32_32x32x16_bf16 v[176:191], a[232:235], v[40:43], v[176:191]
  ds_read_b128 a[228:231], v0 offset:33792
  buffer_load_dwordx4 v[76:79], v0, s[8:11], s49 offen offset:3072 sc1
  v_mfma_f32_32x32x16_bf16 v[192:207], a[236:239], v[40:43], v[192:207]
  ds_read_b128 a[232:235], v0 offset:34816
  s_waitcnt vmcnt(12)
  s_waitcnt lgkmcnt(3)
  v_mfma_f32_32x32x16_bf16 v[144:159], a[240:243], v[44:47], v[144:159]
  ds_read_b128 a[236:239], v0 offset:35840
  s_waitcnt vmcnt(4)
  v_add_f32 v224, v224, v232
  v_add_f32 v225, v225, v233
  s_add_u32 s49, s49, 4096
  buffer_load_dwordx4 v[80:83], v0, s[8:11], s49 offen sc1
  v_mfma_f32_32x32x16_bf16 v[160:175], a[244:247], v[44:47], v[160:175]
  ds_read_b128 a[240:243], v0 offset:36864
  v_add_f32 v226, v226, v234
  v_add_f32 v227, v227, v235
  v_mfma_f32_32x32x16_bf16 v[176:191], a[248:251], v[44:47], v[176:191]
  ds_read_b128 a[244:247], v0 offset:37888
  v_add_f32 v228, v228, v236
  v_add_f32 v229, v229, v237
  buffer_load_dwordx4 v[84:87], v0, s[8:11], s49 offen offset:1024 sc1
  v_mfma_f32_32x32x16_bf16 v[192:207], a[252:255], v[44:47], v[192:207]
  ds_read_b128 a[248:251], v0 offset:38912
  v_add_f32 v230, v230, v238
  v_add_f32 v231, v231, v239
  s_waitcnt lgkmcnt(3)
  v_mfma_f32_32x32x16_bf16 v[144:159], a[224:227], v[48:51], v[144:159]
  ds_read_b128 a[252:255], v0 offset:39936
  v_add_f32 v224, v224, v228
  v_add_f32 v225, v225, v229
  buffer_load_dwordx4 v[88:91], v0, s[8:11], s49 offen offset:2048 sc1
  v_mfma_f32_32x32x16_bf16 v[160:175], a[228:231], v[48:51], v[160:175]
  ds_read_b128 a[224:227], v0 offset:40960
  v_add_f32 v226, v226, v230
  v_add_f32 v227, v227, v231
  v_mfma_f32_32x32x16_bf16 v[176:191], a[232:235], v[48:51], v[176:191]
  ds_read_b128 a[228:231], v0 offset:41984
  v_add_f32 v224, v224, v226
  v_add_f32 v225, v225, v227
  buffer_load_dwordx4 v[92:95], v0, s[8:11], s49 offen offset:3072 sc1
  v_mfma_f32_32x32x16_bf16 v[192:207], a[236:239], v[48:51], v[192:207]
  ds_read_b128 a[232:235], v0 offset:43008
  v_add_f32 v224, v224, v225
  v_mov_b32 v225, v224
  s_waitcnt lgkmcnt(3)
  v_mfma_f32_32x32x16_bf16 v[144:159], a[240:243], v[52:55], v[144:159]
  ds_read_b128 a[236:239], v0 offset:44032
  s_nop 1
  v_permlane32_swap_b32 v224, v225
  s_add_u32 s49, s49, 4096
  buffer_load_dwordx4 v[96:99], v0, s[8:11], s49 offen sc1
  v_mfma_f32_32x32x16_bf16 v[160:175], a[244:247], v[52:55], v[160:175]
  ds_read_b128 a[240:243], v0 offset:45056
  v_mul_f32 v224, 0xbb000000, v224
  v_mul_f32 v225, 0x3b000000, v225
  v_mfma_f32_32x32x16_bf16 v[176:191], a[248:251], v[52:55], v[176:191]
  ds_read_b128 a[244:247], v0 offset:46080
  v_fma_f32 v225, -v224, v224, v225
  v_max_f32 v225, 0, v225
  buffer_load_dwordx4 v[100:103], v0, s[8:11], s49 offen offset:1024 sc1
  v_mfma_f32_32x32x16_bf16 v[192:207], a[252:255], v[52:55], v[192:207]
  ds_read_b128 a[248:251], v0 offset:47104
  v_cvt_pk_bf16_f32 v225, v225, v225
  v_lshlrev_b32 v225, 16, v225
  s_waitcnt lgkmcnt(3)
  v_mfma_f32_32x32x16_bf16 v[144:159], a[224:227], v[56:59], v[144:159]
  ds_read_b128 a[252:255], v0 offset:48128
  v_add_f32 v225, 0x3727c5ac, v225
  v_cvt_pk_bf16_f32 v225, v225, v225
  buffer_load_dwordx4 v[104:107], v0, s[8:11], s49 offen offset:2048 sc1
  v_mfma_f32_32x32x16_bf16 v[160:175], a[228:231], v[56:59], v[160:175]
  ds_read_b128 a[224:227], v0 offset:49152
  v_lshlrev_b32 v225, 16, v225
  v_sqrt_f32 v225, v225
  v_mfma_f32_32x32x16_bf16 v[176:191], a[232:235], v[56:59], v[176:191]
  ds_read_b128 a[228:231], v0 offset:50176
  v_cvt_pk_bf16_f32 v248, v224, v224
  v_cvt_pk_bf16_f32 v225, v225, v225
  buffer_load_dwordx4 v[108:111], v0, s[8:11], s49 offen offset:3072 sc1
  v_mfma_f32_32x32x16_bf16 v[192:207], a[236:239], v[56:59], v[192:207]
  ds_read_b128 a[232:235], v0 offset:51200
  v_lshlrev_b32 v225, 16, v225
  v_rcp_f32 v242, v225
  s_waitcnt lgkmcnt(3)
  v_mfma_f32_32x32x16_bf16 v[144:159], a[240:243], v[60:63], v[144:159]
  ds_read_b128 a[236:239], v0 offset:52224
  v_mul_f32 v243, v225, v225
  v_mov_b32 v249, v248
  s_add_u32 s49, s49, 4096
  buffer_load_dwordx4 v[112:115], v0, s[8:11], s49 offen sc1
  v_mfma_f32_32x32x16_bf16 v[160:175], a[244:247], v[60:63], v[160:175]
  ds_read_b128 a[240:243], v0 offset:53248
  v_mov_b32 v250, v248
  v_mov_b32 v251, v248
  v_mfma_f32_32x32x16_bf16 v[176:191], a[248:251], v[60:63], v[176:191]
  ds_read_b128 a[244:247], v0 offset:54272
  s_nop 0
  v_mul_f32 v242, 0xbfb8aa3b, v242
  buffer_load_dwordx4 v[116:119], v0, s[8:11], s49 offen offset:1024 sc1
  v_mfma_f32_32x32x16_bf16 v[192:207], a[252:255], v[60:63], v[192:207]
  ds_read_b128 a[248:251], v0 offset:55296
  s_waitcnt vmcnt(13)
  s_waitcnt lgkmcnt(3)
  v_mfma_f32_32x32x16_bf16 v[144:159], a[224:227], v[64:67], v[144:159]
  ds_read_b128 a[252:255], v0 offset:56320
  buffer_load_dwordx4 v[120:123], v0, s[8:11], s49 offen offset:2048 sc1
  v_mfma_f32_32x32x16_bf16 v[160:175], a[228:231], v[64:67], v[160:175]
  ds_read_b128 a[224:227], v0 offset:57344
  v_mfma_f32_32x32x16_bf16 v[176:191], a[232:235], v[64:67], v[176:191]
  ds_read_b128 a[228:231], v0 offset:58368
  buffer_load_dwordx4 v[124:127], v0, s[8:11], s49 offen offset:3072 sc1
  v_mfma_f32_32x32x16_bf16 v[192:207], a[236:239], v[64:67], v[192:207]
  ds_read_b128 a[232:235], v0 offset:59392
  s_waitcnt vmcnt(14)
  s_waitcnt lgkmcnt(3)
  v_mfma_f32_32x32x16_bf16 v[144:159], a[240:243], v[68:71], v[144:159]
  ds_read_b128 a[236:239], v0 offset:60416
  s_add_u32 s49, s49, 4096
  buffer_load_dwordx4 v[128:131], v0, s[8:11], s49 offen sc1
  v_mfma_f32_32x32x16_bf16 v[160:175], a[244:247], v[68:71], v[160:175]
  ds_read_b128 a[240:243], v0 offset:61440
  v_mfma_f32_32x32x16_bf16 v[176:191], a[248:251], v[68:71], v[176:191]
  ds_read_b128 a[244:247], v0 offset:62464
  buffer_load_dwordx4 v[132:135], v0, s[8:11], s49 offen offset:1024 sc1
  v_mfma_f32_32x32x16_bf16 v[192:207], a[252:255], v[68:71], v[192:207]
  ds_read_b128 a[248:251], v0 offset:63488
  s_waitcnt vmcnt(15)
  s_waitcnt lgkmcnt(3)
  v_mfma_f32_32x32x16_bf16 v[144:159], a[224:227], v[72:75], v[144:159]
  ds_read_b128 a[252:255], v0 offset:64512
  buffer_load_dwordx4 v[136:139], v0, s[8:11], s49 offen offset:2048 sc1
  v_mfma_f32_32x32x16_bf16 v[160:175], a[228:231], v[72:75], v[160:175]
  ds_read_b128 a[224:227], v240 offset:0
  v_mfma_f32_32x32x16_bf16 v[176:191], a[232:235], v[72:75], v[176:191]
  ds_read_b128 a[228:231], v240 offset:1024
  buffer_load_dwordx4 v[140:143], v0, s[8:11], s49 offen offset:3072 sc1
  v_mfma_f32_32x32x16_bf16 v[192:207], a[236:239], v[72:75], v[192:207]
  ds_read_b128 a[232:235], v240 offset:2048
  s_mul_i32 s56, s38, 7168
  s_add_u32 s57, s56, s59
  s_waitcnt vmcnt(16)
  s_waitcnt lgkmcnt(3)
  v_mfma_f32_32x32x16_bf16 v[144:159], a[240:243], v[76:79], v[144:159]
  ds_read_b128 a[236:239], v240 offset:3072
  s_add_u32 s57, s57, 106496
  s_add_u32 s56, s56, 106496
  v_mfma_f32_32x32x16_bf16 v[160:175], a[244:247], v[76:79], v[160:175]
  ds_read_b128 a[240:243], v240 offset:4096
  v_mfma_f32_32x32x16_bf16 v[176:191], a[248:251], v[76:79], v[176:191]
  ds_read_b128 a[244:247], v240 offset:5120
  s_mov_b32 m0, s56
  s_nop 0
  buffer_load_dwordx4 v0, s[8:11], s57 offen sc1 lds
  v_mfma_f32_32x32x16_bf16 v[192:207], a[252:255], v[76:79], v[192:207]
  ds_read_b128 a[248:251], v240 offset:6144
  s_waitcnt vmcnt(16)
  s_waitcnt lgkmcnt(3)
  v_mfma_f32_32x32x16_bf16 v[144:159], a[224:227], v[80:83], v[144:159]
  ds_read_b128 a[252:255], v240 offset:7168
  buffer_load_dwordx4 v0, s[8:11], s57 offen offset:1024 sc1 lds
  v_mfma_f32_32x32x16_bf16 v[160:175], a[228:231], v[80:83], v[160:175]
  ds_read_b128 a[224:227], v240 offset:8192
  v_mfma_f32_32x32x16_bf16 v[176:191], a[232:235], v[80:83], v[176:191]
  ds_read_b128 a[228:231], v240 offset:9216
  buffer_load_dwordx4 v0, s[8:11], s57 offen offset:2048 sc1 lds
  v_mfma_f32_32x32x16_bf16 v[192:207], a[236:239], v[80:83], v[192:207]
  ds_read_b128 a[232:235], v240 offset:10240
  s_waitcnt vmcnt(17)
  s_waitcnt lgkmcnt(3)
  v_mfma_f32_32x32x16_bf16 v[144:159], a[240:243], v[84:87], v[144:159]
  ds_read_b128 a[236:239], v240 offset:11264
  buffer_load_dwordx4 v0, s[8:11], s57 offen offset:3072 sc1 lds
  v_mfma_f32_32x32x16_bf16 v[160:175], a[244:247], v[84:87], v[160:175]
  s_barrier
  ds_read_b128 a[240:243], v240 offset:12288
  s_add_u32 s56, s56, 4096
  s_add_u32 s57, s57, 4096
  v_mfma_f32_32x32x16_bf16 v[176:191], a[248:251], v[84:87], v[176:191]
  ds_read_b128 a[244:247], v240 offset:13312
  s_mov_b32 m0, s56
  s_nop 0
  buffer_load_dwordx4 v0, s[8:11], s57 offen sc1 lds
  v_mfma_f32_32x32x16_bf16 v[192:207], a[252:255], v[84:87], v[192:207]
  ds_read_b128 a[248:251], v240 offset:14336
  s_waitcnt vmcnt(18)
  s_waitcnt lgkmcnt(3)
  v_mfma_f32_32x32x16_bf16 v[144:159], a[224:227], v[88:91], v[144:159]
  ds_read_b128 a[252:255], v240 offset:15360
  buffer_load_dwordx4 v0, s[8:11], s57 offen offset:1024 sc1 lds
  v_mfma_f32_32x32x16_bf16 v[160:175], a[228:231], v[88:91], v[160:175]
  ds_read_b128 a[224:227], v240 offset:16384
  v_mfma_f32_32x32x16_bf16 v[176:191], a[232:235], v[88:91], v[176:191]
  ds_read_b128 a[228:231], v240 offset:17408
  buffer_load_dwordx4 v0, s[8:11], s57 offen offset:2048 sc1 lds
  v_mfma_f32_32x32x16_bf16 v[192:207], a[236:239], v[88:91], v[192:207]
  ds_read_b128 a[232:235], v240 offset:18432
  s_waitcnt vmcnt(19)
  s_waitcnt lgkmcnt(3)
  v_mfma_f32_32x32x16_bf16 v[144:159], a[240:243], v[92:95], v[144:159]
  ds_read_b128 a[236:239], v240 offset:19456
  buffer_load_dwordx4 v[220:223], v0, s[8:11], s51 offen offset:3072 sc1
  v_mfma_f32_32x32x16_bf16 v[160:175], a[244:247], v[92:95], v[160:175]
  ds_read_b128 a[240:243], v240 offset:20480
  v_mfma_f32_32x32x16_bf16 v[176:191], a[248:251], v[92:95], v[176:191]
  ds_read_b128 a[244:247], v240 offset:21504
  buffer_load_dwordx4 v[224:227], v0, s[8:11], s3 offen sc1
  v_mfma_f32_32x32x16_bf16 v[192:207], a[252:255], v[92:95], v[192:207]
  ds_read_b128 a[248:251], v240 offset:22528
  s_waitcnt vmcnt(20)
  s_waitcnt lgkmcnt(3)
  v_mfma_f32_32x32x16_bf16 v[144:159], a[224:227], v[96:99], v[144:159]
  ds_read_b128 a[252:255], v240 offset:23552
  buffer_load_dwordx4 v[244:247], v0, s[8:11], s3 offen offset:1024 sc1
  v_mfma_f32_32x32x16_bf16 v[160:175], a[228:231], v[96:99], v[160:175]
  ds_read_b128 a[224:227], v240 offset:24576
  s_mul_i32 s56, s38, 5120
  s_add_u32 s57, s56, s59
  v_mfma_f32_32x32x16_bf16 v[176:191], a[232:235], v[96:99], v[176:191]
  ds_read_b128 a[228:231], v240 offset:25600
  s_add_u32 s57, s57, 135168
  s_add_u32 s56, s56, 135168
  v_mfma_f32_32x32x16_bf16 v[192:207], a[236:239], v[96:99], v[192:207]
  ds_read_b128 a[232:235], v240 offset:26624
  s_waitcnt vmcnt(20)
  s_waitcnt lgkmcnt(3)
  v_mfma_f32_32x32x16_bf16 v[144:159], a[240:243], v[100:103], v[144:159]
  ds_read_b128 a[236:239], v240 offset:27648
  s_mov_b32 m0, s56
  s_nop 0
  buffer_load_dwordx4 v0, s[8:11], s57 offen sc1 lds
  v_mfma_f32_32x32x16_bf16 v[160:175], a[244:247], v[100:103], v[160:175]
  ds_read_b128 a[240:243], v240 offset:28672
  v_mfma_f32_32x32x16_bf16 v[176:191], a[248:251], v[100:103], v[176:191]
  ds_read_b128 a[244:247], v240 offset:29696
  buffer_load_dwordx4 v0, s[8:11], s57 offen offset:1024 sc1 lds
  v_mfma_f32_32x32x16_bf16 v[192:207], a[252:255], v[100:103], v[192:207]
  ds_read_b128 a[248:251], v240 offset:30720
  s_waitcnt vmcnt(21)
  s_waitcnt lgkmcnt(3)
  v_mfma_f32_32x32x16_bf16 v[144:159], a[224:227], v[104:107], v[144:159]
  ds_read_b128 a[252:255], v240 offset:31744
  buffer_load_dwordx4 v0, s[8:11], s57 offen offset:2048 sc1 lds
  v_mfma_f32_32x32x16_bf16 v[160:175], a[228:231], v[104:107], v[160:175]
  ds_read_b128 a[224:227], v240 offset:32768
  v_mfma_f32_32x32x16_bf16 v[176:191], a[232:235], v[104:107], v[176:191]
  ds_read_b128 a[228:231], v240 offset:33792
  buffer_load_dwordx4 v0, s[8:11], s57 offen offset:3072 sc1 lds
  v_mfma_f32_32x32x16_bf16 v[192:207], a[236:239], v[104:107], v[192:207]
  ds_read_b128 a[232:235], v240 offset:34816
  s_add_u32 s56, s56, 4096
  s_add_u32 s57, s57, 4096
  s_waitcnt vmcnt(22)
  s_waitcnt lgkmcnt(3)
  v_mfma_f32_32x32x16_bf16 v[144:159], a[240:243], v[108:111], v[144:159]
  ds_read_b128 a[236:239], v240 offset:35840
  s_mov_b32 m0, s56
  s_nop 0
  buffer_load_dwordx4 v0, s[8:11], s57 offen sc1 lds
  v_mfma_f32_32x32x16_bf16 v[160:175], a[244:247], v[108:111], v[160:175]
  ds_read_b128 a[240:243], v240 offset:36864
  s_mul_i32 s56, s38, 8192
  s_add_u32 s57, s56, s59
  v_mfma_f32_32x32x16_bf16 v[176:191], a[248:251], v[108:111], v[176:191]
  ds_read_b128 a[244:247], v240 offset:37888
  s_add_u32 s57, s57, 163840
  s_add_u32 s56, s56, 0
  v_mfma_f32_32x32x16_bf16 v[192:207], a[252:255], v[108:111], v[192:207]
  ds_read_b128 a[248:251], v240 offset:38912
  s_waitcnt vmcnt(22)
  s_waitcnt lgkmcnt(3)
  v_mfma_f32_32x32x16_bf16 v[144:159], a[224:227], v[112:115], v[144:159]
  ds_read_b128 a[252:255], v240 offset:39936
  s_mov_b32 m0, s56
  s_nop 0
  buffer_load_dwordx4 v0, s[8:11], s57 offen sc1 lds
  v_mfma_f32_32x32x16_bf16 v[160:175], a[228:231], v[112:115], v[160:175]
  s_waitcnt vmcnt(9)
  s_barrier
  ds_read_b128 a[224:227], v240 offset:40960
  v_mfma_f32_32x32x16_bf16 v[176:191], a[232:235], v[112:115], v[176:191]
  ds_read_b128 a[228:231], v240 offset:41984
  buffer_load_dwordx4 v0, s[8:11], s57 offen offset:1024 sc1 lds
  v_mfma_f32_32x32x16_bf16 v[192:207], a[236:239], v[112:115], v[192:207]
  ds_read_b128 a[232:235], v240 offset:43008
  s_waitcnt lgkmcnt(3)
  v_mfma_f32_32x32x16_bf16 v[144:159], a[240:243], v[116:119], v[144:159]
  ds_read_b128 a[236:239], v240 offset:44032
  buffer_load_dwordx4 v0, s[8:11], s57 offen offset:2048 sc1 lds
  v_mfma_f32_32x32x16_bf16 v[160:175], a[244:247], v[116:119], v[160:175]
  ds_read_b128 a[240:243], v240 offset:45056
  v_mfma_f32_32x32x16_bf16 v[176:191], a[248:251], v[116:119], v[176:191]
  ds_read_b128 a[244:247], v240 offset:46080
  buffer_load_dwordx4 v0, s[8:11], s57 offen offset:3072 sc1 lds
  v_mfma_f32_32x32x16_bf16 v[192:207], a[252:255], v[116:119], v[192:207]
  ds_read_b128 a[248:251], v240 offset:47104
  s_add_u32 s56, s56, 4096
  s_add_u32 s57, s57, 4096
  s_waitcnt lgkmcnt(3)
  v_mfma_f32_32x32x16_bf16 v[144:159], a[224:227], v[120:123], v[144:159]
  ds_read_b128 a[252:255], v240 offset:48128
  s_mov_b32 m0, s56
  s_nop 0
  buffer_load_dwordx4 v0, s[8:11], s57 offen sc1 lds
  v_mfma_f32_32x32x16_bf16 v[160:175], a[228:231], v[120:123], v[160:175]
  ds_read_b128 a[224:227], v240 offset:49152
  v_mfma_f32_32x32x16_bf16 v[176:191], a[232:235], v[120:123], v[176:191]
  ds_read_b128 a[228:231], v240 offset:50176
  buffer_load_dwordx4 v0, s[8:11], s57 offen offset:1024 sc1 lds
  v_mfma_f32_32x32x16_bf16 v[192:207], a[236:239], v[120:123], v[192:207]
  ds_read_b128 a[232:235], v240 offset:51200
  s_waitcnt lgkmcnt(3)
  v_mfma_f32_32x32x16_bf16 v[144:159], a[240:243], v[124:127], v[144:159]
  ds_read_b128 a[236:239], v240 offset:52224
  buffer_load_dwordx4 v0, s[8:11], s57 offen offset:2048 sc1 lds
  v_mfma_f32_32x32x16_bf16 v[160:175], a[244:247], v[124:127], v[160:175]
  ds_read_b128 a[240:243], v240 offset:53248
  v_mfma_f32_32x32x16_bf16 v[176:191], a[248:251], v[124:127], v[176:191]
  ds_read_b128 a[244:247], v240 offset:54272
  buffer_load_dwordx4 v0, s[8:11], s57 offen offset:3072 sc1 lds
  v_mfma_f32_32x32x16_bf16 v[192:207], a[252:255], v[124:127], v[192:207]
  ds_read_b128 a[248:251], v240 offset:55296
  s_mul_i32 s56, s38, 8192
  s_add_u32 s57, s56, s59
  s_waitcnt lgkmcnt(3)
  v_mfma_f32_32x32x16_bf16 v[144:159], a[224:227], v[128:131], v[144:159]
  ds_read_b128 a[252:255], v240 offset:56320
  s_add_u32 s57, s57, 196608
  s_add_u32 s56, s56, 32768
  v_mfma_f32_32x32x16_bf16 v[160:175], a[228:231], v[128:131], v[160:175]
  ds_read_b128 a[224:227], v240 offset:57344
  v_mfma_f32_32x32x16_bf16 v[176:191], a[232:235], v[128:131], v[176:191]
  ds_read_b128 a[228:231], v240 offset:58368
  s_mov_b32 m0, s56
  s_nop 0
  buffer_load_dwordx4 v0, s[8:11], s57 offen sc1 lds
  v_mfma_f32_32x32x16_bf16 v[192:207], a[236:239], v[128:131], v[192:207]
  ds_read_b128 a[232:235], v240 offset:59392
  s_waitcnt lgkmcnt(3)
  v_mfma_f32_32x32x16_bf16 v[144:159], a[240:243], v[132:135], v[144:159]
  ds_read_b128 a[236:239], v240 offset:60416
  buffer_load_dwordx4 v0, s[8:11], s57 offen offset:1024 sc1 lds
  v_mfma_f32_32x32x16_bf16 v[160:175], a[244:247], v[132:135], v[160:175]
  ds_read_b128 a[240:243], v240 offset:61440
  v_mfma_f32_32x32x16_bf16 v[176:191], a[248:251], v[132:135], v[176:191]
  ds_read_b128 a[244:247], v240 offset:62464
  buffer_load_dwordx4 v0, s[8:11], s57 offen offset:2048 sc1 lds
  v_mfma_f32_32x32x16_bf16 v[192:207], a[252:255], v[132:135], v[192:207]
  ds_read_b128 a[248:251], v240 offset:63488
  s_waitcnt lgkmcnt(3)
  v_mfma_f32_32x32x16_bf16 v[144:159], a[224:227], v[136:139], v[144:159]
  ds_read_b128 a[252:255], v240 offset:64512
  buffer_load_dwordx4 v0, s[8:11], s57 offen offset:3072 sc1 lds
  v_mfma_f32_32x32x16_bf16 v[160:175], a[228:231], v[136:139], v[160:175]
  ds_read_b128 a[224:227], v241 offset:0
  s_add_u32 s56, s56, 4096
  s_add_u32 s57, s57, 4096
  v_mfma_f32_32x32x16_bf16 v[176:191], a[232:235], v[136:139], v[176:191]
  ds_read_b128 a[228:231], v241 offset:1024
  s_mov_b32 m0, s56
  s_nop 0
  buffer_load_dwordx4 v0, s[8:11], s57 offen sc1 lds
  v_mfma_f32_32x32x16_bf16 v[192:207], a[236:239], v[136:139], v[192:207]
  ds_read_b128 a[232:235], v241 offset:2048
  s_waitcnt lgkmcnt(3)
  v_mfma_f32_32x32x16_bf16 v[144:159], a[240:243], v[140:143], v[144:159]
  ds_read_b128 a[236:239], v241 offset:3072
  buffer_load_dwordx4 v0, s[8:11], s57 offen offset:1024 sc1 lds
  v_mfma_f32_32x32x16_bf16 v[160:175], a[244:247], v[140:143], v[160:175]
  s_waitcnt vmcnt(14)
  s_barrier
  ds_read_b128 a[240:243], v241 offset:4096
  v_mfma_f32_32x32x16_bf16 v[176:191], a[248:251], v[140:143], v[176:191]
  ds_read_b128 a[244:247], v241 offset:5120
  buffer_load_dwordx4 v0, s[8:11], s57 offen offset:2048 sc1 lds
  v_mfma_f32_32x32x16_bf16 v[192:207], a[252:255], v[140:143], v[192:207]
  ds_read_b128 a[248:251], v241 offset:6144
  v_mfma_f32_32x32x16_bf16 v[144:159], v[208:211], v[248:251], v[144:159]
  v_mfma_f32_32x32x16_bf16 v[160:175], v[212:215], v[248:251], v[160:175]
  v_mfma_f32_32x32x16_bf16 v[176:191], v[216:219], v[248:251], v[176:191]
  v_mfma_f32_32x32x16_bf16 v[192:207], v[220:223], v[248:251], v[192:207]
  v_mfma_f32_32x32x16_bf16 v[208:223], v[224:227], v[248:251], 0
  v_mfma_f32_32x32x16_bf16 v[224:239], v[244:247], v[248:251], 0
  s_waitcnt lgkmcnt(3)
  v_mfma_f32_32x32x16_bf16 v[208:223], a[224:227], v[16:19], v[208:223]
  ds_read_b128 a[252:255], v241 offset:7168
  buffer_load_dwordx4 v0, s[8:11], s57 offen offset:3072 sc1 lds
  v_mfma_f32_32x32x16_bf16 v[224:239], a[228:231], v[16:19], v[224:239]
  ds_read_b128 a[224:227], v241 offset:8192
  v_mfma_f32_32x32x16_bf16 v[208:223], a[232:235], v[20:23], v[208:223]
  ds_read_b128 a[228:231], v241 offset:9216
  v_mul_f32 v244, v242, v144
  v_mul_f32 v245, v242, v145
  v_mul_f32 v246, v242, v146
  v_mul_f32 v247, v242, v147
  s_getpc_b64 s[4:5]
L_pc_72:
  s_lshl_b32 s46, s37, 2
  s_add_u32 s46, s46, s38
  s_and_b32 s46, s46, 3
  s_lshl_b32 s46, s46, 11
  s_add_u32 s46, s46, 4096
  v_lshrrev_b32 v6, 6, v0
  v_lshl_add_u32 v6, v6, 7, s46
  v_min_u32 v6, L_end-L_pc_72-4, v6
  global_load_dword v7, v6, s[4:5]
  v_mfma_f32_32x32x16_bf16 v[224:239], a[236:239], v[20:23], v[224:239]
  ds_read_b128 a[232:235], v241 offset:10240
  v_exp_f32 v244, v244
  v_exp_f32 v245, v245
  s_waitcnt lgkmcnt(3)
  v_mfma_f32_32x32x16_bf16 v[208:223], a[240:243], v[24:27], v[208:223]
  ds_read_b128 a[236:239], v241 offset:11264
  v_exp_f32 v246, v246
  v_exp_f32 v247, v247
  v_mul_f32 v144, v144, v152
  v_mfma_f32_32x32x16_bf16 v[224:239], a[244:247], v[24:27], v[224:239]
  ds_read_b128 a[240:243], v241 offset:12288
  v_mul_f32 v145, v145, v153
  v_mul_f32 v146, v146, v154
  v_mul_f32 v147, v147, v155
  v_fma_f32 v244, v244, v243, v243
  v_fma_f32 v245, v245, v243, v243
  v_mfma_f32_32x32x16_bf16 v[208:223], a[248:251], v[28:31], v[208:223]
  ds_read_b128 a[244:247], v241 offset:13312
  v_fma_f32 v246, v246, v243, v243
  v_fma_f32 v247, v247, v243, v243
  v_rcp_f32 v244, v244
  v_mfma_f32_32x32x16_bf16 v[224:239], a[252:255], v[28:31], v[224:239]
  ds_read_b128 a[248:251], v241 offset:14336
  v_rcp_f32 v245, v245
  v_rcp_f32 v246, v246
  s_waitcnt lgkmcnt(3)
  v_mfma_f32_32x32x16_bf16 v[208:223], a[224:227], v[32:35], v[208:223]
  ds_read_b128 a[252:255], v241 offset:15360
  v_rcp_f32 v247, v247
  v_mul_f32 v144, v144, v244
  v_mul_f32 v145, v145, v245
  v_mul_f32 v146, v146, v246
  v_mfma_f32_32x32x16_bf16 v[224:239], a[228:231], v[32:35], v[224:239]
  ds_read_b128 a[224:227], v241 offset:16384
  v_mul_f32 v147, v147, v247
  v_mul_f32 v244, v242, v148
  v_mul_f32 v245, v242, v149
  v_mul_f32 v246, v242, v150
  v_mul_f32 v247, v242, v151
  v_mfma_f32_32x32x16_bf16 v[208:223], a[232:235], v[36:39], v[208:223]
  ds_read_b128 a[228:231], v241 offset:17408
  v_exp_f32 v244, v244
  v_exp_f32 v245, v245
  v_mfma_f32_32x32x16_bf16 v[224:239], a[236:239], v[36:39], v[224:239]
  ds_read_b128 a[232:235], v241 offset:18432
  v_exp_f32 v246, v246
  v_exp_f32 v247, v247
  s_waitcnt lgkmcnt(3)
  v_mfma_f32_32x32x16_bf16 v[208:223], a[240:243], v[40:43], v[208:223]
  ds_read_b128 a[236:239], v241 offset:19456
  v_mul_f32 v148, v148, v156
  v_mul_f32 v149, v149, v157
  v_mul_f32 v150, v150, v158
  v_mul_f32 v151, v151, v159
  v_fma_f32 v244, v244, v243, v243
  v_mfma_f32_32x32x16_bf16 v[224:239], a[244:247], v[40:43], v[224:239]
  ds_read_b128 a[240:243], v241 offset:20480
  v_fma_f32 v245, v245, v243, v243
  v_fma_f32 v246, v246, v243, v243
  v_fma_f32 v247, v247, v243, v243
  v_rcp_f32 v244, v244
  v_mfma_f32_32x32x16_bf16 v[208:223], a[248:251], v[44:47], v[208:223]
  ds_read_b128 a[244:247], v241 offset:21504
  v_rcp_f32 v245, v245
  v_rcp_f32 v246, v246
  v_mfma_f32_32x32x16_bf16 v[224:239], a[252:255], v[44:47], v[224:239]
  ds_read_b128 a[248:251], v241 offset:22528
  v_rcp_f32 v247, v247
  v_mul_f32 v148, v148, v244
  v_mul_f32 v149, v149, v245
  s_waitcnt lgkmcnt(3)
  v_mfma_f32_32x32x16_bf16 v[208:223], a[224:227], v[48:51], v[208:223]
  ds_read_b128 a[252:255], v241 offset:23552
  v_mul_f32 v150, v150, v246
  v_mul_f32 v151, v151, v247
  v_cvt_pk_bf16_f32 v152, v144, v145
  v_cvt_pk_bf16_f32 v153, v146, v147
  v_cvt_pk_bf16_f32 v154, v148, v149
  v_mfma_f32_32x32x16_bf16 v[224:239], a[228:231], v[48:51], v[224:239]
  ds_read_b128 a[224:227], v241 offset:24576
  v_cvt_pk_bf16_f32 v155, v150, v151
  buffer_store_dwordx4 v[152:155], v0, s[8:11], s6 offen
  v_mul_f32 v244, v242, v160
  v_mul_f32 v245, v242, v161
  v_mul_f32 v246, v242, v162
  v_mfma_f32_32x32x16_bf16 v[208:223], a[232:235], v[52:55], v[208:223]
  ds_read_b128 a[228:231], v241 offset:25600
  v_mul_f32 v247, v242, v163
  v_exp_f32 v244, v244
  v_exp_f32 v245, v245
  v_mfma_f32_32x32x16_bf16 v[224:239], a[236:239], v[52:55], v[224:239]
  ds_read_b128 a[232:235], v241 offset:26624
  v_exp_f32 v246, v246
  v_exp_f32 v247, v247
  s_waitcnt lgkmcnt(3)
  v_mfma_f32_32x32x16_bf16 v[208:223], a[240:243], v[56:59], v[208:223]
  ds_read_b128 a[236:239], v241 offset:27648
  v_mul_f32 v160, v160, v168
  v_mul_f32 v161, v161, v169
  v_mul_f32 v162, v162, v170
  v_mul_f32 v163, v163, v171
  v_fma_f32 v244, v244, v243, v243
  v_mfma_f32_32x32x16_bf16 v[224:239], a[244:247], v[56:59], v[224:239]
  ds_read_b128 a[240:243], v241 offset:28672
  v_fma_f32 v245, v245, v243, v243
  v_fma_f32 v246, v246, v243, v243
  v_fma_f32 v247, v247, v243, v243
  v_rcp_f32 v244, v244
  v_mfma_f32_32x32x16_bf16 v[208:223], a[248:251], v[60:63], v[208:223]
  ds_read_b128 a[244:247], v241 offset:29696
  v_rcp_f32 v245, v245
  v_rcp_f32 v246, v246
  v_mfma_f32_32x32x16_bf16 v[224:239], a[252:255], v[60:63], v[224:239]
  ds_read_b128 a[248:251], v241 offset:30720
  v_rcp_f32 v247, v247
  v_mul_f32 v160, v160, v244
  v_mul_f32 v161, v161, v245
  s_waitcnt lgkmcnt(3)
  v_mfma_f32_32x32x16_bf16 v[208:223], a[224:227], v[64:67], v[208:223]
  ds_read_b128 a[252:255], v241 offset:31744
  v_mul_f32 v162, v162, v246
  v_mul_f32 v163, v163, v247
  v_mul_f32 v244, v242, v164
  v_mul_f32 v245, v242, v165
  v_mul_f32 v246, v242, v166
  v_mfma_f32_32x32x16_bf16 v[224:239], a[228:231], v[64:67], v[224:239]
  s_waitcnt vmcnt(10)
  s_waitcnt lgkmcnt(0)
  s_barrier
  ds_read_b128 a[224:227], v0 offset:0
  v_mul_f32 v247, v242, v167
  v_exp_f32 v244, v244
  v_exp_f32 v245, v245
  s_mul_i32 s64, s40, 98304
  s_add_u32 s64, s64, 2097152
  v_mfma_f32_32x32x16_bf16 v[208:223], a[232:235], v[68:71], v[208:223]
  ds_read_b128 a[228:231], v0 offset:1024
  v_exp_f32 v246, v246
  v_exp_f32 v247, v247
  v_mul_f32 v164, v164, v172
  s_mul_i32 s62, s38, 24576
  s_add_u32 s63, s62, s64
  v_mfma_f32_32x32x16_bf16 v[224:239], a[236:239], v[68:71], v[224:239]
  ds_read_b128 a[232:235], v0 offset:2048
  v_mul_f32 v165, v165, v173
  v_mul_f32 v166, v166, v174
  v_mul_f32 v167, v167, v175
  v_fma_f32 v244, v244, v243, v243
  s_add_u32 s63, s63, 0
  s_add_u32 s62, s62, 65536
  v_mfma_f32_32x32x16_bf16 v[208:223], a[240:243], v[72:75], v[208:223]
  ds_read_b128 a[236:239], v0 offset:3072
  v_fma_f32 v245, v245, v243, v243
  v_fma_f32 v246, v246, v243, v243
  v_fma_f32 v247, v247, v243, v243
  v_rcp_f32 v244, v244
  s_mov_b32 m0, s62
  s_nop 0
  buffer_load_dwordx4 v0, s[8:11], s63 offen sc1 lds
  v_mfma_f32_32x32x16_bf16 v[224:239], a[244:247], v[72:75], v[224:239]
  ds_read_b128 a[240:243], v0 offset:4096
  v_rcp_f32 v245, v245
  v_rcp_f32 v246, v246
  v_mfma_f32_32x32x16_bf16 v[208:223], a[248:251], v[76:79], v[208:223]
  ds_read_b128 a[244:247], v0 offset:5120
  v_rcp_f32 v247, v247
  v_mul_f32 v164, v164, v244
  v_mul_f32 v165, v165, v245
  v_mul_f32 v166, v166, v246
  buffer_load_dwordx4 v0, s[8:11], s63 offen offset:1024 sc1 lds
  v_mfma_f32_32x32x16_bf16 v[224:239], a[252:255], v[76:79], v[224:239]
  ds_read_b128 a[248:251], v0 offset:6144
  v_mul_f32 v167, v167, v247
  v_cvt_pk_bf16_f32 v168, v160, v161
  v_cvt_pk_bf16_f32 v169, v162, v163
  v_cvt_pk_bf16_f32 v170, v164, v165
  s_waitcnt lgkmcnt(3)
  v_mfma_f32_32x32x16_bf16 v[208:223], a[224:227], v[80:83], v[208:223]
  ds_read_b128 a[252:255], v0 offset:7168
  v_cvt_pk_bf16_f32 v171, v166, v167
  buffer_store_dwordx4 v[168:171], v0, s[8:11], s6 offen offset:1024
  v_mul_f32 v244, v242, v176
  v_mul_f32 v245, v242, v177
  v_mul_f32 v246, v242, v178
  buffer_load_dwordx4 v0, s[8:11], s63 offen offset:2048 sc1 lds
  v_mfma_f32_32x32x16_bf16 v[224:239], a[228:231], v[80:83], v[224:239]
  ds_read_b128 a[224:227], v0 offset:8192
  v_mul_f32 v247, v242, v179
  v_exp_f32 v244, v244
  v_exp_f32 v245, v245
  v_mfma_f32_32x32x16_bf16 v[208:223], a[232:235], v[84:87], v[208:223]
  ds_read_b128 a[228:231], v0 offset:9216
  v_exp_f32 v246, v246
  v_exp_f32 v247, v247
  v_mul_f32 v176, v176, v184
  buffer_load_dwordx4 v0, s[8:11], s63 offen offset:3072 sc1 lds
  v_mfma_f32_32x32x16_bf16 v[224:239], a[236:239], v[84:87], v[224:239]
  ds_read_b128 a[232:235], v0 offset:10240
  v_mul_f32 v177, v177, v185
  v_mul_f32 v178, v178, v186
  v_mul_f32 v179, v179, v187
  v_fma_f32 v244, v244, v243, v243
  s_add_u32 s62, s62, 4096
  s_add_u32 s63, s63, 4096
  s_waitcnt lgkmcnt(3)
  v_mfma_f32_32x32x16_bf16 v[208:223], a[240:243], v[88:91], v[208:223]
  ds_read_b128 a[236:239], v0 offset:11264
  v_fma_f32 v245, v245, v243, v243
  v_fma_f32 v246, v246, v243, v243
  v_fma_f32 v247, v247, v243, v243
  v_rcp_f32 v244, v244
  s_mov_b32 m0, s62
  s_nop 0
  buffer_load_dwordx4 v0, s[8:11], s63 offen sc1 lds
  v_mfma_f32_32x32x16_bf16 v[224:239], a[244:247], v[88:91], v[224:239]
  ds_read_b128 a[240:243], v0 offset:12288
  v_rcp_f32 v245, v245
  v_rcp_f32 v246, v246
  v_mfma_f32_32x32x16_bf16 v[208:223], a[248:251], v[92:95], v[208:223]
  ds_read_b128 a[244:247], v0 offset:13312
  v_rcp_f32 v247, v247
  v_mul_f32 v176, v176, v244
  v_mul_f32 v177, v177, v245
  v_mul_f32 v178, v178, v246
  buffer_load_dwordx4 v0, s[8:11], s63 offen offset:1024 sc1 lds
  v_mfma_f32_32x32x16_bf16 v[224:239], a[252:255], v[92:95], v[224:239]
  ds_read_b128 a[248:251], v0 offset:14336
  v_mul_f32 v179, v179, v247
  v_mul_f32 v244, v242, v180
  v_mul_f32 v245, v242, v181
  v_mul_f32 v246, v242, v182
  s_waitcnt lgkmcnt(3)
  v_mfma_f32_32x32x16_bf16 v[208:223], a[224:227], v[96:99], v[208:223]
  ds_read_b128 a[252:255], v0 offset:15360
  v_mul_f32 v247, v242, v183
  v_exp_f32 v244, v244
  v_exp_f32 v245, v245
  buffer_load_dwordx4 v0, s[8:11], s63 offen offset:2048 sc1 lds
  v_mfma_f32_32x32x16_bf16 v[224:239], a[228:231], v[96:99], v[224:239]
  ds_read_b128 a[224:227], v0 offset:16384
  v_exp_f32 v246, v246
  v_exp_f32 v247, v247
  v_mul_f32 v180, v180, v188
  v_mfma_f32_32x32x16_bf16 v[208:223], a[232:235], v[100:103], v[208:223]
  ds_read_b128 a[228:231], v0 offset:17408
  v_mul_f32 v181, v181, v189
  v_mul_f32 v182, v182, v190
  v_mul_f32 v183, v183, v191
  v_fma_f32 v244, v244, v243, v243
  v_fma_f32 v245, v245, v243, v243
  buffer_load_dwordx4 v0, s[8:11], s63 offen offset:3072 sc1 lds
  v_mfma_f32_32x32x16_bf16 v[224:239], a[236:239], v[100:103], v[224:239]
  ds_read_b128 a[232:235], v0 offset:18432
  v_fma_f32 v246, v246, v243, v243
  v_fma_f32 v247, v247, v243, v243
  v_rcp_f32 v244, v244
  s_add_u32 s62, s62, 4096
  s_add_u32 s63, s63, 4096
  s_waitcnt lgkmcnt(3)
  v_mfma_f32_32x32x16_bf16 v[208:223], a[240:243], v[104:107], v[208:223]
  ds_read_b128 a[236:239], v0 offset:19456
  v_rcp_f32 v245, v245
  v_rcp_f32 v246, v246
  s_mov_b32 m0, s62
  s_nop 0
  buffer_load_dwordx4 v0, s[8:11], s63 offen sc1 lds
  v_mfma_f32_32x32x16_bf16 v[224:239], a[244:247], v[104:107], v[224:239]
  ds_read_b128 a[240:243], v0 offset:20480
  v_rcp_f32 v247, v247
  v_mul_f32 v180, v180, v244
  v_mul_f32 v181, v181, v245
  v_mul_f32 v182, v182, v246
  v_mfma_f32_32x32x16_bf16 v[208:223], a[248:251], v[108:111], v[208:223]
  ds_read_b128 a[244:247], v0 offset:21504
  v_mul_f32 v183, v183, v247
  v_cvt_pk_bf16_f32 v184, v176, v177
  v_cvt_pk_bf16_f32 v185, v178, v179
  v_cvt_pk_bf16_f32 v186, v180, v181
  v_cvt_pk_bf16_f32 v187, v182, v183
  buffer_load_dwordx4 v0, s[8:11], s63 offen offset:1024 sc1 lds
  v_mfma_f32_32x32x16_bf16 v[224:239], a[252:255], v[108:111], v[224:239]
  ds_read_b128 a[248:251], v0 offset:22528
  buffer_store_dwordx4 v[184:187], v0, s[8:11], s6 offen offset:2048
  v_mul_f32 v244, v242, v192
  v_mul_f32 v245, v242, v193
  v_mul_f32 v246, v242, v194
  s_waitcnt lgkmcnt(3)
  v_mfma_f32_32x32x16_bf16 v[208:223], a[224:227], v[112:115], v[208:223]
  ds_read_b128 a[252:255], v0 offset:23552
  v_mul_f32 v247, v242, v195
  v_exp_f32 v244, v244
  v_exp_f32 v245, v245
  buffer_load_dwordx4 v0, s[8:11], s63 offen offset:2048 sc1 lds
  v_mfma_f32_32x32x16_bf16 v[224:239], a[228:231], v[112:115], v[224:239]
  ds_read_b128 a[224:227], v0 offset:24576
  v_exp_f32 v246, v246
  v_exp_f32 v247, v247
  v_mul_f32 v192, v192, v200
  v_mfma_f32_32x32x16_bf16 v[208:223], a[232:235], v[116:119], v[208:223]
  ds_read_b128 a[228:231], v0 offset:25600
  v_mul_f32 v193, v193, v201
  v_mul_f32 v194, v194, v202
  v_mul_f32 v195, v195, v203
  v_fma_f32 v244, v244, v243, v243
  v_fma_f32 v245, v245, v243, v243
  buffer_load_dwordx4 v0, s[8:11], s63 offen offset:3072 sc1 lds
  v_mfma_f32_32x32x16_bf16 v[224:239], a[236:239], v[116:119], v[224:239]
  ds_read_b128 a[232:235], v0 offset:26624
  v_fma_f32 v246, v246, v243, v243
  v_fma_f32 v247, v247, v243, v243
  v_rcp_f32 v244, v244
  s_waitcnt lgkmcnt(3)
  v_mfma_f32_32x32x16_bf16 v[208:223], a[240:243], v[120:123], v[208:223]
  ds_read_b128 a[236:239], v0 offset:27648
  v_rcp_f32 v245, v245
  v_rcp_f32 v246, v246
  v_mfma_f32_32x32x16_bf16 v[224:239], a[244:247], v[120:123], v[224:239]
  ds_read_b128 a[240:243], v0 offset:28672
  v_rcp_f32 v247, v247
  v_mul_f32 v192, v192, v244
  v_mul_f32 v193, v193, v245
  v_mul_f32 v194, v194, v246
  v_mfma_f32_32x32x16_bf16 v[208:223], a[248:251], v[124:127], v[208:223]
  ds_read_b128 a[244:247], v0 offset:29696
  v_mul_f32 v195, v195, v247
  v_mul_f32 v244, v242, v196
  v_mul_f32 v245, v242, v197
  v_mul_f32 v246, v242, v198
  v_mul_f32 v247, v242, v199
  v_mfma_f32_32x32x16_bf16 v[224:239], a[252:255], v[124:127], v[224:239]
  ds_read_b128 a[248:251], v0 offset:30720
  v_exp_f32 v244, v244
  v_exp_f32 v245, v245
  s_waitcnt lgkmcnt(3)
  v_mfma_f32_32x32x16_bf16 v[208:223], a[224:227], v[128:131], v[208:223]
  ds_read_b128 a[252:255], v0 offset:31744
  v_exp_f32 v246, v246
  v_exp_f32 v247, v247
  v_mul_f32 v196, v196, v204
  v_mfma_f32_32x32x16_bf16 v[224:239], a[228:231], v[128:131], v[224:239]
  s_waitcnt vmcnt(16)
  s_barrier
  ds_read_b128 a[224:227], v0 offset:32768
  v_mul_f32 v197, v197, v205
  v_mul_f32 v198, v198, v206
  v_mul_f32 v199, v199, v207
  v_fma_f32 v244, v244, v243, v243
  v_fma_f32 v245, v245, v243, v243
  v_mfma_f32_32x32x16_bf16 v[208:223], a[232:235], v[132:135], v[208:223]
  ds_read_b128 a[228:231], v0 offset:33792
  v_fma_f32 v246, v246, v243, v243
  v_fma_f32 v247, v247, v243, v243
  v_rcp_f32 v244, v244
  v_mfma_f32_32x32x16_bf16 v[224:239], a[236:239], v[132:135], v[224:239]
  ds_read_b128 a[232:235], v0 offset:34816
  v_rcp_f32 v245, v245
  v_rcp_f32 v246, v246
  s_waitcnt lgkmcnt(3)
  v_mfma_f32_32x32x16_bf16 v[208:223], a[240:243], v[136:139], v[208:223]
  ds_read_b128 a[236:239], v0 offset:35840
  v_rcp_f32 v247, v247
  v_mul_f32 v196, v196, v244
  v_mul_f32 v197, v197, v245
  v_mul_f32 v198, v198, v246
  v_mfma_f32_32x32x16_bf16 v[224:239], a[244:247], v[136:139], v[224:239]
  ds_read_b128 a[240:243], v0 offset:36864
  v_mul_f32 v199, v199, v247
  v_cvt_pk_bf16_f32 v200, v192, v193
  v_cvt_pk_bf16_f32 v201, v194, v195
  v_cvt_pk_bf16_f32 v202, v196, v197
  v_cvt_pk_bf16_f32 v203, v198, v199
  v_mfma_f32_32x32x16_bf16 v[208:223], a[248:251], v[140:143], v[208:223]
  ds_read_b128 a[244:247], v0 offset:37888
  buffer_store_dwordx4 v[200:203], v0, s[8:11], s6 offen offset:3072
  v_mfma_f32_32x32x16_bf16 v[224:239], a[252:255], v[140:143], v[224:239]
  ds_read_b128 a[248:251], v0 offset:38912
  v_mfma_f32_32x32x16_bf16 v[144:159], v[252:255], v[248:251], 0
  s_waitcnt lgkmcnt(3)
  v_mfma_f32_32x32x16_bf16 v[144:159], a[224:227], v[16:19], v[144:159]
  ds_read_b128 a[252:255], v0 offset:39936
  v_mfma_f32_32x32x16_bf16 v[144:159], a[228:231], v[20:23], v[144:159]
  ds_read_b128 a[224:227], v0 offset:40960
  v_mfma_f32_32x32x16_bf16 v[144:159], a[232:235], v[24:27], v[144:159]
  ds_read_b128 a[228:231], v0 offset:41984
  v_mul_f32 v244, v242, v208
  v_mul_f32 v245, v242, v209
  v_mul_f32 v246, v242, v210
  v_mul_f32 v247, v242, v211
  v_mfma_f32_32x32x16_bf16 v[144:159], a[236:239], v[28:31], v[144:159]
  ds_read_b128 a[232:235], v0 offset:43008
  v_exp_f32 v244, v244
  v_exp_f32 v245, v245
  s_waitcnt lgkmcnt(3)
  v_mfma_f32_32x32x16_bf16 v[144:159], a[240:243], v[32:35], v[144:159]
  ds_read_b128 a[236:239], v0 offset:44032
  v_exp_f32 v246, v246
  v_exp_f32 v247, v247
  v_mul_f32 v208, v208, v216
  s_waitcnt vmcnt(0)
  v_mov_b32 v5, 1
  s_cmp_lg_u32 s45, 0
  s_cbranch_scc1 L_slow_74
  s_mov_b64 exec, 16
  buffer_store_dword v5, v3, s[8:11], 0 offen
  s_mov_b64 exec, -1
L_join_75:
  v_mfma_f32_32x32x16_bf16 v[144:159], a[244:247], v[36:39], v[144:159]
  ds_read_b128 a[240:243], v0 offset:45056
  v_mul_f32 v209, v209, v217
  v_mul_f32 v210, v210, v218
  v_mul_f32 v211, v211, v219
  v_fma_f32 v244, v244, v243, v243
  v_fma_f32 v245, v245, v243, v243
  v_and_b32 v4, 28, v1
  v_mfma_f32_32x32x16_bf16 v[144:159], a[248:251], v[40:43], v[144:159]
  ds_read_b128 a[244:247], v0 offset:46080
  v_fma_f32 v246, v246, v243, v243
  v_fma_f32 v247, v247, v243, v243
  v_rcp_f32 v244, v244
  s_lshr_b32 s50, s41, 1
  s_lshl_b32 s50, s50, 2
  v_mfma_f32_32x32x16_bf16 v[144:159], a[252:255], v[44:47], v[144:159]
  ds_read_b128 a[248:251], v0 offset:47104
  v_rcp_f32 v245, v245
  v_rcp_f32 v246, v246
  s_add_u32 s50, s50, s38
  s_lshl_b32 s50, s50, 7
  s_waitcnt lgkmcnt(3)
  v_mfma_f32_32x32x16_bf16 v[144:159], a[224:227], v[48:51], v[144:159]
  ds_read_b128 a[252:255], v0 offset:48128
  v_rcp_f32 v247, v247
  v_mul_f32 v208, v208, v244
  v_mul_f32 v209, v209, v245
  v_mul_f32 v210, v210, v246
  s_add_u32 s50, s50, 32768
  s_mul_i32 s53, s38, 28672
  v_mfma_f32_32x32x16_bf16 v[144:159], a[228:231], v[52:55], v[144:159]
  ds_read_b128 a[224:227], v0 offset:49152
  v_mul_f32 v211, v211, v247
  v_mul_f32 v244, v242, v212
  v_mul_f32 v245, v242, v213
  v_mul_f32 v246, v242, v214
  v_mul_f32 v247, v242, v215
  s_add_u32 s53, s53, 14680064
  s_mul_i32 s51, s42, 114688
  v_mfma_f32_32x32x16_bf16 v[144:159], a[232:235], v[56:59], v[144:159]
  ds_read_b128 a[228:231], v0 offset:50176
  v_exp_f32 v244, v244
  v_exp_f32 v245, v245
  s_add_u32 s51, s51, s53
  s_mul_i32 s52, s41, 114688
  v_mfma_f32_32x32x16_bf16 v[144:159], a[236:239], v[60:63], v[144:159]
  ds_read_b128 a[232:235], v0 offset:51200
  v_exp_f32 v246, v246
  v_exp_f32 v247, v247
  s_add_u32 s52, s52, s53
  s_waitcnt lgkmcnt(3)
  v_mfma_f32_32x32x16_bf16 v[144:159], a[240:243], v[64:67], v[144:159]
  ds_read_b128 a[236:239], v0 offset:52224
  v_mul_f32 v212, v212, v220
  v_mul_f32 v213, v213, v221
  v_mul_f32 v214, v214, v222
  v_mul_f32 v215, v215, v223
  v_fma_f32 v244, v244, v243, v243
  v_mfma_f32_32x32x16_bf16 v[144:159], a[244:247], v[68:71], v[144:159]
  ds_read_b128 a[240:243], v0 offset:53248
  v_fma_f32 v245, v245, v243, v243
  v_fma_f32 v246, v246, v243, v243
  v_fma_f32 v247, v247, v243, v243
  v_rcp_f32 v244, v244
  v_mfma_f32_32x32x16_bf16 v[144:159], a[248:251], v[72:75], v[144:159]
  ds_read_b128 a[244:247], v0 offset:54272
  v_rcp_f32 v245, v245
  v_rcp_f32 v246, v246
  buffer_load_dword v5, v4, s[8:11], s50 offen sc1
  v_mfma_f32_32x32x16_bf16 v[144:159], a[252:255], v[76:79], v[144:159]
  ds_read_b128 a[248:251], v0 offset:55296
  v_rcp_f32 v247, v247
  v_mul_f32 v212, v212, v244
  v_mul_f32 v213, v213, v245
  s_waitcnt lgkmcnt(3)
  v_mfma_f32_32x32x16_bf16 v[144:159], a[224:227], v[80:83], v[144:159]
  ds_read_b128 a[252:255], v0 offset:56320
  v_mul_f32 v214, v214, v246
  v_mul_f32 v215, v215, v247
  v_cvt_pk_bf16_f32 v216, v208, v209
  v_cvt_pk_bf16_f32 v217, v210, v211
  v_cvt_pk_bf16_f32 v218, v212, v213
  v_mfma_f32_32x32x16_bf16 v[144:159], a[228:231], v[84:87], v[144:159]
  ds_read_b128 a[224:227], v0 offset:57344
  v_cvt_pk_bf16_f32 v219, v214, v215
  buffer_store_dwordx4 v[216:219], v0, s[8:11], s7 offen
  v_mul_f32 v244, v242, v224
  v_mul_f32 v245, v242, v225
  v_mul_f32 v246, v242, v226
  v_mfma_f32_32x32x16_bf16 v[144:159], a[232:235], v[88:91], v[144:159]
  ds_read_b128 a[228:231], v0 offset:58368
  v_mul_f32 v247, v242, v227
  v_exp_f32 v244, v244
  v_exp_f32 v245, v245
  v_mfma_f32_32x32x16_bf16 v[144:159], a[236:239], v[92:95], v[144:159]
  ds_read_b128 a[232:235], v0 offset:59392
  v_exp_f32 v246, v246
  v_exp_f32 v247, v247
  s_waitcnt lgkmcnt(3)
  v_mfma_f32_32x32x16_bf16 v[144:159], a[240:243], v[96:99], v[144:159]
  ds_read_b128 a[236:239], v0 offset:60416
  v_mul_f32 v224, v224, v232
  v_mul_f32 v225, v225, v233
  v_mul_f32 v226, v226, v234
  v_mul_f32 v227, v227, v235
  v_fma_f32 v244, v244, v243, v243
  v_mfma_f32_32x32x16_bf16 v[144:159], a[244:247], v[100:103], v[144:159]
  ds_read_b128 a[240:243], v0 offset:61440
  v_fma_f32 v245, v245, v243, v243
  v_fma_f32 v246, v246, v243, v243
  v_fma_f32 v247, v247, v243, v243
  v_rcp_f32 v244, v244
  v_mfma_f32_32x32x16_bf16 v[144:159], a[248:251], v[104:107], v[144:159]
  ds_read_b128 a[244:247], v0 offset:62464
  v_rcp_f32 v245, v245
  v_rcp_f32 v246, v246
  s_waitcnt vmcnt(1)
  v_cmp_gt_u32 vcc, 1, v5
  s_nop 0
  s_cbranch_vccnz L_lslow_76
L_ljoin_77:
  s_cmp_lg_u32 s45, 0
  s_cbranch_scc1 L_slow_79
L_join_80:
  s_add_u32 s53, s51, 0
  buffer_load_dwordx4 v[16:19], v0, s[8:11], s53 offen sc1
  v_mfma_f32_32x32x16_bf16 v[144:159], a[252:255], v[108:111], v[144:159]
  ds_read_b128 a[248:251], v0 offset:63488
  v_rcp_f32 v247, v247
  v_mul_f32 v224, v224, v244
  v_mul_f32 v225, v225, v245
  buffer_load_dwordx4 v[20:23], v0, s[8:11], s53 offen offset:1024 sc1
  s_waitcnt lgkmcnt(3)
  v_mfma_f32_32x32x16_bf16 v[144:159], a[224:227], v[112:115], v[144:159]
  ds_read_b128 a[252:255], v0 offset:64512
  v_mul_f32 v226, v226, v246
  v_mul_f32 v227, v227, v247
  v_mul_f32 v244, v242, v228
  v_mul_f32 v245, v242, v229
  v_mul_f32 v246, v242, v230
  buffer_load_dwordx4 v[24:27], v0, s[8:11], s53 offen offset:2048 sc1
  v_mfma_f32_32x32x16_bf16 v[144:159], a[228:231], v[116:119], v[144:159]
  v_mul_f32 v247, v242, v231
  v_exp_f32 v244, v244
  v_exp_f32 v245, v245
  buffer_load_dwordx4 v[28:31], v0, s[8:11], s53 offen offset:3072 sc1
  v_mfma_f32_32x32x16_bf16 v[144:159], a[232:235], v[120:123], v[144:159]
  v_exp_f32 v246, v246
  v_exp_f32 v247, v247
  v_mul_f32 v228, v228, v236
  s_add_u32 s53, s51, 7168
  buffer_load_dwordx4 v[32:35], v0, s[8:11], s53 offen sc1
  v_mfma_f32_32x32x16_bf16 v[144:159], a[236:239], v[124:127], v[144:159]
  v_mul_f32 v229, v229, v237
  v_mul_f32 v230, v230, v238
  v_mul_f32 v231, v231, v239
  v_fma_f32 v244, v244, v243, v243
  buffer_load_dwordx4 v[36:39], v0, s[8:11], s53 offen offset:1024 sc1
  s_waitcnt lgkmcnt(0)
  v_mfma_f32_32x32x16_bf16 v[144:159], a[240:243], v[128:131], v[144:159]
  v_fma_f32 v245, v245, v243, v243
  v_fma_f32 v246, v246, v243, v243
  v_fma_f32 v247, v247, v243, v243
  v_rcp_f32 v244, v244
  buffer_load_dwordx4 v[40:43], v0, s[8:11], s53 offen offset:2048 sc1
  v_mfma_f32_32x32x16_bf16 v[144:159], a[244:247], v[132:135], v[144:159]
  v_rcp_f32 v245, v245
  v_rcp_f32 v246, v246
  buffer_load_dwordx4 v[44:47], v0, s[8:11], s53 offen offset:3072 sc1
  v_mfma_f32_32x32x16_bf16 v[144:159], a[248:251], v[136:139], v[144:159]
  v_rcp_f32 v247, v247
  v_mul_f32 v228, v228, v244
  v_mul_f32 v229, v229, v245
  v_mul_f32 v230, v230, v246
  s_add_u32 s53, s51, 14336
  buffer_load_dwordx4 v[48:51], v0, s[8:11], s53 offen sc1
  v_mfma_f32_32x32x16_bf16 v[144:159], a[252:255], v[140:143], v[144:159]
  v_mul_f32 v231, v231, v247
  v_cvt_pk_bf16_f32 v232, v224, v225
  v_cvt_pk_bf16_f32 v233, v226, v227
  v_cvt_pk_bf16_f32 v234, v228, v229
  buffer_load_dwordx4 v[52:55], v0, s[8:11], s53 offen offset:1024 sc1
  v_cvt_pk_bf16_f32 v235, v230, v231
  buffer_store_dwordx4 v[232:235], v0, s[8:11], s7 offen offset:1024
  s_barrier
  s_waitcnt vmcnt(10)
  v_mfma_f32_32x32x16_bf16 v[192:207], a[4:7], v[16:19], 0
  s_nop 1
  v_mul_f32 v244, v242, v144
  v_mul_f32 v245, v242, v145
  v_mul_f32 v246, v242, v146
  v_mul_f32 v247, v242, v147
  v_mfma_f32_32x32x16_bf16 v[208:223], a[0:3], v[16:19], 0
  v_exp_f32 v244, v244
  v_exp_f32 v245, v245
  buffer_load_dwordx4 v[56:59], v0, s[8:11], s53 offen offset:2048 sc1
  s_waitcnt vmcnt(10)
  v_mfma_f32_32x32x16_bf16 v[192:207], a[12:15], v[20:23], v[192:207]
  v_exp_f32 v246, v246
  v_exp_f32 v247, v247
  v_mul_f32 v144, v144, v152
  v_mfma_f32_32x32x16_bf16 v[208:223], a[8:11], v[20:23], v[208:223]
  v_mul_f32 v145, v145, v153
  v_mul_f32 v146, v146, v154
  v_mul_f32 v147, v147, v155
  v_fma_f32 v244, v244, v243, v243
  v_fma_f32 v245, v245, v243, v243
  buffer_load_dwordx4 v[60:63], v0, s[8:11], s53 offen offset:3072 sc1
  s_waitcnt vmcnt(10)
  v_mfma_f32_32x32x16_bf16 v[192:207], a[20:23], v[24:27], v[192:207]
  v_fma_f32 v246, v246, v243, v243
  v_fma_f32 v247, v247, v243, v243
  v_rcp_f32 v244, v244
  v_mfma_f32_32x32x16_bf16 v[208:223], a[16:19], v[24:27], v[208:223]
  v_rcp_f32 v245, v245
  v_rcp_f32 v246, v246
  s_add_u32 s53, s51, 21504
  buffer_load_dwordx4 v[64:67], v0, s[8:11], s53 offen sc1
  s_waitcnt vmcnt(10)
  v_mfma_f32_32x32x16_bf16 v[192:207], a[28:31], v[28:31], v[192:207]
  v_rcp_f32 v247, v247
  v_mul_f32 v144, v144, v244
  v_mul_f32 v145, v145, v245
  v_mul_f32 v146, v146, v246
  v_mfma_f32_32x32x16_bf16 v[208:223], a[24:27], v[28:31], v[208:223]
  v_mul_f32 v147, v147, v247
  v_mul_f32 v244, v242, v148
  v_mul_f32 v245, v242, v149
  v_mul_f32 v246, v242, v150
  v_mul_f32 v247, v242, v151
  buffer_load_dwordx4 v[68:71], v0, s[8:11], s53 offen offset:1024 sc1
  s_waitcnt vmcnt(10)
  v_mfma_f32_32x32x16_bf16 v[192:207], a[60:63], v[32:35], v[192:207]
  v_exp_f32 v244, v244
  v_exp_f32 v245, v245
  v_mfma_f32_32x32x16_bf16 v[208:223], a[56:59], v[32:35], v[208:223]
  v_exp_f32 v246, v246
  v_exp_f32 v247, v247
  v_mul_f32 v148, v148, v156
  buffer_load_dwordx4 v[72:75], v0, s[8:11], s53 offen offset:2048 sc1
  s_waitcnt vmcnt(10)
  v_mfma_f32_32x32x16_bf16 v[192:207], a[68:71], v[36:39], v[192:207]
  v_mul_f32 v149, v149, v157
  v_mul_f32 v150, v150, v158
  v_mul_f32 v151, v151, v159
  v_fma_f32 v244, v244, v243, v243
  v_fma_f32 v245, v245, v243, v243
  v_mfma_f32_32x32x16_bf16 v[208:223], a[64:67], v[36:39], v[208:223]
  v_fma_f32 v246, v246, v243, v243
  v_fma_f32 v247, v247, v243, v243
  v_rcp_f32 v244, v244
  buffer_load_dwordx4 v[76:79], v0, s[8:11], s53 offen offset:3072 sc1
  s_waitcnt vmcnt(10)
  v_mfma_f32_32x32x16_bf16 v[192:207], a[76:79], v[40:43], v[192:207]
  v_rcp_f32 v245, v245
  v_rcp_f32 v246, v246
  v_mfma_f32_32x32x16_bf16 v[208:223], a[72:75], v[40:43], v[208:223]
  v_rcp_f32 v247, v247
  v_mul_f32 v148, v148, v244
  v_mul_f32 v149, v149, v245
  v_mul_f32 v150, v150, v246
  s_add_u32 s53, s52, 0
  buffer_load_dwordx4 v[80:83], v0, s[8:11], s53 offen sc1
  s_waitcnt vmcnt(10)
  v_mfma_f32_32x32x16_bf16 v[192:207], a[84:87], v[44:47], v[192:207]
  v_mul_f32 v151, v151, v247
  v_cvt_pk_bf16_f32 v152, v144, v145
  v_cvt_pk_bf16_f32 v153, v146, v147
  v_cvt_pk_bf16_f32 v154, v148, v149
  v_cvt_pk_bf16_f32 v155, v150, v151
  v_mfma_f32_32x32x16_bf16 v[208:223], a[80:83], v[44:47], v[208:223]
  buffer_store_dwordx4 v[152:155], v0, s[8:11], s7 offen offset:2048
  buffer_load_dwordx4 v[84:87], v0, s[8:11], s53 offen offset:1024 sc1
  s_waitcnt vmcnt(11)
  v_mfma_f32_32x32x16_bf16 v[192:207], a[116:119], v[48:51], v[192:207]
  s_mul_i32 s54, s38, 12288
  s_add_u32 s54, s54, 0
  v_add_u32 v6, s54, v0
  v_mfma_f32_32x32x16_bf16 v[208:223], a[112:115], v[48:51], v[208:223]
  v_lshlrev_b32 v176, 16, v8
  v_and_b32 v177, s47, v8
  buffer_load_dwordx4 v[88:91], v0, s[8:11], s53 offen offset:2048 sc1
  s_waitcnt vmcnt(11)
  v_mfma_f32_32x32x16_bf16 v[192:207], a[124:127], v[52:55], v[192:207]
  v_lshlrev_b32 v178, 16, v9
  v_and_b32 v179, s47, v9
  v_mfma_f32_32x32x16_bf16 v[208:223], a[120:123], v[52:55], v[208:223]
  v_lshlrev_b32 v180, 16, v10
  v_and_b32 v181, s47, v10
  buffer_load_dwordx4 v[92:95], v0, s[8:11], s53 offen offset:3072 sc1
  s_waitcnt vmcnt(10)
  v_mfma_f32_32x32x16_bf16 v[192:207], a[132:135], v[56:59], v[192:207]
  v_lshlrev_b32 v182, 16, v11
  v_and_b32 v183, s47, v11
  v_mfma_f32_32x32x16_bf16 v[208:223], a[128:131], v[56:59], v[208:223]
  v_lshlrev_b32 v184, 16, v12
  v_and_b32 v185, s47, v12
  s_add_u32 s53, s52, 7168
  buffer_load_dwordx4 v[96:99], v0, s[8:11], s53 offen sc1
  s_waitcnt vmcnt(10)
  v_mfma_f32_32x32x16_bf16 v[192:207], a[140:143], v[60:63], v[192:207]
  v_lshlrev_b32 v186, 16, v13
  v_and_b32 v187, s47, v13
  v_mfma_f32_32x32x16_bf16 v[208:223], a[136:139], v[60:63], v[208:223]
  v_lshlrev_b32 v188, 16, v14
  v_and_b32 v189, s47, v14
  buffer_load_dwordx4 v[100:103], v0, s[8:11], s53 offen offset:1024 sc1
  s_waitcnt vmcnt(10)
  v_mfma_f32_32x32x16_bf16 v[192:207], a[172:175], v[64:67], v[192:207]
  v_lshlrev_b32 v190, 16, v15
  v_and_b32 v191, s47, v15
  v_mfma_f32_32x32x16_bf16 v[208:223], a[168:171], v[64:67], v[208:223]
  s_lshl_b32 s48, s44, 1
  s_add_u32 s48, s48, s43
  v_mov_b32 v7, 0x3f803f80
  buffer_load_dwordx4 v[104:107], v0, s[8:11], s53 offen offset:2048 sc1
  s_waitcnt vmcnt(10)
  v_mfma_f32_32x32x16_bf16 v[192:207], a[180:183], v[68:71], v[192:207]
  s_lshl_b32 s55, s41, 15
  s_lshl_b32 s56, s48, 11
  s_add_u32 s55, s55, s56
  s_add_u32 s55, s55, 12582912
  v_mfma_f32_32x32x16_bf16 v[208:223], a[176:179], v[68:71], v[208:223]
  s_lshl_b32 s56, s41, 12
  s_lshr_b32 s57, s48, 2
  s_lshl_b32 s57, s57, 10
  s_add_u32 s56, s56, s57
  s_waitcnt vmcnt(6)
  v_mov_b32 v5, 2
  s_cmp_lg_u32 s45, 0
  s_cbranch_scc1 L_slow_81
  s_mov_b64 exec, 16
  buffer_store_dword v5, v3, s[8:11], 0 offen
  s_mov_b64 exec, -1
L_join_82:
  buffer_load_dwordx4 v[108:111], v0, s[8:11], s53 offen offset:3072 sc1
  v_mfma_f32_32x32x16_bf16 v[192:207], a[188:191], v[72:75], v[192:207]
  s_and_b32 s57, s48, 3
  s_lshl_b32 s57, s57, 2
  s_add_u32 s56, s56, s57
  s_add_u32 s56, s56, 1048576
  v_mfma_f32_32x32x16_bf16 v[208:223], a[184:187], v[72:75], v[208:223]
  s_add_u32 s53, s52, 14336
  buffer_load_dwordx4 v[112:115], v0, s[8:11], s53 offen sc1
  v_mfma_f32_32x32x16_bf16 v[192:207], a[196:199], v[76:79], v[192:207]
  v_mfma_f32_32x32x16_bf16 v[208:223], a[192:195], v[76:79], v[208:223]
  buffer_load_dwordx4 v[116:119], v0, s[8:11], s53 offen offset:1024 sc1
  v_mfma_f32_32x32x16_bf16 v[224:239], a[4:7], v[80:83], 0
  v_mfma_f32_32x32x16_bf16 v[240:255], a[0:3], v[80:83], 0
  buffer_load_dwordx4 v[120:123], v0, s[8:11], s53 offen offset:2048 sc1
  s_waitcnt vmcnt(10)
  v_mfma_f32_32x32x16_bf16 v[224:239], a[12:15], v[84:87], v[224:239]
  v_mfma_f32_32x32x16_bf16 v[240:255], a[8:11], v[84:87], v[240:255]
  buffer_load_dwordx4 v[124:127], v0, s[8:11], s53 offen offset:3072 sc1
  s_waitcnt vmcnt(10)
  v_mfma_f32_32x32x16_bf16 v[224:239], a[20:23], v[88:91], v[224:239]
  v_mfma_f32_32x32x16_bf16 v[240:255], a[16:19], v[88:91], v[240:255]
  buffer_load_dword v5, v4, s[8:11], s50 offen sc1
  s_add_u32 s53, s52, 21504
  buffer_load_dwordx4 v[128:131], v0, s[8:11], s53 offen sc1
  s_waitcnt vmcnt(11)
  v_mfma_f32_32x32x16_bf16 v[224:239], a[28:31], v[92:95], v[224:239]
  v_mfma_f32_32x32x16_bf16 v[240:255], a[24:27], v[92:95], v[240:255]
  buffer_load_dwordx4 v[132:135], v0, s[8:11], s53 offen offset:1024 sc1
  s_waitcnt vmcnt(11)
  v_mfma_f32_32x32x16_bf16 v[224:239], a[60:63], v[96:99], v[224:239]
  v_mfma_f32_32x32x16_bf16 v[240:255], a[56:59], v[96:99], v[240:255]
  buffer_load_dwordx4 v[136:139], v0, s[8:11], s53 offen offset:2048 sc1
  s_waitcnt vmcnt(11)
  v_mfma_f32_32x32x16_bf16 v[224:239], a[68:71], v[100:103], v[224:239]
  v_mfma_f32_32x32x16_bf16 v[240:255], a[64:67], v[100:103], v[240:255]
  buffer_load_dwordx4 v[140:143], v0, s[8:11], s53 offen offset:3072 sc1
  s_waitcnt vmcnt(11)
  v_mfma_f32_32x32x16_bf16 v[224:239], a[76:79], v[104:107], v[224:239]
  v_mfma_f32_32x32x16_bf16 v[240:255], a[72:75], v[104:107], v[240:255]
  s_waitcnt vmcnt(9)
  v_mfma_f32_32x32x16_bf16 v[224:239], a[84:87], v[108:111], v[224:239]
  v_mfma_f32_32x32x16_bf16 v[240:255], a[80:83], v[108:111], v[240:255]
  s_waitcnt vmcnt(4)
  v_cmp_gt_u32 vcc, 2, v5
  s_nop 0
  s_cbranch_vccnz L_lslow_83
L_ljoin_84:
  s_cmp_lg_u32 s45, 0
  s_cbranch_scc1 L_slow_86
L_join_87:
  s_add_u32 s53, s51, 4096
  buffer_load_dwordx4 v[16:19], v0, s[8:11], s53 offen sc1
  buffer_load_dwordx4 v[20:23], v0, s[8:11], s53 offen offset:1024 sc1
  v_mfma_f32_32x32x16_bf16 v[224:239], a[116:119], v[112:115], v[224:239]
  v_mfma_f32_32x32x16_bf16 v[240:255], a[112:115], v[112:115], v[240:255]
  buffer_load_dwordx4 v[24:27], v0, s[8:11], s53 offen offset:2048 sc1
  v_mfma_f32_32x32x16_bf16 v[224:239], a[124:127], v[116:119], v[224:239]
  v_mfma_f32_32x32x16_bf16 v[240:255], a[120:123], v[116:119], v[240:255]
  s_add_u32 s53, s51, 11264
  buffer_load_dwordx4 v[28:31], v0, s[8:11], s53 offen sc1
  v_mfma_f32_32x32x16_bf16 v[224:239], a[132:135], v[120:123], v[224:239]
  v_mfma_f32_32x32x16_bf16 v[240:255], a[128:131], v[120:123], v[240:255]
  buffer_load_dwordx4 v[32:35], v0, s[8:11], s53 offen offset:1024 sc1
  v_mfma_f32_32x32x16_bf16 v[224:239], a[140:143], v[124:127], v[224:239]
  v_mfma_f32_32x32x16_bf16 v[240:255], a[136:139], v[124:127], v[240:255]
  buffer_load_dwordx4 v[36:39], v0, s[8:11], s53 offen offset:2048 sc1
  s_waitcnt vmcnt(9)
  v_mfma_f32_32x32x16_bf16 v[224:239], a[172:175], v[128:131], v[224:239]
  v_mfma_f32_32x32x16_bf16 v[240:255], a[168:171], v[128:131], v[240:255]
  s_add_u32 s53, s51, 18432
  buffer_load_dwordx4 v[40:43], v0, s[8:11], s53 offen sc1
  s_waitcnt vmcnt(9)
  v_mfma_f32_32x32x16_bf16 v[224:239], a[180:183], v[132:135], v[224:239]
  v_mfma_f32_32x32x16_bf16 v[240:255], a[176:179], v[132:135], v[240:255]
  buffer_load_dwordx4 v[44:47], v0, s[8:11], s53 offen offset:1024 sc1
  s_waitcnt vmcnt(9)
  v_mfma_f32_32x32x16_bf16 v[224:239], a[188:191], v[136:139], v[224:239]
  v_mfma_f32_32x32x16_bf16 v[240:255], a[184:187], v[136:139], v[240:255]
  buffer_load_dwordx4 v[48:51], v0, s[8:11], s53 offen offset:2048 sc1
  s_waitcnt vmcnt(9)
  v_mfma_f32_32x32x16_bf16 v[224:239], a[196:199], v[140:143], v[224:239]
  v_mfma_f32_32x32x16_bf16 v[240:255], a[192:195], v[140:143], v[240:255]
  s_add_u32 s53, s51, 25600
  buffer_load_dwordx4 v[52:55], v0, s[8:11], s53 offen sc1
  s_waitcnt vmcnt(9)
  v_mfma_f32_32x32x16_bf16 v[192:207], a[36:39], v[16:19], v[192:207]
  v_mfma_f32_32x32x16_bf16 v[208:223], a[32:35], v[16:19], v[208:223]
  buffer_load_dwordx4 v[56:59], v0, s[8:11], s53 offen offset:1024 sc1
  s_waitcnt vmcnt(9)
  v_mfma_f32_32x32x16_bf16 v[192:207], a[44:47], v[20:23], v[192:207]
  v_mfma_f32_32x32x16_bf16 v[208:223], a[40:43], v[20:23], v[208:223]
  buffer_load_dwordx4 v[60:63], v0, s[8:11], s53 offen offset:2048 sc1
  s_waitcnt vmcnt(9)
  v_mfma_f32_32x32x16_bf16 v[192:207], a[52:55], v[24:27], v[192:207]
  v_mfma_f32_32x32x16_bf16 v[208:223], a[48:51], v[24:27], v[208:223]
  s_add_u32 s53, s52, 4096
  buffer_load_dwordx4 v[64:67], v0, s[8:11], s53 offen sc1
  s_waitcnt vmcnt(9)
  v_mfma_f32_32x32x16_bf16 v[192:207], a[92:95], v[28:31], v[192:207]
  v_mfma_f32_32x32x16_bf16 v[208:223], a[88:91], v[28:31], v[208:223]
  buffer_load_dwordx4 v[68:71], v0, s[8:11], s53 offen offset:1024 sc1
  s_waitcnt vmcnt(9)
  v_mfma_f32_32x32x16_bf16 v[192:207], a[100:103], v[32:35], v[192:207]
  v_mfma_f32_32x32x16_bf16 v[208:223], a[96:99], v[32:35], v[208:223]
  buffer_load_dwordx4 v[72:75], v0, s[8:11], s53 offen offset:2048 sc1
  s_waitcnt vmcnt(9)
  v_mfma_f32_32x32x16_bf16 v[192:207], a[108:111], v[36:39], v[192:207]
  v_mfma_f32_32x32x16_bf16 v[208:223], a[104:107], v[36:39], v[208:223]
  s_add_u32 s53, s52, 11264
  buffer_load_dwordx4 v[76:79], v0, s[8:11], s53 offen sc1
  s_waitcnt vmcnt(9)
  v_mfma_f32_32x32x16_bf16 v[192:207], a[148:151], v[40:43], v[192:207]
  v_mfma_f32_32x32x16_bf16 v[208:223], a[144:147], v[40:43], v[208:223]
  buffer_load_dwordx4 v[80:83], v0, s[8:11], s53 offen offset:1024 sc1
  s_waitcnt vmcnt(9)
  v_mfma_f32_32x32x16_bf16 v[192:207], a[156:159], v[44:47], v[192:207]
  v_mfma_f32_32x32x16_bf16 v[208:223], a[152:155], v[44:47], v[208:223]
  buffer_load_dwordx4 v[84:87], v0, s[8:11], s53 offen offset:2048 sc1
  s_waitcnt vmcnt(9)
  v_mfma_f32_32x32x16_bf16 v[192:207], a[164:167], v[48:51], v[192:207]
  v_mfma_f32_32x32x16_bf16 v[208:223], a[160:163], v[48:51], v[208:223]
  s_add_u32 s53, s52, 18432
  buffer_load_dwordx4 v[88:91], v0, s[8:11], s53 offen sc1
  s_waitcnt vmcnt(9)
  v_mfma_f32_32x32x16_bf16 v[192:207], a[204:207], v[52:55], v[192:207]
  v_mfma_f32_32x32x16_bf16 v[208:223], a[200:203], v[52:55], v[208:223]
  buffer_load_dwordx4 v[92:95], v0, s[8:11], s53 offen offset:1024 sc1
  s_waitcnt vmcnt(9)
  v_mfma_f32_32x32x16_bf16 v[192:207], a[212:215], v[56:59], v[192:207]
  v_mfma_f32_32x32x16_bf16 v[208:223], a[208:211], v[56:59], v[208:223]
  buffer_load_dwordx4 v[96:99], v0, s[8:11], s53 offen offset:2048 sc1
  s_waitcnt vmcnt(9)
  v_mfma_f32_32x32x16_bf16 v[192:207], a[220:223], v[60:63], v[192:207]
  v_mfma_f32_32x32x16_bf16 v[208:223], a[216:219], v[60:63], v[208:223]
  s_add_u32 s53, s52, 25600
  buffer_load_dwordx4 v[100:103], v0, s[8:11], s53 offen sc1
  s_waitcnt vmcnt(9)
  v_mfma_f32_32x32x16_bf16 v[224:239], a[36:39], v[64:67], v[224:239]
  buffer_load_dwordx4 v[104:107], v0, s[8:11], s53 offen offset:1024 sc1
  s_xor_b32 s54, s38, 3
  s_mul_i32 s54, s54, 12288
  s_add_u32 s54, s54, 8192
  v_add_u32 v4, s54, v0
  s_waitcnt vmcnt(9)
  v_mfma_f32_32x32x16_bf16 v[224:239], a[44:47], v[68:71], v[224:239]
  buffer_load_dwordx4 v[108:111], v0, s[8:11], s53 offen offset:2048 sc1
  v_and_b32 v5, 0x3c0, v0
  v_lshlrev_b32 v5, 1, v5
  s_and_b32 s57, s56, 0xfffffc00
  buffer_load_dword v2, v5, s[8:11], s55 offen sc1
  s_waitcnt vmcnt(10)
  v_mfma_f32_32x32x16_bf16 v[224:239], a[52:55], v[72:75], v[224:239]
  ds_write_b128 v4, v[192:195] offset:0
  ds_write_b128 v4, v[196:199] offset:1024
  buffer_load_dword v2, v5, s[8:11], s57 offen sc1
  s_waitcnt vmcnt(10)
  v_mfma_f32_32x32x16_bf16 v[224:239], a[92:95], v[76:79], v[224:239]
  ds_write_b128 v4, v[200:203] offset:2048
  ds_write_b128 v4, v[204:207] offset:3072
  s_add_u32 s62, s62, 4096
  s_add_u32 s63, s63, 4096
  s_mov_b32 m0, s62
  s_nop 0
  buffer_load_dwordx4 v0, s[8:11], s63 offen sc1 lds
  s_waitcnt vmcnt(10)
  v_mfma_f32_32x32x16_bf16 v[224:239], a[100:103], v[80:83], v[224:239]
  s_xor_b32 s54, s38, 2
  s_mul_i32 s54, s54, 12288
  s_add_u32 s54, s54, 4096
  v_add_u32 v4, s54, v0
  buffer_load_dwordx4 v0, s[8:11], s63 offen offset:1024 sc1 lds
  s_waitcnt vmcnt(10)
  v_mfma_f32_32x32x16_bf16 v[224:239], a[108:111], v[84:87], v[224:239]
  ds_write_b128 v4, v[208:211] offset:0
  ds_write_b128 v4, v[212:215] offset:1024
  buffer_load_dwordx4 v0, s[8:11], s63 offen offset:2048 sc1 lds
  s_waitcnt vmcnt(10)
  v_mfma_f32_32x32x16_bf16 v[224:239], a[148:151], v[88:91], v[224:239]
  ds_write_b128 v4, v[216:219] offset:2048
  ds_write_b128 v4, v[220:223] offset:3072
  buffer_load_dwordx4 v0, s[8:11], s63 offen offset:3072 sc1 lds
  s_waitcnt vmcnt(10)
  v_mfma_f32_32x32x16_bf16 v[224:239], a[156:159], v[92:95], v[224:239]
  s_waitcnt lgkmcnt(0)
  s_barrier
  s_add_u32 s62, s62, 4096
  s_add_u32 s63, s63, 4096
  s_mov_b32 m0, s62
  s_nop 0
  buffer_load_dwordx4 v0, s[8:11], s63 offen sc1 lds
  s_waitcnt vmcnt(10)
  v_mfma_f32_32x32x16_bf16 v[224:239], a[164:167], v[96:99], v[224:239]
  ds_read_b128 v[144:147], v6 offset:8192
  ds_read_b128 v[148:151], v6 offset:9216
  buffer_load_dwordx4 v0, s[8:11], s63 offen offset:1024 sc1 lds
  v_mfma_f32_32x32x16_bf16 v[240:255], a[32:35], v[64:67], v[240:255]
  ds_read_b128 v[152:155], v6 offset:10240
  ds_read_b128 v[156:159], v6 offset:11264
  s_waitcnt vmcnt(10)
  v_mfma_f32_32x32x16_bf16 v[224:239], a[204:207], v[100:103], v[224:239]
  ds_read_b128 v[160:163], v6 offset:4096
  ds_read_b128 v[164:167], v6 offset:5120
  buffer_load_dwordx4 v0, s[8:11], s63 offen offset:2048 sc1 lds
  v_mfma_f32_32x32x16_bf16 v[240:255], a[40:43], v[68:71], v[240:255]
  ds_read_b128 v[168:171], v6 offset:6144
  ds_read_b128 v[172:175], v6 offset:7168
  s_waitcnt vmcnt(10)
  v_mfma_f32_32x32x16_bf16 v[224:239], a[212:215], v[104:107], v[224:239]
  s_waitcnt lgkmcnt(7)
  v_add_f32 v176, v176, v144
  v_add_f32 v177, v177, v145
  v_add_f32 v178, v178, v146
  v_add_f32 v179, v179, v147
  s_waitcnt lgkmcnt(6)
  v_add_f32 v180, v180, v148
  v_add_f32 v181, v181, v149
  v_add_f32 v182, v182, v150
  v_add_f32 v183, v183, v151
  buffer_load_dwordx4 v0, s[8:11], s63 offen offset:3072 sc1 lds
  v_mfma_f32_32x32x16_bf16 v[240:255], a[48:51], v[72:75], v[240:255]
  s_waitcnt lgkmcnt(5)
  v_add_f32 v184, v184, v152
  v_add_f32 v185, v185, v153
  v_add_f32 v186, v186, v154
  v_add_f32 v187, v187, v155
  s_waitcnt lgkmcnt(4)
  v_add_f32 v188, v188, v156
  v_add_f32 v189, v189, v157
  v_add_f32 v190, v190, v158
  v_add_f32 v191, v191, v159
  s_waitcnt vmcnt(10)
  v_mfma_f32_32x32x16_bf16 v[224:239], a[220:223], v[108:111], v[224:239]
  s_waitcnt lgkmcnt(3)
  v_add_f32 v176, v176, v160
  v_add_f32 v177, v177, v161
  v_add_f32 v178, v178, v162
  v_add_f32 v179, v179, v163
  s_waitcnt lgkmcnt(2)
  v_add_f32 v180, v180, v164
  v_add_f32 v181, v181, v165
  v_add_f32 v182, v182, v166
  v_add_f32 v183, v183, v167
  s_add_u32 s62, s62, 4096
  s_add_u32 s63, s63, 4096
  s_mov_b32 m0, s62
  s_nop 0
  buffer_load_dwordx4 v0, s[8:11], s63 offen sc1 lds
  v_mfma_f32_32x32x16_bf16 v[240:255], a[88:91], v[76:79], v[240:255]
  s_waitcnt lgkmcnt(1)
  v_add_f32 v184, v184, v168
  v_add_f32 v185, v185, v169
  v_add_f32 v186, v186, v170
  v_add_f32 v187, v187, v171
  s_waitcnt lgkmcnt(0)
  v_add_f32 v188, v188, v172
  v_add_f32 v189, v189, v173
  v_add_f32 v190, v190, v174
  v_add_f32 v191, v191, v175
  buffer_load_dwordx4 v0, s[8:11], s63 offen offset:1024 sc1 lds
  v_mfma_f32_32x32x16_bf16 v[240:255], a[96:99], v[80:83], v[240:255]
  s_xor_b32 s54, s38, 1
  s_mul_i32 s54, s54, 12288
  s_add_u32 s54, s54, 0
  v_add_u32 v4, s54, v0
  buffer_load_dwordx4 v0, s[8:11], s63 offen offset:2048 sc1 lds
  v_mfma_f32_32x32x16_bf16 v[240:255], a[104:107], v[84:87], v[240:255]
  buffer_load_dwordx4 v0, s[8:11], s63 offen offset:3072 sc1 lds
  v_mfma_f32_32x32x16_bf16 v[240:255], a[144:147], v[88:91], v[240:255]
  ds_write_b128 v4, v[224:227] offset:0
  v_mfma_f32_32x32x16_bf16 v[240:255], a[152:155], v[92:95], v[240:255]
  ds_write_b128 v4, v[228:231] offset:1024
  ds_write_b128 v4, v[232:235] offset:2048
  v_mfma_f32_32x32x16_bf16 v[240:255], a[160:163], v[96:99], v[240:255]
  ds_write_b128 v4, v[236:239] offset:3072
  s_waitcnt lgkmcnt(0)
  s_barrier
  v_mfma_f32_32x32x16_bf16 v[240:255], a[200:203], v[100:103], v[240:255]
  ds_read_b128 v[144:147], v6 offset:0
  ds_read_b128 v[148:151], v6 offset:1024
  v_mfma_f32_32x32x16_bf16 v[240:255], a[208:211], v[104:107], v[240:255]
  ds_read_b128 v[152:155], v6 offset:2048
  ds_read_b128 v[156:159], v6 offset:3072
  v_mfma_f32_32x32x16_bf16 v[240:255], a[216:219], v[108:111], v[240:255]
  s_waitcnt lgkmcnt(3)
  v_pk_add_f32 v[176:177], v[176:177], v[144:145]
  v_pk_add_f32 v[178:179], v[178:179], v[146:147]
  s_waitcnt lgkmcnt(2)
  v_pk_add_f32 v[180:181], v[180:181], v[148:149]
  v_pk_add_f32 v[182:183], v[182:183], v[150:151]
  s_waitcnt lgkmcnt(1)
  v_pk_add_f32 v[184:185], v[184:185], v[152:153]
  v_pk_add_f32 v[186:187], v[186:187], v[154:155]
  s_waitcnt lgkmcnt(0)
  v_pk_add_f32 v[188:189], v[188:189], v[156:157]
  v_pk_add_f32 v[190:191], v[190:191], v[158:159]
  v_pk_add_f32 v[240:241], v[240:241], v[176:177]
  v_pk_add_f32 v[242:243], v[242:243], v[178:179]
  v_pk_add_f32 v[244:245], v[244:245], v[180:181]
  v_pk_add_f32 v[246:247], v[246:247], v[182:183]
  v_cvt_pk_bf16_f32 v8, v240, v241
  v_cvt_pk_bf16_f32 v9, v242, v243
  v_cvt_pk_bf16_f32 v10, v244, v245
  v_cvt_pk_bf16_f32 v11, v246, v247
  buffer_store_dwordx4 v[8:11], v0, s[8:11], s55 offen
  v_pk_add_f32 v[248:249], v[248:249], v[184:185]
  v_pk_add_f32 v[250:251], v[250:251], v[186:187]
  v_pk_add_f32 v[252:253], v[252:253], v[188:189]
  v_pk_add_f32 v[254:255], v[254:255], v[190:191]
  v_cvt_pk_bf16_f32 v12, v248, v249
  v_cvt_pk_bf16_f32 v13, v250, v251
  v_cvt_pk_bf16_f32 v14, v252, v253
  v_cvt_pk_bf16_f32 v15, v254, v255
  buffer_store_dwordx4 v[12:15], v0, s[8:11], s55 offen offset:1024
  v_mov_b32 v176, 0
  v_mov_b32 v177, 0
  v_mov_b32 v178, 0
  v_mov_b32 v179, 0
  v_dot2c_f32_bf16 v176, v8, v7
  v_dot2c_f32_bf16 v178, v8, v8
  v_dot2c_f32_bf16 v177, v9, v7
  v_dot2c_f32_bf16 v179, v9, v9
  v_dot2c_f32_bf16 v176, v10, v7
  v_dot2c_f32_bf16 v178, v10, v10
  v_dot2c_f32_bf16 v177, v11, v7
  v_dot2c_f32_bf16 v179, v11, v11
  v_dot2c_f32_bf16 v176, v12, v7
  v_dot2c_f32_bf16 v178, v12, v12
  v_dot2c_f32_bf16 v177, v13, v7
  v_dot2c_f32_bf16 v179, v13, v13
  v_dot2c_f32_bf16 v176, v14, v7
  v_dot2c_f32_bf16 v178, v14, v14
  v_dot2c_f32_bf16 v177, v15, v7
  v_dot2c_f32_bf16 v179, v15, v15
  s_nop 1
  v_add_f32 v176, v176, v177
  v_add_f32 v178, v178, v179
  s_nop 1
  v_permlane32_swap_b32 v176, v178
  v_add_f32 v176, v176, v178
  s_cmp_lg_u32 s45, 0
  s_cbranch_scc1 L_slow_88
  buffer_store_dword v176, v0, s[8:11], s56 offen
L_join_89:
  s_waitcnt vmcnt(0)
  v_mov_b32 v5, 1
  s_cmp_lg_u32 s45, 0
  s_cbranch_scc1 L_slow_90
  s_mov_b64 exec, 32
  buffer_store_dword v5, v3, s[8:11], 0 offen
  s_mov_b64 exec, -1
L_join_91:
  s_barrier
  v_add_u32 v224, 65536, v0
  v_add_u32 v225, 114688, v0
  v_lshrrev_b32 v4, 4, v0
  v_and_b32 v6, 0x33, v4
  v_bfe_u32 v7, v4, 2, 1
  v_lshl_add_u32 v6, v7, 3, v6
  v_bfe_u32 v7, v4, 3, 1
  v_lshl_add_u32 v6, v7, 2, v6
  v_lshlrev_b32 v242, 4, v6
  v_bfe_u32 v6, v4, 4, 1
  v_lshlrev_b32 v243, 17, v6
  v_lshrrev_b32 v6, 5, v4
  v_lshl_add_u32 v243, v6, 8, v243
  v_and_b32 v6, 15, v4
  v_lshl_add_u32 v243, v6, 4, v243
  s_lshl_b32 s59, s40, 7
  s_add_u32 s59, s59, s39
  s_lshl_b32 s55, s59, 11
  s_add_u32 s55, s55, 27262976
  s_add_u32 s56, s55, 0x20000
  s_lshl_b32 s57, s39, 4
  s_add_u32 s57, s57, s40
  s_lshl_b32 s57, s57, 11
  s_add_u32 s57, s57, 10485760
  s_lshl_b32 s52, s40, 10
  s_add_u32 s52, s52, 9830400
  s_lshl_b32 s54, s38, 8
  s_add_u32 s54, s54, 49152
  v_and_b32 v4, 60, v1
  s_lshl_b32 s50, s39, 7
  s_add_u32 s50, s50, 57344
  s_lshl_b32 s48, s39, 12
  s_add_u32 s48, s48, 1048576
  s_lshl_b32 s49, s39, 15
  s_add_u32 s49, s49, 12582912
  ds_read_b128 a[224:227], v224 offset:1024
  ds_read_b128 a[228:231], v224 offset:2048
  ds_read_b128 a[232:235], v224 offset:0
  ds_read_b128 a[236:239], v224 offset:4096
  ds_read_b128 a[240:243], v224 offset:5120
  ds_read_b128 a[244:247], v224 offset:3072
  ds_read_b128 a[248:251], v224 offset:7168
  s_mov_b32 s46, 2097152
L_poll_92:
  buffer_load_dword v5, v4, s[8:11], s50 offen sc1
  s_sub_u32 s46, s46, 1
  s_cbranch_scc1 L_exit
  s_waitcnt vmcnt(0)
  v_cmp_gt_u32 vcc, 1, v5
  s_nop 0
  s_cbranch_vccnz L_poll_92
  s_cmp_lg_u32 s45, 0
  s_cbranch_scc1 L_slow_93
L_join_94:
  buffer_load_dwordx4 v[16:19], v0, s[8:11], s49 offen sc1
  buffer_load_dwordx4 v[20:23], v0, s[8:11], s49 offen offset:1024 sc1
  buffer_load_dwordx4 v[24:27], v0, s[8:11], s49 offen offset:2048 sc1
  buffer_load_dwordx4 v[28:31], v0, s[8:11], s49 offen offset:3072 sc1
  s_add_u32 s49, s49, 4096
  buffer_load_dwordx4 v[32:35], v0, s[8:11], s49 offen sc1
  buffer_load_dwordx4 v[36:39], v0, s[8:11], s49 offen offset:1024 sc1
  buffer_load_dwordx4 v[40:43], v0, s[8:11], s49 offen offset:2048 sc1
  buffer_load_dwordx4 v[44:47], v0, s[8:11], s49 offen offset:3072 sc1
  s_waitcnt vmcnt(7)
  s_waitcnt lgkmcnt(3)
  v_mfma_f32_32x32x16_bf16 v[160:175], a[224:227], v[16:19], 0
  ds_read_b128 a[252:255], v224 offset:8192
  s_add_u32 s49, s49, 4096
  buffer_load_dwordx4 v[48:51], v0, s[8:11], s49 offen sc1
  v_mfma_f32_32x32x16_bf16 v[176:191], v[16:19], a[228:231], 0
  ds_read_b128 a[224:227], v224 offset:6144
  v_mfma_f32_32x32x16_bf16 v[144:159], a[232:235], v[16:19], 0
  ds_read_b128 a[228:231], v224 offset:10240
  buffer_load_dwordx4 v[52:55], v0, s[8:11], s49 offen offset:1024 sc1
  s_waitcnt vmcnt(8)
  v_mfma_f32_32x32x16_bf16 v[160:175], a[236:239], v[20:23], v[160:175]
  ds_read_b128 a[232:235], v224 offset:11264
  buffer_load_dwordx4 v[56:59], v0, s[8:11], s49 offen offset:2048 sc1
  s_waitcnt lgkmcnt(3)
  v_mfma_f32_32x32x16_bf16 v[176:191], v[20:23], a[240:243], v[176:191]
  ds_read_b128 a[236:239], v224 offset:9216
  v_mfma_f32_32x32x16_bf16 v[144:159], a[244:247], v[20:23], v[144:159]
  ds_read_b128 a[240:243], v224 offset:13312
  buffer_load_dwordx4 v[60:63], v0, s[8:11], s49 offen offset:3072 sc1
  s_waitcnt vmcnt(9)
  v_mfma_f32_32x32x16_bf16 v[160:175], a[248:251], v[24:27], v[160:175]
  ds_read_b128 a[244:247], v224 offset:14336
  s_add_u32 s49, s49, 4096
  buffer_load_dwordx4 v[64:67], v0, s[8:11], s49 offen sc1
  v_mfma_f32_32x32x16_bf16 v[176:191], v[24:27], a[252:255], v[176:191]
  ds_read_b128 a[248:251], v224 offset:12288
  s_waitcnt lgkmcnt(3)
  v_mfma_f32_32x32x16_bf16 v[144:159], a[224:227], v[24:27], v[144:159]
  ds_read_b128 a[252:255], v224 offset:16384
  buffer_load_dwordx4 v[68:71], v0, s[8:11], s49 offen offset:1024 sc1
  s_waitcnt vmcnt(10)
  v_mfma_f32_32x32x16_bf16 v[160:175], a[228:231], v[28:31], v[160:175]
  ds_read_b128 a[224:227], v224 offset:17408
  buffer_load_dwordx4 v[72:75], v0, s[8:11], s49 offen offset:2048 sc1
  v_mfma_f32_32x32x16_bf16 v[176:191], v[28:31], a[232:235], v[176:191]
  ds_read_b128 a[228:231], v224 offset:15360
  v_mfma_f32_32x32x16_bf16 v[144:159], a[236:239], v[28:31], v[144:159]
  ds_read_b128 a[232:235], v224 offset:19456
  buffer_load_dwordx4 v[76:79], v0, s[8:11], s49 offen offset:3072 sc1
  s_waitcnt vmcnt(11)
  s_waitcnt lgkmcnt(3)
  v_mfma_f32_32x32x16_bf16 v[160:175], a[240:243], v[32:35], v[160:175]
  ds_read_b128 a[236:239], v224 offset:20480
  s_add_u32 s49, s49, 4096
  buffer_load_dwordx4 v[80:83], v0, s[8:11], s49 offen sc1
  v_mfma_f32_32x32x16_bf16 v[176:191], v[32:35], a[244:247], v[176:191]
  ds_read_b128 a[240:243], v224 offset:18432
  v_mfma_f32_32x32x16_bf16 v[144:159], a[248:251], v[32:35], v[144:159]
  ds_read_b128 a[244:247], v224 offset:22528
  buffer_load_dwordx4 v[84:87], v0, s[8:11], s49 offen offset:1024 sc1
  s_waitcnt vmcnt(12)
  v_mfma_f32_32x32x16_bf16 v[160:175], a[252:255], v[36:39], v[160:175]
  ds_read_b128 a[248:251], v224 offset:23552
  buffer_load_dwordx4 v[88:91], v0, s[8:11], s49 offen offset:2048 sc1
  s_waitcnt lgkmcnt(3)
  v_mfma_f32_32x32x16_bf16 v[176:191], v[36:39], a[224:227], v[176:191]
  ds_read_b128 a[252:255], v224 offset:21504
  v_mfma_f32_32x32x16_bf16 v[144:159], a[228:231], v[36:39], v[144:159]
  ds_read_b128 a[224:227], v224 offset:25600
  buffer_load_dwordx4 v[92:95], v0, s[8:11], s49 offen offset:3072 sc1
  s_waitcnt vmcnt(13)
  v_mfma_f32_32x32x16_bf16 v[160:175], a[232:235], v[40:43], v[160:175]
  ds_read_b128 a[228:231], v224 offset:26624
  s_add_u32 s49, s49, 4096
  buffer_load_dwordx4 v[96:99], v0, s[8:11], s49 offen sc1
  v_mfma_f32_32x32x16_bf16 v[176:191], v[40:43], a[236:239], v[176:191]
  ds_read_b128 a[232:235], v224 offset:24576
  s_waitcnt lgkmcnt(3)
  v_mfma_f32_32x32x16_bf16 v[144:159], a[240:243], v[40:43], v[144:159]
  ds_read_b128 a[236:239], v224 offset:28672
  buffer_load_dwordx4 v[100:103], v0, s[8:11], s49 offen offset:1024 sc1
  s_waitcnt vmcnt(14)
  v_mfma_f32_32x32x16_bf16 v[160:175], a[244:247], v[44:47], v[160:175]
  ds_read_b128 a[240:243], v224 offset:29696
  buffer_load_dwordx4 v[104:107], v0, s[8:11], s49 offen offset:2048 sc1
  v_mfma_f32_32x32x16_bf16 v[176:191], v[44:47], a[248:251], v[176:191]
  ds_read_b128 a[244:247], v224 offset:27648
  v_mfma_f32_32x32x16_bf16 v[144:159], a[252:255], v[44:47], v[144:159]
  ds_read_b128 a[248:251], v224 offset:31744
  buffer_load_dwordx4 v[108:111], v0, s[8:11], s49 offen offset:3072 sc1
  s_waitcnt vmcnt(15)
  s_waitcnt lgkmcnt(3)
  v_mfma_f32_32x32x16_bf16 v[160:175], a[224:227], v[48:51], v[160:175]
  ds_read_b128 a[252:255], v224 offset:32768
  s_add_u32 s49, s49, 4096
  buffer_load_dwordx4 v[112:115], v0, s[8:11], s49 offen sc1
  v_mfma_f32_32x32x16_bf16 v[176:191], v[48:51], a[228:231], v[176:191]
  ds_read_b128 a[224:227], v224 offset:30720
  v_mfma_f32_32x32x16_bf16 v[144:159], a[232:235], v[48:51], v[144:159]
  ds_read_b128 a[228:231], v224 offset:34816
  s_waitcnt vmcnt(15)
  v_mfma_f32_32x32x16_bf16 v[160:175], a[236:239], v[52:55], v[160:175]
  ds_read_b128 a[232:235], v224 offset:35840
  buffer_load_dwordx4 v[116:119], v0, s[8:11], s49 offen offset:1024 sc1
  s_waitcnt lgkmcnt(3)
  v_mfma_f32_32x32x16_bf16 v[176:191], v[52:55], a[240:243], v[176:191]
  ds_read_b128 a[236:239], v224 offset:33792
  v_mfma_f32_32x32x16_bf16 v[144:159], a[244:247], v[52:55], v[144:159]
  ds_read_b128 a[240:243], v224 offset:37888
  s_waitcnt vmcnt(15)
  v_mfma_f32_32x32x16_bf16 v[160:175], a[248:251], v[56:59], v[160:175]
  ds_read_b128 a[244:247], v224 offset:38912
  buffer_load_dwordx4 v[120:123], v0, s[8:11], s49 offen offset:2048 sc1
  v_mfma_f32_32x32x16_bf16 v[176:191], v[56:59], a[252:255], v[176:191]
  ds_read_b128 a[248:251], v224 offset:36864
  s_waitcnt lgkmcnt(3)
  v_mfma_f32_32x32x16_bf16 v[144:159], a[224:227], v[56:59], v[144:159]
  ds_read_b128 a[252:255], v224 offset:40960
  s_waitcnt vmcnt(15)
  v_mfma_f32_32x32x16_bf16 v[160:175], a[228:231], v[60:63], v[160:175]
  ds_read_b128 a[224:227], v224 offset:41984
  buffer_load_dwordx4 v[124:127], v0, s[8:11], s49 offen offset:3072 sc1
  v_mfma_f32_32x32x16_bf16 v[176:191], v[60:63], a[232:235], v[176:191]
  ds_read_b128 a[228:231], v224 offset:39936
  v_mfma_f32_32x32x16_bf16 v[144:159], a[236:239], v[60:63], v[144:159]
  ds_read_b128 a[232:235], v224 offset:44032
  s_waitcnt vmcnt(15)
  s_waitcnt lgkmcnt(3)
  v_mfma_f32_32x32x16_bf16 v[160:175], a[240:243], v[64:67], v[160:175]
  ds_read_b128 a[236:239], v224 offset:45056
  s_add_u32 s49, s49, 4096
  buffer_load_dwordx4 v[128:131], v0, s[8:11], s49 offen sc1
  v_mfma_f32_32x32x16_bf16 v[176:191], v[64:67], a[244:247], v[176:191]
  ds_read_b128 a[240:243], v224 offset:43008
  buffer_load_dwordx4 v[192:195], v0, s[8:11], s48 offen sc1
  v_mfma_f32_32x32x16_bf16 v[144:159], a[248:251], v[64:67], v[144:159]
  ds_read_b128 a[244:247], v224 offset:47104
  s_waitcnt vmcnt(16)
  v_mfma_f32_32x32x16_bf16 v[160:175], a[252:255], v[68:71], v[160:175]
  ds_read_b128 a[248:251], v224 offset:48128
  buffer_load_dwordx4 v[132:135], v0, s[8:11], s49 offen offset:1024 sc1
  s_waitcnt lgkmcnt(3)
  v_mfma_f32_32x32x16_bf16 v[176:191], v[68:71], a[224:227], v[176:191]
  ds_read_b128 a[252:255], v224 offset:46080
  buffer_load_dwordx4 v[196:199], v0, s[8:11], s48 offen offset:1024 sc1
  v_mfma_f32_32x32x16_bf16 v[144:159], a[228:231], v[68:71], v[144:159]
  ds_read_b128 a[224:227], v225 offset:1024
  s_waitcnt vmcnt(17)
  v_mfma_f32_32x32x16_bf16 v[160:175], a[232:235], v[72:75], v[160:175]
  ds_read_b128 a[228:231], v225 offset:2048
  buffer_load_dwordx4 v[136:139], v0, s[8:11], s49 offen offset:2048 sc1
  v_mfma_f32_32x32x16_bf16 v[176:191], v[72:75], a[236:239], v[176:191]
  ds_read_b128 a[232:235], v225 offset:0
  buffer_load_dwordx4 v[200:203], v0, s[8:11], s48 offen offset:2048 sc1
  s_waitcnt lgkmcnt(3)
  v_mfma_f32_32x32x16_bf16 v[144:159], a[240:243], v[72:75], v[144:159]
  ds_read_b128 a[236:239], v225 offset:4096
  s_waitcnt vmcnt(18)
  v_mfma_f32_32x32x16_bf16 v[160:175], a[244:247], v[76:79], v[160:175]
  ds_read_b128 a[240:243], v225 offset:5120
  buffer_load_dwordx4 v[140:143], v0, s[8:11], s49 offen offset:3072 sc1
  v_mfma_f32_32x32x16_bf16 v[176:191], v[76:79], a[248:251], v[176:191]
  ds_read_b128 a[244:247], v225 offset:3072
  buffer_load_dwordx4 v[204:207], v0, s[8:11], s48 offen offset:3072 sc1
  v_mfma_f32_32x32x16_bf16 v[144:159], a[252:255], v[76:79], v[144:159]
  ds_read_b128 a[248:251], v225 offset:7168
  s_waitcnt vmcnt(19)
  s_waitcnt lgkmcnt(3)
  v_mfma_f32_32x32x16_bf16 v[160:175], a[224:227], v[80:83], v[160:175]
  ds_read_b128 a[252:255], v225 offset:8192
  v_and_b32 v254, 0x3c0, v0
  v_lshlrev_b32 v254, 1, v254
  v_mfma_f32_32x32x16_bf16 v[176:191], v[80:83], a[228:231], v[176:191]
  ds_read_b128 a[224:227], v225 offset:6144
  buffer_load_dwordx4 v[232:235], v0, s[8:11], s52 offen sc1
  s_add_u32 s52, s52, 16384
  v_mfma_f32_32x32x16_bf16 v[144:159], a[232:235], v[80:83], v[144:159]
  ds_read_b128 a[228:231], v225 offset:10240
  s_waitcnt vmcnt(19)
  v_mfma_f32_32x32x16_bf16 v[160:175], a[236:239], v[84:87], v[160:175]
  ds_read_b128 a[232:235], v225 offset:11264
  buffer_load_dword v255, v254, s[8:11], s57 offen sc1
  s_waitcnt lgkmcnt(3)
  v_mfma_f32_32x32x16_bf16 v[176:191], v[84:87], a[240:243], v[176:191]
  ds_read_b128 a[236:239], v225 offset:9216
  buffer_load_dwordx4 v[208:211], v0, s[8:11], s52 offen sc1
  s_add_u32 s52, s52, 16384
  v_mfma_f32_32x32x16_bf16 v[144:159], a[244:247], v[84:87], v[144:159]
  ds_read_b128 a[240:243], v225 offset:13312
  s_waitcnt vmcnt(20)
  v_mfma_f32_32x32x16_bf16 v[160:175], a[248:251], v[88:91], v[160:175]
  ds_read_b128 a[244:247], v225 offset:14336
  v_mfma_f32_32x32x16_bf16 v[176:191], v[88:91], a[252:255], v[176:191]
  ds_read_b128 a[248:251], v225 offset:16384
  buffer_load_dwordx4 v[212:215], v0, s[8:11], s52 offen sc1
  s_add_u32 s52, s52, 16384
  s_waitcnt lgkmcnt(3)
  v_mfma_f32_32x32x16_bf16 v[144:159], a[224:227], v[88:91], v[144:159]
  ds_read_b128 a[252:255], v225 offset:17408
  s_waitcnt vmcnt(20)
  v_mfma_f32_32x32x16_bf16 v[160:175], a[228:231], v[92:95], v[160:175]
  ds_read_b128 a[224:227], v225 offset:19456
  v_mfma_f32_32x32x16_bf16 v[176:191], v[92:95], a[232:235], v[176:191]
  ds_read_b128 a[228:231], v225 offset:20480
  v_mfma_f32_32x32x16_bf16 v[144:159], a[236:239], v[92:95], v[144:159]
  ds_read_b128 a[232:235], v225 offset:22528
  s_waitcnt vmcnt(19)
  s_waitcnt lgkmcnt(3)
  v_mfma_f32_32x32x16_bf16 v[160:175], a[240:243], v[96:99], v[160:175]
  ds_read_b128 a[236:239], v225 offset:23552
  v_mfma_f32_32x32x16_bf16 v[176:191], v[96:99], a[244:247], v[176:191]
  ds_read_b128 a[240:243], v225 offset:25600
  s_waitcnt vmcnt(18)
  v_mfma_f32_32x32x16_bf16 v[160:175], a[248:251], v[100:103], v[160:175]
  ds_read_b128 a[244:247], v225 offset:26624
  v_mfma_f32_32x32x16_bf16 v[176:191], v[100:103], a[252:255], v[176:191]
  ds_read_b128 a[248:251], v225 offset:28672
  s_waitcnt vmcnt(17)
  s_waitcnt lgkmcnt(3)
  v_mfma_f32_32x32x16_bf16 v[160:175], a[224:227], v[104:107], v[160:175]
  ds_read_b128 a[252:255], v225 offset:29696
  v_mfma_f32_32x32x16_bf16 v[176:191], v[104:107], a[228:231], v[176:191]
  ds_read_b128 a[224:227], v225 offset:31744
  s_waitcnt vmcnt(4)
  v_add_f32 v192, v192, v200
  v_add_f32 v193, v193, v201
  v_add_f32 v194, v194, v202
  v_mfma_f32_32x32x16_bf16 v[160:175], a[232:235], v[108:111], v[160:175]
  ds_read_b128 a[228:231], v225 offset:32768
  v_add_f32 v195, v195, v203
  v_add_f32 v196, v196, v204
  v_add_f32 v197, v197, v205
  v_mfma_f32_32x32x16_bf16 v[176:191], v[108:111], a[236:239], v[176:191]
  ds_read_b128 a[232:235], v225 offset:34816
  v_add_f32 v198, v198, v206
  v_add_f32 v199, v199, v207
  v_add_f32 v192, v192, v196
  s_waitcnt lgkmcnt(3)
  v_mfma_f32_32x32x16_bf16 v[160:175], a[240:243], v[112:115], v[160:175]
  ds_read_b128 a[236:239], v225 offset:35840
  v_add_f32 v193, v193, v197
  v_add_f32 v194, v194, v198
  v_add_f32 v195, v195, v199
  v_mfma_f32_32x32x16_bf16 v[176:191], v[112:115], a[244:247], v[176:191]
  ds_read_b128 a[240:243], v225 offset:37888
  v_add_f32 v192, v192, v194
  v_add_f32 v193, v193, v195
  v_add_f32 v192, v192, v193
  v_mfma_f32_32x32x16_bf16 v[160:175], a[248:251], v[116:119], v[160:175]
  ds_read_b128 a[244:247], v225 offset:38912
  v_mov_b32 v193, v192
  s_nop 1
  v_permlane32_swap_b32 v192, v193
  v_mfma_f32_32x32x16_bf16 v[176:191], v[116:119], a[252:255], v[176:191]
  ds_read_b128 a[248:251], v225 offset:40960
  v_mul_f32 v192, 0xbb000000, v192
  v_mul_f32 v193, 0x3b000000, v193
  v_fma_f32 v193, -v192, v192, v193
  s_waitcnt lgkmcnt(3)
  v_mfma_f32_32x32x16_bf16 v[160:175], a[224:227], v[120:123], v[160:175]
  ds_read_b128 a[252:255], v225 offset:41984
  v_max_f32 v193, 0, v193
  v_cvt_pk_bf16_f32 v193, v193, v193
  v_lshlrev_b32 v193, 16, v193
  v_mfma_f32_32x32x16_bf16 v[176:191], v[120:123], a[228:231], v[176:191]
  ds_read_b128 a[224:227], v225 offset:44032
  v_add_f32 v193, 0x3727c5ac, v193
  v_cvt_pk_bf16_f32 v193, v193, v193
  v_lshlrev_b32 v193, 16, v193
  v_mfma_f32_32x32x16_bf16 v[160:175], a[232:235], v[124:127], v[160:175]
  ds_read_b128 a[228:231], v225 offset:45056
  v_sqrt_f32 v193, v193
  v_cvt_pk_bf16_f32 v236, v192, v192
  v_mfma_f32_32x32x16_bf16 v[176:191], v[124:127], a[236:239], v[176:191]
  ds_read_b128 a[232:235], v225 offset:47104
  v_cvt_pk_bf16_f32 v193, v193, v193
  v_lshlrev_b32 v193, 16, v193
  v_rcp_f32 v240, v193
  s_waitcnt lgkmcnt(3)
  v_mfma_f32_32x32x16_bf16 v[160:175], a[240:243], v[128:131], v[160:175]
  ds_read_b128 a[236:239], v225 offset:48128
  v_mul_f32 v241, v193, v193
  v_mov_b32 v237, v236
  v_mov_b32 v238, v236
  v_mfma_f32_32x32x16_bf16 v[176:191], v[128:131], a[244:247], v[176:191]
  ds_read_b128 a[240:243], v225 offset:12288
  v_mov_b32 v239, v236
  v_and_b32 v4, 0x7c, v1
  v_add_u32 v4, s54, v4
  v_mfma_f32_32x32x16_bf16 v[160:175], a[248:251], v[132:135], v[160:175]
  ds_read_b128 a[244:247], v225 offset:15360
  ds_write_b32 v4, v240
  v_lshrrev_b32 v4, 9, v0
  v_lshlrev_b32 v4, 4, v4
  v_mfma_f32_32x32x16_bf16 v[176:191], v[132:135], a[252:255], v[176:191]
  ds_read_b128 a[248:251], v225 offset:18432
  v_add_u32 v4, s54, v4
  v_mul_f32 v252, 0x3eb8aa3b, v240
  ds_read_b128 v[192:195], v4 offset:0
  s_waitcnt lgkmcnt(5)
  v_mfma_f32_32x32x16_bf16 v[160:175], a[224:227], v[136:139], v[160:175]
  ds_read_b128 a[252:255], v225 offset:21504
  ds_read_b128 v[196:199], v4 offset:32
  ds_read_b128 v[200:203], v4 offset:64
  ds_read_b128 v[204:207], v4 offset:96
  v_mfma_f32_32x32x16_bf16 v[176:191], v[136:139], a[228:231], v[176:191]
  ds_read_b128 a[224:227], v225 offset:24576
  v_mfma_f32_32x32x16_bf16 v[160:175], a[232:235], v[140:143], v[160:175]
  ds_read_b128 a[228:231], v225 offset:27648
  v_mfma_f32_32x32x16_bf16 v[176:191], v[140:143], a[236:239], v[176:191]
  ds_read_b128 a[232:235], v225 offset:30720
  s_waitcnt vmcnt(0)
  v_mfma_f32_32x32x16_bf16 v[160:175], v[208:211], v[236:239], v[160:175]
  v_mfma_f32_32x32x16_bf16 v[176:191], v[236:239], v[212:215], v[176:191]
  s_waitcnt lgkmcnt(6)
  v_mfma_f32_32x32x16_bf16 v[144:159], a[240:243], v[96:99], v[144:159]
  ds_read_b128 a[236:239], v225 offset:33792
  v_mfma_f32_32x32x16_bf16 v[144:159], a[244:247], v[100:103], v[144:159]
  ds_read_b128 a[240:243], v225 offset:36864
  s_nop 5
  v_mul_f32 v160, v240, v160
  v_mul_f32 v161, v240, v161
  v_mul_f32 v162, v240, v162
  v_mul_f32 v163, v240, v163
  v_mul_f32 v164, v240, v164
  v_mul_f32 v165, v240, v165
  v_mfma_f32_32x32x16_bf16 v[144:159], a[248:251], v[104:107], v[144:159]
  ds_read_b128 a[244:247], v225 offset:39936
  v_mul_f32 v166, v240, v166
  v_mul_f32 v167, v240, v167
  v_cvt_pk_bf16_f32 v208, v160, v161
  v_cvt_pk_bf16_f32 v209, v162, v163
  v_cvt_pk_bf16_f32 v210, v164, v165
  v_cvt_pk_bf16_f32 v211, v166, v167
  buffer_store_dwordx4 v[208:211], v242, s[8:11], s55 offen sc1
  v_mfma_f32_32x32x16_bf16 v[144:159], a[252:255], v[108:111], v[144:159]
  ds_read_b128 a[248:251], v225 offset:43008
  v_mul_f32 v168, v240, v168
  v_mul_f32 v169, v240, v169
  v_mul_f32 v170, v240, v170
  v_mul_f32 v171, v240, v171
  v_mul_f32 v172, v240, v172
  v_mul_f32 v173, v240, v173
  v_mul_f32 v174, v240, v174
  s_waitcnt lgkmcnt(3)
  v_mfma_f32_32x32x16_bf16 v[144:159], a[224:227], v[112:115], v[144:159]
  ds_read_b128 a[252:255], v225 offset:46080
  v_mul_f32 v175, v240, v175
  v_cvt_pk_bf16_f32 v212, v168, v169
  v_cvt_pk_bf16_f32 v213, v170, v171
  v_cvt_pk_bf16_f32 v214, v172, v173
  v_cvt_pk_bf16_f32 v215, v174, v175
  buffer_store_dwordx4 v[212:215], v242, s[8:11], s56 offen sc1
  v_mul_f32 v176, v192, v176
  v_mfma_f32_32x32x16_bf16 v[144:159], a[228:231], v[116:119], v[144:159]
  v_mul_f32 v177, v193, v177
  v_mul_f32 v178, v194, v178
  v_mul_f32 v179, v195, v179
  v_mul_f32 v180, v196, v180
  v_mul_f32 v181, v197, v181
  v_mul_f32 v182, v198, v182
  v_mul_f32 v183, v199, v183
  v_mfma_f32_32x32x16_bf16 v[144:159], a[232:235], v[120:123], v[144:159]
  v_cvt_pk_bf16_f32 v216, v176, v177
  v_cvt_pk_bf16_f32 v217, v178, v179
  v_cvt_pk_bf16_f32 v218, v180, v181
  v_cvt_pk_bf16_f32 v219, v182, v183
  buffer_store_dwordx4 v[216:219], v243, s[8:11], s55 offen offset:1024 sc1
  v_mul_f32 v184, v200, v184
  v_mul_f32 v185, v201, v185
  v_mfma_f32_32x32x16_bf16 v[144:159], a[236:239], v[124:127], v[144:159]
  v_mul_f32 v186, v202, v186
  v_mul_f32 v187, v203, v187
  v_mul_f32 v188, v204, v188
  v_mul_f32 v189, v205, v189
  v_mul_f32 v190, v206, v190
  v_mul_f32 v191, v207, v191
  v_cvt_pk_bf16_f32 v220, v184, v185
  s_waitcnt lgkmcnt(0)
  v_mfma_f32_32x32x16_bf16 v[144:159], a[240:243], v[128:131], v[144:159]
  v_cvt_pk_bf16_f32 v221, v186, v187
  v_cvt_pk_bf16_f32 v222, v188, v189
  v_cvt_pk_bf16_f32 v223, v190, v191
  buffer_store_dwordx4 v[220:223], v243, s[8:11], s55 offen offset:1536 sc1
  v_mfma_f32_32x32x16_bf16 v[144:159], a[244:247], v[132:135], v[144:159]
  v_mfma_f32_32x32x16_bf16 v[144:159], a[248:251], v[136:139], v[144:159]
  v_mfma_f32_32x32x16_bf16 v[144:159], a[252:255], v[140:143], v[144:159]
  v_mfma_f32_32x32x16_bf16 v[144:159], v[232:235], v[236:239], v[144:159]
  s_barrier
  s_nop 10
  v_mul_f32 v144, v252, v144
  v_mul_f32 v145, v252, v145
  v_mul_f32 v146, v252, v146
  v_mul_f32 v147, v252, v147
  v_mul_f32 v148, v252, v148
  v_mul_f32 v149, v252, v149
  v_mul_f32 v150, v252, v150
  v_mul_f32 v151, v252, v151
  v_cvt_pk_bf16_f32 v224, v144, v145
  v_cvt_pk_bf16_f32 v225, v146, v147
  v_cvt_pk_bf16_f32 v226, v148, v149
  v_cvt_pk_bf16_f32 v227, v150, v151
  buffer_store_dwordx4 v[224:227], v0, s[8:11], s57 offen
  v_mul_f32 v152, v252, v152
  v_mul_f32 v153, v252, v153
  v_mul_f32 v154, v252, v154
  v_mul_f32 v155, v252, v155
  v_mul_f32 v156, v252, v156
  v_mul_f32 v157, v252, v157
  v_mul_f32 v158, v252, v158
  v_mul_f32 v159, v252, v159
  v_cvt_pk_bf16_f32 v228, v152, v153
  v_cvt_pk_bf16_f32 v229, v154, v155
  v_cvt_pk_bf16_f32 v230, v156, v157
  v_cvt_pk_bf16_f32 v231, v158, v159
  buffer_store_dwordx4 v[228:231], v0, s[8:11], s57 offen offset:1024
  v_mov_b32 v4, 0x3f803f80
  s_mov_b32 s48, 0x110000
  s_mov_b32 s49, 0x110000
  v_cndmask_b32 v2, 0, v4, s[48:49]
  v_mov_b32 v212, v2
  v_mov_b32 v213, v2
  v_mov_b32 v214, v2
  v_mov_b32 v215, v2
  v_mov_b32 v216, v2
  v_mov_b32 v217, v2
  v_mov_b32 v218, v2
  v_mov_b32 v219, v2
  v_lshrrev_b32 v4, 9, v0
  v_lshlrev_b32 v252, 8, v4
  v_and_b32 v4, 0xf0, v0
  v_add_u32 v252, v252, v4
  v_and_b32 v4, 28, v1
  s_lshl_b32 s48, s36, 4
  s_lshr_b32 s49, s37, 1
  s_add_u32 s48, s48, s49
  s_lshl_b32 s48, s48, 7
  s_add_u32 s48, s48, 0
  s_lshl_b32 s7, s49, 10
  s_lshl_b32 s50, s38, 3
  s_add_u32 s7, s7, s50
  s_add_u32 s7, s7, 65536
  s_lshl_b32 s50, s38, 1
  s_lshl_b32 s6, s37, 6
  s_add_u32 s6, s6, s50
  s_lshl_b32 s6, s6, 11
  s_add_u32 s6, s6, 27262976
  s_lshl_b32 s51, s36, 8
  s_add_u32 s51, s51, s37
  s_lshl_b32 s51, s51, 10
  s_add_u32 s51, s51, 10485760
  s_add_u32 s52, s50, 2
  s_and_b32 s52, s52, 7
  s_lshl_b32 s52, s52, 15
  s_add_u32 s52, s52, s51
  s_add_u32 s53, s50, 3
  s_and_b32 s53, s53, 7
  s_lshl_b32 s53, s53, 15
  s_add_u32 s53, s53, s51
  s_add_u32 s54, s50, 4
  s_and_b32 s54, s54, 7
  s_lshl_b32 s54, s54, 15
  s_add_u32 s54, s54, s51
  s_add_u32 s55, s50, 5
  s_and_b32 s55, s55, 7
  s_lshl_b32 s55, s55, 15
  s_add_u32 s55, s55, s51
  s_add_u32 s56, s50, 6
  s_and_b32 s56, s56, 7
  s_lshl_b32 s56, s56, 15
  s_add_u32 s56, s56, s51
  s_add_u32 s57, s50, 7
  s_and_b32 s57, s57, 7
  s_lshl_b32 s57, s57, 15
  s_add_u32 s57, s57, s51
  s_add_u32 s58, s50, 8
  s_and_b32 s58, s58, 7
  s_lshl_b32 s58, s58, 15
  s_add_u32 s58, s58, s51
  s_add_u32 s59, s50, 9
  s_and_b32 s59, s59, 7
  s_lshl_b32 s59, s59, 15
  s_add_u32 s59, s59, s51
  s_lshl_b32 s3, s36, 14
  s_add_u32 s3, s3, s6
  s_waitcnt vmcnt(0)
  v_mov_b32 v5, 2
  s_cmp_lg_u32 s45, 0
  s_cbranch_scc1 L_slow_95
  s_mov_b64 exec, 1
  buffer_store_dword v5, v3, s[8:11], 0 offen
  s_mov_b64 exec, -1
L_join_96:
  s_barrier
  s_cmp_eq_u32 s38, 3
  s_cbranch_scc0 L_b3_97
  v_readlane_b32 s49, v3, 1
  v_mov_b32 v5, 2
  s_mov_b64 exec, 15
  s_sub_u32 s49, s49, 12
  s_nop 1
  buffer_store_dword v5, v1, s[8:11], s49 offen sc1
  s_mov_b64 exec, -1
L_b3_97:
  s_cmp_eq_u32 s38, 0
  s_cbranch_scc0 L_b0_98
  s_mov_b32 s46, 2097152
L_poll_99:
  buffer_load_dword v5, v4, s[8:11], s48 offen sc1
  s_sub_u32 s46, s46, 1
  s_cbranch_scc1 L_exit
  s_waitcnt vmcnt(0)
  v_cmp_gt_u32 vcc, 2, v5
  s_nop 0
  s_cbranch_vccnz L_poll_99
L_b0_98:
  s_barrier
  s_cmp_lg_u32 s45, 0
  s_cbranch_scc1 L_slow_100
L_join_101:
  buffer_load_dwordx4 v[208:211], v0, s[8:11], s3 offen sc1
  buffer_load_dwordx4 v[144:147], v0, s[8:11], s52 offen sc1
  buffer_load_dwordx4 v[148:151], v0, s[8:11], s53 offen sc1
  s_mov_b64 exec, s[60:61]
  buffer_load_dwordx4 v[212:215], v252, s[8:11], s3 offen offset:1024 sc1
  buffer_load_dwordx4 v[216:219], v252, s[8:11], s3 offen offset:1536 sc1
  s_mov_b64 exec, -1
  buffer_load_dwordx4 v[152:155], v0, s[8:11], s54 offen sc1
  buffer_load_dwordx4 v[156:159], v0, s[8:11], s55 offen sc1
  v_mov_b32 v224, v2
  v_mov_b32 v225, v2
  v_mov_b32 v226, v2
  v_mov_b32 v227, v2
  v_mov_b32 v228, v2
  v_mov_b32 v229, v2
  v_mov_b32 v230, v2
  v_mov_b32 v231, v2
  v_mov_b32 v236, v2
  v_mov_b32 v237, v2
  v_mov_b32 v238, v2
  v_mov_b32 v239, v2
  v_mov_b32 v240, v2
  v_mov_b32 v241, v2
  v_mov_b32 v242, v2
  v_mov_b32 v243, v2
  v_mov_b32 v2, 0xdddddddd
  v_pk_mov_b32 v[16:17], 0, 0
  v_pk_mov_b32 v[18:19], 0, 0
  v_pk_mov_b32 v[20:21], 0, 0
  v_pk_mov_b32 v[22:23], 0, 0
  v_pk_mov_b32 v[24:25], 0, 0
  v_pk_mov_b32 v[26:27], 0, 0
  v_pk_mov_b32 v[28:29], 0, 0
  v_pk_mov_b32 v[30:31], 0, 0
  v_pk_mov_b32 v[32:33], 0, 0
  v_pk_mov_b32 v[34:35], 0, 0
  v_pk_mov_b32 v[36:37], 0, 0
  v_pk_mov_b32 v[38:39], 0, 0
  v_pk_mov_b32 v[40:41], 0, 0
  v_pk_mov_b32 v[42:43], 0, 0
  v_pk_mov_b32 v[44:45], 0, 0
  v_pk_mov_b32 v[46:47], 0, 0
  v_pk_mov_b32 v[48:49], 0, 0
  v_pk_mov_b32 v[50:51], 0, 0
  v_pk_mov_b32 v[52:53], 0, 0
  v_pk_mov_b32 v[54:55], 0, 0
  v_pk_mov_b32 v[56:57], 0, 0
  v_pk_mov_b32 v[58:59], 0, 0
  v_pk_mov_b32 v[60:61], 0, 0
  v_pk_mov_b32 v[62:63], 0, 0
  v_pk_mov_b32 v[64:65], 0, 0
  v_pk_mov_b32 v[66:67], 0, 0
  v_pk_mov_b32 v[68:69], 0, 0
  v_pk_mov_b32 v[70:71], 0, 0
  v_pk_mov_b32 v[72:73], 0, 0
  v_pk_mov_b32 v[74:75], 0, 0
  v_pk_mov_b32 v[76:77], 0, 0
  v_pk_mov_b32 v[78:79], 0, 0
  v_pk_mov_b32 v[80:81], 0, 0
  v_pk_mov_b32 v[82:83], 0, 0
  v_pk_mov_b32 v[84:85], 0, 0
  v_pk_mov_b32 v[86:87], 0, 0
  v_pk_mov_b32 v[88:89], 0, 0
  v_pk_mov_b32 v[90:91], 0, 0
  v_pk_mov_b32 v[92:93], 0, 0
  v_pk_mov_b32 v[94:95], 0, 0
  v_pk_mov_b32 v[96:97], 0, 0
  v_pk_mov_b32 v[98:99], 0, 0
  v_pk_mov_b32 v[100:101], 0, 0
  v_pk_mov_b32 v[102:103], 0, 0
  v_pk_mov_b32 v[104:105], 0, 0
  v_pk_mov_b32 v[106:107], 0, 0
  v_pk_mov_b32 v[108:109], 0, 0
  v_pk_mov_b32 v[110:111], 0, 0
  v_pk_mov_b32 v[112:113], 0, 0
  v_pk_mov_b32 v[114:115], 0, 0
  v_pk_mov_b32 v[116:117], 0, 0
  v_pk_mov_b32 v[118:119], 0, 0
  v_pk_mov_b32 v[120:121], 0, 0
  v_pk_mov_b32 v[122:123], 0, 0
  v_pk_mov_b32 v[124:125], 0, 0
  v_pk_mov_b32 v[126:127], 0, 0
  v_pk_mov_b32 v[128:129], 0, 0
  v_pk_mov_b32 v[130:131], 0, 0
  v_pk_mov_b32 v[132:133], 0, 0
  v_pk_mov_b32 v[134:135], 0, 0
  v_pk_mov_b32 v[136:137], 0, 0
  v_pk_mov_b32 v[138:139], 0, 0
  v_pk_mov_b32 v[140:141], 0, 0
  v_pk_mov_b32 v[142:143], 0, 0
  v_bfe_u32 v4, v0, 5, 3
  v_add_u32 v4, s36, v4
  v_and_b32 v4, 7, v4
  v_lshlrev_b32 v253, 7, v4
  v_bfe_u32 v4, v0, 4, 1
  v_lshl_add_u32 v253, v4, 2, v253
  s_waitcnt vmcnt(5)
  v_mfma_f32_32x32x16_bf16 v[176:191], v[208:211], v[144:147], 0
  s_nop 11
  v_exp_f32 v176, v176
  v_exp_f32 v177, v177
  buffer_load_dwordx4 v[160:163], v0, s[8:11], s56 offen sc1
  s_waitcnt vmcnt(5)
  v_exp_f32 v178, v178
  v_exp_f32 v179, v179
  v_exp_f32 v180, v180
  v_mfma_f32_32x32x16_bf16 v[192:207], v[208:211], v[148:151], 0
  s_waitcnt vmcnt(3)
  v_exp_f32 v181, v181
  v_exp_f32 v182, v182
  v_exp_f32 v183, v183
  v_exp_f32 v184, v184
  v_exp_f32 v185, v185
  v_smfmac_f32_32x32x32_bf16 v[16:31], v[212:215], v[176:183], v2
  buffer_load_dwordx4 v[164:167], v0, s[8:11], s57 offen sc1
  v_exp_f32 v186, v186
  v_exp_f32 v187, v187
  v_exp_f32 v188, v188
  v_exp_f32 v189, v189
  v_exp_f32 v190, v190
  v_exp_f32 v191, v191
  v_exp_f32 v192, v192
  v_exp_f32 v193, v193
  v_smfmac_f32_32x32x32_bf16 v[16:31], v[216:219], v[184:191], v2
  buffer_load_dwordx4 v[168:171], v0, s[8:11], s58 offen sc1
  s_waitcnt vmcnt(4)
  v_exp_f32 v194, v194
  v_exp_f32 v195, v195
  v_exp_f32 v196, v196
  v_mfma_f32_32x32x16_bf16 v[176:191], v[208:211], v[152:155], 0
  v_exp_f32 v197, v197
  v_exp_f32 v198, v198
  v_exp_f32 v199, v199
  v_exp_f32 v200, v200
  v_exp_f32 v201, v201
  v_smfmac_f32_32x32x32_bf16 v[32:47], v[212:215], v[192:199], v2
  buffer_load_dwordx4 v[172:175], v0, s[8:11], s59 offen sc1
  v_exp_f32 v202, v202
  v_exp_f32 v203, v203
  v_exp_f32 v204, v204
  v_exp_f32 v205, v205
  v_exp_f32 v206, v206
  v_exp_f32 v207, v207
  v_exp_f32 v176, v176
  v_exp_f32 v177, v177
  v_smfmac_f32_32x32x32_bf16 v[32:47], v[216:219], v[200:207], v2
  buffer_load_dwordx4 v[220:223], v0, s[8:11], s3 offen offset:2048 sc1
  s_waitcnt vmcnt(5)
  v_exp_f32 v178, v178
  v_exp_f32 v179, v179
  v_exp_f32 v180, v180
  v_mfma_f32_32x32x16_bf16 v[192:207], v[208:211], v[156:159], 0
  v_exp_f32 v181, v181
  v_exp_f32 v182, v182
  v_exp_f32 v183, v183
  v_exp_f32 v184, v184
  v_exp_f32 v185, v185
  v_smfmac_f32_32x32x32_bf16 v[48:63], v[212:215], v[176:183], v2
  s_mov_b64 exec, s[60:61]
  buffer_load_dwordx4 v[224:227], v252, s[8:11], s3 offen offset:3072 sc1
  buffer_load_dwordx4 v[228:231], v252, s[8:11], s3 offen offset:3584 sc1
  s_mov_b64 exec, -1
  v_exp_f32 v186, v186
  v_exp_f32 v187, v187
  v_exp_f32 v188, v188
  v_exp_f32 v189, v189
  v_exp_f32 v190, v190
  v_exp_f32 v191, v191
  v_exp_f32 v192, v192
  v_exp_f32 v193, v193
  v_smfmac_f32_32x32x32_bf16 v[48:63], v[216:219], v[184:191], v2
  s_waitcnt vmcnt(6)
  v_exp_f32 v194, v194
  v_exp_f32 v195, v195
  v_exp_f32 v196, v196
  v_mfma_f32_32x32x16_bf16 v[176:191], v[208:211], v[160:163], 0
  v_exp_f32 v197, v197
  v_exp_f32 v198, v198
  v_exp_f32 v199, v199
  v_exp_f32 v200, v200
  v_exp_f32 v201, v201
  v_smfmac_f32_32x32x32_bf16 v[64:79], v[212:215], v[192:199], v2
  v_exp_f32 v202, v202
  v_exp_f32 v203, v203
  v_exp_f32 v204, v204
  v_exp_f32 v205, v205
  v_exp_f32 v206, v206
  v_exp_f32 v207, v207
  v_exp_f32 v176, v176
  v_exp_f32 v177, v177
  v_smfmac_f32_32x32x32_bf16 v[64:79], v[216:219], v[200:207], v2
  s_waitcnt vmcnt(5)
  v_exp_f32 v178, v178
  v_exp_f32 v179, v179
  v_exp_f32 v180, v180
  v_mfma_f32_32x32x16_bf16 v[192:207], v[208:211], v[164:167], 0
  v_exp_f32 v181, v181
  v_exp_f32 v182, v182
  v_exp_f32 v183, v183
  v_exp_f32 v184, v184
  v_exp_f32 v185, v185
  v_smfmac_f32_32x32x32_bf16 v[80:95], v[212:215], v[176:183], v2
  buffer_load_dword v249, v253, s[8:11], s7 offen sc1
  v_exp_f32 v186, v186
  v_exp_f32 v187, v187
  v_exp_f32 v188, v188
  v_exp_f32 v189, v189
  v_exp_f32 v190, v190
  v_exp_f32 v191, v191
  v_exp_f32 v192, v192
  v_exp_f32 v193, v193
  v_smfmac_f32_32x32x32_bf16 v[80:95], v[216:219], v[184:191], v2
  s_waitcnt vmcnt(5)
  v_exp_f32 v194, v194
  v_exp_f32 v195, v195
  v_exp_f32 v196, v196
  v_mfma_f32_32x32x16_bf16 v[176:191], v[208:211], v[168:171], 0
  v_exp_f32 v197, v197
  v_exp_f32 v198, v198
  v_exp_f32 v199, v199
  v_exp_f32 v200, v200
  v_exp_f32 v201, v201
  v_smfmac_f32_32x32x32_bf16 v[96:111], v[212:215], v[192:199], v2
  v_exp_f32 v202, v202
  v_exp_f32 v203, v203
  v_exp_f32 v204, v204
  v_exp_f32 v205, v205
  v_exp_f32 v206, v206
  v_exp_f32 v207, v207
  v_exp_f32 v176, v176
  v_exp_f32 v177, v177
  v_smfmac_f32_32x32x32_bf16 v[96:111], v[216:219], v[200:207], v2
  s_waitcnt vmcnt(4)
  v_exp_f32 v178, v178
  v_exp_f32 v179, v179
  v_exp_f32 v180, v180
  v_mfma_f32_32x32x16_bf16 v[192:207], v[208:211], v[172:175], 0
  v_exp_f32 v181, v181
  v_exp_f32 v182, v182
  v_exp_f32 v183, v183
  v_exp_f32 v184, v184
  v_exp_f32 v185, v185
  v_smfmac_f32_32x32x32_bf16 v[112:127], v[212:215], v[176:183], v2
  v_exp_f32 v186, v186
  v_exp_f32 v187, v187
  v_exp_f32 v188, v188
  v_exp_f32 v189, v189
  v_exp_f32 v190, v190
  v_exp_f32 v191, v191
  v_exp_f32 v192, v192
  v_exp_f32 v193, v193
  v_smfmac_f32_32x32x32_bf16 v[112:127], v[216:219], v[184:191], v2
  s_waitcnt vmcnt(1)
  v_exp_f32 v194, v194
  v_exp_f32 v195, v195
  v_exp_f32 v196, v196
  v_mfma_f32_32x32x16_bf16 v[176:191], v[220:223], v[144:147], 0
  s_waitcnt vmcnt(0)
  v_cmp_gt_u32 s[100:101], 2, v249
  v_exp_f32 v197, v197
  v_exp_f32 v198, v198
  v_exp_f32 v199, v199
  v_exp_f32 v200, v200
  v_exp_f32 v201, v201
  v_smfmac_f32_32x32x32_bf16 v[128:143], v[212:215], v[192:199], v2
  s_and_b32 s46, s100, 12
  s_cbranch_scc1 L_gslow_103
L_gjoin_104:
  v_exp_f32 v202, v202
  v_exp_f32 v203, v203
  v_exp_f32 v204, v204
  v_exp_f32 v205, v205
  v_exp_f32 v206, v206
  v_exp_f32 v207, v207
  v_exp_f32 v176, v176
  v_exp_f32 v177, v177
  v_smfmac_f32_32x32x32_bf16 v[128:143], v[216:219], v[200:207], v2
  s_add_u32 s3, s36, 1
  s_and_b32 s3, s3, 7
  v_exp_f32 v178, v178
  v_exp_f32 v179, v179
  v_exp_f32 v180, v180
  v_mfma_f32_32x32x16_bf16 v[192:207], v[220:223], v[148:151], 0
  s_lshl_b32 s3, s3, 14
  s_add_u32 s3, s3, s6
  v_exp_f32 v181, v181
  v_exp_f32 v182, v182
  v_exp_f32 v183, v183
  v_exp_f32 v184, v184
  v_exp_f32 v185, v185
  v_smfmac_f32_32x32x32_bf16 v[16:31], v[224:227], v[176:183], v2
  buffer_load_dwordx4 v[232:235], v0, s[8:11], s3 offen sc1
  v_exp_f32 v186, v186
  v_exp_f32 v187, v187
  v_exp_f32 v188, v188
  v_exp_f32 v189, v189
  v_exp_f32 v190, v190
  v_exp_f32 v191, v191
  v_exp_f32 v192, v192
  v_exp_f32 v193, v193
  v_smfmac_f32_32x32x32_bf16 v[16:31], v[228:231], v[184:191], v2
  s_mov_b64 exec, s[60:61]
  buffer_load_dwordx4 v[236:239], v252, s[8:11], s3 offen offset:1024 sc1
  buffer_load_dwordx4 v[240:243], v252, s[8:11], s3 offen offset:1536 sc1
  s_mov_b64 exec, -1
  v_exp_f32 v194, v194
  v_exp_f32 v195, v195
  v_exp_f32 v196, v196
  v_mfma_f32_32x32x16_bf16 v[176:191], v[220:223], v[152:155], 0
  v_exp_f32 v197, v197
  v_exp_f32 v198, v198
  v_exp_f32 v199, v199
  v_exp_f32 v200, v200
  v_exp_f32 v201, v201
  v_smfmac_f32_32x32x32_bf16 v[32:47], v[224:227], v[192:199], v2
  v_exp_f32 v202, v202
  v_exp_f32 v203, v203
  v_exp_f32 v204, v204
  v_exp_f32 v205, v205
  v_exp_f32 v206, v206
  v_exp_f32 v207, v207
  v_exp_f32 v176, v176
  v_exp_f32 v177, v177
  v_smfmac_f32_32x32x32_bf16 v[32:47], v[228:231], v[200:207], v2
  buffer_load_dwordx4 v[208:211], v0, s[8:11], s3 offen offset:2048 sc1
  s_mul_i32 s58, s40, 229376
  s_add_u32 s58, s58, 4194304
  v_exp_f32 v178, v178
  v_exp_f32 v179, v179
  v_exp_f32 v180, v180
  v_mfma_f32_32x32x16_bf16 v[192:207], v[220:223], v[156:159], 0
  v_exp_f32 v181, v181
  v_exp_f32 v182, v182
  v_exp_f32 v183, v183
  v_exp_f32 v184, v184
  v_exp_f32 v185, v185
  v_smfmac_f32_32x32x32_bf16 v[48:63], v[224:227], v[176:183], v2
  s_mov_b64 exec, s[60:61]
  buffer_load_dwordx4 v[212:215], v252, s[8:11], s3 offen offset:3072 sc1
  buffer_load_dwordx4 v[216:219], v252, s[8:11], s3 offen offset:3584 sc1
  s_mov_b64 exec, -1
  v_exp_f32 v186, v186
  v_exp_f32 v187, v187
  v_exp_f32 v188, v188
  v_exp_f32 v189, v189
  v_exp_f32 v190, v190
  v_exp_f32 v191, v191
  v_exp_f32 v192, v192
  v_exp_f32 v193, v193
  v_smfmac_f32_32x32x32_bf16 v[48:63], v[228:231], v[184:191], v2
  s_mul_i32 s56, s38, 26624
  s_add_u32 s57, s56, s58
  v_exp_f32 v194, v194
  v_exp_f32 v195, v195
  v_exp_f32 v196, v196
  v_mfma_f32_32x32x16_bf16 v[176:191], v[220:223], v[160:163], 0
  v_exp_f32 v197, v197
  v_exp_f32 v198, v198
  v_exp_f32 v199, v199
  v_exp_f32 v200, v200
  v_exp_f32 v201, v201
  v_smfmac_f32_32x32x32_bf16 v[64:79], v[224:227], v[192:199], v2
  s_add_u32 s57, s57, 0
  s_add_u32 s56, s56, 0
  v_exp_f32 v202, v202
  v_exp_f32 v203, v203
  v_exp_f32 v204, v204
  v_exp_f32 v205, v205
  v_exp_f32 v206, v206
  v_exp_f32 v207, v207
  v_exp_f32 v176, v176
  v_exp_f32 v177, v177
  v_smfmac_f32_32x32x32_bf16 v[64:79], v[228:231], v[200:207], v2
  s_mov_b32 m0, s56
  s_nop 0
  buffer_load_dwordx4 v0, s[8:11], s57 offen sc1 lds
  v_exp_f32 v178, v178
  v_exp_f32 v179, v179
  v_exp_f32 v180, v180
  v_mfma_f32_32x32x16_bf16 v[192:207], v[220:223], v[164:167], 0
  v_exp_f32 v181, v181
  v_exp_f32 v182, v182
  v_exp_f32 v183, v183
  v_exp_f32 v184, v184
  v_exp_f32 v185, v185
  v_smfmac_f32_32x32x32_bf16 v[80:95], v[224:227], v[176:183], v2
  s_getpc_b64 s[4:5]
L_pc_106:
  s_lshl_b32 s46, s37, 2
  s_add_u32 s46, s46, s38
  s_and_b32 s46, s46, 7
  s_lshl_b32 s46, s46, 11
  s_add_u32 s46, s46, 1024
  v_lshrrev_b32 v6, 6, v0
  v_lshl_add_u32 v6, v6, 7, s46
  v_min_u32 v6, L_end-L_pc_106-4, v6
  global_load_dword v255, v6, s[4:5]
  v_exp_f32 v186, v186
  v_exp_f32 v187, v187
  v_exp_f32 v188, v188
  v_exp_f32 v189, v189
  v_exp_f32 v190, v190
  v_exp_f32 v191, v191
  v_exp_f32 v192, v192
  v_exp_f32 v193, v193
  v_smfmac_f32_32x32x32_bf16 v[80:95], v[228:231], v[184:191], v2
  v_exp_f32 v194, v194
  v_exp_f32 v195, v195
  v_exp_f32 v196, v196
  v_mfma_f32_32x32x16_bf16 v[176:191], v[220:223], v[168:171], 0
  v_exp_f32 v197, v197
  v_exp_f32 v198, v198
  v_exp_f32 v199, v199
  v_exp_f32 v200, v200
  v_exp_f32 v201, v201
  v_smfmac_f32_32x32x32_bf16 v[96:111], v[224:227], v[192:199], v2
  buffer_load_dwordx4 v0, s[8:11], s57 offen offset:1024 sc1 lds
  v_exp_f32 v202, v202
  v_exp_f32 v203, v203
  v_exp_f32 v204, v204
  v_exp_f32 v205, v205
  v_exp_f32 v206, v206
  v_exp_f32 v207, v207
  v_exp_f32 v176, v176
  v_exp_f32 v177, v177
  v_smfmac_f32_32x32x32_bf16 v[96:111], v[228:231], v[200:207], v2
  s_and_b32 s46, s100, 48
  s_cbranch_scc1 L_gslow_107
L_gjoin_108:
  v_exp_f32 v178, v178
  v_exp_f32 v179, v179
  v_exp_f32 v180, v180
  v_mfma_f32_32x32x16_bf16 v[192:207], v[220:223], v[172:175], 0
  v_exp_f32 v181, v181
  v_exp_f32 v182, v182
  v_exp_f32 v183, v183
  v_exp_f32 v184, v184
  v_exp_f32 v185, v185
  v_smfmac_f32_32x32x32_bf16 v[112:127], v[224:227], v[176:183], v2
  s_add_u32 s3, s36, 2
  s_and_b32 s3, s3, 7
  v_exp_f32 v186, v186
  v_exp_f32 v187, v187
  v_exp_f32 v188, v188
  v_exp_f32 v189, v189
  v_exp_f32 v190, v190
  v_exp_f32 v191, v191
  v_exp_f32 v192, v192
  v_exp_f32 v193, v193
  v_smfmac_f32_32x32x32_bf16 v[112:127], v[228:231], v[184:191], v2
  s_waitcnt vmcnt(6)
  v_exp_f32 v194, v194
  v_exp_f32 v195, v195
  v_exp_f32 v196, v196
  v_mfma_f32_32x32x16_bf16 v[176:191], v[232:235], v[144:147], 0
  v_exp_f32 v197, v197
  v_exp_f32 v198, v198
  v_exp_f32 v199, v199
  v_exp_f32 v200, v200
  v_exp_f32 v201, v201
  v_smfmac_f32_32x32x32_bf16 v[128:143], v[224:227], v[192:199], v2
  s_lshl_b32 s3, s3, 14
  s_add_u32 s3, s3, s6
  v_exp_f32 v202, v202
  v_exp_f32 v203, v203
  v_exp_f32 v204, v204
  v_exp_f32 v205, v205
  v_exp_f32 v206, v206
  v_exp_f32 v207, v207
  v_exp_f32 v176, v176
  v_exp_f32 v177, v177
  v_smfmac_f32_32x32x32_bf16 v[128:143], v[228:231], v[200:207], v2
  buffer_load_dwordx4 v[220:223], v0, s[8:11], s3 offen sc1
  v_exp_f32 v178, v178
  v_exp_f32 v179, v179
  v_exp_f32 v180, v180
  v_mfma_f32_32x32x16_bf16 v[192:207], v[232:235], v[148:151], 0
  v_exp_f32 v181, v181
  v_exp_f32 v182, v182
  v_exp_f32 v183, v183
  v_exp_f32 v184, v184
  v_exp_f32 v185, v185
  v_smfmac_f32_32x32x32_bf16 v[16:31], v[236:239], v[176:183], v2
  s_mov_b64 exec, s[60:61]
  buffer_load_dwordx4 v[224:227], v252, s[8:11], s3 offen offset:1024 sc1
  buffer_load_dwordx4 v[228:231], v252, s[8:11], s3 offen offset:1536 sc1
  s_mov_b64 exec, -1
  v_exp_f32 v186, v186
  v_exp_f32 v187, v187
  v_exp_f32 v188, v188
  v_exp_f32 v189, v189
  v_exp_f32 v190, v190
  v_exp_f32 v191, v191
  v_exp_f32 v192, v192
  v_exp_f32 v193, v193
  v_smfmac_f32_32x32x32_bf16 v[16:31], v[240:243], v[184:191], v2
  buffer_load_dwordx4 v0, s[8:11], s57 offen offset:2048 sc1 lds
  v_exp_f32 v194, v194
  v_exp_f32 v195, v195
  v_exp_f32 v196, v196
  v_mfma_f32_32x32x16_bf16 v[176:191], v[232:235], v[152:155], 0
  v_exp_f32 v197, v197
  v_exp_f32 v198, v198
  v_exp_f32 v199, v199
  v_exp_f32 v200, v200
  v_exp_f32 v201, v201
  v_smfmac_f32_32x32x32_bf16 v[32:47], v[236:239], v[192:199], v2
  v_exp_f32 v202, v202
  v_exp_f32 v203, v203
  v_exp_f32 v204, v204
  v_exp_f32 v205, v205
  v_exp_f32 v206, v206
  v_exp_f32 v207, v207
  v_exp_f32 v176, v176
  v_exp_f32 v177, v177
  v_smfmac_f32_32x32x32_bf16 v[32:47], v[240:243], v[200:207], v2
  buffer_load_dwordx4 v0, s[8:11], s57 offen offset:3072 sc1 lds
  v_exp_f32 v178, v178
  v_exp_f32 v179, v179
  v_exp_f32 v180, v180
  v_mfma_f32_32x32x16_bf16 v[192:207], v[232:235], v[156:159], 0
  v_exp_f32 v181, v181
  v_exp_f32 v182, v182
  v_exp_f32 v183, v183
  v_exp_f32 v184, v184
  v_exp_f32 v185, v185
  v_smfmac_f32_32x32x32_bf16 v[48:63], v[236:239], v[176:183], v2
  v_exp_f32 v186, v186
  v_exp_f32 v187, v187
  v_exp_f32 v188, v188
  v_exp_f32 v189, v189
  v_exp_f32 v190, v190
  v_exp_f32 v191, v191
  v_exp_f32 v192, v192
  v_exp_f32 v193, v193
  v_smfmac_f32_32x32x32_bf16 v[48:63], v[240:243], v[184:191], v2
  v_exp_f32 v194, v194
  v_exp_f32 v195, v195
  v_exp_f32 v196, v196
  v_mfma_f32_32x32x16_bf16 v[176:191], v[232:235], v[160:163], 0
  v_exp_f32 v197, v197
  v_exp_f32 v198, v198
  v_exp_f32 v199, v199
  v_exp_f32 v200, v200
  v_exp_f32 v201, v201
  v_smfmac_f32_32x32x32_bf16 v[64:79], v[236:239], v[192:199], v2
  v_exp_f32 v202, v202
  v_exp_f32 v203, v203
  v_exp_f32 v204, v204
  v_exp_f32 v205, v205
  v_exp_f32 v206, v206
  v_exp_f32 v207, v207
  v_exp_f32 v176, v176
  v_exp_f32 v177, v177
  v_smfmac_f32_32x32x32_bf16 v[64:79], v[240:243], v[200:207], v2
  v_exp_f32 v178, v178
  v_exp_f32 v179, v179
  v_exp_f32 v180, v180
  v_mfma_f32_32x32x16_bf16 v[192:207], v[232:235], v[164:167], 0
  v_exp_f32 v181, v181
  v_exp_f32 v182, v182
  v_exp_f32 v183, v183
  v_exp_f32 v184, v184
  v_exp_f32 v185, v185
  v_smfmac_f32_32x32x32_bf16 v[80:95], v[236:239], v[176:183], v2
  s_add_u32 s56, s56, 4096
  s_add_u32 s57, s57, 4096
  v_exp_f32 v186, v186
  v_exp_f32 v187, v187
  v_exp_f32 v188, v188
  v_exp_f32 v189, v189
  v_exp_f32 v190, v190
  v_exp_f32 v191, v191
  v_exp_f32 v192, v192
  v_exp_f32 v193, v193
  v_smfmac_f32_32x32x32_bf16 v[80:95], v[240:243], v[184:191], v2
  s_mov_b32 m0, s56
  s_nop 0
  buffer_load_dwordx4 v0, s[8:11], s57 offen sc1 lds
  v_exp_f32 v194, v194
  v_exp_f32 v195, v195
  v_exp_f32 v196, v196
  v_mfma_f32_32x32x16_bf16 v[176:191], v[232:235], v[168:171], 0
  v_exp_f32 v197, v197
  v_exp_f32 v198, v198
  v_exp_f32 v199, v199
  v_exp_f32 v200, v200
  v_exp_f32 v201, v201
  v_smfmac_f32_32x32x32_bf16 v[96:111], v[236:239], v[192:199], v2
  v_exp_f32 v202, v202
  v_exp_f32 v203, v203
  v_exp_f32 v204, v204
  v_exp_f32 v205, v205
  v_exp_f32 v206, v206
  v_exp_f32 v207, v207
  v_exp_f32 v176, v176
  v_exp_f32 v177, v177
  v_smfmac_f32_32x32x32_bf16 v[96:111], v[240:243], v[200:207], v2
  v_exp_f32 v178, v178
  v_exp_f32 v179, v179
  v_exp_f32 v180, v180
  v_mfma_f32_32x32x16_bf16 v[192:207], v[232:235], v[172:175], 0
  v_exp_f32 v181, v181
  v_exp_f32 v182, v182
  v_exp_f32 v183, v183
  v_exp_f32 v184, v184
  v_exp_f32 v185, v185
  v_smfmac_f32_32x32x32_bf16 v[112:127], v[236:239], v[176:183], v2
  buffer_load_dwordx4 v0, s[8:11], s57 offen offset:1024 sc1 lds
  v_exp_f32 v186, v186
  v_exp_f32 v187, v187
  v_exp_f32 v188, v188
  v_exp_f32 v189, v189
  v_exp_f32 v190, v190
  v_exp_f32 v191, v191
  v_exp_f32 v192, v192
  v_exp_f32 v193, v193
  v_smfmac_f32_32x32x32_bf16 v[112:127], v[240:243], v[184:191], v2
  s_waitcnt vmcnt(10)
  v_exp_f32 v194, v194
  v_exp_f32 v195, v195
  v_exp_f32 v196, v196
  v_mfma_f32_32x32x16_bf16 v[176:191], v[208:211], v[144:147], 0
  v_exp_f32 v197, v197
  v_exp_f32 v198, v198
  v_exp_f32 v199, v199
  v_exp_f32 v200, v200
  v_exp_f32 v201, v201
  v_smfmac_f32_32x32x32_bf16 v[128:143], v[236:239], v[192:199], v2
  v_exp_f32 v202, v202
  v_exp_f32 v203, v203
  v_exp_f32 v204, v204
  v_exp_f32 v205, v205
  v_exp_f32 v206, v206
  v_exp_f32 v207, v207
  v_exp_f32 v176, v176
  v_exp_f32 v177, v177
  v_smfmac_f32_32x32x32_bf16 v[128:143], v[240:243], v[200:207], v2
  buffer_load_dwordx4 v[232:235], v0, s[8:11], s3 offen offset:2048 sc1
  v_exp_f32 v178, v178
  v_exp_f32 v179, v179
  v_exp_f32 v180, v180
  v_mfma_f32_32x32x16_bf16 v[192:207], v[208:211], v[148:151], 0
  v_exp_f32 v181, v181
  v_exp_f32 v182, v182
  v_exp_f32 v183, v183
  v_exp_f32 v184, v184
  v_exp_f32 v185, v185
  v_smfmac_f32_32x32x32_bf16 v[16:31], v[212:215], v[176:183], v2
  s_mov_b64 exec, s[60:61]
  buffer_load_dwordx4 v[236:239], v252, s[8:11], s3 offen offset:3072 sc1
  buffer_load_dwordx4 v[240:243], v252, s[8:11], s3 offen offset:3584 sc1
  s_mov_b64 exec, -1
  v_exp_f32 v186, v186
  v_exp_f32 v187, v187
  v_exp_f32 v188, v188
  v_exp_f32 v189, v189
  v_exp_f32 v190, v190
  v_exp_f32 v191, v191
  v_exp_f32 v192, v192
  v_exp_f32 v193, v193
  v_smfmac_f32_32x32x32_bf16 v[16:31], v[216:219], v[184:191], v2
  buffer_load_dwordx4 v0, s[8:11], s57 offen offset:2048 sc1 lds
  v_exp_f32 v194, v194
  v_exp_f32 v195, v195
  v_exp_f32 v196, v196
  v_mfma_f32_32x32x16_bf16 v[176:191], v[208:211], v[152:155], 0
  v_exp_f32 v197, v197
  v_exp_f32 v198, v198
  v_exp_f32 v199, v199
  v_exp_f32 v200, v200
  v_exp_f32 v201, v201
  v_smfmac_f32_32x32x32_bf16 v[32:47], v[212:215], v[192:199], v2
  v_exp_f32 v202, v202
  v_exp_f32 v203, v203
  v_exp_f32 v204, v204
  v_exp_f32 v205, v205
  v_exp_f32 v206, v206
  v_exp_f32 v207, v207
  v_exp_f32 v176, v176
  v_exp_f32 v177, v177
  v_smfmac_f32_32x32x32_bf16 v[32:47], v[216:219], v[200:207], v2
  v_exp_f32 v178, v178
  v_exp_f32 v179, v179
  v_exp_f32 v180, v180
  v_mfma_f32_32x32x16_bf16 v[192:207], v[208:211], v[156:159], 0
  v_exp_f32 v181, v181
  v_exp_f32 v182, v182
  v_exp_f32 v183, v183
  v_exp_f32 v184, v184
  v_exp_f32 v185, v185
  v_smfmac_f32_32x32x32_bf16 v[48:63], v[212:215], v[176:183], v2
  v_exp_f32 v186, v186
  v_exp_f32 v187, v187
  v_exp_f32 v188, v188
  v_exp_f32 v189, v189
  v_exp_f32 v190, v190
  v_exp_f32 v191, v191
  v_exp_f32 v192, v192
  v_exp_f32 v193, v193
  v_smfmac_f32_32x32x32_bf16 v[48:63], v[216:219], v[184:191], v2
  v_exp_f32 v194, v194
  v_exp_f32 v195, v195
  v_exp_f32 v196, v196
  v_mfma_f32_32x32x16_bf16 v[176:191], v[208:211], v[160:163], 0
  v_exp_f32 v197, v197
  v_exp_f32 v198, v198
  v_exp_f32 v199, v199
  v_exp_f32 v200, v200
  v_exp_f32 v201, v201
  v_smfmac_f32_32x32x32_bf16 v[64:79], v[212:215], v[192:199], v2
  buffer_load_dwordx4 v0, s[8:11], s57 offen offset:3072 sc1 lds
  v_exp_f32 v202, v202
  v_exp_f32 v203, v203
  v_exp_f32 v204, v204
  v_exp_f32 v205, v205
  v_exp_f32 v206, v206
  v_exp_f32 v207, v207
  v_exp_f32 v176, v176
  v_exp_f32 v177, v177
  v_smfmac_f32_32x32x32_bf16 v[64:79], v[216:219], v[200:207], v2
  v_exp_f32 v178, v178
  v_exp_f32 v179, v179
  v_exp_f32 v180, v180
  v_mfma_f32_32x32x16_bf16 v[192:207], v[208:211], v[164:167], 0
  v_exp_f32 v181, v181
  v_exp_f32 v182, v182
  v_exp_f32 v183, v183
  v_exp_f32 v184, v184
  v_exp_f32 v185, v185
  v_smfmac_f32_32x32x32_bf16 v[80:95], v[212:215], v[176:183], v2
  v_exp_f32 v186, v186
  v_exp_f32 v187, v187
  v_exp_f32 v188, v188
  v_exp_f32 v189, v189
  v_exp_f32 v190, v190
  v_exp_f32 v191, v191
  v_exp_f32 v192, v192
  v_exp_f32 v193, v193
  v_smfmac_f32_32x32x32_bf16 v[80:95], v[216:219], v[184:191], v2
  v_exp_f32 v194, v194
  v_exp_f32 v195, v195
  v_exp_f32 v196, v196
  v_mfma_f32_32x32x16_bf16 v[176:191], v[208:211], v[168:171], 0
  v_exp_f32 v197, v197
  v_exp_f32 v198, v198
  v_exp_f32 v199, v199
  v_exp_f32 v200, v200
  v_exp_f32 v201, v201
  v_smfmac_f32_32x32x32_bf16 v[96:111], v[212:215], v[192:199], v2
  s_add_u32 s56, s56, 4096
  s_add_u32 s57, s57, 4096
  v_exp_f32 v202, v202
  v_exp_f32 v203, v203
  v_exp_f32 v204, v204
  v_exp_f32 v205, v205
  v_exp_f32 v206, v206
  v_exp_f32 v207, v207
  v_exp_f32 v176, v176
  v_exp_f32 v177, v177
  v_smfmac_f32_32x32x32_bf16 v[96:111], v[216:219], v[200:207], v2
  s_and_b32 s46, s100, 192
  s_cbranch_scc1 L_gslow_110
L_gjoin_111:
  v_exp_f32 v178, v178
  v_exp_f32 v179, v179
  v_exp_f32 v180, v180
  v_mfma_f32_32x32x16_bf16 v[192:207], v[208:211], v[172:175], 0
  v_exp_f32 v181, v181
  v_exp_f32 v182, v182
  v_exp_f32 v183, v183
  v_exp_f32 v184, v184
  v_exp_f32 v185, v185
  v_smfmac_f32_32x32x32_bf16 v[112:127], v[212:215], v[176:183], v2
  s_add_u32 s3, s36, 3
  s_and_b32 s3, s3, 7
  v_exp_f32 v186, v186
  v_exp_f32 v187, v187
  v_exp_f32 v188, v188
  v_exp_f32 v189, v189
  v_exp_f32 v190, v190
  v_exp_f32 v191, v191
  v_exp_f32 v192, v192
  v_exp_f32 v193, v193
  v_smfmac_f32_32x32x32_bf16 v[112:127], v[216:219], v[184:191], v2
  s_waitcnt vmcnt(9)
  v_exp_f32 v194, v194
  v_exp_f32 v195, v195
  v_exp_f32 v196, v196
  v_mfma_f32_32x32x16_bf16 v[176:191], v[220:223], v[144:147], 0
  v_exp_f32 v197, v197
  v_exp_f32 v198, v198
  v_exp_f32 v199, v199
  v_exp_f32 v200, v200
  v_exp_f32 v201, v201
  v_smfmac_f32_32x32x32_bf16 v[128:143], v[212:215], v[192:199], v2
  s_lshl_b32 s3, s3, 14
  s_add_u32 s3, s3, s6
  v_exp_f32 v202, v202
  v_exp_f32 v203, v203
  v_exp_f32 v204, v204
  v_exp_f32 v205, v205
  v_exp_f32 v206, v206
  v_exp_f32 v207, v207
  v_exp_f32 v176, v176
  v_exp_f32 v177, v177
  v_smfmac_f32_32x32x32_bf16 v[128:143], v[216:219], v[200:207], v2
  buffer_load_dwordx4 v[208:211], v0, s[8:11], s3 offen sc1
  v_exp_f32 v178, v178
  v_exp_f32 v179, v179
  v_exp_f32 v180, v180
  v_mfma_f32_32x32x16_bf16 v[192:207], v[220:223], v[148:151], 0
  v_exp_f32 v181, v181
  v_exp_f32 v182, v182
  v_exp_f32 v183, v183
  v_exp_f32 v184, v184
  v_exp_f32 v185, v185
  v_smfmac_f32_32x32x32_bf16 v[16:31], v[224:227], v[176:183], v2
  s_mov_b64 exec, s[60:61]
  buffer_load_dwordx4 v[212:215], v252, s[8:11], s3 offen offset:1024 sc1
  buffer_load_dwordx4 v[216:219], v252, s[8:11], s3 offen offset:1536 sc1
  s_mov_b64 exec, -1
  v_exp_f32 v186, v186
  v_exp_f32 v187, v187
  v_exp_f32 v188, v188
  v_exp_f32 v189, v189
  v_exp_f32 v190, v190
  v_exp_f32 v191, v191
  v_exp_f32 v192, v192
  v_exp_f32 v193, v193
  v_smfmac_f32_32x32x32_bf16 v[16:31], v[228:231], v[184:191], v2
  s_mov_b32 m0, s56
  s_nop 0
  buffer_load_dwordx4 v0, s[8:11], s57 offen sc1 lds
  v_exp_f32 v194, v194
  v_exp_f32 v195, v195
  v_exp_f32 v196, v196
  v_mfma_f32_32x32x16_bf16 v[176:191], v[220:223], v[152:155], 0
  v_exp_f32 v197, v197
  v_exp_f32 v198, v198
  v_exp_f32 v199, v199
  v_exp_f32 v200, v200
  v_exp_f32 v201, v201
  v_smfmac_f32_32x32x32_bf16 v[32:47], v[224:227], v[192:199], v2
  buffer_load_dwordx4 v0, s[8:11], s57 offen offset:1024 sc1 lds
  v_exp_f32 v202, v202
  v_exp_f32 v203, v203
  v_exp_f32 v204, v204
  v_exp_f32 v205, v205
  v_exp_f32 v206, v206
  v_exp_f32 v207, v207
  v_exp_f32 v176, v176
  v_exp_f32 v177, v177
  v_smfmac_f32_32x32x32_bf16 v[32:47], v[228:231], v[200:207], v2
  v_exp_f32 v178, v178
  v_exp_f32 v179, v179
  v_exp_f32 v180, v180
  v_mfma_f32_32x32x16_bf16 v[192:207], v[220:223], v[156:159], 0
  v_exp_f32 v181, v181
  v_exp_f32 v182, v182
  v_exp_f32 v183, v183
  v_exp_f32 v184, v184
  v_exp_f32 v185, v185
  v_smfmac_f32_32x32x32_bf16 v[48:63], v[224:227], v[176:183], v2
  buffer_load_dwordx4 v0, s[8:11], s57 offen offset:2048 sc1 lds
  v_exp_f32 v186, v186
  v_exp_f32 v187, v187
  v_exp_f32 v188, v188
  v_exp_f32 v189, v189
  v_exp_f32 v190, v190
  v_exp_f32 v191, v191
  v_exp_f32 v192, v192
  v_exp_f32 v193, v193
  v_smfmac_f32_32x32x32_bf16 v[48:63], v[228:231], v[184:191], v2
  v_exp_f32 v194, v194
  v_exp_f32 v195, v195
  v_exp_f32 v196, v196
  v_mfma_f32_32x32x16_bf16 v[176:191], v[220:223], v[160:163], 0
  v_exp_f32 v197, v197
  v_exp_f32 v198, v198
  v_exp_f32 v199, v199
  v_exp_f32 v200, v200
  v_exp_f32 v201, v201
  v_smfmac_f32_32x32x32_bf16 v[64:79], v[224:227], v[192:199], v2
  v_exp_f32 v202, v202
  v_exp_f32 v203, v203
  v_exp_f32 v204, v204
  v_exp_f32 v205, v205
  v_exp_f32 v206, v206
  v_exp_f32 v207, v207
  v_exp_f32 v176, v176
  v_exp_f32 v177, v177
  v_smfmac_f32_32x32x32_bf16 v[64:79], v[228:231], v[200:207], v2
  v_exp_f32 v178, v178
  v_exp_f32 v179, v179
  v_exp_f32 v180, v180
  v_mfma_f32_32x32x16_bf16 v[192:207], v[220:223], v[164:167], 0
  v_exp_f32 v181, v181
  v_exp_f32 v182, v182
  v_exp_f32 v183, v183
  v_exp_f32 v184, v184
  v_exp_f32 v185, v185
  v_smfmac_f32_32x32x32_bf16 v[80:95], v[224:227], v[176:183], v2
  buffer_load_dwordx4 v0, s[8:11], s57 offen offset:3072 sc1 lds
  v_exp_f32 v186, v186
  v_exp_f32 v187, v187
  v_exp_f32 v188, v188
  v_exp_f32 v189, v189
  v_exp_f32 v190, v190
  v_exp_f32 v191, v191
  v_exp_f32 v192, v192
  v_exp_f32 v193, v193
  v_smfmac_f32_32x32x32_bf16 v[80:95], v[228:231], v[184:191], v2
  v_exp_f32 v194, v194
  v_exp_f32 v195, v195
  v_exp_f32 v196, v196
  v_mfma_f32_32x32x16_bf16 v[176:191], v[220:223], v[168:171], 0
  v_exp_f32 v197, v197
  v_exp_f32 v198, v198
  v_exp_f32 v199, v199
  v_exp_f32 v200, v200
  v_exp_f32 v201, v201
  v_smfmac_f32_32x32x32_bf16 v[96:111], v[224:227], v[192:199], v2
  v_exp_f32 v202, v202
  v_exp_f32 v203, v203
  v_exp_f32 v204, v204
  v_exp_f32 v205, v205
  v_exp_f32 v206, v206
  v_exp_f32 v207, v207
  v_exp_f32 v176, v176
  v_exp_f32 v177, v177
  v_smfmac_f32_32x32x32_bf16 v[96:111], v[228:231], v[200:207], v2
  v_exp_f32 v178, v178
  v_exp_f32 v179, v179
  v_exp_f32 v180, v180
  v_mfma_f32_32x32x16_bf16 v[192:207], v[220:223], v[172:175], 0
  v_exp_f32 v181, v181
  v_exp_f32 v182, v182
  v_exp_f32 v183, v183
  v_exp_f32 v184, v184
  v_exp_f32 v185, v185
  v_smfmac_f32_32x32x32_bf16 v[112:127], v[224:227], v[176:183], v2
  v_exp_f32 v186, v186
  v_exp_f32 v187, v187
  v_exp_f32 v188, v188
  v_exp_f32 v189, v189
  v_exp_f32 v190, v190
  v_exp_f32 v191, v191
  v_exp_f32 v192, v192
  v_exp_f32 v193, v193
  v_smfmac_f32_32x32x32_bf16 v[112:127], v[228:231], v[184:191], v2
  s_waitcnt vmcnt(9)
  v_exp_f32 v194, v194
  v_exp_f32 v195, v195
  v_exp_f32 v196, v196
  v_mfma_f32_32x32x16_bf16 v[176:191], v[232:235], v[144:147], 0
  v_exp_f32 v197, v197
  v_exp_f32 v198, v198
  v_exp_f32 v199, v199
  v_exp_f32 v200, v200
  v_exp_f32 v201, v201
  v_smfmac_f32_32x32x32_bf16 v[128:143], v[224:227], v[192:199], v2
  s_add_u32 s56, s56, 4096
  s_add_u32 s57, s57, 4096
  v_exp_f32 v202, v202
  v_exp_f32 v203, v203
  v_exp_f32 v204, v204
  v_exp_f32 v205, v205
  v_exp_f32 v206, v206
  v_exp_f32 v207, v207
  v_exp_f32 v176, v176
  v_exp_f32 v177, v177
  v_smfmac_f32_32x32x32_bf16 v[128:143], v[228:231], v[200:207], v2
  buffer_load_dwordx4 v[220:223], v0, s[8:11], s3 offen offset:2048 sc1
  v_exp_f32 v178, v178
  v_exp_f32 v179, v179
  v_exp_f32 v180, v180
  v_mfma_f32_32x32x16_bf16 v[192:207], v[232:235], v[148:151], 0
  v_exp_f32 v181, v181
  v_exp_f32 v182, v182
  v_exp_f32 v183, v183
  v_exp_f32 v184, v184
  v_exp_f32 v185, v185
  v_smfmac_f32_32x32x32_bf16 v[16:31], v[236:239], v[176:183], v2
  s_mov_b64 exec, s[60:61]
  buffer_load_dwordx4 v[224:227], v252, s[8:11], s3 offen offset:3072 sc1
  buffer_load_dwordx4 v[228:231], v252, s[8:11], s3 offen offset:3584 sc1
  s_mov_b64 exec, -1
  v_exp_f32 v186, v186
  v_exp_f32 v187, v187
  v_exp_f32 v188, v188
  v_exp_f32 v189, v189
  v_exp_f32 v190, v190
  v_exp_f32 v191, v191
  v_exp_f32 v192, v192
  v_exp_f32 v193, v193
  v_smfmac_f32_32x32x32_bf16 v[16:31], v[240:243], v[184:191], v2
  s_mov_b32 m0, s56
  s_nop 0
  buffer_load_dwordx4 v0, s[8:11], s57 offen sc1 lds
  v_exp_f32 v194, v194
  v_exp_f32 v195, v195
  v_exp_f32 v196, v196
  v_mfma_f32_32x32x16_bf16 v[176:191], v[232:235], v[152:155], 0
  v_exp_f32 v197, v197
  v_exp_f32 v198, v198
  v_exp_f32 v199, v199
  v_exp_f32 v200, v200
  v_exp_f32 v201, v201
  v_smfmac_f32_32x32x32_bf16 v[32:47], v[236:239], v[192:199], v2
  buffer_load_dwordx4 v0, s[8:11], s57 offen offset:1024 sc1 lds
  v_exp_f32 v202, v202
  v_exp_f32 v203, v203
  v_exp_f32 v204, v204
  v_exp_f32 v205, v205
  v_exp_f32 v206, v206
  v_exp_f32 v207, v207
  v_exp_f32 v176, v176
  v_exp_f32 v177, v177
  v_smfmac_f32_32x32x32_bf16 v[32:47], v[240:243], v[200:207], v2
  v_exp_f32 v178, v178
  v_exp_f32 v179, v179
  v_exp_f32 v180, v180
  v_mfma_f32_32x32x16_bf16 v[192:207], v[232:235], v[156:159], 0
  v_exp_f32 v181, v181
  v_exp_f32 v182, v182
  v_exp_f32 v183, v183
  v_exp_f32 v184, v184
  v_exp_f32 v185, v185
  v_smfmac_f32_32x32x32_bf16 v[48:63], v[236:239], v[176:183], v2
  v_exp_f32 v186, v186
  v_exp_f32 v187, v187
  v_exp_f32 v188, v188
  v_exp_f32 v189, v189
  v_exp_f32 v190, v190
  v_exp_f32 v191, v191
  v_exp_f32 v192, v192
  v_exp_f32 v193, v193
  v_smfmac_f32_32x32x32_bf16 v[48:63], v[240:243], v[184:191], v2
  v_exp_f32 v194, v194
  v_exp_f32 v195, v195
  v_exp_f32 v196, v196
  v_mfma_f32_32x32x16_bf16 v[176:191], v[232:235], v[160:163], 0
  v_exp_f32 v197, v197
  v_exp_f32 v198, v198
  v_exp_f32 v199, v199
  v_exp_f32 v200, v200
  v_exp_f32 v201, v201
  v_smfmac_f32_32x32x32_bf16 v[64:79], v[236:239], v[192:199], v2
  buffer_load_dwordx4 v0, s[8:11], s57 offen offset:2048 sc1 lds
  v_exp_f32 v202, v202
  v_exp_f32 v203, v203
  v_exp_f32 v204, v204
  v_exp_f32 v205, v205
  v_exp_f32 v206, v206
  v_exp_f32 v207, v207
  v_exp_f32 v176, v176
  v_exp_f32 v177, v177
  v_smfmac_f32_32x32x32_bf16 v[64:79], v[240:243], v[200:207], v2
  v_exp_f32 v178, v178
  v_exp_f32 v179, v179
  v_exp_f32 v180, v180
  v_mfma_f32_32x32x16_bf16 v[192:207], v[232:235], v[164:167], 0
  v_exp_f32 v181, v181
  v_exp_f32 v182, v182
  v_exp_f32 v183, v183
  v_exp_f32 v184, v184
  v_exp_f32 v185, v185
  v_smfmac_f32_32x32x32_bf16 v[80:95], v[236:239], v[176:183], v2
  v_exp_f32 v186, v186
  v_exp_f32 v187, v187
  v_exp_f32 v188, v188
  v_exp_f32 v189, v189
  v_exp_f32 v190, v190
  v_exp_f32 v191, v191
  v_exp_f32 v192, v192
  v_exp_f32 v193, v193
  v_smfmac_f32_32x32x32_bf16 v[80:95], v[240:243], v[184:191], v2
  v_exp_f32 v194, v194
  v_exp_f32 v195, v195
  v_exp_f32 v196, v196
  v_mfma_f32_32x32x16_bf16 v[176:191], v[232:235], v[168:171], 0
  v_exp_f32 v197, v197
  v_exp_f32 v198, v198
  v_exp_f32 v199, v199
  v_exp_f32 v200, v200
  v_exp_f32 v201, v201
  v_smfmac_f32_32x32x32_bf16 v[96:111], v[236:239], v[192:199], v2
  v_exp_f32 v202, v202
  v_exp_f32 v203, v203
  v_exp_f32 v204, v204
  v_exp_f32 v205, v205
  v_exp_f32 v206, v206
  v_exp_f32 v207, v207
  v_exp_f32 v176, v176
  v_exp_f32 v177, v177
  v_smfmac_f32_32x32x32_bf16 v[96:111], v[240:243], v[200:207], v2
  s_and_b32 s46, s100, 768
  s_cbranch_scc1 L_gslow_113
L_gjoin_114:
  v_exp_f32 v178, v178
  v_exp_f32 v179, v179
  v_exp_f32 v180, v180
  v_mfma_f32_32x32x16_bf16 v[192:207], v[232:235], v[172:175], 0
  v_exp_f32 v181, v181
  v_exp_f32 v182, v182
  v_exp_f32 v183, v183
  v_exp_f32 v184, v184
  v_exp_f32 v185, v185
  v_smfmac_f32_32x32x32_bf16 v[112:127], v[236:239], v[176:183], v2
  s_add_u32 s3, s36, 4
  s_and_b32 s3, s3, 7
  v_exp_f32 v186, v186
  v_exp_f32 v187, v187
  v_exp_f32 v188, v188
  v_exp_f32 v189, v189
  v_exp_f32 v190, v190
  v_exp_f32 v191, v191
  v_exp_f32 v192, v192
  v_exp_f32 v193, v193
  v_smfmac_f32_32x32x32_bf16 v[112:127], v[240:243], v[184:191], v2
  s_waitcnt vmcnt(10)
  v_exp_f32 v194, v194
  v_exp_f32 v195, v195
  v_exp_f32 v196, v196
  v_mfma_f32_32x32x16_bf16 v[176:191], v[208:211], v[144:147], 0
  v_exp_f32 v197, v197
  v_exp_f32 v198, v198
  v_exp_f32 v199, v199
  v_exp_f32 v200, v200
  v_exp_f32 v201, v201
  v_smfmac_f32_32x32x32_bf16 v[128:143], v[236:239], v[192:199], v2
  s_lshl_b32 s3, s3, 14
  s_add_u32 s3, s3, s6
  v_exp_f32 v202, v202
  v_exp_f32 v203, v203
  v_exp_f32 v204, v204
  v_exp_f32 v205, v205
  v_exp_f32 v206, v206
  v_exp_f32 v207, v207
  v_exp_f32 v176, v176
  v_exp_f32 v177, v177
  v_smfmac_f32_32x32x32_bf16 v[128:143], v[240:243], v[200:207], v2
  buffer_load_dwordx4 v[232:235], v0, s[8:11], s3 offen sc1
  v_exp_f32 v178, v178
  v_exp_f32 v179, v179
  v_exp_f32 v180, v180
  v_mfma_f32_32x32x16_bf16 v[192:207], v[208:211], v[148:151], 0
  v_exp_f32 v181, v181
  v_exp_f32 v182, v182
  v_exp_f32 v183, v183
  v_exp_f32 v184, v184
  v_exp_f32 v185, v185
  v_smfmac_f32_32x32x32_bf16 v[16:31], v[212:215], v[176:183], v2
  s_mov_b64 exec, s[60:61]
  buffer_load_dwordx4 v[236:239], v252, s[8:11], s3 offen offset:1024 sc1
  buffer_load_dwordx4 v[240:243], v252, s[8:11], s3 offen offset:1536 sc1
  s_mov_b64 exec, -1
  v_exp_f32 v186, v186
  v_exp_f32 v187, v187
  v_exp_f32 v188, v188
  v_exp_f32 v189, v189
  v_exp_f32 v190, v190
  v_exp_f32 v191, v191
  v_exp_f32 v192, v192
  v_exp_f32 v193, v193
  v_smfmac_f32_32x32x32_bf16 v[16:31], v[216:219], v[184:191], v2
  buffer_load_dwordx4 v0, s[8:11], s57 offen offset:3072 sc1 lds
  v_exp_f32 v194, v194
  v_exp_f32 v195, v195
  v_exp_f32 v196, v196
  v_mfma_f32_32x32x16_bf16 v[176:191], v[208:211], v[152:155], 0
  v_exp_f32 v197, v197
  v_exp_f32 v198, v198
  v_exp_f32 v199, v199
  v_exp_f32 v200, v200
  v_exp_f32 v201, v201
  v_smfmac_f32_32x32x32_bf16 v[32:47], v[212:215], v[192:199], v2
  s_add_u32 s56, s56, 4096
  s_add_u32 s57, s57, 4096
  v_exp_f32 v202, v202
  v_exp_f32 v203, v203
  v_exp_f32 v204, v204
  v_exp_f32 v205, v205
  v_exp_f32 v206, v206
  v_exp_f32 v207, v207
  v_exp_f32 v176, v176
  v_exp_f32 v177, v177
  v_smfmac_f32_32x32x32_bf16 v[32:47], v[216:219], v[200:207], v2
  s_mov_b32 m0, s56
  s_nop 0
  buffer_load_dwordx4 v0, s[8:11], s57 offen sc1 lds
  v_exp_f32 v178, v178
  v_exp_f32 v179, v179
  v_exp_f32 v180, v180
  v_mfma_f32_32x32x16_bf16 v[192:207], v[208:211], v[156:159], 0
  v_exp_f32 v181, v181
  v_exp_f32 v182, v182
  v_exp_f32 v183, v183
  v_exp_f32 v184, v184
  v_exp_f32 v185, v185
  v_smfmac_f32_32x32x32_bf16 v[48:63], v[212:215], v[176:183], v2
  buffer_load_dwordx4 v0, s[8:11], s57 offen offset:1024 sc1 lds
  v_exp_f32 v186, v186
  v_exp_f32 v187, v187
  v_exp_f32 v188, v188
  v_exp_f32 v189, v189
  v_exp_f32 v190, v190
  v_exp_f32 v191, v191
  v_exp_f32 v192, v192
  v_exp_f32 v193, v193
  v_smfmac_f32_32x32x32_bf16 v[48:63], v[216:219], v[184:191], v2
  v_exp_f32 v194, v194
  v_exp_f32 v195, v195
  v_exp_f32 v196, v196
  v_mfma_f32_32x32x16_bf16 v[176:191], v[208:211], v[160:163], 0
  v_exp_f32 v197, v197
  v_exp_f32 v198, v198
  v_exp_f32 v199, v199
  v_exp_f32 v200, v200
  v_exp_f32 v201, v201
  v_smfmac_f32_32x32x32_bf16 v[64:79], v[212:215], v[192:199], v2
  v_exp_f32 v202, v202
  v_exp_f32 v203, v203
  v_exp_f32 v204, v204
  v_exp_f32 v205, v205
  v_exp_f32 v206, v206
  v_exp_f32 v207, v207
  v_exp_f32 v176, v176
  v_exp_f32 v177, v177
  v_smfmac_f32_32x32x32_bf16 v[64:79], v[216:219], v[200:207], v2
  v_exp_f32 v178, v178
  v_exp_f32 v179, v179
  v_exp_f32 v180, v180
  v_mfma_f32_32x32x16_bf16 v[192:207], v[208:211], v[164:167], 0
  v_exp_f32 v181, v181
  v_exp_f32 v182, v182
  v_exp_f32 v183, v183
  v_exp_f32 v184, v184
  v_exp_f32 v185, v185
  v_smfmac_f32_32x32x32_bf16 v[80:95], v[212:215], v[176:183], v2
  v_exp_f32 v186, v186
  v_exp_f32 v187, v187
  v_exp_f32 v188, v188
  v_exp_f32 v189, v189
  v_exp_f32 v190, v190
  v_exp_f32 v191, v191
  v_exp_f32 v192, v192
  v_exp_f32 v193, v193
  v_smfmac_f32_32x32x32_bf16 v[80:95], v[216:219], v[184:191], v2
  buffer_load_dwordx4 v0, s[8:11], s57 offen offset:2048 sc1 lds
  v_exp_f32 v194, v194
  v_exp_f32 v195, v195
  v_exp_f32 v196, v196
  v_mfma_f32_32x32x16_bf16 v[176:191], v[208:211], v[168:171], 0
  v_exp_f32 v197, v197
  v_exp_f32 v198, v198
  v_exp_f32 v199, v199
  v_exp_f32 v200, v200
  v_exp_f32 v201, v201
  v_smfmac_f32_32x32x32_bf16 v[96:111], v[212:215], v[192:199], v2
  v_exp_f32 v202, v202
  v_exp_f32 v203, v203
  v_exp_f32 v204, v204
  v_exp_f32 v205, v205
  v_exp_f32 v206, v206
  v_exp_f32 v207, v207
  v_exp_f32 v176, v176
  v_exp_f32 v177, v177
  v_smfmac_f32_32x32x32_bf16 v[96:111], v[216:219], v[200:207], v2
  v_exp_f32 v178, v178
  v_exp_f32 v179, v179
  v_exp_f32 v180, v180
  v_mfma_f32_32x32x16_bf16 v[192:207], v[208:211], v[172:175], 0
  v_exp_f32 v181, v181
  v_exp_f32 v182, v182
  v_exp_f32 v183, v183
  v_exp_f32 v184, v184
  v_exp_f32 v185, v185
  v_smfmac_f32_32x32x32_bf16 v[112:127], v[212:215], v[176:183], v2
  v_exp_f32 v186, v186
  v_exp_f32 v187, v187
  v_exp_f32 v188, v188
  v_exp_f32 v189, v189
  v_exp_f32 v190, v190
  v_exp_f32 v191, v191
  v_exp_f32 v192, v192
  v_exp_f32 v193, v193
  v_smfmac_f32_32x32x32_bf16 v[112:127], v[216:219], v[184:191], v2
  s_waitcnt vmcnt(10)
  v_exp_f32 v194, v194
  v_exp_f32 v195, v195
  v_exp_f32 v196, v196
  v_mfma_f32_32x32x16_bf16 v[176:191], v[220:223], v[144:147], 0
  v_exp_f32 v197, v197
  v_exp_f32 v198, v198
  v_exp_f32 v199, v199
  v_exp_f32 v200, v200
  v_exp_f32 v201, v201
  v_smfmac_f32_32x32x32_bf16 v[128:143], v[212:215], v[192:199], v2
  buffer_load_dwordx4 v0, s[8:11], s57 offen offset:3072 sc1 lds
  v_exp_f32 v202, v202
  v_exp_f32 v203, v203
  v_exp_f32 v204, v204
  v_exp_f32 v205, v205
  v_exp_f32 v206, v206
  v_exp_f32 v207, v207
  v_exp_f32 v176, v176
  v_exp_f32 v177, v177
  v_smfmac_f32_32x32x32_bf16 v[128:143], v[216:219], v[200:207], v2
  buffer_load_dwordx4 v[208:211], v0, s[8:11], s3 offen offset:2048 sc1
  v_exp_f32 v178, v178
  v_exp_f32 v179, v179
  v_exp_f32 v180, v180
  v_mfma_f32_32x32x16_bf16 v[192:207], v[220:223], v[148:151], 0
  v_exp_f32 v181, v181
  v_exp_f32 v182, v182
  v_exp_f32 v183, v183
  v_exp_f32 v184, v184
  v_exp_f32 v185, v185
  v_smfmac_f32_32x32x32_bf16 v[16:31], v[224:227], v[176:183], v2
  s_mov_b64 exec, s[60:61]
  buffer_load_dwordx4 v[212:215], v252, s[8:11], s3 offen offset:3072 sc1
  buffer_load_dwordx4 v[216:219], v252, s[8:11], s3 offen offset:3584 sc1
  s_mov_b64 exec, -1
  v_exp_f32 v186, v186
  v_exp_f32 v187, v187
  v_exp_f32 v188, v188
  v_exp_f32 v189, v189
  v_exp_f32 v190, v190
  v_exp_f32 v191, v191
  v_exp_f32 v192, v192
  v_exp_f32 v193, v193
  v_smfmac_f32_32x32x32_bf16 v[16:31], v[228:231], v[184:191], v2
  v_exp_f32 v194, v194
  v_exp_f32 v195, v195
  v_exp_f32 v196, v196
  v_mfma_f32_32x32x16_bf16 v[176:191], v[220:223], v[152:155], 0
  v_exp_f32 v197, v197
  v_exp_f32 v198, v198
  v_exp_f32 v199, v199
  v_exp_f32 v200, v200
  v_exp_f32 v201, v201
  v_smfmac_f32_32x32x32_bf16 v[32:47], v[224:227], v[192:199], v2
  s_add_u32 s56, s56, 4096
  s_add_u32 s57, s57, 4096
  v_exp_f32 v202, v202
  v_exp_f32 v203, v203
  v_exp_f32 v204, v204
  v_exp_f32 v205, v205
  v_exp_f32 v206, v206
  v_exp_f32 v207, v207
  v_exp_f32 v176, v176
  v_exp_f32 v177, v177
  v_smfmac_f32_32x32x32_bf16 v[32:47], v[228:231], v[200:207], v2
  s_mov_b32 m0, s56
  s_nop 0
  buffer_load_dwordx4 v0, s[8:11], s57 offen sc1 lds
  v_exp_f32 v178, v178
  v_exp_f32 v179, v179
  v_exp_f32 v180, v180
  v_mfma_f32_32x32x16_bf16 v[192:207], v[220:223], v[156:159], 0
  v_exp_f32 v181, v181
  v_exp_f32 v182, v182
  v_exp_f32 v183, v183
  v_exp_f32 v184, v184
  v_exp_f32 v185, v185
  v_smfmac_f32_32x32x32_bf16 v[48:63], v[224:227], v[176:183], v2
  v_exp_f32 v186, v186
  v_exp_f32 v187, v187
  v_exp_f32 v188, v188
  v_exp_f32 v189, v189
  v_exp_f32 v190, v190
  v_exp_f32 v191, v191
  v_exp_f32 v192, v192
  v_exp_f32 v193, v193
  v_smfmac_f32_32x32x32_bf16 v[48:63], v[228:231], v[184:191], v2
  v_exp_f32 v194, v194
  v_exp_f32 v195, v195
  v_exp_f32 v196, v196
  v_mfma_f32_32x32x16_bf16 v[176:191], v[220:223], v[160:163], 0
  v_exp_f32 v197, v197
  v_exp_f32 v198, v198
  v_exp_f32 v199, v199
  v_exp_f32 v200, v200
  v_exp_f32 v201, v201
  v_smfmac_f32_32x32x32_bf16 v[64:79], v[224:227], v[192:199], v2
  v_exp_f32 v202, v202
  v_exp_f32 v203, v203
  v_exp_f32 v204, v204
  v_exp_f32 v205, v205
  v_exp_f32 v206, v206
  v_exp_f32 v207, v207
  v_exp_f32 v176, v176
  v_exp_f32 v177, v177
  v_smfmac_f32_32x32x32_bf16 v[64:79], v[228:231], v[200:207], v2
  buffer_load_dwordx4 v0, s[8:11], s57 offen offset:1024 sc1 lds
  v_exp_f32 v178, v178
  v_exp_f32 v179, v179
  v_exp_f32 v180, v180
  v_mfma_f32_32x32x16_bf16 v[192:207], v[220:223], v[164:167], 0
  v_exp_f32 v181, v181
  v_exp_f32 v182, v182
  v_exp_f32 v183, v183
  v_exp_f32 v184, v184
  v_exp_f32 v185, v185
  v_smfmac_f32_32x32x32_bf16 v[80:95], v[224:227], v[176:183], v2
  v_exp_f32 v186, v186
  v_exp_f32 v187, v187
  v_exp_f32 v188, v188
  v_exp_f32 v189, v189
  v_exp_f32 v190, v190
  v_exp_f32 v191, v191
  v_exp_f32 v192, v192
  v_exp_f32 v193, v193
  v_smfmac_f32_32x32x32_bf16 v[80:95], v[228:231], v[184:191], v2
  v_exp_f32 v194, v194
  v_exp_f32 v195, v195
  v_exp_f32 v196, v196
  v_mfma_f32_32x32x16_bf16 v[176:191], v[220:223], v[168:171], 0
  v_exp_f32 v197, v197
  v_exp_f32 v198, v198
  v_exp_f32 v199, v199
  v_exp_f32 v200, v200
  v_exp_f32 v201, v201
  v_smfmac_f32_32x32x32_bf16 v[96:111], v[224:227], v[192:199], v2
  v_exp_f32 v202, v202
  v_exp_f32 v203, v203
  v_exp_f32 v204, v204
  v_exp_f32 v205, v205
  v_exp_f32 v206, v206
  v_exp_f32 v207, v207
  v_exp_f32 v176, v176
  v_exp_f32 v177, v177
  v_smfmac_f32_32x32x32_bf16 v[96:111], v[228:231], v[200:207], v2
  s_and_b32 s46, s100, 3072
  s_cbranch_scc1 L_gslow_116
L_gjoin_117:
  v_exp_f32 v178, v178
  v_exp_f32 v179, v179
  v_exp_f32 v180, v180
  v_mfma_f32_32x32x16_bf16 v[192:207], v[220:223], v[172:175], 0
  v_exp_f32 v181, v181
  v_exp_f32 v182, v182
  v_exp_f32 v183, v183
  v_exp_f32 v184, v184
  v_exp_f32 v185, v185
  v_smfmac_f32_32x32x32_bf16 v[112:127], v[224:227], v[176:183], v2
  s_add_u32 s3, s36, 5
  s_and_b32 s3, s3, 7
  v_exp_f32 v186, v186
  v_exp_f32 v187, v187
  v_exp_f32 v188, v188
  v_exp_f32 v189, v189
  v_exp_f32 v190, v190
  v_exp_f32 v191, v191
  v_exp_f32 v192, v192
  v_exp_f32 v193, v193
  v_smfmac_f32_32x32x32_bf16 v[112:127], v[228:231], v[184:191], v2
  s_waitcnt vmcnt(10)
  v_exp_f32 v194, v194
  v_exp_f32 v195, v195
  v_exp_f32 v196, v196
  v_mfma_f32_32x32x16_bf16 v[176:191], v[232:235], v[144:147], 0
  v_exp_f32 v197, v197
  v_exp_f32 v198, v198
  v_exp_f32 v199, v199
  v_exp_f32 v200, v200
  v_exp_f32 v201, v201
  v_smfmac_f32_32x32x32_bf16 v[128:143], v[224:227], v[192:199], v2
  s_lshl_b32 s3, s3, 14
  s_add_u32 s3, s3, s6
  v_exp_f32 v202, v202
  v_exp_f32 v203, v203
  v_exp_f32 v204, v204
  v_exp_f32 v205, v205
  v_exp_f32 v206, v206
  v_exp_f32 v207, v207
  v_exp_f32 v176, v176
  v_exp_f32 v177, v177
  v_smfmac_f32_32x32x32_bf16 v[128:143], v[228:231], v[200:207], v2
  buffer_load_dwordx4 v[220:223], v0, s[8:11], s3 offen sc1
  v_exp_f32 v178, v178
  v_exp_f32 v179, v179
  v_exp_f32 v180, v180
  v_mfma_f32_32x32x16_bf16 v[192:207], v[232:235], v[148:151], 0
  v_exp_f32 v181, v181
  v_exp_f32 v182, v182
  v_exp_f32 v183, v183
  v_exp_f32 v184, v184
  v_exp_f32 v185, v185
  v_smfmac_f32_32x32x32_bf16 v[16:31], v[236:239], v[176:183], v2
  s_mov_b64 exec, s[60:61]
  buffer_load_dwordx4 v[224:227], v252, s[8:11], s3 offen offset:1024 sc1
  buffer_load_dwordx4 v[228:231], v252, s[8:11], s3 offen offset:1536 sc1
  s_mov_b64 exec, -1
  v_exp_f32 v186, v186
  v_exp_f32 v187, v187
  v_exp_f32 v188, v188
  v_exp_f32 v189, v189
  v_exp_f32 v190, v190
  v_exp_f32 v191, v191
  v_exp_f32 v192, v192
  v_exp_f32 v193, v193
  v_smfmac_f32_32x32x32_bf16 v[16:31], v[240:243], v[184:191], v2
  buffer_load_dwordx4 v0, s[8:11], s57 offen offset:2048 sc1 lds
  v_exp_f32 v194, v194
  v_exp_f32 v195, v195
  v_exp_f32 v196, v196
  v_mfma_f32_32x32x16_bf16 v[176:191], v[232:235], v[152:155], 0
  v_exp_f32 v197, v197
  v_exp_f32 v198, v198
  v_exp_f32 v199, v199
  v_exp_f32 v200, v200
  v_exp_f32 v201, v201
  v_smfmac_f32_32x32x32_bf16 v[32:47], v[236:239], v[192:199], v2
  buffer_load_dwordx4 v0, s[8:11], s57 offen offset:3072 sc1 lds
  v_exp_f32 v202, v202
  v_exp_f32 v203, v203
  v_exp_f32 v204, v204
  v_exp_f32 v205, v205
  v_exp_f32 v206, v206
  v_exp_f32 v207, v207
  v_exp_f32 v176, v176
  v_exp_f32 v177, v177
  v_smfmac_f32_32x32x32_bf16 v[32:47], v[240:243], v[200:207], v2
  v_exp_f32 v178, v178
  v_exp_f32 v179, v179
  v_exp_f32 v180, v180
  v_mfma_f32_32x32x16_bf16 v[192:207], v[232:235], v[156:159], 0
  v_exp_f32 v181, v181
  v_exp_f32 v182, v182
  v_exp_f32 v183, v183
  v_exp_f32 v184, v184
  v_exp_f32 v185, v185
  v_smfmac_f32_32x32x32_bf16 v[48:63], v[236:239], v[176:183], v2
  s_add_u32 s56, s56, 4096
  s_add_u32 s57, s57, 4096
  v_exp_f32 v186, v186
  v_exp_f32 v187, v187
  v_exp_f32 v188, v188
  v_exp_f32 v189, v189
  v_exp_f32 v190, v190
  v_exp_f32 v191, v191
  v_exp_f32 v192, v192
  v_exp_f32 v193, v193
  v_smfmac_f32_32x32x32_bf16 v[48:63], v[240:243], v[184:191], v2
  s_mov_b32 m0, s56
  s_nop 0
  buffer_load_dwordx4 v0, s[8:11], s57 offen sc1 lds
  v_exp_f32 v194, v194
  v_exp_f32 v195, v195
  v_exp_f32 v196, v196
  v_mfma_f32_32x32x16_bf16 v[176:191], v[232:235], v[160:163], 0
  v_exp_f32 v197, v197
  v_exp_f32 v198, v198
  v_exp_f32 v199, v199
  v_exp_f32 v200, v200
  v_exp_f32 v201, v201
  v_smfmac_f32_32x32x32_bf16 v[64:79], v[236:239], v[192:199], v2
  v_exp_f32 v202, v202
  v_exp_f32 v203, v203
  v_exp_f32 v204, v204
  v_exp_f32 v205, v205
  v_exp_f32 v206, v206
  v_exp_f32 v207, v207
  v_exp_f32 v176, v176
  v_exp_f32 v177, v177
  v_smfmac_f32_32x32x32_bf16 v[64:79], v[240:243], v[200:207], v2
  v_exp_f32 v178, v178
  v_exp_f32 v179, v179
  v_exp_f32 v180, v180
  v_mfma_f32_32x32x16_bf16 v[192:207], v[232:235], v[164:167], 0
  v_exp_f32 v181, v181
  v_exp_f32 v182, v182
  v_exp_f32 v183, v183
  v_exp_f32 v184, v184
  v_exp_f32 v185, v185
  v_smfmac_f32_32x32x32_bf16 v[80:95], v[236:239], v[176:183], v2
  v_exp_f32 v186, v186
  v_exp_f32 v187, v187
  v_exp_f32 v188, v188
  v_exp_f32 v189, v189
  v_exp_f32 v190, v190
  v_exp_f32 v191, v191
  v_exp_f32 v192, v192
  v_exp_f32 v193, v193
  v_smfmac_f32_32x32x32_bf16 v[80:95], v[240:243], v[184:191], v2
  v_exp_f32 v194, v194
  v_exp_f32 v195, v195
  v_exp_f32 v196, v196
  v_mfma_f32_32x32x16_bf16 v[176:191], v[232:235], v[168:171], 0
  v_exp_f32 v197, v197
  v_exp_f32 v198, v198
  v_exp_f32 v199, v199
  v_exp_f32 v200, v200
  v_exp_f32 v201, v201
  v_smfmac_f32_32x32x32_bf16 v[96:111], v[236:239], v[192:199], v2
  buffer_load_dwordx4 v0, s[8:11], s57 offen offset:1024 sc1 lds
  v_exp_f32 v202, v202
  v_exp_f32 v203, v203
  v_exp_f32 v204, v204
  v_exp_f32 v205, v205
  v_exp_f32 v206, v206
  v_exp_f32 v207, v207
  v_exp_f32 v176, v176
  v_exp_f32 v177, v177
  v_smfmac_f32_32x32x32_bf16 v[96:111], v[240:243], v[200:207], v2
  v_exp_f32 v178, v178
  v_exp_f32 v179, v179
  v_exp_f32 v180, v180
  v_mfma_f32_32x32x16_bf16 v[192:207], v[232:235], v[172:175], 0
  v_exp_f32 v181, v181
  v_exp_f32 v182, v182
  v_exp_f32 v183, v183
  v_exp_f32 v184, v184
  v_exp_f32 v185, v185
  v_smfmac_f32_32x32x32_bf16 v[112:127], v[236:239], v[176:183], v2
  v_exp_f32 v186, v186
  v_exp_f32 v187, v187
  v_exp_f32 v188, v188
  v_exp_f32 v189, v189
  v_exp_f32 v190, v190
  v_exp_f32 v191, v191
  v_exp_f32 v192, v192
  v_exp_f32 v193, v193
  v_smfmac_f32_32x32x32_bf16 v[112:127], v[240:243], v[184:191], v2
  s_waitcnt vmcnt(9)
  v_exp_f32 v194, v194
  v_exp_f32 v195, v195
  v_exp_f32 v196, v196
  v_mfma_f32_32x32x16_bf16 v[176:191], v[208:211], v[144:147], 0
  v_exp_f32 v197, v197
  v_exp_f32 v198, v198
  v_exp_f32 v199, v199
  v_exp_f32 v200, v200
  v_exp_f32 v201, v201
  v_smfmac_f32_32x32x32_bf16 v[128:143], v[236:239], v[192:199], v2
  v_and_b32 v254, 0x3c0, v0
  v_lshlrev_b32 v254, 1, v254
  v_exp_f32 v202, v202
  v_exp_f32 v203, v203
  v_exp_f32 v204, v204
  v_exp_f32 v205, v205
  v_exp_f32 v206, v206
  v_exp_f32 v207, v207
  v_exp_f32 v176, v176
  v_exp_f32 v177, v177
  v_smfmac_f32_32x32x32_bf16 v[128:143], v[240:243], v[200:207], v2
  buffer_load_dwordx4 v[232:235], v0, s[8:11], s3 offen offset:2048 sc1
  v_exp_f32 v178, v178
  v_exp_f32 v179, v179
  v_exp_f32 v180, v180
  v_mfma_f32_32x32x16_bf16 v[192:207], v[208:211], v[148:151], 0
  v_exp_f32 v181, v181
  v_exp_f32 v182, v182
  v_exp_f32 v183, v183
  v_exp_f32 v184, v184
  v_exp_f32 v185, v185
  v_smfmac_f32_32x32x32_bf16 v[16:31], v[212:215], v[176:183], v2
  s_mov_b64 exec, s[60:61]
  buffer_load_dwordx4 v[236:239], v252, s[8:11], s3 offen offset:3072 sc1
  buffer_load_dwordx4 v[240:243], v252, s[8:11], s3 offen offset:3584 sc1
  s_mov_b64 exec, -1
  v_exp_f32 v186, v186
  v_exp_f32 v187, v187
  v_exp_f32 v188, v188
  v_exp_f32 v189, v189
  v_exp_f32 v190, v190
  v_exp_f32 v191, v191
  v_exp_f32 v192, v192
  v_exp_f32 v193, v193
  v_smfmac_f32_32x32x32_bf16 v[16:31], v[216:219], v[184:191], v2
  s_mul_i32 s52, s40, 7168
  s_lshl_b32 s53, s38, 11
  v_exp_f32 v194, v194
  v_exp_f32 v195, v195
  v_exp_f32 v196, v196
  v_mfma_f32_32x32x16_bf16 v[176:191], v[208:211], v[152:155], 0
  v_exp_f32 v197, v197
  v_exp_f32 v198, v198
  v_exp_f32 v199, v199
  v_exp_f32 v200, v200
  v_exp_f32 v201, v201
  v_smfmac_f32_32x32x32_bf16 v[32:47], v[212:215], v[192:199], v2
  s_add_u32 s52, s52, s53
  s_add_u32 s52, s52, 9699328
  v_exp_f32 v202, v202
  v_exp_f32 v203, v203
  v_exp_f32 v204, v204
  v_exp_f32 v205, v205
  v_exp_f32 v206, v206
  v_exp_f32 v207, v207
  v_exp_f32 v176, v176
  v_exp_f32 v177, v177
  v_smfmac_f32_32x32x32_bf16 v[32:47], v[216:219], v[200:207], v2
  buffer_load_dword v255, v254, s[8:11], s52 offen sc1
  v_exp_f32 v178, v178
  v_exp_f32 v179, v179
  v_exp_f32 v180, v180
  v_mfma_f32_32x32x16_bf16 v[192:207], v[208:211], v[156:159], 0
  v_exp_f32 v181, v181
  v_exp_f32 v182, v182
  v_exp_f32 v183, v183
  v_exp_f32 v184, v184
  v_exp_f32 v185, v185
  v_smfmac_f32_32x32x32_bf16 v[48:63], v[212:215], v[176:183], v2
  v_exp_f32 v186, v186
  v_exp_f32 v187, v187
  v_exp_f32 v188, v188
  v_exp_f32 v189, v189
  v_exp_f32 v190, v190
  v_exp_f32 v191, v191
  v_exp_f32 v192, v192
  v_exp_f32 v193, v193
  v_smfmac_f32_32x32x32_bf16 v[48:63], v[216:219], v[184:191], v2
  v_exp_f32 v194, v194
  v_exp_f32 v195, v195
  v_exp_f32 v196, v196
  v_mfma_f32_32x32x16_bf16 v[176:191], v[208:211], v[160:163], 0
  v_exp_f32 v197, v197
  v_exp_f32 v198, v198
  v_exp_f32 v199, v199
  v_exp_f32 v200, v200
  v_exp_f32 v201, v201
  v_smfmac_f32_32x32x32_bf16 v[64:79], v[212:215], v[192:199], v2
  v_exp_f32 v202, v202
  v_exp_f32 v203, v203
  v_exp_f32 v204, v204
  v_exp_f32 v205, v205
  v_exp_f32 v206, v206
  v_exp_f32 v207, v207
  v_exp_f32 v176, v176
  v_exp_f32 v177, v177
  v_smfmac_f32_32x32x32_bf16 v[64:79], v[216:219], v[200:207], v2
  v_exp_f32 v178, v178
  v_exp_f32 v179, v179
  v_exp_f32 v180, v180
  v_mfma_f32_32x32x16_bf16 v[192:207], v[208:211], v[164:167], 0
  v_exp_f32 v181, v181
  v_exp_f32 v182, v182
  v_exp_f32 v183, v183
  v_exp_f32 v184, v184
  v_exp_f32 v185, v185
  v_smfmac_f32_32x32x32_bf16 v[80:95], v[212:215], v[176:183], v2
  s_lshl_b32 s52, s41, 4
  s_lshl_b32 s53, s44, 1
  v_exp_f32 v186, v186
  v_exp_f32 v187, v187
  v_exp_f32 v188, v188
  v_exp_f32 v189, v189
  v_exp_f32 v190, v190
  v_exp_f32 v191, v191
  v_exp_f32 v192, v192
  v_exp_f32 v193, v193
  v_smfmac_f32_32x32x32_bf16 v[80:95], v[216:219], v[184:191], v2
  s_add_u32 s52, s52, s53
  s_add_u32 s52, s52, s43
  v_exp_f32 v194, v194
  v_exp_f32 v195, v195
  v_exp_f32 v196, v196
  v_mfma_f32_32x32x16_bf16 v[176:191], v[208:211], v[168:171], 0
  v_exp_f32 v197, v197
  v_exp_f32 v198, v198
  v_exp_f32 v199, v199
  v_exp_f32 v200, v200
  v_exp_f32 v201, v201
  v_smfmac_f32_32x32x32_bf16 v[96:111], v[212:215], v[192:199], v2
  s_lshl_b32 s52, s52, 11
  s_add_u32 s52, s52, 12582912
  v_exp_f32 v202, v202
  v_exp_f32 v203, v203
  v_exp_f32 v204, v204
  v_exp_f32 v205, v205
  v_exp_f32 v206, v206
  v_exp_f32 v207, v207
  v_exp_f32 v176, v176
  v_exp_f32 v177, v177
  v_smfmac_f32_32x32x32_bf16 v[96:111], v[216:219], v[200:207], v2
  s_and_b32 s46, s100, 12288
  s_cbranch_scc1 L_gslow_119
L_gjoin_120:
  v_exp_f32 v178, v178
  v_exp_f32 v179, v179
  v_exp_f32 v180, v180
  v_mfma_f32_32x32x16_bf16 v[192:207], v[208:211], v[172:175], 0
  v_exp_f32 v181, v181
  v_exp_f32 v182, v182
  v_exp_f32 v183, v183
  v_exp_f32 v184, v184
  v_exp_f32 v185, v185
  v_smfmac_f32_32x32x32_bf16 v[112:127], v[212:215], v[176:183], v2
  s_add_u32 s3, s36, 6
  s_and_b32 s3, s3, 7
  v_exp_f32 v186, v186
  v_exp_f32 v187, v187
  v_exp_f32 v188, v188
  v_exp_f32 v189, v189
  v_exp_f32 v190, v190
  v_exp_f32 v191, v191
  v_exp_f32 v192, v192
  v_exp_f32 v193, v193
  v_smfmac_f32_32x32x32_bf16 v[112:127], v[216:219], v[184:191], v2
  s_waitcnt vmcnt(8)
  v_exp_f32 v194, v194
  v_exp_f32 v195, v195
  v_exp_f32 v196, v196
  v_mfma_f32_32x32x16_bf16 v[176:191], v[220:223], v[144:147], 0
  v_exp_f32 v197, v197
  v_exp_f32 v198, v198
  v_exp_f32 v199, v199
  v_exp_f32 v200, v200
  v_exp_f32 v201, v201
  v_smfmac_f32_32x32x32_bf16 v[128:143], v[212:215], v[192:199], v2
  s_lshl_b32 s3, s3, 14
  s_add_u32 s3, s3, s6
  v_exp_f32 v202, v202
  v_exp_f32 v203, v203
  v_exp_f32 v204, v204
  v_exp_f32 v205, v205
  v_exp_f32 v206, v206
  v_exp_f32 v207, v207
  v_exp_f32 v176, v176
  v_exp_f32 v177, v177
  v_smfmac_f32_32x32x32_bf16 v[128:143], v[216:219], v[200:207], v2
  buffer_load_dwordx4 v[208:211], v0, s[8:11], s3 offen sc1
  v_exp_f32 v178, v178
  v_exp_f32 v179, v179
  v_exp_f32 v180, v180
  v_mfma_f32_32x32x16_bf16 v[192:207], v[220:223], v[148:151], 0
  v_exp_f32 v181, v181
  v_exp_f32 v182, v182
  v_exp_f32 v183, v183
  v_exp_f32 v184, v184
  v_exp_f32 v185, v185
  v_smfmac_f32_32x32x32_bf16 v[16:31], v[224:227], v[176:183], v2
  s_mov_b64 exec, s[60:61]
  buffer_load_dwordx4 v[212:215], v252, s[8:11], s3 offen offset:1024 sc1
  buffer_load_dwordx4 v[216:219], v252, s[8:11], s3 offen offset:1536 sc1
  s_mov_b64 exec, -1
  v_exp_f32 v186, v186
  v_exp_f32 v187, v187
  v_exp_f32 v188, v188
  v_exp_f32 v189, v189
  v_exp_f32 v190, v190
  v_exp_f32 v191, v191
  v_exp_f32 v192, v192
  v_exp_f32 v193, v193
  v_smfmac_f32_32x32x32_bf16 v[16:31], v[228:231], v[184:191], v2
  buffer_load_dword v255, v254, s[8:11], s52 offen sc1
  v_exp_f32 v194, v194
  v_exp_f32 v195, v195
  v_exp_f32 v196, v196
  v_mfma_f32_32x32x16_bf16 v[176:191], v[220:223], v[152:155], 0
  v_exp_f32 v197, v197
  v_exp_f32 v198, v198
  v_exp_f32 v199, v199
  v_exp_f32 v200, v200
  v_exp_f32 v201, v201
  v_smfmac_f32_32x32x32_bf16 v[32:47], v[224:227], v[192:199], v2
  v_exp_f32 v202, v202
  v_exp_f32 v203, v203
  v_exp_f32 v204, v204
  v_exp_f32 v205, v205
  v_exp_f32 v206, v206
  v_exp_f32 v207, v207
  v_exp_f32 v176, v176
  v_exp_f32 v177, v177
  v_smfmac_f32_32x32x32_bf16 v[32:47], v[228:231], v[200:207], v2
  v_exp_f32 v178, v178
  v_exp_f32 v179, v179
  v_exp_f32 v180, v180
  v_mfma_f32_32x32x16_bf16 v[192:207], v[220:223], v[156:159], 0
  v_exp_f32 v181, v181
  v_exp_f32 v182, v182
  v_exp_f32 v183, v183
  v_exp_f32 v184, v184
  v_exp_f32 v185, v185
  v_smfmac_f32_32x32x32_bf16 v[48:63], v[224:227], v[176:183], v2
  v_exp_f32 v186, v186
  v_exp_f32 v187, v187
  v_exp_f32 v188, v188
  v_exp_f32 v189, v189
  v_exp_f32 v190, v190
  v_exp_f32 v191, v191
  v_exp_f32 v192, v192
  v_exp_f32 v193, v193
  v_smfmac_f32_32x32x32_bf16 v[48:63], v[228:231], v[184:191], v2
  v_exp_f32 v194, v194
  v_exp_f32 v195, v195
  v_exp_f32 v196, v196
  v_mfma_f32_32x32x16_bf16 v[176:191], v[220:223], v[160:163], 0
  v_exp_f32 v197, v197
  v_exp_f32 v198, v198
  v_exp_f32 v199, v199
  v_exp_f32 v200, v200
  v_exp_f32 v201, v201
  v_smfmac_f32_32x32x32_bf16 v[64:79], v[224:227], v[192:199], v2
  v_exp_f32 v202, v202
  v_exp_f32 v203, v203
  v_exp_f32 v204, v204
  v_exp_f32 v205, v205
  v_exp_f32 v206, v206
  v_exp_f32 v207, v207
  v_exp_f32 v176, v176
  v_exp_f32 v177, v177
  v_smfmac_f32_32x32x32_bf16 v[64:79], v[228:231], v[200:207], v2
  v_exp_f32 v178, v178
  v_exp_f32 v179, v179
  v_exp_f32 v180, v180
  v_mfma_f32_32x32x16_bf16 v[192:207], v[220:223], v[164:167], 0
  v_exp_f32 v181, v181
  v_exp_f32 v182, v182
  v_exp_f32 v183, v183
  v_exp_f32 v184, v184
  v_exp_f32 v185, v185
  v_smfmac_f32_32x32x32_bf16 v[80:95], v[224:227], v[176:183], v2
  v_exp_f32 v186, v186
  v_exp_f32 v187, v187
  v_exp_f32 v188, v188
  v_exp_f32 v189, v189
  v_exp_f32 v190, v190
  v_exp_f32 v191, v191
  v_exp_f32 v192, v192
  v_exp_f32 v193, v193
  v_smfmac_f32_32x32x32_bf16 v[80:95], v[228:231], v[184:191], v2
  v_exp_f32 v194, v194
  v_exp_f32 v195, v195
  v_exp_f32 v196, v196
  v_mfma_f32_32x32x16_bf16 v[176:191], v[220:223], v[168:171], 0
  v_exp_f32 v197, v197
  v_exp_f32 v198, v198
  v_exp_f32 v199, v199
  v_exp_f32 v200, v200
  v_exp_f32 v201, v201
  v_smfmac_f32_32x32x32_bf16 v[96:111], v[224:227], v[192:199], v2
  s_lshl_b32 s52, s41, 2
  s_lshr_b32 s53, s44, 1
  v_exp_f32 v202, v202
  v_exp_f32 v203, v203
  v_exp_f32 v204, v204
  v_exp_f32 v205, v205
  v_exp_f32 v206, v206
  v_exp_f32 v207, v207
  v_exp_f32 v176, v176
  v_exp_f32 v177, v177
  v_smfmac_f32_32x32x32_bf16 v[96:111], v[228:231], v[200:207], v2
  s_add_u32 s52, s52, s53
  s_lshl_b32 s52, s52, 10
  v_exp_f32 v178, v178
  v_exp_f32 v179, v179
  v_exp_f32 v180, v180
  v_mfma_f32_32x32x16_bf16 v[192:207], v[220:223], v[172:175], 0
  v_exp_f32 v181, v181
  v_exp_f32 v182, v182
  v_exp_f32 v183, v183
  v_exp_f32 v184, v184
  v_exp_f32 v185, v185
  v_smfmac_f32_32x32x32_bf16 v[112:127], v[224:227], v[176:183], v2
  s_add_u32 s52, s52, 1048576
  v_exp_f32 v186, v186
  v_exp_f32 v187, v187
  v_exp_f32 v188, v188
  v_exp_f32 v189, v189
  v_exp_f32 v190, v190
  v_exp_f32 v191, v191
  v_exp_f32 v192, v192
  v_exp_f32 v193, v193
  v_smfmac_f32_32x32x32_bf16 v[112:127], v[228:231], v[184:191], v2
  s_waitcnt vmcnt(5)
  v_exp_f32 v194, v194
  v_exp_f32 v195, v195
  v_exp_f32 v196, v196
  v_mfma_f32_32x32x16_bf16 v[176:191], v[232:235], v[144:147], 0
  v_exp_f32 v197, v197
  v_exp_f32 v198, v198
  v_exp_f32 v199, v199
  v_exp_f32 v200, v200
  v_exp_f32 v201, v201
  v_smfmac_f32_32x32x32_bf16 v[128:143], v[224:227], v[192:199], v2
  buffer_load_dword v255, v254, s[8:11], s52 offen sc1
  v_exp_f32 v202, v202
  v_exp_f32 v203, v203
  v_exp_f32 v204, v204
  v_exp_f32 v205, v205
  v_exp_f32 v206, v206
  v_exp_f32 v207, v207
  v_exp_f32 v176, v176
  v_exp_f32 v177, v177
  v_smfmac_f32_32x32x32_bf16 v[128:143], v[228:231], v[200:207], v2
  buffer_load_dwordx4 v[220:223], v0, s[8:11], s3 offen offset:2048 sc1
  v_exp_f32 v178, v178
  v_exp_f32 v179, v179
  v_exp_f32 v180, v180
  v_mfma_f32_32x32x16_bf16 v[192:207], v[232:235], v[148:151], 0
  v_exp_f32 v181, v181
  v_exp_f32 v182, v182
  v_exp_f32 v183, v183
  v_exp_f32 v184, v184
  v_exp_f32 v185, v185
  v_smfmac_f32_32x32x32_bf16 v[16:31], v[236:239], v[176:183], v2
  s_mov_b64 exec, s[60:61]
  buffer_load_dwordx4 v[224:227], v252, s[8:11], s3 offen offset:3072 sc1
  buffer_load_dwordx4 v[228:231], v252, s[8:11], s3 offen offset:3584 sc1
  s_mov_b64 exec, -1
  v_exp_f32 v186, v186
  v_exp_f32 v187, v187
  v_exp_f32 v188, v188
  v_exp_f32 v189, v189
  v_exp_f32 v190, v190
  v_exp_f32 v191, v191
  v_exp_f32 v192, v192
  v_exp_f32 v193, v193
  v_smfmac_f32_32x32x32_bf16 v[16:31], v[240:243], v[184:191], v2
  s_lshl_b32 s52, s36, 2
  s_add_u32 s52, s52, s38
  v_exp_f32 v194, v194
  v_exp_f32 v195, v195
  v_exp_f32 v196, v196
  v_mfma_f32_32x32x16_bf16 v[176:191], v[232:235], v[152:155], 0
  v_exp_f32 v197, v197
  v_exp_f32 v198, v198
  v_exp_f32 v199, v199
  v_exp_f32 v200, v200
  v_exp_f32 v201, v201
  v_smfmac_f32_32x32x32_bf16 v[32:47], v[236:239], v[192:199], v2
  s_lshl_b32 s52, s52, 6
  s_add_u32 s52, s52, s37
  v_exp_f32 v202, v202
  v_exp_f32 v203, v203
  v_exp_f32 v204, v204
  v_exp_f32 v205, v205
  v_exp_f32 v206, v206
  v_exp_f32 v207, v207
  v_exp_f32 v176, v176
  v_exp_f32 v177, v177
  v_smfmac_f32_32x32x32_bf16 v[32:47], v[240:243], v[200:207], v2
  s_lshl_b32 s52, s52, 10
  s_add_u32 s52, s52, 10485760
  v_exp_f32 v178, v178
  v_exp_f32 v179, v179
  v_exp_f32 v180, v180
  v_mfma_f32_32x32x16_bf16 v[192:207], v[232:235], v[156:159], 0
  v_exp_f32 v181, v181
  v_exp_f32 v182, v182
  v_exp_f32 v183, v183
  v_exp_f32 v184, v184
  v_exp_f32 v185, v185
  v_smfmac_f32_32x32x32_bf16 v[48:63], v[236:239], v[176:183], v2
  buffer_load_dword v255, v254, s[8:11], s52 offen sc1
  v_exp_f32 v186, v186
  v_exp_f32 v187, v187
  v_exp_f32 v188, v188
  v_exp_f32 v189, v189
  v_exp_f32 v190, v190
  v_exp_f32 v191, v191
  v_exp_f32 v192, v192
  v_exp_f32 v193, v193
  v_smfmac_f32_32x32x32_bf16 v[48:63], v[240:243], v[184:191], v2
  v_exp_f32 v194, v194
  v_exp_f32 v195, v195
  v_exp_f32 v196, v196
  v_mfma_f32_32x32x16_bf16 v[176:191], v[232:235], v[160:163], 0
  v_exp_f32 v197, v197
  v_exp_f32 v198, v198
  v_exp_f32 v199, v199
  v_exp_f32 v200, v200
  v_exp_f32 v201, v201
  v_smfmac_f32_32x32x32_bf16 v[64:79], v[236:239], v[192:199], v2
  v_exp_f32 v202, v202
  v_exp_f32 v203, v203
  v_exp_f32 v204, v204
  v_exp_f32 v205, v205
  v_exp_f32 v206, v206
  v_exp_f32 v207, v207
  v_exp_f32 v176, v176
  v_exp_f32 v177, v177
  v_smfmac_f32_32x32x32_bf16 v[64:79], v[240:243], v[200:207], v2
  v_exp_f32 v178, v178
  v_exp_f32 v179, v179
  v_exp_f32 v180, v180
  v_mfma_f32_32x32x16_bf16 v[192:207], v[232:235], v[164:167], 0
  v_exp_f32 v181, v181
  v_exp_f32 v182, v182
  v_exp_f32 v183, v183
  v_exp_f32 v184, v184
  v_exp_f32 v185, v185
  v_smfmac_f32_32x32x32_bf16 v[80:95], v[236:239], v[176:183], v2
  s_add_u32 s52, s52, 32768
  v_exp_f32 v186, v186
  v_exp_f32 v187, v187
  v_exp_f32 v188, v188
  v_exp_f32 v189, v189
  v_exp_f32 v190, v190
  v_exp_f32 v191, v191
  v_exp_f32 v192, v192
  v_exp_f32 v193, v193
  v_smfmac_f32_32x32x32_bf16 v[80:95], v[240:243], v[184:191], v2
  buffer_load_dword v255, v254, s[8:11], s52 offen sc1
  v_exp_f32 v194, v194
  v_exp_f32 v195, v195
  v_exp_f32 v196, v196
  v_mfma_f32_32x32x16_bf16 v[176:191], v[232:235], v[168:171], 0
  v_exp_f32 v197, v197
  v_exp_f32 v198, v198
  v_exp_f32 v199, v199
  v_exp_f32 v200, v200
  v_exp_f32 v201, v201
  v_smfmac_f32_32x32x32_bf16 v[96:111], v[236:239], v[192:199], v2
  v_exp_f32 v202, v202
  v_exp_f32 v203, v203
  v_exp_f32 v204, v204
  v_exp_f32 v205, v205
  v_exp_f32 v206, v206
  v_exp_f32 v207, v207
  v_exp_f32 v176, v176
  v_exp_f32 v177, v177
  v_smfmac_f32_32x32x32_bf16 v[96:111], v[240:243], v[200:207], v2
  s_and_b32 s46, s100, 49152
  s_cbranch_scc1 L_gslow_122
L_gjoin_123:
  v_exp_f32 v178, v178
  v_exp_f32 v179, v179
  v_exp_f32 v180, v180
  v_mfma_f32_32x32x16_bf16 v[192:207], v[232:235], v[172:175], 0
  v_exp_f32 v181, v181
  v_exp_f32 v182, v182
  v_exp_f32 v183, v183
  v_exp_f32 v184, v184
  v_exp_f32 v185, v185
  v_smfmac_f32_32x32x32_bf16 v[112:127], v[236:239], v[176:183], v2
  s_add_u32 s3, s36, 7
  s_and_b32 s3, s3, 7
  v_exp_f32 v186, v186
  v_exp_f32 v187, v187
  v_exp_f32 v188, v188
  v_exp_f32 v189, v189
  v_exp_f32 v190, v190
  v_exp_f32 v191, v191
  v_exp_f32 v192, v192
  v_exp_f32 v193, v193
  v_smfmac_f32_32x32x32_bf16 v[112:127], v[240:243], v[184:191], v2
  s_waitcnt vmcnt(7)
  v_exp_f32 v194, v194
  v_exp_f32 v195, v195
  v_exp_f32 v196, v196
  v_mfma_f32_32x32x16_bf16 v[176:191], v[208:211], v[144:147], 0
  v_exp_f32 v197, v197
  v_exp_f32 v198, v198
  v_exp_f32 v199, v199
  v_exp_f32 v200, v200
  v_exp_f32 v201, v201
  v_smfmac_f32_32x32x32_bf16 v[128:143], v[236:239], v[192:199], v2
  s_lshl_b32 s3, s3, 14
  s_add_u32 s3, s3, s6
  v_exp_f32 v202, v202
  v_exp_f32 v203, v203
  v_exp_f32 v204, v204
  v_exp_f32 v205, v205
  v_exp_f32 v206, v206
  v_exp_f32 v207, v207
  v_exp_f32 v176, v176
  v_exp_f32 v177, v177
  v_smfmac_f32_32x32x32_bf16 v[128:143], v[240:243], v[200:207], v2
  buffer_load_dwordx4 v[232:235], v0, s[8:11], s3 offen sc1
  v_exp_f32 v178, v178
  v_exp_f32 v179, v179
  v_exp_f32 v180, v180
  v_mfma_f32_32x32x16_bf16 v[192:207], v[208:211], v[148:151], 0
  v_exp_f32 v181, v181
  v_exp_f32 v182, v182
  v_exp_f32 v183, v183
  v_exp_f32 v184, v184
  v_exp_f32 v185, v185
  v_smfmac_f32_32x32x32_bf16 v[16:31], v[212:215], v[176:183], v2
  s_mov_b64 exec, s[60:61]
  buffer_load_dwordx4 v[236:239], v252, s[8:11], s3 offen offset:1024 sc1
  buffer_load_dwordx4 v[240:243], v252, s[8:11], s3 offen offset:1536 sc1
  s_mov_b64 exec, -1
  v_exp_f32 v186, v186
  v_exp_f32 v187, v187
  v_exp_f32 v188, v188
  v_exp_f32 v189, v189
  v_exp_f32 v190, v190
  v_exp_f32 v191, v191
  v_exp_f32 v192, v192
  v_exp_f32 v193, v193
  v_smfmac_f32_32x32x32_bf16 v[16:31], v[216:219], v[184:191], v2
  s_lshl_b32 s56, s44, 16
  s_lshl_b32 s57, s38, 14
  v_exp_f32 v194, v194
  v_exp_f32 v195, v195
  v_exp_f32 v196, v196
  v_mfma_f32_32x32x16_bf16 v[176:191], v[208:211], v[152:155], 0
  v_exp_f32 v197, v197
  v_exp_f32 v198, v198
  v_exp_f32 v199, v199
  v_exp_f32 v200, v200
  v_exp_f32 v201, v201
  v_smfmac_f32_32x32x32_bf16 v[32:47], v[212:215], v[192:199], v2
  s_add_u32 s56, s56, s57
  s_lshl_b32 s57, s43, 10
  v_exp_f32 v202, v202
  v_exp_f32 v203, v203
  v_exp_f32 v204, v204
  v_exp_f32 v205, v205
  v_exp_f32 v206, v206
  v_exp_f32 v207, v207
  v_exp_f32 v176, v176
  v_exp_f32 v177, v177
  v_smfmac_f32_32x32x32_bf16 v[32:47], v[216:219], v[200:207], v2
  s_add_u32 s56, s56, s57
  s_add_u32 s56, s56, 3670016
  v_exp_f32 v178, v178
  v_exp_f32 v179, v179
  v_exp_f32 v180, v180
  v_mfma_f32_32x32x16_bf16 v[192:207], v[208:211], v[156:159], 0
  v_exp_f32 v181, v181
  v_exp_f32 v182, v182
  v_exp_f32 v183, v183
  v_exp_f32 v184, v184
  v_exp_f32 v185, v185
  v_smfmac_f32_32x32x32_bf16 v[48:63], v[212:215], v[176:183], v2
  s_xor_b32 s57, s56, 1024
  v_exp_f32 v186, v186
  v_exp_f32 v187, v187
  v_exp_f32 v188, v188
  v_exp_f32 v189, v189
  v_exp_f32 v190, v190
  v_exp_f32 v191, v191
  v_exp_f32 v192, v192
  v_exp_f32 v193, v193
  v_smfmac_f32_32x32x32_bf16 v[48:63], v[216:219], v[184:191], v2
  buffer_load_dwordx4 a[224:227], v0, s[8:11], s56 offen sc1
  v_exp_f32 v194, v194
  v_exp_f32 v195, v195
  v_exp_f32 v196, v196
  v_mfma_f32_32x32x16_bf16 v[176:191], v[208:211], v[160:163], 0
  v_exp_f32 v197, v197
  v_exp_f32 v198, v198
  v_exp_f32 v199, v199
  v_exp_f32 v200, v200
  v_exp_f32 v201, v201
  v_smfmac_f32_32x32x32_bf16 v[64:79], v[212:215], v[192:199], v2
  buffer_load_dwordx4 a[228:231], v0, s[8:11], s57 offen sc1
  v_exp_f32 v202, v202
  v_exp_f32 v203, v203
  v_exp_f32 v204, v204
  v_exp_f32 v205, v205
  v_exp_f32 v206, v206
  v_exp_f32 v207, v207
  v_exp_f32 v176, v176
  v_exp_f32 v177, v177
  v_smfmac_f32_32x32x32_bf16 v[64:79], v[216:219], v[200:207], v2
  v_exp_f32 v178, v178
  v_exp_f32 v179, v179
  v_exp_f32 v180, v180
  v_mfma_f32_32x32x16_bf16 v[192:207], v[208:211], v[164:167], 0
  v_exp_f32 v181, v181
  v_exp_f32 v182, v182
  v_exp_f32 v183, v183
  v_exp_f32 v184, v184
  v_exp_f32 v185, v185
  v_smfmac_f32_32x32x32_bf16 v[80:95], v[212:215], v[176:183], v2
  buffer_load_dwordx4 a[232:235], v0, s[8:11], s56 offen offset:2048 sc1
  v_exp_f32 v186, v186
  v_exp_f32 v187, v187
  v_exp_f32 v188, v188
  v_exp_f32 v189, v189
  v_exp_f32 v190, v190
  v_exp_f32 v191, v191
  v_exp_f32 v192, v192
  v_exp_f32 v193, v193
  v_smfmac_f32_32x32x32_bf16 v[80:95], v[216:219], v[184:191], v2
  v_exp_f32 v194, v194
  v_exp_f32 v195, v195
  v_exp_f32 v196, v196
  v_mfma_f32_32x32x16_bf16 v[176:191], v[208:211], v[168:171], 0
  v_exp_f32 v197, v197
  v_exp_f32 v198, v198
  v_exp_f32 v199, v199
  v_exp_f32 v200, v200
  v_exp_f32 v201, v201
  v_smfmac_f32_32x32x32_bf16 v[96:111], v[212:215], v[192:199], v2
  buffer_load_dwordx4 a[236:239], v0, s[8:11], s57 offen offset:2048 sc1
  v_exp_f32 v202, v202
  v_exp_f32 v203, v203
  v_exp_f32 v204, v204
  v_exp_f32 v205, v205
  v_exp_f32 v206, v206
  v_exp_f32 v207, v207
  v_exp_f32 v176, v176
  v_exp_f32 v177, v177
  v_smfmac_f32_32x32x32_bf16 v[96:111], v[216:219], v[200:207], v2
  v_exp_f32 v178, v178
  v_exp_f32 v179, v179
  v_exp_f32 v180, v180
  v_mfma_f32_32x32x16_bf16 v[192:207], v[208:211], v[172:175], 0
  v_exp_f32 v181, v181
  v_exp_f32 v182, v182
  v_exp_f32 v183, v183
  v_exp_f32 v184, v184
  v_exp_f32 v185, v185
  v_smfmac_f32_32x32x32_bf16 v[112:127], v[212:215], v[176:183], v2
  v_exp_f32 v186, v186
  v_exp_f32 v187, v187
  v_exp_f32 v188, v188
  v_exp_f32 v189, v189
  v_exp_f32 v190, v190
  v_exp_f32 v191, v191
  v_exp_f32 v192, v192
  v_exp_f32 v193, v193
  v_smfmac_f32_32x32x32_bf16 v[112:127], v[216:219], v[184:191], v2
  s_waitcnt vmcnt(9)
  v_exp_f32 v194, v194
  v_exp_f32 v195, v195
  v_exp_f32 v196, v196
  v_mfma_f32_32x32x16_bf16 v[176:191], v[220:223], v[144:147], 0
  v_exp_f32 v197, v197
  v_exp_f32 v198, v198
  v_exp_f32 v199, v199
  v_exp_f32 v200, v200
  v_exp_f32 v201, v201
  v_smfmac_f32_32x32x32_bf16 v[128:143], v[212:215], v[192:199], v2
  s_add_u32 s56, s56, 4096
  s_add_u32 s57, s57, 4096
  buffer_load_dwordx4 a[240:243], v0, s[8:11], s56 offen sc1
  v_exp_f32 v202, v202
  v_exp_f32 v203, v203
  v_exp_f32 v204, v204
  v_exp_f32 v205, v205
  v_exp_f32 v206, v206
  v_exp_f32 v207, v207
  v_exp_f32 v176, v176
  v_exp_f32 v177, v177
  v_smfmac_f32_32x32x32_bf16 v[128:143], v[216:219], v[200:207], v2
  buffer_load_dwordx4 v[208:211], v0, s[8:11], s3 offen offset:2048 sc1
  v_exp_f32 v178, v178
  v_exp_f32 v179, v179
  v_exp_f32 v180, v180
  v_mfma_f32_32x32x16_bf16 v[192:207], v[220:223], v[148:151], 0
  v_exp_f32 v181, v181
  v_exp_f32 v182, v182
  v_exp_f32 v183, v183
  v_exp_f32 v184, v184
  v_exp_f32 v185, v185
  v_smfmac_f32_32x32x32_bf16 v[16:31], v[224:227], v[176:183], v2
  s_mov_b64 exec, s[60:61]
  buffer_load_dwordx4 v[212:215], v252, s[8:11], s3 offen offset:3072 sc1
  buffer_load_dwordx4 v[216:219], v252, s[8:11], s3 offen offset:3584 sc1
  s_mov_b64 exec, -1
  v_exp_f32 v186, v186
  v_exp_f32 v187, v187
  v_exp_f32 v188, v188
  v_exp_f32 v189, v189
  v_exp_f32 v190, v190
  v_exp_f32 v191, v191
  v_exp_f32 v192, v192
  v_exp_f32 v193, v193
  v_smfmac_f32_32x32x32_bf16 v[16:31], v[228:231], v[184:191], v2
  buffer_load_dwordx4 a[244:247], v0, s[8:11], s57 offen sc1
  v_exp_f32 v194, v194
  v_exp_f32 v195, v195
  v_exp_f32 v196, v196
  v_mfma_f32_32x32x16_bf16 v[176:191], v[220:223], v[152:155], 0
  v_exp_f32 v197, v197
  v_exp_f32 v198, v198
  v_exp_f32 v199, v199
  v_exp_f32 v200, v200
  v_exp_f32 v201, v201
  v_smfmac_f32_32x32x32_bf16 v[32:47], v[224:227], v[192:199], v2
  buffer_load_dwordx4 a[248:251], v0, s[8:11], s56 offen offset:2048 sc1
  v_exp_f32 v202, v202
  v_exp_f32 v203, v203
  v_exp_f32 v204, v204
  v_exp_f32 v205, v205
  v_exp_f32 v206, v206
  v_exp_f32 v207, v207
  v_exp_f32 v176, v176
  v_exp_f32 v177, v177
  v_smfmac_f32_32x32x32_bf16 v[32:47], v[228:231], v[200:207], v2
  v_exp_f32 v178, v178
  v_exp_f32 v179, v179
  v_exp_f32 v180, v180
  v_mfma_f32_32x32x16_bf16 v[192:207], v[220:223], v[156:159], 0
  v_exp_f32 v181, v181
  v_exp_f32 v182, v182
  v_exp_f32 v183, v183
  v_exp_f32 v184, v184
  v_exp_f32 v185, v185
  v_smfmac_f32_32x32x32_bf16 v[48:63], v[224:227], v[176:183], v2
  buffer_load_dwordx4 a[252:255], v0, s[8:11], s57 offen offset:2048 sc1
  v_exp_f32 v186, v186
  v_exp_f32 v187, v187
  v_exp_f32 v188, v188
  v_exp_f32 v189, v189
  v_exp_f32 v190, v190
  v_exp_f32 v191, v191
  v_exp_f32 v192, v192
  v_exp_f32 v193, v193
  v_smfmac_f32_32x32x32_bf16 v[48:63], v[228:231], v[184:191], v2
  v_exp_f32 v194, v194
  v_exp_f32 v195, v195
  v_exp_f32 v196, v196
  v_mfma_f32_32x32x16_bf16 v[176:191], v[220:223], v[160:163], 0
  v_exp_f32 v197, v197
  v_exp_f32 v198, v198
  v_exp_f32 v199, v199
  v_exp_f32 v200, v200
  v_exp_f32 v201, v201
  v_smfmac_f32_32x32x32_bf16 v[64:79], v[224:227], v[192:199], v2
  v_exp_f32 v202, v202
  v_exp_f32 v203, v203
  v_exp_f32 v204, v204
  v_exp_f32 v205, v205
  v_exp_f32 v206, v206
  v_exp_f32 v207, v207
  v_exp_f32 v176, v176
  v_exp_f32 v177, v177
  v_smfmac_f32_32x32x32_bf16 v[64:79], v[228:231], v[200:207], v2
  v_exp_f32 v178, v178
  v_exp_f32 v179, v179
  v_exp_f32 v180, v180
  v_mfma_f32_32x32x16_bf16 v[192:207], v[220:223], v[164:167], 0
  v_exp_f32 v181, v181
  v_exp_f32 v182, v182
  v_exp_f32 v183, v183
  v_exp_f32 v184, v184
  v_exp_f32 v185, v185
  v_smfmac_f32_32x32x32_bf16 v[80:95], v[224:227], v[176:183], v2
  v_exp_f32 v186, v186
  v_exp_f32 v187, v187
  v_exp_f32 v188, v188
  v_exp_f32 v189, v189
  v_exp_f32 v190, v190
  v_exp_f32 v191, v191
  v_exp_f32 v192, v192
  v_exp_f32 v193, v193
  v_smfmac_f32_32x32x32_bf16 v[80:95], v[228:231], v[184:191], v2
  v_exp_f32 v194, v194
  v_exp_f32 v195, v195
  v_exp_f32 v196, v196
  v_mfma_f32_32x32x16_bf16 v[176:191], v[220:223], v[168:171], 0
  v_exp_f32 v197, v197
  v_exp_f32 v198, v198
  v_exp_f32 v199, v199
  v_exp_f32 v200, v200
  v_exp_f32 v201, v201
  v_smfmac_f32_32x32x32_bf16 v[96:111], v[224:227], v[192:199], v2
  v_exp_f32 v202, v202
  v_exp_f32 v203, v203
  v_exp_f32 v204, v204
  v_exp_f32 v205, v205
  v_exp_f32 v206, v206
  v_exp_f32 v207, v207
  v_exp_f32 v176, v176
  v_exp_f32 v177, v177
  v_smfmac_f32_32x32x32_bf16 v[96:111], v[228:231], v[200:207], v2
  s_getpc_b64 s[4:5]
L_pc_125:
  s_lshl_b32 s46, s37, 2
  s_add_u32 s46, s46, s38
  s_and_b32 s46, s46, 7
  s_lshl_b32 s46, s46, 11
  s_add_u32 s46, s46, 512
  v_lshrrev_b32 v6, 6, v0
  v_lshl_add_u32 v6, v6, 7, s46
  v_min_u32 v6, L_end-L_pc_125-4, v6
  global_load_dword v255, v6, s[4:5]
  v_exp_f32 v178, v178
  v_exp_f32 v179, v179
  v_exp_f32 v180, v180
  v_mfma_f32_32x32x16_bf16 v[192:207], v[220:223], v[172:175], 0
  v_exp_f32 v181, v181
  v_exp_f32 v182, v182
  v_exp_f32 v183, v183
  v_exp_f32 v184, v184
  v_exp_f32 v185, v185
  v_smfmac_f32_32x32x32_bf16 v[112:127], v[224:227], v[176:183], v2
  v_exp_f32 v186, v186
  v_exp_f32 v187, v187
  v_exp_f32 v188, v188
  v_exp_f32 v189, v189
  v_exp_f32 v190, v190
  v_exp_f32 v191, v191
  v_exp_f32 v192, v192
  v_exp_f32 v193, v193
  v_smfmac_f32_32x32x32_bf16 v[112:127], v[228:231], v[184:191], v2
  s_waitcnt vmcnt(12)
  v_exp_f32 v194, v194
  v_exp_f32 v195, v195
  v_exp_f32 v196, v196
  v_mfma_f32_32x32x16_bf16 v[176:191], v[232:235], v[144:147], 0
  v_exp_f32 v197, v197
  v_exp_f32 v198, v198
  v_exp_f32 v199, v199
  v_exp_f32 v200, v200
  v_exp_f32 v201, v201
  v_smfmac_f32_32x32x32_bf16 v[128:143], v[224:227], v[192:199], v2
  v_exp_f32 v202, v202
  v_exp_f32 v203, v203
  v_exp_f32 v204, v204
  v_exp_f32 v205, v205
  v_exp_f32 v206, v206
  v_exp_f32 v207, v207
  v_exp_f32 v176, v176
  v_exp_f32 v177, v177
  v_smfmac_f32_32x32x32_bf16 v[128:143], v[228:231], v[200:207], v2
  s_waitcnt vmcnt(4)
  v_exp_f32 v178, v178
  v_exp_f32 v179, v179
  v_exp_f32 v180, v180
  v_mfma_f32_32x32x16_bf16 v[192:207], v[208:211], v[144:147], 0
  s_add_u32 s48, s38, 1
  s_and_b32 s48, s48, 3
  v_exp_f32 v181, v181
  v_exp_f32 v182, v182
  v_exp_f32 v183, v183
  v_exp_f32 v184, v184
  v_exp_f32 v185, v185
  v_smfmac_f32_32x32x32_bf16 v[16:31], v[236:239], v[176:183], v2
  s_mul_i32 s48, s48, 6
  s_add_u32 s48, s48, 0
  v_exp_f32 v186, v186
  v_exp_f32 v187, v187
  v_exp_f32 v188, v188
  v_exp_f32 v189, v189
  v_exp_f32 v190, v190
  v_exp_f32 v191, v191
  v_exp_f32 v192, v192
  v_exp_f32 v193, v193
  v_smfmac_f32_32x32x32_bf16 v[16:31], v[240:243], v[184:191], v2
  s_add_u32 s56, s56, 4096
  s_add_u32 s57, s57, 4096
  buffer_load_dwordx4 v[220:223], v0, s[8:11], s56 offen sc1
  v_exp_f32 v194, v194
  v_exp_f32 v195, v195
  v_exp_f32 v196, v196
  v_mfma_f32_32x32x16_bf16 v[176:191], v[232:235], v[148:151], 0
  buffer_load_dwordx4 v[224:227], v0, s[8:11], s57 offen sc1
  v_exp_f32 v197, v197
  v_exp_f32 v198, v198
  v_exp_f32 v199, v199
  v_exp_f32 v200, v200
  v_exp_f32 v201, v201
  v_smfmac_f32_32x32x32_bf16 v[16:31], v[212:215], v[192:199], v2
  buffer_load_dwordx4 v[228:231], v0, s[8:11], s56 offen offset:2048 sc1
  v_exp_f32 v202, v202
  v_exp_f32 v203, v203
  v_exp_f32 v204, v204
  v_exp_f32 v205, v205
  v_exp_f32 v206, v206
  v_exp_f32 v207, v207
  v_exp_f32 v176, v176
  v_exp_f32 v177, v177
  v_smfmac_f32_32x32x32_bf16 v[16:31], v[216:219], v[200:207], v2
  s_lshl_b32 s49, s48, 11
  s_add_u32 s49, s49, 106496
  v_add_u32 v4, s49, v0
  v_exp_f32 v178, v178
  v_exp_f32 v179, v179
  v_exp_f32 v180, v180
  v_mfma_f32_32x32x16_bf16 v[192:207], v[208:211], v[148:151], 0
  buffer_load_dwordx4 v[244:247], v0, s[8:11], s57 offen offset:2048 sc1
  v_exp_f32 v181, v181
  v_exp_f32 v182, v182
  v_exp_f32 v183, v183
  v_exp_f32 v184, v184
  v_exp_f32 v185, v185
  v_smfmac_f32_32x32x32_bf16 v[32:47], v[236:239], v[176:183], v2
  s_lshl_b32 s49, s48, 8
  s_add_u32 s49, s49, 155648
  v_add_u32 v6, s49, v1
  v_exp_f32 v186, v186
  v_exp_f32 v187, v187
  v_exp_f32 v188, v188
  v_exp_f32 v189, v189
  v_exp_f32 v190, v190
  v_exp_f32 v191, v191
  v_exp_f32 v192, v192
  v_exp_f32 v193, v193
  v_smfmac_f32_32x32x32_bf16 v[32:47], v[240:243], v[184:191], v2
  ds_write_b128 v4, v[16:19] offset:0
  v_exp_f32 v194, v194
  v_exp_f32 v195, v195
  v_exp_f32 v196, v196
  v_mfma_f32_32x32x16_bf16 v[176:191], v[232:235], v[152:155], 0
  ds_write_b32 v6, v24 offset:0
  v_exp_f32 v197, v197
  v_exp_f32 v198, v198
  v_exp_f32 v199, v199
  v_exp_f32 v200, v200
  v_exp_f32 v201, v201
  v_smfmac_f32_32x32x32_bf16 v[32:47], v[212:215], v[192:199], v2
  ds_write_b128 v4, v[20:23] offset:1024
  v_exp_f32 v202, v202
  v_exp_f32 v203, v203
  v_exp_f32 v204, v204
  v_exp_f32 v205, v205
  v_exp_f32 v206, v206
  v_exp_f32 v207, v207
  v_exp_f32 v176, v176
  v_exp_f32 v177, v177
  v_smfmac_f32_32x32x32_bf16 v[32:47], v[216:219], v[200:207], v2
  s_add_u32 s56, s56, 4096
  s_add_u32 s57, s57, 4096
  buffer_load_dwordx4 v[248:251], v0, s[8:11], s56 offen sc1
  v_exp_f32 v178, v178
  v_exp_f32 v179, v179
  v_exp_f32 v180, v180
  v_mfma_f32_32x32x16_bf16 v[192:207], v[208:211], v[152:155], 0
  s_add_u32 s48, s38, 2
  s_and_b32 s48, s48, 3
  v_exp_f32 v181, v181
  v_exp_f32 v182, v182
  v_exp_f32 v183, v183
  v_exp_f32 v184, v184
  v_exp_f32 v185, v185
  v_smfmac_f32_32x32x32_bf16 v[48:63], v[236:239], v[176:183], v2
  s_mul_i32 s48, s48, 6
  s_add_u32 s48, s48, 2
  v_exp_f32 v186, v186
  v_exp_f32 v187, v187
  v_exp_f32 v188, v188
  v_exp_f32 v189, v189
  v_exp_f32 v190, v190
  v_exp_f32 v191, v191
  v_exp_f32 v192, v192
  v_exp_f32 v193, v193
  v_smfmac_f32_32x32x32_bf16 v[48:63], v[240:243], v[184:191], v2
  ds_write_b128 v4, v[32:35] offset:2048
  v_exp_f32 v194, v194
  v_exp_f32 v195, v195
  v_exp_f32 v196, v196
  v_mfma_f32_32x32x16_bf16 v[176:191], v[232:235], v[156:159], 0
  ds_write_b32 v6, v40 offset:256
  v_exp_f32 v197, v197
  v_exp_f32 v198, v198
  v_exp_f32 v199, v199
  v_exp_f32 v200, v200
  v_exp_f32 v201, v201
  v_smfmac_f32_32x32x32_bf16 v[48:63], v[212:215], v[192:199], v2
  ds_write_b128 v4, v[36:39] offset:3072
  v_exp_f32 v202, v202
  v_exp_f32 v203, v203
  v_exp_f32 v204, v204
  v_exp_f32 v205, v205
  v_exp_f32 v206, v206
  v_exp_f32 v207, v207
  v_exp_f32 v176, v176
  v_exp_f32 v177, v177
  v_smfmac_f32_32x32x32_bf16 v[48:63], v[216:219], v[200:207], v2
  s_lshl_b32 s49, s48, 11
  s_add_u32 s49, s49, 106496
  v_add_u32 v5, s49, v0
  v_exp_f32 v178, v178
  v_exp_f32 v179, v179
  v_exp_f32 v180, v180
  v_mfma_f32_32x32x16_bf16 v[192:207], v[208:211], v[156:159], 0
  buffer_load_dwordx4 v[144:147], v0, s[8:11], s57 offen sc1
  v_exp_f32 v181, v181
  v_exp_f32 v182, v182
  v_exp_f32 v183, v183
  v_exp_f32 v184, v184
  v_exp_f32 v185, v185
  v_smfmac_f32_32x32x32_bf16 v[64:79], v[236:239], v[176:183], v2
  s_lshl_b32 s49, s48, 8
  s_add_u32 s49, s49, 155648
  v_add_u32 v7, s49, v1
  v_exp_f32 v186, v186
  v_exp_f32 v187, v187
  v_exp_f32 v188, v188
  v_exp_f32 v189, v189
  v_exp_f32 v190, v190
  v_exp_f32 v191, v191
  v_exp_f32 v192, v192
  v_exp_f32 v193, v193
  v_smfmac_f32_32x32x32_bf16 v[64:79], v[240:243], v[184:191], v2
  ds_write_b128 v5, v[48:51] offset:0
  v_exp_f32 v194, v194
  v_exp_f32 v195, v195
  v_exp_f32 v196, v196
  v_mfma_f32_32x32x16_bf16 v[176:191], v[232:235], v[160:163], 0
  ds_write_b32 v7, v56 offset:0
  v_exp_f32 v197, v197
  v_exp_f32 v198, v198
  v_exp_f32 v199, v199
  v_exp_f32 v200, v200
  v_exp_f32 v201, v201
  v_smfmac_f32_32x32x32_bf16 v[64:79], v[212:215], v[192:199], v2
  ds_write_b128 v5, v[52:55] offset:1024
  v_exp_f32 v202, v202
  v_exp_f32 v203, v203
  v_exp_f32 v204, v204
  v_exp_f32 v205, v205
  v_exp_f32 v206, v206
  v_exp_f32 v207, v207
  v_exp_f32 v176, v176
  v_exp_f32 v177, v177
  v_smfmac_f32_32x32x32_bf16 v[64:79], v[216:219], v[200:207], v2
  buffer_load_dwordx4 v[148:151], v0, s[8:11], s56 offen offset:2048 sc1
  v_exp_f32 v178, v178
  v_exp_f32 v179, v179
  v_exp_f32 v180, v180
  v_mfma_f32_32x32x16_bf16 v[192:207], v[208:211], v[160:163], 0
  s_add_u32 s48, s38, 3
  s_and_b32 s48, s48, 3
  v_exp_f32 v181, v181
  v_exp_f32 v182, v182
  v_exp_f32 v183, v183
  v_exp_f32 v184, v184
  v_exp_f32 v185, v185
  v_smfmac_f32_32x32x32_bf16 v[80:95], v[236:239], v[176:183], v2
  s_mul_i32 s48, s48, 6
  s_add_u32 s48, s48, 4
  v_exp_f32 v186, v186
  v_exp_f32 v187, v187
  v_exp_f32 v188, v188
  v_exp_f32 v189, v189
  v_exp_f32 v190, v190
  v_exp_f32 v191, v191
  v_exp_f32 v192, v192
  v_exp_f32 v193, v193
  v_smfmac_f32_32x32x32_bf16 v[80:95], v[240:243], v[184:191], v2
  ds_write_b128 v5, v[64:67] offset:2048
  v_exp_f32 v194, v194
  v_exp_f32 v195, v195
  v_exp_f32 v196, v196
  v_mfma_f32_32x32x16_bf16 v[176:191], v[232:235], v[164:167], 0
  ds_write_b32 v7, v72 offset:256
  v_exp_f32 v197, v197
  v_exp_f32 v198, v198
  v_exp_f32 v199, v199
  v_exp_f32 v200, v200
  v_exp_f32 v201, v201
  v_smfmac_f32_32x32x32_bf16 v[80:95], v[212:215], v[192:199], v2
  ds_write_b128 v5, v[68:71] offset:3072
  v_exp_f32 v202, v202
  v_exp_f32 v203, v203
  v_exp_f32 v204, v204
  v_exp_f32 v205, v205
  v_exp_f32 v206, v206
  v_exp_f32 v207, v207
  v_exp_f32 v176, v176
  v_exp_f32 v177, v177
  v_smfmac_f32_32x32x32_bf16 v[80:95], v[216:219], v[200:207], v2
  s_lshl_b32 s49, s48, 11
  s_add_u32 s49, s49, 106496
  v_add_u32 v4, s49, v0
  v_exp_f32 v178, v178
  v_exp_f32 v179, v179
  v_exp_f32 v180, v180
  v_mfma_f32_32x32x16_bf16 v[192:207], v[208:211], v[164:167], 0
  buffer_load_dwordx4 v[152:155], v0, s[8:11], s57 offen offset:2048 sc1
  v_exp_f32 v181, v181
  v_exp_f32 v182, v182
  v_exp_f32 v183, v183
  v_exp_f32 v184, v184
  v_exp_f32 v185, v185
  v_smfmac_f32_32x32x32_bf16 v[96:111], v[236:239], v[176:183], v2
  s_lshl_b32 s49, s48, 8
  s_add_u32 s49, s49, 155648
  v_add_u32 v6, s49, v1
  v_exp_f32 v186, v186
  v_exp_f32 v187, v187
  v_exp_f32 v188, v188
  v_exp_f32 v189, v189
  v_exp_f32 v190, v190
  v_exp_f32 v191, v191
  v_exp_f32 v192, v192
  v_exp_f32 v193, v193
  v_smfmac_f32_32x32x32_bf16 v[96:111], v[240:243], v[184:191], v2
  ds_write_b128 v4, v[80:83] offset:0
  v_exp_f32 v194, v194
  v_exp_f32 v195, v195
  v_exp_f32 v196, v196
  v_mfma_f32_32x32x16_bf16 v[176:191], v[232:235], v[168:171], 0
  ds_write_b32 v6, v88 offset:0
  v_exp_f32 v197, v197
  v_exp_f32 v198, v198
  v_exp_f32 v199, v199
  v_exp_f32 v200, v200
  v_exp_f32 v201, v201
  v_smfmac_f32_32x32x32_bf16 v[96:111], v[212:215], v[192:199], v2
  ds_write_b128 v4, v[84:87] offset:1024
  v_exp_f32 v202, v202
  v_exp_f32 v203, v203
  v_exp_f32 v204, v204
  v_exp_f32 v205, v205
  v_exp_f32 v206, v206
  v_exp_f32 v207, v207
  v_exp_f32 v176, v176
  v_exp_f32 v177, v177
  v_smfmac_f32_32x32x32_bf16 v[96:111], v[216:219], v[200:207], v2
  s_mul_i32 s48, s38, 6
  s_lshl_b32 s49, s48, 11
  s_add_u32 s49, s49, 106496
  v_add_u32 v5, s49, v0
  s_lshl_b32 s49, s48, 8
  s_add_u32 s49, s49, 155648
  v_add_u32 v7, s49, v1
  v_exp_f32 v178, v178
  v_exp_f32 v179, v179
  v_exp_f32 v180, v180
  v_mfma_f32_32x32x16_bf16 v[192:207], v[232:235], v[172:175], 0
  v_exp_f32 v181, v181
  v_exp_f32 v182, v182
  v_exp_f32 v183, v183
  v_exp_f32 v184, v184
  v_exp_f32 v185, v185
  v_smfmac_f32_32x32x32_bf16 v[112:127], v[236:239], v[176:183], v2
  s_lshl_b32 s48, s36, 3
  s_lshl_b32 s49, s38, 1
  s_add_u32 s48, s48, s49
  s_lshl_b32 s48, s48, 5
  s_add_u32 s48, s48, s37
  s_lshl_b32 s48, s48, 10
  s_add_u32 s48, s48, 10485760
  s_add_u32 s49, s48, 32768
  v_exp_f32 v186, v186
  v_exp_f32 v187, v187
  v_exp_f32 v188, v188
  v_exp_f32 v189, v189
  v_exp_f32 v190, v190
  v_exp_f32 v191, v191
  v_exp_f32 v192, v192
  v_exp_f32 v193, v193
  v_smfmac_f32_32x32x32_bf16 v[112:127], v[240:243], v[184:191], v2
  ds_write_b128 v4, v[96:99] offset:2048
  v_exp_f32 v194, v194
  v_exp_f32 v195, v195
  v_exp_f32 v196, v196
  v_mfma_f32_32x32x16_bf16 v[176:191], v[208:211], v[168:171], 0
  ds_write_b32 v6, v104 offset:256
  v_exp_f32 v197, v197
  v_exp_f32 v198, v198
  v_exp_f32 v199, v199
  v_exp_f32 v200, v200
  v_exp_f32 v201, v201
  v_smfmac_f32_32x32x32_bf16 v[128:143], v[236:239], v[192:199], v2
  ds_write_b128 v4, v[100:103] offset:3072
  v_exp_f32 v202, v202
  v_exp_f32 v203, v203
  v_exp_f32 v204, v204
  v_exp_f32 v205, v205
  v_exp_f32 v206, v206
  v_exp_f32 v207, v207
  v_exp_f32 v176, v176
  v_exp_f32 v177, v177
  v_smfmac_f32_32x32x32_bf16 v[128:143], v[240:243], v[200:207], v2
  s_waitcnt lgkmcnt(0)
  s_barrier
  v_exp_f32 v178, v178
  v_exp_f32 v179, v179
  v_exp_f32 v180, v180
  v_mfma_f32_32x32x16_bf16 v[192:207], v[208:211], v[172:175], 0
  ds_read_b128 v[16:19], v5 offset:0
  ds_read_b128 v[20:23], v5 offset:1024
  ds_read_b32 v24, v7 offset:0
  v_exp_f32 v181, v181
  v_exp_f32 v182, v182
  v_exp_f32 v183, v183
  v_exp_f32 v184, v184
  v_exp_f32 v185, v185
  v_smfmac_f32_32x32x32_bf16 v[112:127], v[212:215], v[176:183], v2
  ds_read_b128 v[26:29], v5 offset:4096
  ds_read_b128 v[30:33], v5 offset:5120
  ds_read_b32 v34, v7 offset:512
  ds_read_b128 v[36:39], v5 offset:8192
  ds_read_b128 v[40:43], v5 offset:9216
  ds_read_b32 v44, v7 offset:1024
  v_exp_f32 v186, v186
  v_exp_f32 v187, v187
  v_exp_f32 v188, v188
  v_exp_f32 v189, v189
  v_exp_f32 v190, v190
  v_exp_f32 v191, v191
  v_exp_f32 v192, v192
  v_exp_f32 v193, v193
  v_smfmac_f32_32x32x32_bf16 v[112:127], v[216:219], v[184:191], v2
  ds_read_b128 v[46:49], v5 offset:2048
  ds_read_b128 v[50:53], v5 offset:3072
  ds_read_b32 v54, v7 offset:256
  ds_read_b128 v[56:59], v5 offset:6144
  ds_read_b128 v[60:63], v5 offset:7168
  ds_read_b32 v64, v7 offset:768
  v_exp_f32 v194, v194
  v_exp_f32 v195, v195
  v_exp_f32 v196, v196
  ds_read_b128 v[66:69], v5 offset:10240
  ds_read_b128 v[70:73], v5 offset:11264
  ds_read_b32 v74, v7 offset:1280
  v_exp_f32 v197, v197
  v_exp_f32 v198, v198
  v_exp_f32 v199, v199
  v_exp_f32 v200, v200
  v_exp_f32 v201, v201
  v_smfmac_f32_32x32x32_bf16 v[128:143], v[212:215], v[192:199], v2
  v_exp_f32 v202, v202
  v_exp_f32 v203, v203
  v_exp_f32 v204, v204
  v_exp_f32 v205, v205
  v_exp_f32 v206, v206
  v_exp_f32 v207, v207
  s_nop 1
  v_smfmac_f32_32x32x32_bf16 v[128:143], v[216:219], v[200:207], v2
  s_waitcnt lgkmcnt(9)
  v_add_f32 v120, v120, v24
  v_pk_add_f32 v[112:113], v[112:113], v[16:17]
  v_pk_add_f32 v[114:115], v[114:115], v[18:19]
  v_pk_add_f32 v[116:117], v[116:117], v[20:21]
  v_pk_add_f32 v[118:119], v[118:119], v[22:23]
  v_add_f32 v120, v120, v34
  v_pk_add_f32 v[112:113], v[112:113], v[26:27]
  v_pk_add_f32 v[114:115], v[114:115], v[28:29]
  v_pk_add_f32 v[116:117], v[116:117], v[30:31]
  v_pk_add_f32 v[118:119], v[118:119], v[32:33]
  v_add_f32 v120, v120, v44
  v_pk_add_f32 v[112:113], v[112:113], v[36:37]
  v_pk_add_f32 v[114:115], v[114:115], v[38:39]
  v_pk_add_f32 v[116:117], v[116:117], v[40:41]
  v_pk_add_f32 v[118:119], v[118:119], v[42:43]
  v_rcp_f32 v122, v120
  s_nop 0
  v_pk_mul_f32 v[112:113], v[112:113], v[122:123] op_sel_hi:[1,0]
  v_pk_mul_f32 v[114:115], v[114:115], v[122:123] op_sel_hi:[1,0]
  v_pk_mul_f32 v[116:117], v[116:117], v[122:123] op_sel_hi:[1,0]
  v_pk_mul_f32 v[118:119], v[118:119], v[122:123] op_sel_hi:[1,0]
  v_cvt_pk_bf16_f32 v124, v112, v113
  v_cvt_pk_bf16_f32 v125, v114, v115
  v_cvt_pk_bf16_f32 v126, v116, v117
  v_cvt_pk_bf16_f32 v127, v118, v119
  buffer_store_dwordx4 v[124:127], v0, s[8:11], s48 offen
  s_waitcnt lgkmcnt(0)
  v_add_f32 v54, v54, v64
  v_pk_add_f32 v[46:47], v[46:47], v[56:57]
  v_pk_add_f32 v[48:49], v[48:49], v[58:59]
  v_pk_add_f32 v[50:51], v[50:51], v[60:61]
  v_pk_add_f32 v[52:53], v[52:53], v[62:63]
  v_add_f32 v54, v54, v74
  v_pk_add_f32 v[46:47], v[46:47], v[66:67]
  v_pk_add_f32 v[48:49], v[48:49], v[68:69]
  v_pk_add_f32 v[50:51], v[50:51], v[70:71]
  v_pk_add_f32 v[52:53], v[52:53], v[72:73]
  v_add_f32 v136, v136, v54
  v_pk_add_f32 v[128:129], v[128:129], v[46:47]
  v_pk_add_f32 v[130:131], v[130:131], v[48:49]
  v_pk_add_f32 v[132:133], v[132:133], v[50:51]
  v_pk_add_f32 v[134:135], v[134:135], v[52:53]
  v_rcp_f32 v138, v136
  s_nop 0
  v_pk_mul_f32 v[128:129], v[128:129], v[138:139] op_sel_hi:[1,0]
  v_pk_mul_f32 v[130:131], v[130:131], v[138:139] op_sel_hi:[1,0]
  v_pk_mul_f32 v[132:133], v[132:133], v[138:139] op_sel_hi:[1,0]
  v_pk_mul_f32 v[134:135], v[134:135], v[138:139] op_sel_hi:[1,0]
  v_cvt_pk_bf16_f32 v140, v128, v129
  v_cvt_pk_bf16_f32 v141, v130, v131
  v_cvt_pk_bf16_f32 v142, v132, v133
  v_cvt_pk_bf16_f32 v143, v134, v135
  buffer_store_dwordx4 v[140:143], v0, s[8:11], s49 offen
  v_maximum3_f32 v18, abs(v112), abs(v113), abs(v114)
  v_maximum3_f32 v18, abs(v115), abs(v116), v18
  v_maximum3_f32 v18, abs(v117), abs(v118), v18
  v_maximum3_f32 v19, abs(v128), abs(v129), abs(v130)
  v_maximum3_f32 v19, abs(v131), abs(v132), v19
  v_maximum3_f32 v19, abs(v133), abs(v134), v19
  v_maximum3_f32 v18, abs(v119), abs(v135), v18
  v_minimum3_f32 v16, v120, v136, v136
  v_maximum3_f32 v17, v120, v136, v136
  v_maximum3_f32 v18, v18, v19, v19
  s_mov_b32 s50, 0x1f800000
  s_mov_b32 s51, 0x7b800000
  s_mov_b32 s52, 0x7f7fffff
  v_cmp_nle_f32 vcc, s50, v16
  v_cmp_nge_f32 s[54:55], s51, v17
  v_cmp_nge_f32 s[58:59], s52, v18
  s_nop 0
  s_or_b64 vcc, vcc, s[54:55]
  s_or_b64 vcc, vcc, s[58:59]
  s_cbranch_scc1 L_fb_126
L_fbj_127:
  v_and_b32 v4, 28, v1
  s_lshl_b32 s50, s36, 2
  s_lshr_b32 s51, s37, 3
  s_add_u32 s50, s50, s51
  s_lshl_b32 s50, s50, 2
  s_add_u32 s50, s50, s38
  s_lshl_b32 s50, s50, 7
  s_add_u32 s50, s50, 16384
  s_lshl_b32 s51, s42, 15
  s_lshl_b32 s52, s38, 13
  s_add_u32 s51, s51, s52
  s_add_u32 s51, s51, 10485760
  s_xor_b32 s52, s51, 32768
  s_waitcnt vmcnt(0)
  v_mov_b32 v5, 2
  s_cmp_lg_u32 s45, 0
  s_cbranch_scc1 L_slow_130
  s_mov_b64 exec, 4
  buffer_store_dword v5, v3, s[8:11], 0 offen
  s_mov_b64 exec, -1
L_join_131:
  s_barrier
  s_mul_i32 s54, s38, 12288
  s_add_u32 s54, s54, 106496
  v_add_u32 v6, s54, v0
  v_lshlrev_b32 v128, 16, v8
  v_and_b32 v129, s47, v8
  v_lshlrev_b32 v130, 16, v9
  v_and_b32 v131, s47, v9
  v_lshlrev_b32 v132, 16, v10
  v_and_b32 v133, s47, v10
  v_lshlrev_b32 v134, 16, v11
  v_and_b32 v135, s47, v11
  v_lshlrev_b32 v136, 16, v12
  v_and_b32 v137, s47, v12
  v_lshlrev_b32 v138, 16, v13
  v_and_b32 v139, s47, v13
  v_lshlrev_b32 v140, 16, v14
  v_and_b32 v141, s47, v14
  v_lshlrev_b32 v142, 16, v15
  v_and_b32 v143, s47, v15
  s_lshl_b32 s48, s44, 1
  s_add_u32 s48, s48, s43
  v_mov_b32 v7, 0x3f803f80
  s_lshl_b32 s55, s41, 15
  s_lshl_b32 s56, s48, 11
  s_add_u32 s55, s55, s56
  s_add_u32 s55, s55, 12582912
  s_lshl_b32 s56, s41, 12
  s_lshr_b32 s57, s48, 2
  s_lshl_b32 s57, s57, 10
  s_add_u32 s56, s56, s57
  s_and_b32 s57, s48, 3
  s_lshl_b32 s57, s57, 2
  s_add_u32 s56, s56, s57
  s_add_u32 s56, s56, 1048576
  s_mov_b32 s46, 2097152
L_poll_132:
  buffer_load_dword v5, v4, s[8:11], s50 offen sc1
  s_sub_u32 s46, s46, 1
  s_cbranch_scc1 L_exit
  s_waitcnt vmcnt(0)
  v_cmp_gt_u32 vcc, 2, v5
  s_nop 0
  s_cbranch_vccnz L_poll_132
  s_cmp_lg_u32 s45, 0
  s_cbranch_scc1 L_slow_133
L_join_134:
  buffer_load_dwordx4 v[208:211], v0, s[8:11], s51 offen sc1
  buffer_load_dwordx4 v[212:215], v0, s[8:11], s51 offen offset:1024 sc1
  buffer_load_dwordx4 v[216:219], v0, s[8:11], s51 offen offset:2048 sc1
  buffer_load_dwordx4 v[156:159], v0, s[8:11], s51 offen offset:3072 sc1
  s_add_u32 s51, s51, 4096
  buffer_load_dwordx4 v[160:163], v0, s[8:11], s51 offen sc1
  buffer_load_dwordx4 v[164:167], v0, s[8:11], s51 offen offset:1024 sc1
  buffer_load_dwordx4 v[168:171], v0, s[8:11], s51 offen offset:2048 sc1
  buffer_load_dwordx4 v[172:175], v0, s[8:11], s51 offen offset:3072 sc1
  buffer_load_dwordx4 v[176:179], v0, s[8:11], s52 offen sc1
  buffer_load_dwordx4 v[180:183], v0, s[8:11], s52 offen offset:1024 sc1
  s_waitcnt vmcnt(9)
  v_mfma_f32_32x32x16_bf16 v[64:79], a[228:231], v[208:211], 0
  v_mfma_f32_32x32x16_bf16 v[48:63], a[224:227], v[208:211], 0
  buffer_load_dwordx4 v[184:187], v0, s[8:11], s52 offen offset:2048 sc1
  s_waitcnt vmcnt(9)
  v_mfma_f32_32x32x16_bf16 v[64:79], a[236:239], v[212:215], v[64:79]
  v_mfma_f32_32x32x16_bf16 v[48:63], a[232:235], v[212:215], v[48:63]
  buffer_load_dwordx4 v[188:191], v0, s[8:11], s52 offen offset:3072 sc1
  s_waitcnt vmcnt(9)
  v_mfma_f32_32x32x16_bf16 v[64:79], a[244:247], v[216:219], v[64:79]
  v_mfma_f32_32x32x16_bf16 v[48:63], a[240:243], v[216:219], v[48:63]
  s_add_u32 s52, s52, 4096
  buffer_load_dwordx4 v[192:195], v0, s[8:11], s52 offen sc1
  s_waitcnt vmcnt(9)
  v_mfma_f32_32x32x16_bf16 v[64:79], a[252:255], v[156:159], v[64:79]
  v_mfma_f32_32x32x16_bf16 v[48:63], a[248:251], v[156:159], v[48:63]
  buffer_load_dwordx4 v[196:199], v0, s[8:11], s52 offen offset:1024 sc1
  s_waitcnt vmcnt(9)
  v_mfma_f32_32x32x16_bf16 v[64:79], v[224:227], v[160:163], v[64:79]
  v_mfma_f32_32x32x16_bf16 v[48:63], v[220:223], v[160:163], v[48:63]
  buffer_load_dwordx4 v[200:203], v0, s[8:11], s52 offen offset:2048 sc1
  s_waitcnt vmcnt(9)
  v_mfma_f32_32x32x16_bf16 v[64:79], v[244:247], v[164:167], v[64:79]
  v_mfma_f32_32x32x16_bf16 v[48:63], v[228:231], v[164:167], v[48:63]
  buffer_load_dwordx4 v[204:207], v0, s[8:11], s52 offen offset:3072 sc1
  s_waitcnt vmcnt(9)
  v_mfma_f32_32x32x16_bf16 v[64:79], v[144:147], v[168:171], v[64:79]
  v_mfma_f32_32x32x16_bf16 v[48:63], v[248:251], v[168:171], v[48:63]
  s_mul_i32 s57, s40, 7168
  s_add_u32 s57, s57, 9699328
  s_add_u32 s58, s57, 4096
  s_waitcnt vmcnt(8)
  v_mfma_f32_32x32x16_bf16 v[64:79], v[152:155], v[172:175], v[64:79]
  v_mfma_f32_32x32x16_bf16 v[48:63], v[148:151], v[172:175], v[48:63]
  buffer_load_dwordx4 v[208:211], v0, s[8:11], s57 offen sc1
  s_waitcnt vmcnt(8)
  v_mfma_f32_32x32x16_bf16 v[32:47], a[228:231], v[176:179], 0
  buffer_load_dwordx4 v[212:215], v0, s[8:11], s57 offen offset:1024 sc1
  s_xor_b32 s54, s38, 3
  s_mul_i32 s54, s54, 12288
  s_add_u32 s54, s54, 114688
  v_add_u32 v4, s54, v0
  s_waitcnt vmcnt(8)
  v_mfma_f32_32x32x16_bf16 v[32:47], a[236:239], v[180:183], v[32:47]
  buffer_load_dwordx4 v[216:219], v0, s[8:11], s57 offen offset:2048 sc1
  s_waitcnt vmcnt(8)
  v_mfma_f32_32x32x16_bf16 v[32:47], a[244:247], v[184:187], v[32:47]
  buffer_load_dwordx4 v[252:255], v0, s[8:11], s58 offen offset:2048 sc1
  ds_write_b128 v4, v[64:67] offset:0
  ds_write_b128 v4, v[68:71] offset:1024
  s_waitcnt vmcnt(8)
  v_mfma_f32_32x32x16_bf16 v[32:47], a[252:255], v[188:191], v[32:47]
  s_mul_i32 s59, s40, 229376
  s_add_u32 s59, s59, 4194304
  ds_write_b128 v4, v[72:75] offset:2048
  ds_write_b128 v4, v[76:79] offset:3072
  s_waitcnt vmcnt(7)
  v_mfma_f32_32x32x16_bf16 v[32:47], v[224:227], v[192:195], v[32:47]
  s_mul_i32 s57, s38, 2048
  s_add_u32 s58, s57, s59
  s_xor_b32 s54, s38, 2
  s_mul_i32 s54, s54, 12288
  s_add_u32 s54, s54, 110592
  v_add_u32 v4, s54, v0
  s_waitcnt vmcnt(6)
  v_mfma_f32_32x32x16_bf16 v[32:47], v[244:247], v[196:199], v[32:47]
  s_add_u32 s58, s58, 155648
  s_add_u32 s57, s57, 155648
  ds_write_b128 v4, v[48:51] offset:0
  ds_write_b128 v4, v[52:55] offset:1024
  s_waitcnt vmcnt(5)
  v_mfma_f32_32x32x16_bf16 v[32:47], v[144:147], v[200:203], v[32:47]
  s_mov_b32 m0, s57
  s_nop 0
  buffer_load_dwordx4 v0, s[8:11], s58 offen sc1 lds
  ds_write_b128 v4, v[56:59] offset:2048
  ds_write_b128 v4, v[60:63] offset:3072
  s_waitcnt vmcnt(5)
  v_mfma_f32_32x32x16_bf16 v[32:47], v[152:155], v[204:207], v[32:47]
  buffer_load_dwordx4 v0, s[8:11], s58 offen offset:1024 sc1 lds
  v_mfma_f32_32x32x16_bf16 v[16:31], a[224:227], v[176:179], 0
  s_xor_b32 s54, s38, 1
  s_mul_i32 s54, s54, 12288
  s_add_u32 s54, s54, 106496
  v_add_u32 v4, s54, v0
  v_mfma_f32_32x32x16_bf16 v[16:31], a[232:235], v[180:183], v[16:31]
  s_nop 4
  ds_write_b128 v4, v[32:35] offset:0
  v_mfma_f32_32x32x16_bf16 v[16:31], a[240:243], v[184:187], v[16:31]
  ds_write_b128 v4, v[36:39] offset:1024
  ds_write_b128 v4, v[40:43] offset:2048
  ds_write_b128 v4, v[44:47] offset:3072
  v_mfma_f32_32x32x16_bf16 v[16:31], a[248:251], v[188:191], v[16:31]
  s_waitcnt lgkmcnt(0)
  s_barrier
  ds_read_b128 v[80:83], v6 offset:8192
  ds_read_b128 v[84:87], v6 offset:9216
  v_mfma_f32_32x32x16_bf16 v[16:31], v[220:223], v[192:195], v[16:31]
  ds_read_b128 v[88:91], v6 offset:10240
  ds_read_b128 v[92:95], v6 offset:11264
  ds_read_b128 v[96:99], v6 offset:4096
  v_mfma_f32_32x32x16_bf16 v[16:31], v[228:231], v[196:199], v[16:31]
  ds_read_b128 v[100:103], v6 offset:5120
  ds_read_b128 v[104:107], v6 offset:6144
  ds_read_b128 v[108:111], v6 offset:7168
  v_mfma_f32_32x32x16_bf16 v[16:31], v[248:251], v[200:203], v[16:31]
  ds_read_b128 v[112:115], v6 offset:0
  ds_read_b128 v[116:119], v6 offset:1024
  ds_read_b128 v[120:123], v6 offset:2048
  v_mfma_f32_32x32x16_bf16 v[16:31], v[148:151], v[204:207], v[16:31]
  ds_read_b128 v[124:127], v6 offset:3072
  s_waitcnt lgkmcnt(11)
  v_pk_add_f32 v[128:129], v[128:129], v[80:81]
  v_pk_add_f32 v[130:131], v[130:131], v[82:83]
  s_waitcnt lgkmcnt(10)
  v_pk_add_f32 v[132:133], v[132:133], v[84:85]
  v_pk_add_f32 v[134:135], v[134:135], v[86:87]
  s_waitcnt lgkmcnt(9)
  v_pk_add_f32 v[136:137], v[136:137], v[88:89]
  v_pk_add_f32 v[138:139], v[138:139], v[90:91]
  s_waitcnt lgkmcnt(8)
  v_pk_add_f32 v[140:141], v[140:141], v[92:93]
  v_pk_add_f32 v[142:143], v[142:143], v[94:95]
  s_waitcnt lgkmcnt(7)
  v_pk_add_f32 v[128:129], v[128:129], v[96:97]
  v_pk_add_f32 v[130:131], v[130:131], v[98:99]
  s_waitcnt lgkmcnt(6)
  v_pk_add_f32 v[132:133], v[132:133], v[100:101]
  v_pk_add_f32 v[134:135], v[134:135], v[102:103]
  s_waitcnt lgkmcnt(5)
  v_pk_add_f32 v[136:137], v[136:137], v[104:105]
  v_pk_add_f32 v[138:139], v[138:139], v[106:107]
  s_waitcnt lgkmcnt(4)
  v_pk_add_f32 v[140:141], v[140:141], v[108:109]
  v_pk_add_f32 v[142:143], v[142:143], v[110:111]
  s_waitcnt lgkmcnt(3)
  v_pk_add_f32 v[128:129], v[128:129], v[112:113]
  v_pk_add_f32 v[130:131], v[130:131], v[114:115]
  s_waitcnt lgkmcnt(2)
  v_pk_add_f32 v[132:133], v[132:133], v[116:117]
  v_pk_add_f32 v[134:135], v[134:135], v[118:119]
  s_waitcnt lgkmcnt(1)
  v_pk_add_f32 v[136:137], v[136:137], v[120:121]
  v_pk_add_f32 v[138:139], v[138:139], v[122:123]
  s_waitcnt lgkmcnt(0)
  v_pk_add_f32 v[140:141], v[140:141], v[124:125]
  v_pk_add_f32 v[142:143], v[142:143], v[126:127]
  v_pk_add_f32 v[16:17], v[16:17], v[128:129]
  v_pk_add_f32 v[18:19], v[18:19], v[130:131]
  v_pk_add_f32 v[20:21], v[20:21], v[132:133]
  v_pk_add_f32 v[22:23], v[22:23], v[134:135]
  v_cvt_pk_bf16_f32 v8, v16, v17
  v_cvt_pk_bf16_f32 v9, v18, v19
  v_cvt_pk_bf16_f32 v10, v20, v21
  v_cvt_pk_bf16_f32 v11, v22, v23
  buffer_store_dwordx4 v[8:11], v0, s[8:11], s55 offen
  v_pk_add_f32 v[24:25], v[24:25], v[136:137]
  v_pk_add_f32 v[26:27], v[26:27], v[138:139]
  v_pk_add_f32 v[28:29], v[28:29], v[140:141]
  v_pk_add_f32 v[30:31], v[30:31], v[142:143]
  v_cvt_pk_bf16_f32 v12, v24, v25
  v_cvt_pk_bf16_f32 v13, v26, v27
  v_cvt_pk_bf16_f32 v14, v28, v29
  v_cvt_pk_bf16_f32 v15, v30, v31
  buffer_store_dwordx4 v[12:15], v0, s[8:11], s55 offen offset:1024
  v_mov_b32 v128, 0
  v_mov_b32 v129, 0
  v_mov_b32 v130, 0
  v_mov_b32 v131, 0
  v_dot2c_f32_bf16 v128, v8, v7
  v_dot2c_f32_bf16 v130, v8, v8
  v_dot2c_f32_bf16 v129, v9, v7
  v_dot2c_f32_bf16 v131, v9, v9
  v_dot2c_f32_bf16 v128, v10, v7
  v_dot2c_f32_bf16 v130, v10, v10
  v_dot2c_f32_bf16 v129, v11, v7
  v_dot2c_f32_bf16 v131, v11, v11
  v_dot2c_f32_bf16 v128, v12, v7
  v_dot2c_f32_bf16 v130, v12, v12
  v_dot2c_f32_bf16 v129, v13, v7
  v_dot2c_f32_bf16 v131, v13, v13
  v_dot2c_f32_bf16 v128, v14, v7
  v_dot2c_f32_bf16 v130, v14, v14
  v_dot2c_f32_bf16 v129, v15, v7
  v_dot2c_f32_bf16 v131, v15, v15
  s_nop 1
  v_add_f32 v128, v128, v129
  v_add_f32 v130, v130, v131
  s_nop 1
  v_permlane32_swap_b32 v128, v130
  v_add_f32 v128, v128, v130
  s_cmp_lg_u32 s45, 0
  s_cbranch_scc1 L_slow_136
  buffer_store_dword v128, v0, s[8:11], s56 offen
L_join_137:
  v_and_b32 v4, 60, v1
  s_lshl_b32 s50, s39, 7
  s_add_u32 s50, s50, 49152
  v_add_u32 v240, 0x10000, v0
  v_add_u32 v241, 0x20000, v0
  s_mul_i32 s59, s40, 229376
  s_add_u32 s59, s59, 4194304
  s_mul_i32 s51, s40, 7168
  s_mul_i32 s6, s39, 114688
  s_add_u32 s6, s6, s51
  s_add_u32 s6, s6, 14680064
  s_add_u32 s7, s6, 4096
  s_add_u32 s51, s51, 9699328
  s_add_u32 s3, s51, 4096
  s_waitcnt vmcnt(0)
  v_mov_b32 v5, 2
  s_cmp_lg_u32 s45, 0
  s_cbranch_scc1 L_slow_138
  s_mov_b64 exec, 8
  buffer_store_dword v5, v3, s[8:11], 0 offen
  s_mov_b64 exec, -1
L_join_139:
  s_barrier
  ds_read_b128 a[224:227], v0 offset:0
  ds_read_b128 a[228:231], v0 offset:1024
  ds_read_b128 a[232:235], v0 offset:2048
  ds_read_b128 a[236:239], v0 offset:3072
  ds_read_b128 a[240:243], v0 offset:4096
  ds_read_b128 a[244:247], v0 offset:5120
  ds_read_b128 a[248:251], v0 offset:6144
  s_lshl_b32 s48, s39, 12
  s_add_u32 s48, s48, 1048576
  s_lshl_b32 s49, s39, 15
  s_add_u32 s49, s49, 12582912
  s_mov_b32 s46, 2097152
L_poll_140:
  buffer_load_dword v5, v4, s[8:11], s50 offen sc1
  s_sub_u32 s46, s46, 1
  s_cbranch_scc1 L_exit
  s_waitcnt vmcnt(0)
  v_cmp_gt_u32 vcc, 2, v5
  s_nop 0
  s_cbranch_vccnz L_poll_140
  s_cmp_lg_u32 s45, 0
  s_cbranch_scc1 L_slow_141
L_join_142:
  buffer_load_dwordx4 v[16:19], v0, s[8:11], s49 offen sc1
  buffer_load_dwordx4 v[20:23], v0, s[8:11], s49 offen offset:1024 sc1
  buffer_load_dwordx4 v[24:27], v0, s[8:11], s49 offen offset:2048 sc1
  buffer_load_dwordx4 v[28:31], v0, s[8:11], s49 offen offset:3072 sc1
  s_add_u32 s49, s49, 4096
  buffer_load_dwordx4 v[32:35], v0, s[8:11], s49 offen sc1
  buffer_load_dwordx4 v[36:39], v0, s[8:11], s49 offen offset:1024 sc1
  s_waitcnt vmcnt(5)
  s_waitcnt lgkmcnt(3)
  v_mfma_f32_32x32x16_bf16 v[144:159], a[224:227], v[16:19], 0
  ds_read_b128 a[252:255], v0 offset:7168
  buffer_load_dwordx4 v[40:43], v0, s[8:11], s49 offen offset:2048 sc1
  v_mfma_f32_32x32x16_bf16 v[160:175], a[228:231], v[16:19], 0
  ds_read_b128 a[224:227], v0 offset:8192
  v_mfma_f32_32x32x16_bf16 v[176:191], a[232:235], v[16:19], 0
  ds_read_b128 a[228:231], v0 offset:9216
  buffer_load_dwordx4 v[44:47], v0, s[8:11], s49 offen offset:3072 sc1
  v_mfma_f32_32x32x16_bf16 v[192:207], a[236:239], v[16:19], 0
  ds_read_b128 a[232:235], v0 offset:10240
  s_waitcnt vmcnt(6)
  s_waitcnt lgkmcnt(3)
  v_mfma_f32_32x32x16_bf16 v[144:159], a[240:243], v[20:23], v[144:159]
  ds_read_b128 a[236:239], v0 offset:11264
  s_add_u32 s49, s49, 4096
  buffer_load_dwordx4 v[48:51], v0, s[8:11], s49 offen sc1
  v_mfma_f32_32x32x16_bf16 v[160:175], a[244:247], v[20:23], v[160:175]
  ds_read_b128 a[240:243], v0 offset:12288
  v_mfma_f32_32x32x16_bf16 v[176:191], a[248:251], v[20:23], v[176:191]
  ds_read_b128 a[244:247], v0 offset:13312
  buffer_load_dwordx4 v[52:55], v0, s[8:11], s49 offen offset:1024 sc1
  v_mfma_f32_32x32x16_bf16 v[192:207], a[252:255], v[20:23], v[192:207]
  ds_read_b128 a[248:251], v0 offset:14336
  s_waitcnt vmcnt(7)
  s_waitcnt lgkmcnt(3)
  v_mfma_f32_32x32x16_bf16 v[144:159], a[224:227], v[24:27], v[144:159]
  ds_read_b128 a[252:255], v0 offset:15360
  buffer_load_dwordx4 v[56:59], v0, s[8:11], s49 offen offset:2048 sc1
  v_mfma_f32_32x32x16_bf16 v[160:175], a[228:231], v[24:27], v[160:175]
  ds_read_b128 a[224:227], v0 offset:16384
  v_mfma_f32_32x32x16_bf16 v[176:191], a[232:235], v[24:27], v[176:191]
  ds_read_b128 a[228:231], v0 offset:17408
  buffer_load_dwordx4 v[60:63], v0, s[8:11], s49 offen offset:3072 sc1
  v_mfma_f32_32x32x16_bf16 v[192:207], a[236:239], v[24:27], v[192:207]
  ds_read_b128 a[232:235], v0 offset:18432
  s_waitcnt vmcnt(8)
  s_waitcnt lgkmcnt(3)
  v_mfma_f32_32x32x16_bf16 v[144:159], a[240:243], v[28:31], v[144:159]
  ds_read_b128 a[236:239], v0 offset:19456
  buffer_load_dwordx4 v[224:227], v0, s[8:11], s48 offen sc1
  v_mfma_f32_32x32x16_bf16 v[160:175], a[244:247], v[28:31], v[160:175]
  ds_read_b128 a[240:243], v0 offset:20480
  v_mfma_f32_32x32x16_bf16 v[176:191], a[248:251], v[28:31], v[176:191]
  ds_read_b128 a[244:247], v0 offset:21504
  buffer_load_dwordx4 v[228:231], v0, s[8:11], s48 offen offset:1024 sc1
  v_mfma_f32_32x32x16_bf16 v[192:207], a[252:255], v[28:31], v[192:207]
  ds_read_b128 a[248:251], v0 offset:22528
  s_waitcnt vmcnt(9)
  s_waitcnt lgkmcnt(3)
  v_mfma_f32_32x32x16_bf16 v[144:159], a[224:227], v[32:35], v[144:159]
  ds_read_b128 a[252:255], v0 offset:23552
  buffer_load_dwordx4 v[232:235], v0, s[8:11], s48 offen offset:2048 sc1
  v_mfma_f32_32x32x16_bf16 v[160:175], a[228:231], v[32:35], v[160:175]
  ds_read_b128 a[224:227], v0 offset:24576
  v_mfma_f32_32x32x16_bf16 v[176:191], a[232:235], v[32:35], v[176:191]
  ds_read_b128 a[228:231], v0 offset:25600
  buffer_load_dwordx4 v[236:239], v0, s[8:11], s48 offen offset:3072 sc1
  v_mfma_f32_32x32x16_bf16 v[192:207], a[236:239], v[32:35], v[192:207]
  ds_read_b128 a[232:235], v0 offset:26624
  s_waitcnt vmcnt(10)
  s_waitcnt lgkmcnt(3)
  v_mfma_f32_32x32x16_bf16 v[144:159], a[240:243], v[36:39], v[144:159]
  ds_read_b128 a[236:239], v0 offset:27648
  s_add_u32 s49, s49, 4096
  buffer_load_dwordx4 v[64:67], v0, s[8:11], s49 offen sc1
  v_mfma_f32_32x32x16_bf16 v[160:175], a[244:247], v[36:39], v[160:175]
  ds_read_b128 a[240:243], v0 offset:28672
  v_mfma_f32_32x32x16_bf16 v[176:191], a[248:251], v[36:39], v[176:191]
  ds_read_b128 a[244:247], v0 offset:29696
  buffer_load_dwordx4 v[68:71], v0, s[8:11], s49 offen offset:1024 sc1
  v_mfma_f32_32x32x16_bf16 v[192:207], a[252:255], v[36:39], v[192:207]
  ds_read_b128 a[248:251], v0 offset:30720
  s_waitcnt vmcnt(11)
  s_waitcnt lgkmcnt(3)
  v_mfma_f32_32x32x16_bf16 v[144:159], a[224:227], v[40:43], v[144:159]
  ds_read_b128 a[252:255], v0 offset:31744
  buffer_load_dwordx4 v[72:75], v0, s[8:11], s49 offen offset:2048 sc1
  v_mfma_f32_32x32x16_bf16 v[160:175], a[228:231], v[40:43], v[160:175]
  ds_read_b128 a[224:227], v0 offset:32768
  v_mfma_f32_32x32x16_bf16 v[176:191], a[232:235], v[40:43], v[176:191]
  ds_read_b128 a[228:231], v0 offset:33792
  buffer_load_dwordx4 v[76:79], v0, s[8:11], s49 offen offset:3072 sc1
  v_mfma_f32_32x32x16_bf16 v[192:207], a[236:239], v[40:43], v[192:207]
  ds_read_b128 a[232:235], v0 offset:34816
  s_waitcnt vmcnt(12)
  s_waitcnt lgkmcnt(3)
  v_mfma_f32_32x32x16_bf16 v[144:159], a[240:243], v[44:47], v[144:159]
  ds_read_b128 a[236:239], v0 offset:35840
  s_waitcnt vmcnt(4)
  v_add_f32 v224, v224, v232
  v_add_f32 v225, v225, v233
  s_add_u32 s49, s49, 4096
  buffer_load_dwordx4 v[80:83], v0, s[8:11], s49 offen sc1
  v_mfma_f32_32x32x16_bf16 v[160:175], a[244:247], v[44:47], v[160:175]
  ds_read_b128 a[240:243], v0 offset:36864
  v_add_f32 v226, v226, v234
  v_add_f32 v227, v227, v235
  v_mfma_f32_32x32x16_bf16 v[176:191], a[248:251], v[44:47], v[176:191]
  ds_read_b128 a[244:247], v0 offset:37888
  v_add_f32 v228, v228, v236
  v_add_f32 v229, v229, v237
  buffer_load_dwordx4 v[84:87], v0, s[8:11], s49 offen offset:1024 sc1
  v_mfma_f32_32x32x16_bf16 v[192:207], a[252:255], v[44:47], v[192:207]
  ds_read_b128 a[248:251], v0 offset:38912
  v_add_f32 v230, v230, v238
  v_add_f32 v231, v231, v239
  s_waitcnt lgkmcnt(3)
  v_mfma_f32_32x32x16_bf16 v[144:159], a[224:227], v[48:51], v[144:159]
  ds_read_b128 a[252:255], v0 offset:39936
  v_add_f32 v224, v224, v228
  v_add_f32 v225, v225, v229
  buffer_load_dwordx4 v[88:91], v0, s[8:11], s49 offen offset:2048 sc1
  v_mfma_f32_32x32x16_bf16 v[160:175], a[228:231], v[48:51], v[160:175]
  ds_read_b128 a[224:227], v0 offset:40960
  v_add_f32 v226, v226, v230
  v_add_f32 v227, v227, v231
  v_mfma_f32_32x32x16_bf16 v[176:191], a[232:235], v[48:51], v[176:191]
  ds_read_b128 a[228:231], v0 offset:41984
  v_add_f32 v224, v224, v226
  v_add_f32 v225, v225, v227
  buffer_load_dwordx4 v[92:95], v0, s[8:11], s49 offen offset:3072 sc1
  v_mfma_f32_32x32x16_bf16 v[192:207], a[236:239], v[48:51], v[192:207]
  ds_read_b128 a[232:235], v0 offset:43008
  v_add_f32 v224, v224, v225
  v_mov_b32 v225, v224
  s_waitcnt lgkmcnt(3)
  v_mfma_f32_32x32x16_bf16 v[144:159], a[240:243], v[52:55], v[144:159]
  ds_read_b128 a[236:239], v0 offset:44032
  s_nop 1
  v_permlane32_swap_b32 v224, v225
  s_add_u32 s49, s49, 4096
  buffer_load_dwordx4 v[96:99], v0, s[8:11], s49 offen sc1
  v_mfma_f32_32x32x16_bf16 v[160:175], a[244:247], v[52:55], v[160:175]
  ds_read_b128 a[240:243], v0 offset:45056
  v_mul_f32 v224, 0xbb000000, v224
  v_mul_f32 v225, 0x3b000000, v225
  v_mfma_f32_32x32x16_bf16 v[176:191], a[248:251], v[52:55], v[176:191]
  ds_read_b128 a[244:247], v0 offset:46080
  v_fma_f32 v225, -v224, v224, v225
  v_max_f32 v225, 0, v225
  buffer_load_dwordx4 v[100:103], v0, s[8:11], s49 offen offset:1024 sc1
  v_mfma_f32_32x32x16_bf16 v[192:207], a[252:255], v[52:55], v[192:207]
  ds_read_b128 a[248:251], v0 offset:47104
  v_cvt_pk_bf16_f32 v225, v225, v225
  v_lshlrev_b32 v225, 16, v225
  s_waitcnt lgkmcnt(3)
  v_mfma_f32_32x32x16_bf16 v[144:159], a[224:227], v[56:59], v[144:159]
  ds_read_b128 a[252:255], v0 offset:48128
  v_add_f32 v225, 0x3727c5ac, v225
  v_cvt_pk_bf16_f32 v225, v225, v225
  buffer_load_dwordx4 v[104:107], v0, s[8:11], s49 offen offset:2048 sc1
  v_mfma_f32_32x32x16_bf16 v[160:175], a[228:231], v[56:59], v[160:175]
  ds_read_b128 a[224:227], v0 offset:49152
  v_lshlrev_b32 v225, 16, v225
  v_sqrt_f32 v225, v225
  v_mfma_f32_32x32x16_bf16 v[176:191], a[232:235], v[56:59], v[176:191]
  ds_read_b128 a[228:231], v0 offset:50176
  v_cvt_pk_bf16_f32 v248, v224, v224
  v_cvt_pk_bf16_f32 v225, v225, v225
  buffer_load_dwordx4 v[108:111], v0, s[8:11], s49 offen offset:3072 sc1
  v_mfma_f32_32x32x16_bf16 v[192:207], a[236:239], v[56:59], v[192:207]
  ds_read_b128 a[232:235], v0 offset:51200
  v_lshlrev_b32 v225, 16, v225
  v_rcp_f32 v242, v225
  s_waitcnt lgkmcnt(3)
  v_mfma_f32_32x32x16_bf16 v[144:159], a[240:243], v[60:63], v[144:159]
  ds_read_b128 a[236:239], v0 offset:52224
  v_mul_f32 v243, v225, v225
  v_mov_b32 v249, v248
  s_add_u32 s49, s49, 4096
  buffer_load_dwordx4 v[112:115], v0, s[8:11], s49 offen sc1
  v_mfma_f32_32x32x16_bf16 v[160:175], a[244:247], v[60:63], v[160:175]
  ds_read_b128 a[240:243], v0 offset:53248
  v_mov_b32 v250, v248
  v_mov_b32 v251, v248
  v_mfma_f32_32x32x16_bf16 v[176:191], a[248:251], v[60:63], v[176:191]
  ds_read_b128 a[244:247], v0 offset:54272
  s_nop 0
  v_mul_f32 v242, 0xbfb8aa3b, v242
  buffer_load_dwordx4 v[116:119], v0, s[8:11], s49 offen offset:1024 sc1
  v_mfma_f32_32x32x16_bf16 v[192:207], a[252:255], v[60:63], v[192:207]
  ds_read_b128 a[248:251], v0 offset:55296
  s_waitcnt vmcnt(13)
  s_waitcnt lgkmcnt(3)
  v_mfma_f32_32x32x16_bf16 v[144:159], a[224:227], v[64:67], v[144:159]
  ds_read_b128 a[252:255], v0 offset:56320
  buffer_load_dwordx4 v[120:123], v0, s[8:11], s49 offen offset:2048 sc1
  v_mfma_f32_32x32x16_bf16 v[160:175], a[228:231], v[64:67], v[160:175]
  ds_read_b128 a[224:227], v0 offset:57344
  v_mfma_f32_32x32x16_bf16 v[176:191], a[232:235], v[64:67], v[176:191]
  ds_read_b128 a[228:231], v0 offset:58368
  buffer_load_dwordx4 v[124:127], v0, s[8:11], s49 offen offset:3072 sc1
  v_mfma_f32_32x32x16_bf16 v[192:207], a[236:239], v[64:67], v[192:207]
  ds_read_b128 a[232:235], v0 offset:59392
  s_waitcnt vmcnt(14)
  s_waitcnt lgkmcnt(3)
  v_mfma_f32_32x32x16_bf16 v[144:159], a[240:243], v[68:71], v[144:159]
  ds_read_b128 a[236:239], v0 offset:60416
  s_add_u32 s49, s49, 4096
  buffer_load_dwordx4 v[128:131], v0, s[8:11], s49 offen sc1
  v_mfma_f32_32x32x16_bf16 v[160:175], a[244:247], v[68:71], v[160:175]
  ds_read_b128 a[240:243], v0 offset:61440
  v_mfma_f32_32x32x16_bf16 v[176:191], a[248:251], v[68:71], v[176:191]
  ds_read_b128 a[244:247], v0 offset:62464
  buffer_load_dwordx4 v[132:135], v0, s[8:11], s49 offen offset:1024 sc1
  v_mfma_f32_32x32x16_bf16 v[192:207], a[252:255], v[68:71], v[192:207]
  ds_read_b128 a[248:251], v0 offset:63488
  s_waitcnt vmcnt(15)
  s_waitcnt lgkmcnt(3)
  v_mfma_f32_32x32x16_bf16 v[144:159], a[224:227], v[72:75], v[144:159]
  ds_read_b128 a[252:255], v0 offset:64512
  buffer_load_dwordx4 v[136:139], v0, s[8:11], s49 offen offset:2048 sc1
  v_mfma_f32_32x32x16_bf16 v[160:175], a[228:231], v[72:75], v[160:175]
  ds_read_b128 a[224:227], v240 offset:0
  v_mfma_f32_32x32x16_bf16 v[176:191], a[232:235], v[72:75], v[176:191]
  ds_read_b128 a[228:231], v240 offset:1024
  buffer_load_dwordx4 v[140:143], v0, s[8:11], s49 offen offset:3072 sc1
  v_mfma_f32_32x32x16_bf16 v[192:207], a[236:239], v[72:75], v[192:207]
  ds_read_b128 a[232:235], v240 offset:2048
  s_mul_i32 s56, s38, 7168
  s_add_u32 s57, s56, s59
  s_waitcnt vmcnt(16)
  s_waitcnt lgkmcnt(3)
  v_mfma_f32_32x32x16_bf16 v[144:159], a[240:243], v[76:79], v[144:159]
  ds_read_b128 a[236:239], v240 offset:3072
  s_add_u32 s57, s57, 106496
  s_add_u32 s56, s56, 106496
  v_mfma_f32_32x32x16_bf16 v[160:175], a[244:247], v[76:79], v[160:175]
  ds_read_b128 a[240:243], v240 offset:4096
  v_mfma_f32_32x32x16_bf16 v[176:191], a[248:251], v[76:79], v[176:191]
  ds_read_b128 a[244:247], v240 offset:5120
  s_mov_b32 m0, s56
  s_nop 0
  buffer_load_dwordx4 v0, s[8:11], s57 offen sc1 lds
  v_mfma_f32_32x32x16_bf16 v[192:207], a[252:255], v[76:79], v[192:207]
  ds_read_b128 a[248:251], v240 offset:6144
  s_waitcnt vmcnt(16)
  s_waitcnt lgkmcnt(3)
  v_mfma_f32_32x32x16_bf16 v[144:159], a[224:227], v[80:83], v[144:159]
  ds_read_b128 a[252:255], v240 offset:7168
  buffer_load_dwordx4 v0, s[8:11], s57 offen offset:1024 sc1 lds
  v_mfma_f32_32x32x16_bf16 v[160:175], a[228:231], v[80:83], v[160:175]
  ds_read_b128 a[224:227], v240 offset:8192
  v_mfma_f32_32x32x16_bf16 v[176:191], a[232:235], v[80:83], v[176:191]
  ds_read_b128 a[228:231], v240 offset:9216
  buffer_load_dwordx4 v0, s[8:11], s57 offen offset:2048 sc1 lds
  v_mfma_f32_32x32x16_bf16 v[192:207], a[236:239], v[80:83], v[192:207]
  ds_read_b128 a[232:235], v240 offset:10240
  s_waitcnt vmcnt(17)
  s_waitcnt lgkmcnt(3)
  v_mfma_f32_32x32x16_bf16 v[144:159], a[240:243], v[84:87], v[144:159]
  ds_read_b128 a[236:239], v240 offset:11264
  buffer_load_dwordx4 v0, s[8:11], s57 offen offset:3072 sc1 lds
  v_mfma_f32_32x32x16_bf16 v[160:175], a[244:247], v[84:87], v[160:175]
  s_barrier
  ds_read_b128 a[240:243], v240 offset:12288
  s_add_u32 s56, s56, 4096
  s_add_u32 s57, s57, 4096
  v_mfma_f32_32x32x16_bf16 v[176:191], a[248:251], v[84:87], v[176:191]
  ds_read_b128 a[244:247], v240 offset:13312
  s_mov_b32 m0, s56
  s_nop 0
  buffer_load_dwordx4 v0, s[8:11], s57 offen sc1 lds
  v_mfma_f32_32x32x16_bf16 v[192:207], a[252:255], v[84:87], v[192:207]
  ds_read_b128 a[248:251], v240 offset:14336
  s_waitcnt vmcnt(18)
  s_waitcnt lgkmcnt(3)
  v_mfma_f32_32x32x16_bf16 v[144:159], a[224:227], v[88:91], v[144:159]
  ds_read_b128 a[252:255], v240 offset:15360
  buffer_load_dwordx4 v0, s[8:11], s57 offen offset:1024 sc1 lds
  v_mfma_f32_32x32x16_bf16 v[160:175], a[228:231], v[88:91], v[160:175]
  ds_read_b128 a[224:227], v240 offset:16384
  v_mfma_f32_32x32x16_bf16 v[176:191], a[232:235], v[88:91], v[176:191]
  ds_read_b128 a[228:231], v240 offset:17408
  buffer_load_dwordx4 v0, s[8:11], s57 offen offset:2048 sc1 lds
  v_mfma_f32_32x32x16_bf16 v[192:207], a[236:239], v[88:91], v[192:207]
  ds_read_b128 a[232:235], v240 offset:18432
  s_waitcnt vmcnt(19)
  s_waitcnt lgkmcnt(3)
  v_mfma_f32_32x32x16_bf16 v[144:159], a[240:243], v[92:95], v[144:159]
  ds_read_b128 a[236:239], v240 offset:19456
  buffer_load_dwordx4 v[220:223], v0, s[8:11], s51 offen offset:3072 sc1
  v_mfma_f32_32x32x16_bf16 v[160:175], a[244:247], v[92:95], v[160:175]
  ds_read_b128 a[240:243], v240 offset:20480
  v_mfma_f32_32x32x16_bf16 v[176:191], a[248:251], v[92:95], v[176:191]
  ds_read_b128 a[244:247], v240 offset:21504
  buffer_load_dwordx4 v[224:227], v0, s[8:11], s3 offen sc1
  v_mfma_f32_32x32x16_bf16 v[192:207], a[252:255], v[92:95], v[192:207]
  ds_read_b128 a[248:251], v240 offset:22528
  s_waitcnt vmcnt(20)
  s_waitcnt lgkmcnt(3)
  v_mfma_f32_32x32x16_bf16 v[144:159], a[224:227], v[96:99], v[144:159]
  ds_read_b128 a[252:255], v240 offset:23552
  buffer_load_dwordx4 v[244:247], v0, s[8:11], s3 offen offset:1024 sc1
  v_mfma_f32_32x32x16_bf16 v[160:175], a[228:231], v[96:99], v[160:175]
  ds_read_b128 a[224:227], v240 offset:24576
  s_mul_i32 s56, s38, 5120
  s_add_u32 s57, s56, s59
  v_mfma_f32_32x32x16_bf16 v[176:191], a[232:235], v[96:99], v[176:191]
  ds_read_b128 a[228:231], v240 offset:25600
  s_add_u32 s57, s57, 135168
  s_add_u32 s56, s56, 135168
  v_mfma_f32_32x32x16_bf16 v[192:207], a[236:239], v[96:99], v[192:207]
  ds_read_b128 a[232:235], v240 offset:26624
  s_waitcnt vmcnt(20)
  s_waitcnt lgkmcnt(3)
  v_mfma_f32_32x32x16_bf16 v[144:159], a[240:243], v[100:103], v[144:159]
  ds_read_b128 a[236:239], v240 offset:27648
  s_mov_b32 m0, s56
  s_nop 0
  buffer_load_dwordx4 v0, s[8:11], s57 offen sc1 lds
  v_mfma_f32_32x32x16_bf16 v[160:175], a[244:247], v[100:103], v[160:175]
  ds_read_b128 a[240:243], v240 offset:28672
  v_mfma_f32_32x32x16_bf16 v[176:191], a[248:251], v[100:103], v[176:191]
  ds_read_b128 a[244:247], v240 offset:29696
  buffer_load_dwordx4 v0, s[8:11], s57 offen offset:1024 sc1 lds
  v_mfma_f32_32x32x16_bf16 v[192:207], a[252:255], v[100:103], v[192:207]
  ds_read_b128 a[248:251], v240 offset:30720
  s_waitcnt vmcnt(21)
  s_waitcnt lgkmcnt(3)
  v_mfma_f32_32x32x16_bf16 v[144:159], a[224:227], v[104:107], v[144:159]
  ds_read_b128 a[252:255], v240 offset:31744
  buffer_load_dwordx4 v0, s[8:11], s57 offen offset:2048 sc1 lds
  v_mfma_f32_32x32x16_bf16 v[160:175], a[228:231], v[104:107], v[160:175]
  ds_read_b128 a[224:227], v240 offset:32768
  v_mfma_f32_32x32x16_bf16 v[176:191], a[232:235], v[104:107], v[176:191]
  ds_read_b128 a[228:231], v240 offset:33792
  buffer_load_dwordx4 v0, s[8:11], s57 offen offset:3072 sc1 lds
  v_mfma_f32_32x32x16_bf16 v[192:207], a[236:239], v[104:107], v[192:207]
  ds_read_b128 a[232:235], v240 offset:34816
  s_add_u32 s56, s56, 4096
  s_add_u32 s57, s57, 4096
  s_waitcnt vmcnt(22)
  s_waitcnt lgkmcnt(3)
  v_mfma_f32_32x32x16_bf16 v[144:159], a[240:243], v[108:111], v[144:159]
  ds_read_b128 a[236:239], v240 offset:35840
  s_mov_b32 m0, s56
  s_nop 0
  buffer_load_dwordx4 v0, s[8:11], s57 offen sc1 lds
  v_mfma_f32_32x32x16_bf16 v[160:175], a[244:247], v[108:111], v[160:175]
  ds_read_b128 a[240:243], v240 offset:36864
  s_mul_i32 s56, s38, 8192
  s_add_u32 s57, s56, s59
  v_mfma_f32_32x32x16_bf16 v[176:191], a[248:251], v[108:111], v[176:191]
  ds_read_b128 a[244:247], v240 offset:37888
  s_add_u32 s57, s57, 163840
  s_add_u32 s56, s56, 0
  v_mfma_f32_32x32x16_bf16 v[192:207], a[252:255], v[108:111], v[192:207]
  ds_read_b128 a[248:251], v240 offset:38912
  s_waitcnt vmcnt(22)
  s_waitcnt lgkmcnt(3)
  v_mfma_f32_32x32x16_bf16 v[144:159], a[224:227], v[112:115], v[144:159]
  ds_read_b128 a[252:255], v240 offset:39936
  s_mov_b32 m0, s56
  s_nop 0
  buffer_load_dwordx4 v0, s[8:11], s57 offen sc1 lds
  v_mfma_f32_32x32x16_bf16 v[160:175], a[228:231], v[112:115], v[160:175]
  s_waitcnt vmcnt(9)
  s_barrier
  ds_read_b128 a[224:227], v240 offset:40960
  v_mfma_f32_32x32x16_bf16 v[176:191], a[232:235], v[112:115], v[176:191]
  ds_read_b128 a[228:231], v240 offset:41984
  buffer_load_dwordx4 v0, s[8:11], s57 offen offset:1024 sc1 lds
  v_mfma_f32_32x32x16_bf16 v[192:207], a[236:239], v[112:115], v[192:207]
  ds_read_b128 a[232:235], v240 offset:43008
  s_waitcnt lgkmcnt(3)
  v_mfma_f32_32x32x16_bf16 v[144:159], a[240:243], v[116:119], v[144:159]
  ds_read_b128 a[236:239], v240 offset:44032
  buffer_load_dwordx4 v0, s[8:11], s57 offen offset:2048 sc1 lds
  v_mfma_f32_32x32x16_bf16 v[160:175], a[244:247], v[116:119], v[160:175]
  ds_read_b128 a[240:243], v240 offset:45056
  v_mfma_f32_32x32x16_bf16 v[176:191], a[248:251], v[116:119], v[176:191]
  ds_read_b128 a[244:247], v240 offset:46080
  buffer_load_dwordx4 v0, s[8:11], s57 offen offset:3072 sc1 lds
  v_mfma_f32_32x32x16_bf16 v[192:207], a[252:255], v[116:119], v[192:207]
  ds_read_b128 a[248:251], v240 offset:47104
  s_add_u32 s56, s56, 4096
  s_add_u32 s57, s57, 4096
  s_waitcnt lgkmcnt(3)
  v_mfma_f32_32x32x16_bf16 v[144:159], a[224:227], v[120:123], v[144:159]
  ds_read_b128 a[252:255], v240 offset:48128
  s_mov_b32 m0, s56
  s_nop 0
  buffer_load_dwordx4 v0, s[8:11], s57 offen sc1 lds
  v_mfma_f32_32x32x16_bf16 v[160:175], a[228:231], v[120:123], v[160:175]
  ds_read_b128 a[224:227], v240 offset:49152
  v_mfma_f32_32x32x16_bf16 v[176:191], a[232:235], v[120:123], v[176:191]
  ds_read_b128 a[228:231], v240 offset:50176
  buffer_load_dwordx4 v0, s[8:11], s57 offen offset:1024 sc1 lds
  v_mfma_f32_32x32x16_bf16 v[192:207], a[236:239], v[120:123], v[192:207]
  ds_read_b128 a[232:235], v240 offset:51200
  s_waitcnt lgkmcnt(3)
  v_mfma_f32_32x32x16_bf16 v[144:159], a[240:243], v[124:127], v[144:159]
  ds_read_b128 a[236:239], v240 offset:52224
  buffer_load_dwordx4 v0, s[8:11], s57 offen offset:2048 sc1 lds
  v_mfma_f32_32x32x16_bf16 v[160:175], a[244:247], v[124:127], v[160:175]
  ds_read_b128 a[240:243], v240 offset:53248
  v_mfma_f32_32x32x16_bf16 v[176:191], a[248:251], v[124:127], v[176:191]
  ds_read_b128 a[244:247], v240 offset:54272
  buffer_load_dwordx4 v0, s[8:11], s57 offen offset:3072 sc1 lds
  v_mfma_f32_32x32x16_bf16 v[192:207], a[252:255], v[124:127], v[192:207]
  ds_read_b128 a[248:251], v240 offset:55296
  s_mul_i32 s56, s38, 8192
  s_add_u32 s57, s56, s59
  s_waitcnt lgkmcnt(3)
  v_mfma_f32_32x32x16_bf16 v[144:159], a[224:227], v[128:131], v[144:159]
  ds_read_b128 a[252:255], v240 offset:56320
  s_add_u32 s57, s57, 196608
  s_add_u32 s56, s56, 32768
  v_mfma_f32_32x32x16_bf16 v[160:175], a[228:231], v[128:131], v[160:175]
  ds_read_b128 a[224:227], v240 offset:57344
  v_mfma_f32_32x32x16_bf16 v[176:191], a[232:235], v[128:131], v[176:191]
  ds_read_b128 a[228:231], v240 offset:58368
  s_mov_b32 m0, s56
  s_nop 0
  buffer_load_dwordx4 v0, s[8:11], s57 offen sc1 lds
  v_mfma_f32_32x32x16_bf16 v[192:207], a[236:239], v[128:131], v[192:207]
  ds_read_b128 a[232:235], v240 offset:59392
  s_waitcnt lgkmcnt(3)
  v_mfma_f32_32x32x16_bf16 v[144:159], a[240:243], v[132:135], v[144:159]
  ds_read_b128 a[236:239], v240 offset:60416
  buffer_load_dwordx4 v0, s[8:11], s57 offen offset:1024 sc1 lds
  v_mfma_f32_32x32x16_bf16 v[160:175], a[244:247], v[132:135], v[160:175]
  ds_read_b128 a[240:243], v240 offset:61440
  v_mfma_f32_32x32x16_bf16 v[176:191], a[248:251], v[132:135], v[176:191]
  ds_read_b128 a[244:247], v240 offset:62464
  buffer_load_dwordx4 v0, s[8:11], s57 offen offset:2048 sc1 lds
  v_mfma_f32_32x32x16_bf16 v[192:207], a[252:255], v[132:135], v[192:207]
  ds_read_b128 a[248:251], v240 offset:63488
  s_waitcnt lgkmcnt(3)
  v_mfma_f32_32x32x16_bf16 v[144:159], a[224:227], v[136:139], v[144:159]
  ds_read_b128 a[252:255], v240 offset:64512
  buffer_load_dwordx4 v0, s[8:11], s57 offen offset:3072 sc1 lds
  v_mfma_f32_32x32x16_bf16 v[160:175], a[228:231], v[136:139], v[160:175]
  ds_read_b128 a[224:227], v241 offset:0
  s_add_u32 s56, s56, 4096
  s_add_u32 s57, s57, 4096
  v_mfma_f32_32x32x16_bf16 v[176:191], a[232:235], v[136:139], v[176:191]
  ds_read_b128 a[228:231], v241 offset:1024
  s_mov_b32 m0, s56
  s_nop 0
  buffer_load_dwordx4 v0, s[8:11], s57 offen sc1 lds
  v_mfma_f32_32x32x16_bf16 v[192:207], a[236:239], v[136:139], v[192:207]
  ds_read_b128 a[232:235], v241 offset:2048
  s_waitcnt lgkmcnt(3)
  v_mfma_f32_32x32x16_bf16 v[144:159], a[240:243], v[140:143], v[144:159]
  ds_read_b128 a[236:239], v241 offset:3072
  buffer_load_dwordx4 v0, s[8:11], s57 offen offset:1024 sc1 lds
  v_mfma_f32_32x32x16_bf16 v[160:175], a[244:247], v[140:143], v[160:175]
  s_waitcnt vmcnt(14)
  s_barrier
  ds_read_b128 a[240:243], v241 offset:4096
  v_mfma_f32_32x32x16_bf16 v[176:191], a[248:251], v[140:143], v[176:191]
  ds_read_b128 a[244:247], v241 offset:5120
  buffer_load_dwordx4 v0, s[8:11], s57 offen offset:2048 sc1 lds
  v_mfma_f32_32x32x16_bf16 v[192:207], a[252:255], v[140:143], v[192:207]
  ds_read_b128 a[248:251], v241 offset:6144
  v_mfma_f32_32x32x16_bf16 v[144:159], v[208:211], v[248:251], v[144:159]
  v_mfma_f32_32x32x16_bf16 v[160:175], v[212:215], v[248:251], v[160:175]
  v_mfma_f32_32x32x16_bf16 v[176:191], v[216:219], v[248:251], v[176:191]
  v_mfma_f32_32x32x16_bf16 v[192:207], v[220:223], v[248:251], v[192:207]
  v_mfma_f32_32x32x16_bf16 v[208:223], v[224:227], v[248:251], 0
  v_mfma_f32_32x32x16_bf16 v[224:239], v[244:247], v[248:251], 0
  s_waitcnt lgkmcnt(3)
  v_mfma_f32_32x32x16_bf16 v[208:223], a[224:227], v[16:19], v[208:223]
  ds_read_b128 a[252:255], v241 offset:7168
  buffer_load_dwordx4 v0, s[8:11], s57 offen offset:3072 sc1 lds
  v_mfma_f32_32x32x16_bf16 v[224:239], a[228:231], v[16:19], v[224:239]
  ds_read_b128 a[224:227], v241 offset:8192
  v_mfma_f32_32x32x16_bf16 v[208:223], a[232:235], v[20:23], v[208:223]
  ds_read_b128 a[228:231], v241 offset:9216
  v_mul_f32 v244, v242, v144
  v_mul_f32 v245, v242, v145
  v_mul_f32 v246, v242, v146
  v_mul_f32 v247, v242, v147
  s_getpc_b64 s[4:5]
L_pc_147:
  s_lshl_b32 s46, s37, 2
  s_add_u32 s46, s46, s38
  s_and_b32 s46, s46, 3
  s_lshl_b32 s46, s46, 11
  s_add_u32 s46, s46, 4096
  v_lshrrev_b32 v6, 6, v0
  v_lshl_add_u32 v6, v6, 7, s46
  v_min_u32 v6, L_end-L_pc_147-4, v6
  global_load_dword v7, v6, s[4:5]
  v_mfma_f32_32x32x16_bf16 v[224:239], a[236:239], v[20:23], v[224:239]
  ds_read_b128 a[232:235], v241 offset:10240
  v_exp_f32 v244, v244
  v_exp_f32 v245, v245
  v_lshlrev_b32 v6, 3, v0
  v_min_u32 v6, 7040, v6
  s_waitcnt lgkmcnt(3)
  v_mfma_f32_32x32x16_bf16 v[208:223], a[240:243], v[24:27], v[208:223]
  ds_read_b128 a[236:239], v241 offset:11264
  v_exp_f32 v246, v246
  v_exp_f32 v247, v247
  v_mul_f32 v144, v144, v152
  buffer_load_dword v7, v6, s[8:11], s6 offen sc1
  v_mfma_f32_32x32x16_bf16 v[224:239], a[244:247], v[24:27], v[224:239]
  ds_read_b128 a[240:243], v241 offset:12288
  v_mul_f32 v145, v145, v153
  v_mul_f32 v146, v146, v154
  v_mul_f32 v147, v147, v155
  v_fma_f32 v244, v244, v243, v243
  v_fma_f32 v245, v245, v243, v243
  v_mfma_f32_32x32x16_bf16 v[208:223], a[248:251], v[28:31], v[208:223]
  ds_read_b128 a[244:247], v241 offset:13312
  v_fma_f32 v246, v246, v243, v243
  v_fma_f32 v247, v247, v243, v243
  v_rcp_f32 v244, v244
  v_mfma_f32_32x32x16_bf16 v[224:239], a[252:255], v[28:31], v[224:239]
  ds_read_b128 a[248:251], v241 offset:14336
  v_rcp_f32 v245, v245
  v_rcp_f32 v246, v246
  s_waitcnt lgkmcnt(3)
  v_mfma_f32_32x32x16_bf16 v[208:223], a[224:227], v[32:35], v[208:223]
  ds_read_b128 a[252:255], v241 offset:15360
  v_rcp_f32 v247, v247
  v_mul_f32 v144, v144, v244
  v_mul_f32 v145, v145, v245
  v_mul_f32 v146, v146, v246
  v_mfma_f32_32x32x16_bf16 v[224:239], a[228:231], v[32:35], v[224:239]
  ds_read_b128 a[224:227], v241 offset:16384
  v_mul_f32 v147, v147, v247
  v_mul_f32 v244, v242, v148
  v_mul_f32 v245, v242, v149
  v_mul_f32 v246, v242, v150
  v_mul_f32 v247, v242, v151
  v_mfma_f32_32x32x16_bf16 v[208:223], a[232:235], v[36:39], v[208:223]
  ds_read_b128 a[228:231], v241 offset:17408
  v_exp_f32 v244, v244
  v_exp_f32 v245, v245
  v_mfma_f32_32x32x16_bf16 v[224:239], a[236:239], v[36:39], v[224:239]
  ds_read_b128 a[232:235], v241 offset:18432
  v_exp_f32 v246, v246
  v_exp_f32 v247, v247
  s_waitcnt lgkmcnt(3)
  v_mfma_f32_32x32x16_bf16 v[208:223], a[240:243], v[40:43], v[208:223]
  ds_read_b128 a[236:239], v241 offset:19456
  v_mul_f32 v148, v148, v156
  v_mul_f32 v149, v149, v157
  v_mul_f32 v150, v150, v158
  v_mul_f32 v151, v151, v159
  v_fma_f32 v244, v244, v243, v243
  v_mfma_f32_32x32x16_bf16 v[224:239], a[244:247], v[40:43], v[224:239]
  ds_read_b128 a[240:243], v241 offset:20480
  v_fma_f32 v245, v245, v243, v243
  v_fma_f32 v246, v246, v243, v243
  v_fma_f32 v247, v247, v243, v243
  v_rcp_f32 v244, v244
  v_mfma_f32_32x32x16_bf16 v[208:223], a[248:251], v[44:47], v[208:223]
  ds_read_b128 a[244:247], v241 offset:21504
  v_rcp_f32 v245, v245
  v_rcp_f32 v246, v246
  v_mfma_f32_32x32x16_bf16 v[224:239], a[252:255], v[44:47], v[224:239]
  ds_read_b128 a[248:251], v241 offset:22528
  v_rcp_f32 v247, v247
  v_mul_f32 v148, v148, v244
  v_mul_f32 v149, v149, v245
  s_waitcnt lgkmcnt(3)
  v_mfma_f32_32x32x16_bf16 v[208:223], a[224:227], v[48:51], v[208:223]
  ds_read_b128 a[252:255], v241 offset:23552
  v_mul_f32 v150, v150, v246
  v_mul_f32 v151, v151, v247
  v_cvt_pk_bf16_f32 v152, v144, v145
  v_cvt_pk_bf16_f32 v153, v146, v147
  v_cvt_pk_bf16_f32 v154, v148, v149
  v_mfma_f32_32x32x16_bf16 v[224:239], a[228:231], v[48:51], v[224:239]
  ds_read_b128 a[224:227], v241 offset:24576
  v_cvt_pk_bf16_f32 v155, v150, v151
  buffer_store_dwordx4 v[152:155], v0, s[8:11], s6 offen
  v_mul_f32 v244, v242, v160
  v_mul_f32 v245, v242, v161
  v_mul_f32 v246, v242, v162
  v_mfma_f32_32x32x16_bf16 v[208:223], a[232:235], v[52:55], v[208:223]
  ds_read_b128 a[228:231], v241 offset:25600
  v_mul_f32 v247, v242, v163
  v_exp_f32 v244, v244
  v_exp_f32 v245, v245
  v_mfma_f32_32x32x16_bf16 v[224:239], a[236:239], v[52:55], v[224:239]
  ds_read_b128 a[232:235], v241 offset:26624
  v_exp_f32 v246, v246
  v_exp_f32 v247, v247
  s_waitcnt lgkmcnt(3)
  v_mfma_f32_32x32x16_bf16 v[208:223], a[240:243], v[56:59], v[208:223]
  ds_read_b128 a[236:239], v241 offset:27648
  v_mul_f32 v160, v160, v168
  v_mul_f32 v161, v161, v169
  v_mul_f32 v162, v162, v170
  v_mul_f32 v163, v163, v171
  v_fma_f32 v244, v244, v243, v243
  v_mfma_f32_32x32x16_bf16 v[224:239], a[244:247], v[56:59], v[224:239]
  ds_read_b128 a[240:243], v241 offset:28672
  v_fma_f32 v245, v245, v243, v243
  v_fma_f32 v246, v246, v243, v243
  v_fma_f32 v247, v247, v243, v243
  v_rcp_f32 v244, v244
  v_mfma_f32_32x32x16_bf16 v[208:223], a[248:251], v[60:63], v[208:223]
  ds_read_b128 a[244:247], v241 offset:29696
  v_rcp_f32 v245, v245
  v_rcp_f32 v246, v246
  v_mfma_f32_32x32x16_bf16 v[224:239], a[252:255], v[60:63], v[224:239]
  ds_read_b128 a[248:251], v241 offset:30720
  v_rcp_f32 v247, v247
  v_mul_f32 v160, v160, v244
  v_mul_f32 v161, v161, v245
  s_waitcnt lgkmcnt(3)
  v_mfma_f32_32x32x16_bf16 v[208:223], a[224:227], v[64:67], v[208:223]
  ds_read_b128 a[252:255], v241 offset:31744
  v_mul_f32 v162, v162, v246
  v_mul_f32 v163, v163, v247
  v_mul_f32 v244, v242, v164
  v_mul_f32 v245, v242, v165
  v_mul_f32 v246, v242, v166
  v_mfma_f32_32x32x16_bf16 v[224:239], a[228:231], v[64:67], v[224:239]
  s_waitcnt vmcnt(11)
  s_barrier
  ds_read_b128 a[224:227], v0 offset:0
  v_mul_f32 v247, v242, v167
  v_exp_f32 v244, v244
  v_exp_f32 v245, v245
  v_mfma_f32_32x32x16_bf16 v[208:223], a[232:235], v[68:71], v[208:223]
  ds_read_b128 a[228:231], v0 offset:1024
  v_exp_f32 v246, v246
  v_exp_f32 v247, v247
  v_mul_f32 v164, v164, v172
  v_mfma_f32_32x32x16_bf16 v[224:239], a[236:239], v[68:71], v[224:239]
  ds_read_b128 a[232:235], v0 offset:2048
  v_mul_f32 v165, v165, v173
  v_mul_f32 v166, v166, v174
  v_mul_f32 v167, v167, v175
  v_fma_f32 v244, v244, v243, v243
  s_waitcnt lgkmcnt(3)
  v_mfma_f32_32x32x16_bf16 v[208:223], a[240:243], v[72:75], v[208:223]
  ds_read_b128 a[236:239], v0 offset:3072
  v_fma_f32 v245, v245, v243, v243
  v_fma_f32 v246, v246, v243, v243
  v_fma_f32 v247, v247, v243, v243
  v_rcp_f32 v244, v244
  v_mfma_f32_32x32x16_bf16 v[224:239], a[244:247], v[72:75], v[224:239]
  ds_read_b128 a[240:243], v0 offset:4096
  v_rcp_f32 v245, v245
  v_rcp_f32 v246, v246
  v_mfma_f32_32x32x16_bf16 v[208:223], a[248:251], v[76:79], v[208:223]
  ds_read_b128 a[244:247], v0 offset:5120
  v_rcp_f32 v247, v247
  v_mul_f32 v164, v164, v244
  v_mul_f32 v165, v165, v245
  v_mul_f32 v166, v166, v246
  v_mfma_f32_32x32x16_bf16 v[224:239], a[252:255], v[76:79], v[224:239]
  ds_read_b128 a[248:251], v0 offset:6144
  v_mul_f32 v167, v167, v247
  v_cvt_pk_bf16_f32 v168, v160, v161
  v_cvt_pk_bf16_f32 v169, v162, v163
  v_cvt_pk_bf16_f32 v170, v164, v165
  s_waitcnt lgkmcnt(3)
  v_mfma_f32_32x32x16_bf16 v[208:223], a[224:227], v[80:83], v[208:223]
  ds_read_b128 a[252:255], v0 offset:7168
  v_cvt_pk_bf16_f32 v171, v166, v167
  buffer_store_dwordx4 v[168:171], v0, s[8:11], s6 offen offset:1024
  v_mul_f32 v244, v242, v176
  v_mul_f32 v245, v242, v177
  v_mul_f32 v246, v242, v178
  v_mfma_f32_32x32x16_bf16 v[224:239], a[228:231], v[80:83], v[224:239]
  ds_read_b128 a[224:227], v0 offset:8192
  v_mul_f32 v247, v242, v179
  v_exp_f32 v244, v244
  v_exp_f32 v245, v245
  v_mfma_f32_32x32x16_bf16 v[208:223], a[232:235], v[84:87], v[208:223]
  ds_read_b128 a[228:231], v0 offset:9216
  v_exp_f32 v246, v246
  v_exp_f32 v247, v247
  v_mul_f32 v176, v176, v184
  v_mfma_f32_32x32x16_bf16 v[224:239], a[236:239], v[84:87], v[224:239]
  ds_read_b128 a[232:235], v0 offset:10240
  v_mul_f32 v177, v177, v185
  v_mul_f32 v178, v178, v186
  v_mul_f32 v179, v179, v187
  v_fma_f32 v244, v244, v243, v243
  s_waitcnt lgkmcnt(3)
  v_mfma_f32_32x32x16_bf16 v[208:223], a[240:243], v[88:91], v[208:223]
  ds_read_b128 a[236:239], v0 offset:11264
  v_fma_f32 v245, v245, v243, v243
  v_fma_f32 v246, v246, v243, v243
  v_fma_f32 v247, v247, v243, v243
  v_rcp_f32 v244, v244
  v_mfma_f32_32x32x16_bf16 v[224:239], a[244:247], v[88:91], v[224:239]
  ds_read_b128 a[240:243], v0 offset:12288
  v_rcp_f32 v245, v245
  v_rcp_f32 v246, v246
  v_mfma_f32_32x32x16_bf16 v[208:223], a[248:251], v[92:95], v[208:223]
  ds_read_b128 a[244:247], v0 offset:13312
  v_rcp_f32 v247, v247
  v_mul_f32 v176, v176, v244
  v_mul_f32 v177, v177, v245
  v_mul_f32 v178, v178, v246
  v_mfma_f32_32x32x16_bf16 v[224:239], a[252:255], v[92:95], v[224:239]
  ds_read_b128 a[248:251], v0 offset:14336
  v_mul_f32 v179, v179, v247
  v_mul_f32 v244, v242, v180
  v_mul_f32 v245, v242, v181
  v_mul_f32 v246, v242, v182
  s_waitcnt lgkmcnt(3)
  v_mfma_f32_32x32x16_bf16 v[208:223], a[224:227], v[96:99], v[208:223]
  ds_read_b128 a[252:255], v0 offset:15360
  v_mul_f32 v247, v242, v183
  v_exp_f32 v244, v244
  v_exp_f32 v245, v245
  v_mfma_f32_32x32x16_bf16 v[224:239], a[228:231], v[96:99], v[224:239]
  ds_read_b128 a[224:227], v0 offset:16384
  v_exp_f32 v246, v246
  v_exp_f32 v247, v247
  v_mul_f32 v180, v180, v188
  v_mfma_f32_32x32x16_bf16 v[208:223], a[232:235], v[100:103], v[208:223]
  ds_read_b128 a[228:231], v0 offset:17408
  v_mul_f32 v181, v181, v189
  v_mul_f32 v182, v182, v190
  v_mul_f32 v183, v183, v191
  v_fma_f32 v244, v244, v243, v243
  v_fma_f32 v245, v245, v243, v243
  v_mfma_f32_32x32x16_bf16 v[224:239], a[236:239], v[100:103], v[224:239]
  ds_read_b128 a[232:235], v0 offset:18432
  v_fma_f32 v246, v246, v243, v243
  v_fma_f32 v247, v247, v243, v243
  v_rcp_f32 v244, v244
  s_waitcnt lgkmcnt(3)
  v_mfma_f32_32x32x16_bf16 v[208:223], a[240:243], v[104:107], v[208:223]
  ds_read_b128 a[236:239], v0 offset:19456
  v_rcp_f32 v245, v245
  v_rcp_f32 v246, v246
  v_mfma_f32_32x32x16_bf16 v[224:239], a[244:247], v[104:107], v[224:239]
  ds_read_b128 a[240:243], v0 offset:20480
  v_rcp_f32 v247, v247
  v_mul_f32 v180, v180, v244
  v_mul_f32 v181, v181, v245
  v_mul_f32 v182, v182, v246
  v_mfma_f32_32x32x16_bf16 v[208:223], a[248:251], v[108:111], v[208:223]
  ds_read_b128 a[244:247], v0 offset:21504
  v_mul_f32 v183, v183, v247
  v_cvt_pk_bf16_f32 v184, v176, v177
  v_cvt_pk_bf16_f32 v185, v178, v179
  v_cvt_pk_bf16_f32 v186, v180, v181
  v_cvt_pk_bf16_f32 v187, v182, v183
  v_mfma_f32_32x32x16_bf16 v[224:239], a[252:255], v[108:111], v[224:239]
  ds_read_b128 a[248:251], v0 offset:22528
  buffer_store_dwordx4 v[184:187], v0, s[8:11], s6 offen offset:2048
  v_mul_f32 v244, v242, v192
  v_mul_f32 v245, v242, v193
  v_mul_f32 v246, v242, v194
  s_waitcnt lgkmcnt(3)
  v_mfma_f32_32x32x16_bf16 v[208:223], a[224:227], v[112:115], v[208:223]
  ds_read_b128 a[252:255], v0 offset:23552
  v_mul_f32 v247, v242, v195
  v_exp_f32 v244, v244
  v_exp_f32 v245, v245
  v_mfma_f32_32x32x16_bf16 v[224:239], a[228:231], v[112:115], v[224:239]
  ds_read_b128 a[224:227], v0 offset:24576
  v_exp_f32 v246, v246
  v_exp_f32 v247, v247
  v_mul_f32 v192, v192, v200
  v_mfma_f32_32x32x16_bf16 v[208:223], a[232:235], v[116:119], v[208:223]
  ds_read_b128 a[228:231], v0 offset:25600
  v_mul_f32 v193, v193, v201
  v_mul_f32 v194, v194, v202
  v_mul_f32 v195, v195, v203
  v_fma_f32 v244, v244, v243, v243
  v_fma_f32 v245, v245, v243, v243
  v_mfma_f32_32x32x16_bf16 v[224:239], a[236:239], v[116:119], v[224:239]
  ds_read_b128 a[232:235], v0 offset:26624
  v_fma_f32 v246, v246, v243, v243
  v_fma_f32 v247, v247, v243, v243
  v_rcp_f32 v244, v244
  s_waitcnt lgkmcnt(3)
  v_mfma_f32_32x32x16_bf16 v[208:223], a[240:243], v[120:123], v[208:223]
  ds_read_b128 a[236:239], v0 offset:27648
  v_rcp_f32 v245, v245
  v_rcp_f32 v246, v246
  v_mfma_f32_32x32x16_bf16 v[224:239], a[244:247], v[120:123], v[224:239]
  ds_read_b128 a[240:243], v0 offset:28672
  v_rcp_f32 v247, v247
  v_mul_f32 v192, v192, v244
  v_mul_f32 v193, v193, v245
  v_mul_f32 v194, v194, v246
  v_mfma_f32_32x32x16_bf16 v[208:223], a[248:251], v[124:127], v[208:223]
  ds_read_b128 a[244:247], v0 offset:29696
  v_mul_f32 v195, v195, v247
  v_mul_f32 v244, v242, v196
  v_mul_f32 v245, v242, v197
  v_mul_f32 v246, v242, v198
  v_mul_f32 v247, v242, v199
  v_mfma_f32_32x32x16_bf16 v[224:239], a[252:255], v[124:127], v[224:239]
  ds_read_b128 a[248:251], v0 offset:30720
  v_exp_f32 v244, v244
  v_exp_f32 v245, v245
  s_waitcnt lgkmcnt(3)
  v_mfma_f32_32x32x16_bf16 v[208:223], a[224:227], v[128:131], v[208:223]
  ds_read_b128 a[252:255], v0 offset:31744
  v_exp_f32 v246, v246
  v_exp_f32 v247, v247
  v_mul_f32 v196, v196, v204
  v_mfma_f32_32x32x16_bf16 v[224:239], a[228:231], v[128:131], v[224:239]
  s_waitcnt vmcnt(5)
  s_barrier
  ds_read_b128 a[224:227], v0 offset:32768
  v_mul_f32 v197, v197, v205
  v_mul_f32 v198, v198, v206
  v_mul_f32 v199, v199, v207
  v_fma_f32 v244, v244, v243, v243
  v_fma_f32 v245, v245, v243, v243
  v_mfma_f32_32x32x16_bf16 v[208:223], a[232:235], v[132:135], v[208:223]
  ds_read_b128 a[228:231], v0 offset:33792
  v_fma_f32 v246, v246, v243, v243
  v_fma_f32 v247, v247, v243, v243
  v_rcp_f32 v244, v244
  v_mfma_f32_32x32x16_bf16 v[224:239], a[236:239], v[132:135], v[224:239]
  ds_read_b128 a[232:235], v0 offset:34816
  v_rcp_f32 v245, v245
  v_rcp_f32 v246, v246
  s_waitcnt lgkmcnt(3)
  v_mfma_f32_32x32x16_bf16 v[208:223], a[240:243], v[136:139], v[208:223]
  ds_read_b128 a[236:239], v0 offset:35840
  v_rcp_f32 v247, v247
  v_mul_f32 v196, v196, v244
  v_mul_f32 v197, v197, v245
  v_mul_f32 v198, v198, v246
  v_mfma_f32_32x32x16_bf16 v[224:239], a[244:247], v[136:139], v[224:239]
  ds_read_b128 a[240:243], v0 offset:36864
  v_mul_f32 v199, v199, v247
  v_cvt_pk_bf16_f32 v200, v192, v193
  v_cvt_pk_bf16_f32 v201, v194, v195
  v_cvt_pk_bf16_f32 v202, v196, v197
  v_cvt_pk_bf16_f32 v203, v198, v199
  v_mfma_f32_32x32x16_bf16 v[208:223], a[248:251], v[140:143], v[208:223]
  ds_read_b128 a[244:247], v0 offset:37888
  buffer_store_dwordx4 v[200:203], v0, s[8:11], s6 offen offset:3072
  v_mfma_f32_32x32x16_bf16 v[224:239], a[252:255], v[140:143], v[224:239]
  ds_read_b128 a[248:251], v0 offset:38912
  v_mfma_f32_32x32x16_bf16 v[144:159], v[252:255], v[248:251], 0
  s_waitcnt lgkmcnt(3)
  v_mfma_f32_32x32x16_bf16 v[144:159], a[224:227], v[16:19], v[144:159]
  ds_read_b128 a[252:255], v0 offset:39936
  v_mfma_f32_32x32x16_bf16 v[144:159], a[228:231], v[20:23], v[144:159]
  ds_read_b128 a[224:227], v0 offset:40960
  v_mfma_f32_32x32x16_bf16 v[144:159], a[232:235], v[24:27], v[144:159]
  ds_read_b128 a[228:231], v0 offset:41984
  v_mul_f32 v244, v242, v208
  v_mul_f32 v245, v242, v209
  v_mul_f32 v246, v242, v210
  v_mul_f32 v247, v242, v211
  v_mfma_f32_32x32x16_bf16 v[144:159], a[236:239], v[28:31], v[144:159]
  ds_read_b128 a[232:235], v0 offset:43008
  v_exp_f32 v244, v244
  v_exp_f32 v245, v245
  s_waitcnt lgkmcnt(3)
  v_mfma_f32_32x32x16_bf16 v[144:159], a[240:243], v[32:35], v[144:159]
  ds_read_b128 a[236:239], v0 offset:44032
  v_exp_f32 v246, v246
  v_exp_f32 v247, v247
  v_mul_f32 v208, v208, v216
  s_waitcnt vmcnt(0)
  v_mov_b32 v5, 3
  s_cmp_lg_u32 s45, 0
  s_cbranch_scc1 L_slow_148
  s_mov_b64 exec, 16
  buffer_store_dword v5, v3, s[8:11], 0 offen
  s_mov_b64 exec, -1
L_join_149:
  v_mfma_f32_32x32x16_bf16 v[144:159], a[244:247], v[36:39], v[144:159]
  ds_read_b128 a[240:243], v0 offset:45056
  v_mul_f32 v209, v209, v217
  v_mul_f32 v210, v210, v218
  v_mul_f32 v211, v211, v219
  v_fma_f32 v244, v244, v243, v243
  v_fma_f32 v245, v245, v243, v243
  v_and_b32 v4, 28, v1
  v_mfma_f32_32x32x16_bf16 v[144:159], a[248:251], v[40:43], v[144:159]
  ds_read_b128 a[244:247], v0 offset:46080
  v_fma_f32 v246, v246, v243, v243
  v_fma_f32 v247, v247, v243, v243
  v_rcp_f32 v244, v244
  s_lshr_b32 s50, s41, 1
  s_lshl_b32 s50, s50, 2
  v_mfma_f32_32x32x16_bf16 v[144:159], a[252:255], v[44:47], v[144:159]
  ds_read_b128 a[248:251], v0 offset:47104
  v_rcp_f32 v245, v245
  v_rcp_f32 v246, v246
  s_add_u32 s50, s50, s38
  s_lshl_b32 s50, s50, 7
  s_waitcnt lgkmcnt(3)
  v_mfma_f32_32x32x16_bf16 v[144:159], a[224:227], v[48:51], v[144:159]
  ds_read_b128 a[252:255], v0 offset:48128
  v_rcp_f32 v247, v247
  v_mul_f32 v208, v208, v244
  v_mul_f32 v209, v209, v245
  v_mul_f32 v210, v210, v246
  s_add_u32 s50, s50, 32768
  s_mul_i32 s53, s38, 28672
  v_mfma_f32_32x32x16_bf16 v[144:159], a[228:231], v[52:55], v[144:159]
  ds_read_b128 a[224:227], v0 offset:49152
  v_mul_f32 v211, v211, v247
  v_mul_f32 v244, v242, v212
  v_mul_f32 v245, v242, v213
  v_mul_f32 v246, v242, v214
  v_mul_f32 v247, v242, v215
  s_add_u32 s53, s53, 14680064
  s_mul_i32 s51, s42, 114688
  v_mfma_f32_32x32x16_bf16 v[144:159], a[232:235], v[56:59], v[144:159]
  ds_read_b128 a[228:231], v0 offset:50176
  v_exp_f32 v244, v244
  v_exp_f32 v245, v245
  s_add_u32 s51, s51, s53
  s_mul_i32 s52, s41, 114688
  v_mfma_f32_32x32x16_bf16 v[144:159], a[236:239], v[60:63], v[144:159]
  ds_read_b128 a[232:235], v0 offset:51200
  v_exp_f32 v246, v246
  v_exp_f32 v247, v247
  s_add_u32 s52, s52, s53
  s_waitcnt lgkmcnt(3)
  v_mfma_f32_32x32x16_bf16 v[144:159], a[240:243], v[64:67], v[144:159]
  ds_read_b128 a[236:239], v0 offset:52224
  v_mul_f32 v212, v212, v220
  v_mul_f32 v213, v213, v221
  v_mul_f32 v214, v214, v222
  v_mul_f32 v215, v215, v223
  v_fma_f32 v244, v244, v243, v243
  v_mfma_f32_32x32x16_bf16 v[144:159], a[244:247], v[68:71], v[144:159]
  ds_read_b128 a[240:243], v0 offset:53248
  v_fma_f32 v245, v245, v243, v243
  v_fma_f32 v246, v246, v243, v243
  v_fma_f32 v247, v247, v243, v243
  v_rcp_f32 v244, v244
  v_mfma_f32_32x32x16_bf16 v[144:159], a[248:251], v[72:75], v[144:159]
  ds_read_b128 a[244:247], v0 offset:54272
  v_rcp_f32 v245, v245
  v_rcp_f32 v246, v246
  buffer_load_dword v5, v4, s[8:11], s50 offen sc1
  v_mfma_f32_32x32x16_bf16 v[144:159], a[252:255], v[76:79], v[144:159]
  ds_read_b128 a[248:251], v0 offset:55296
  v_rcp_f32 v247, v247
  v_mul_f32 v212, v212, v244
  v_mul_f32 v213, v213, v245
  s_waitcnt lgkmcnt(3)
  v_mfma_f32_32x32x16_bf16 v[144:159], a[224:227], v[80:83], v[144:159]
  ds_read_b128 a[252:255], v0 offset:56320
  v_mul_f32 v214, v214, v246
  v_mul_f32 v215, v215, v247
  v_cvt_pk_bf16_f32 v216, v208, v209
  v_cvt_pk_bf16_f32 v217, v210, v211
  v_cvt_pk_bf16_f32 v218, v212, v213
  v_mfma_f32_32x32x16_bf16 v[144:159], a[228:231], v[84:87], v[144:159]
  ds_read_b128 a[224:227], v0 offset:57344
  v_cvt_pk_bf16_f32 v219, v214, v215
  buffer_store_dwordx4 v[216:219], v0, s[8:11], s7 offen
  v_mul_f32 v244, v242, v224
  v_mul_f32 v245, v242, v225
  v_mul_f32 v246, v242, v226
  v_mfma_f32_32x32x16_bf16 v[144:159], a[232:235], v[88:91], v[144:159]
  ds_read_b128 a[228:231], v0 offset:58368
  v_mul_f32 v247, v242, v227
  v_exp_f32 v244, v244
  v_exp_f32 v245, v245
  v_mfma_f32_32x32x16_bf16 v[144:159], a[236:239], v[92:95], v[144:159]
  ds_read_b128 a[232:235], v0 offset:59392
  v_exp_f32 v246, v246
  v_exp_f32 v247, v247
  s_waitcnt lgkmcnt(3)
  v_mfma_f32_32x32x16_bf16 v[144:159], a[240:243], v[96:99], v[144:159]
  ds_read_b128 a[236:239], v0 offset:60416
  v_mul_f32 v224, v224, v232
  v_mul_f32 v225, v225, v233
  v_mul_f32 v226, v226, v234
  v_mul_f32 v227, v227, v235
  v_fma_f32 v244, v244, v243, v243
  v_mfma_f32_32x32x16_bf16 v[144:159], a[244:247], v[100:103], v[144:159]
  ds_read_b128 a[240:243], v0 offset:61440
  v_fma_f32 v245, v245, v243, v243
  v_fma_f32 v246, v246, v243, v243
  v_fma_f32 v247, v247, v243, v243
  v_rcp_f32 v244, v244
  v_mfma_f32_32x32x16_bf16 v[144:159], a[248:251], v[104:107], v[144:159]
  ds_read_b128 a[244:247], v0 offset:62464
  v_rcp_f32 v245, v245
  v_rcp_f32 v246, v246
  s_waitcnt vmcnt(1)
  v_cmp_gt_u32 vcc, 3, v5
  s_nop 0
  s_cbranch_vccnz L_lslow_150
L_ljoin_151:
  s_cmp_lg_u32 s45, 0
  s_cbranch_scc1 L_slow_153
L_join_154:
  s_add_u32 s53, s51, 0
  buffer_load_dwordx4 v[16:19], v0, s[8:11], s53 offen sc1
  v_mfma_f32_32x32x16_bf16 v[144:159], a[252:255], v[108:111], v[144:159]
  ds_read_b128 a[248:251], v0 offset:63488
  v_rcp_f32 v247, v247
  v_mul_f32 v224, v224, v244
  v_mul_f32 v225, v225, v245
  buffer_load_dwordx4 v[20:23], v0, s[8:11], s53 offen offset:1024 sc1
  s_waitcnt lgkmcnt(3)
  v_mfma_f32_32x32x16_bf16 v[144:159], a[224:227], v[112:115], v[144:159]
  ds_read_b128 a[252:255], v0 offset:64512
  v_mul_f32 v226, v226, v246
  v_mul_f32 v227, v227, v247
  v_mul_f32 v244, v242, v228
  v_mul_f32 v245, v242, v229
  v_mul_f32 v246, v242, v230
  buffer_load_dwordx4 v[24:27], v0, s[8:11], s53 offen offset:2048 sc1
  v_mfma_f32_32x32x16_bf16 v[144:159], a[228:231], v[116:119], v[144:159]
  v_mul_f32 v247, v242, v231
  v_exp_f32 v244, v244
  v_exp_f32 v245, v245
  buffer_load_dwordx4 v[28:31], v0, s[8:11], s53 offen offset:3072 sc1
  v_mfma_f32_32x32x16_bf16 v[144:159], a[232:235], v[120:123], v[144:159]
  v_exp_f32 v246, v246
  v_exp_f32 v247, v247
  v_mul_f32 v228, v228, v236
  s_add_u32 s53, s51, 7168
  buffer_load_dwordx4 v[32:35], v0, s[8:11], s53 offen sc1
  v_mfma_f32_32x32x16_bf16 v[144:159], a[236:239], v[124:127], v[144:159]
  v_mul_f32 v229, v229, v237
  v_mul_f32 v230, v230, v238
  v_mul_f32 v231, v231, v239
  v_fma_f32 v244, v244, v243, v243
  buffer_load_dwordx4 v[36:39], v0, s[8:11], s53 offen offset:1024 sc1
  s_waitcnt lgkmcnt(0)
  v_mfma_f32_32x32x16_bf16 v[144:159], a[240:243], v[128:131], v[144:159]
  v_fma_f32 v245, v245, v243, v243
  v_fma_f32 v246, v246, v243, v243
  v_fma_f32 v247, v247, v243, v243
  v_rcp_f32 v244, v244
  buffer_load_dwordx4 v[40:43], v0, s[8:11], s53 offen offset:2048 sc1
  v_mfma_f32_32x32x16_bf16 v[144:159], a[244:247], v[132:135], v[144:159]
  v_rcp_f32 v245, v245
  v_rcp_f32 v246, v246
  buffer_load_dwordx4 v[44:47], v0, s[8:11], s53 offen offset:3072 sc1
  v_mfma_f32_32x32x16_bf16 v[144:159], a[248:251], v[136:139], v[144:159]
  v_rcp_f32 v247, v247
  v_mul_f32 v228, v228, v244
  v_mul_f32 v229, v229, v245
  v_mul_f32 v230, v230, v246
  s_add_u32 s53, s51, 14336
  buffer_load_dwordx4 v[48:51], v0, s[8:11], s53 offen sc1
  v_mfma_f32_32x32x16_bf16 v[144:159], a[252:255], v[140:143], v[144:159]
  v_mul_f32 v231, v231, v247
  v_cvt_pk_bf16_f32 v232, v224, v225
  v_cvt_pk_bf16_f32 v233, v226, v227
  v_cvt_pk_bf16_f32 v234, v228, v229
  buffer_load_dwordx4 v[52:55], v0, s[8:11], s53 offen offset:1024 sc1
  v_cvt_pk_bf16_f32 v235, v230, v231
  buffer_store_dwordx4 v[232:235], v0, s[8:11], s7 offen offset:1024
  s_barrier
  s_waitcnt vmcnt(10)
  v_mfma_f32_32x32x16_bf16 v[192:207], a[4:7], v[16:19], 0
  s_nop 1
  v_mul_f32 v244, v242, v144
  v_mul_f32 v245, v242, v145
  v_mul_f32 v246, v242, v146
  v_mul_f32 v247, v242, v147
  v_mfma_f32_32x32x16_bf16 v[208:223], a[0:3], v[16:19], 0
  v_exp_f32 v244, v244
  v_exp_f32 v245, v245
  buffer_load_dwordx4 v[56:59], v0, s[8:11], s53 offen offset:2048 sc1
  s_waitcnt vmcnt(10)
  v_mfma_f32_32x32x16_bf16 v[192:207], a[12:15], v[20:23], v[192:207]
  v_exp_f32 v246, v246
  v_exp_f32 v247, v247
  v_mul_f32 v144, v144, v152
  v_mfma_f32_32x32x16_bf16 v[208:223], a[8:11], v[20:23], v[208:223]
  v_mul_f32 v145, v145, v153
  v_mul_f32 v146, v146, v154
  v_mul_f32 v147, v147, v155
  v_fma_f32 v244, v244, v243, v243
  v_fma_f32 v245, v245, v243, v243
  buffer_load_dwordx4 v[60:63], v0, s[8:11], s53 offen offset:3072 sc1
  s_waitcnt vmcnt(10)
  v_mfma_f32_32x32x16_bf16 v[192:207], a[20:23], v[24:27], v[192:207]
  v_fma_f32 v246, v246, v243, v243
  v_fma_f32 v247, v247, v243, v243
  v_rcp_f32 v244, v244
  v_mfma_f32_32x32x16_bf16 v[208:223], a[16:19], v[24:27], v[208:223]
  v_rcp_f32 v245, v245
  v_rcp_f32 v246, v246
  s_add_u32 s53, s51, 21504
  buffer_load_dwordx4 v[64:67], v0, s[8:11], s53 offen sc1
  s_waitcnt vmcnt(10)
  v_mfma_f32_32x32x16_bf16 v[192:207], a[28:31], v[28:31], v[192:207]
  v_rcp_f32 v247, v247
  v_mul_f32 v144, v144, v244
  v_mul_f32 v145, v145, v245
  v_mul_f32 v146, v146, v246
  v_mfma_f32_32x32x16_bf16 v[208:223], a[24:27], v[28:31], v[208:223]
  v_mul_f32 v147, v147, v247
  v_mul_f32 v244, v242, v148
  v_mul_f32 v245, v242, v149
  v_mul_f32 v246, v242, v150
  v_mul_f32 v247, v242, v151
  buffer_load_dwordx4 v[68:71], v0, s[8:11], s53 offen offset:1024 sc1
  s_waitcnt vmcnt(10)
  v_mfma_f32_32x32x16_bf16 v[192:207], a[60:63], v[32:35], v[192:207]
  v_exp_f32 v244, v244
  v_exp_f32 v245, v245
  v_mfma_f32_32x32x16_bf16 v[208:223], a[56:59], v[32:35], v[208:223]
  v_exp_f32 v246, v246
  v_exp_f32 v247, v247
  v_mul_f32 v148, v148, v156
  buffer_load_dwordx4 v[72:75], v0, s[8:11], s53 offen offset:2048 sc1
  s_waitcnt vmcnt(10)
  v_mfma_f32_32x32x16_bf16 v[192:207], a[68:71], v[36:39], v[192:207]
  v_mul_f32 v149, v149, v157
  v_mul_f32 v150, v150, v158
  v_mul_f32 v151, v151, v159
  v_fma_f32 v244, v244, v243, v243
  v_fma_f32 v245, v245, v243, v243
  v_mfma_f32_32x32x16_bf16 v[208:223], a[64:67], v[36:39], v[208:223]
  v_fma_f32 v246, v246, v243, v243
  v_fma_f32 v247, v247, v243, v243
  v_rcp_f32 v244, v244
  buffer_load_dwordx4 v[76:79], v0, s[8:11], s53 offen offset:3072 sc1
  s_waitcnt vmcnt(10)
  v_mfma_f32_32x32x16_bf16 v[192:207], a[76:79], v[40:43], v[192:207]
  v_rcp_f32 v245, v245
  v_rcp_f32 v246, v246
  v_mfma_f32_32x32x16_bf16 v[208:223], a[72:75], v[40:43], v[208:223]
  v_rcp_f32 v247, v247
  v_mul_f32 v148, v148, v244
  v_mul_f32 v149, v149, v245
  v_mul_f32 v150, v150, v246
  s_add_u32 s53, s52, 0
  buffer_load_dwordx4 v[80:83], v0, s[8:11], s53 offen sc1
  s_waitcnt vmcnt(10)
  v_mfma_f32_32x32x16_bf16 v[192:207], a[84:87], v[44:47], v[192:207]
  v_mul_f32 v151, v151, v247
  v_cvt_pk_bf16_f32 v152, v144, v145
  v_cvt_pk_bf16_f32 v153, v146, v147
  v_cvt_pk_bf16_f32 v154, v148, v149
  v_cvt_pk_bf16_f32 v155, v150, v151
  v_mfma_f32_32x32x16_bf16 v[208:223], a[80:83], v[44:47], v[208:223]
  buffer_store_dwordx4 v[152:155], v0, s[8:11], s7 offen offset:2048
  buffer_load_dwordx4 v[84:87], v0, s[8:11], s53 offen offset:1024 sc1
  s_waitcnt vmcnt(11)
  v_mfma_f32_32x32x16_bf16 v[192:207], a[116:119], v[48:51], v[192:207]
  s_mul_i32 s54, s38, 12288
  s_add_u32 s54, s54, 0
  v_add_u32 v6, s54, v0
  v_mfma_f32_32x32x16_bf16 v[208:223], a[112:115], v[48:51], v[208:223]
  v_lshlrev_b32 v176, 16, v8
  v_and_b32 v177, s47, v8
  buffer_load_dwordx4 v[88:91], v0, s[8:11], s53 offen offset:2048 sc1
  s_waitcnt vmcnt(11)
  v_mfma_f32_32x32x16_bf16 v[192:207], a[124:127], v[52:55], v[192:207]
  v_lshlrev_b32 v178, 16, v9
  v_and_b32 v179, s47, v9
  v_mfma_f32_32x32x16_bf16 v[208:223], a[120:123], v[52:55], v[208:223]
  v_lshlrev_b32 v180, 16, v10
  v_and_b32 v181, s47, v10
  buffer_load_dwordx4 v[92:95], v0, s[8:11], s53 offen offset:3072 sc1
  s_waitcnt vmcnt(10)
  v_mfma_f32_32x32x16_bf16 v[192:207], a[132:135], v[56:59], v[192:207]
  v_lshlrev_b32 v182, 16, v11
  v_and_b32 v183, s47, v11
  v_mfma_f32_32x32x16_bf16 v[208:223], a[128:131], v[56:59], v[208:223]
  v_lshlrev_b32 v184, 16, v12
  v_and_b32 v185, s47, v12
  s_add_u32 s53, s52, 7168
  buffer_load_dwordx4 v[96:99], v0, s[8:11], s53 offen sc1
  s_waitcnt vmcnt(10)
  v_mfma_f32_32x32x16_bf16 v[192:207], a[140:143], v[60:63], v[192:207]
  v_lshlrev_b32 v186, 16, v13
  v_and_b32 v187, s47, v13
  v_mfma_f32_32x32x16_bf16 v[208:223], a[136:139], v[60:63], v[208:223]
  v_lshlrev_b32 v188, 16, v14
  v_and_b32 v189, s47, v14
  buffer_load_dwordx4 v[100:103], v0, s[8:11], s53 offen offset:1024 sc1
  s_waitcnt vmcnt(10)
  v_mfma_f32_32x32x16_bf16 v[192:207], a[172:175], v[64:67], v[192:207]
  v_lshlrev_b32 v190, 16, v15
  v_and_b32 v191, s47, v15
  v_mfma_f32_32x32x16_bf16 v[208:223], a[168:171], v[64:67], v[208:223]
  s_lshl_b32 s48, s44, 1
  s_add_u32 s48, s48, s43
  s_mov_b32 s16, s78
  s_mov_b32 s17, s79
  s_mov_b32 s18, 2097152
  s_mov_b32 s19, 0x20000
  buffer_load_dwordx4 v[104:107], v0, s[8:11], s53 offen offset:2048 sc1
  s_waitcnt vmcnt(10)
  v_mfma_f32_32x32x16_bf16 v[192:207], a[180:183], v[68:71], v[192:207]
  v_bfe_u32 v7, v0, 4, 5
  v_lshlrev_b32 v7, 10, v7
  v_mfma_f32_32x32x16_bf16 v[208:223], a[176:179], v[68:71], v[208:223]
  v_lshrrev_b32 v2, 9, v0
  v_lshl_add_u32 v7, v2, 4, v7
  s_waitcnt vmcnt(6)
  v_mov_b32 v5, 4
  s_cmp_lg_u32 s45, 0
  s_cbranch_scc1 L_slow_155
  s_mov_b64 exec, 16
  buffer_store_dword v5, v3, s[8:11], 0 offen
  s_mov_b64 exec, -1
L_join_156:
  buffer_load_dwordx4 v[108:111], v0, s[8:11], s53 offen offset:3072 sc1
  v_mfma_f32_32x32x16_bf16 v[192:207], a[188:191], v[72:75], v[192:207]
  s_lshl_b32 s55, s41, 15
  s_lshl_b32 s56, s48, 6
  s_add_u32 s55, s55, s56
  v_mfma_f32_32x32x16_bf16 v[208:223], a[184:187], v[72:75], v[208:223]
  s_add_u32 s53, s52, 14336
  buffer_load_dwordx4 v[112:115], v0, s[8:11], s53 offen sc1
  v_mfma_f32_32x32x16_bf16 v[192:207], a[196:199], v[76:79], v[192:207]
  v_mfma_f32_32x32x16_bf16 v[208:223], a[192:195], v[76:79], v[208:223]
  buffer_load_dwordx4 v[116:119], v0, s[8:11], s53 offen offset:1024 sc1
  v_mfma_f32_32x32x16_bf16 v[224:239], a[4:7], v[80:83], 0
  v_mfma_f32_32x32x16_bf16 v[240:255], a[0:3], v[80:83], 0
  buffer_load_dwordx4 v[120:123], v0, s[8:11], s53 offen offset:2048 sc1
  s_waitcnt vmcnt(10)
  v_mfma_f32_32x32x16_bf16 v[224:239], a[12:15], v[84:87], v[224:239]
  v_mfma_f32_32x32x16_bf16 v[240:255], a[8:11], v[84:87], v[240:255]
  buffer_load_dwordx4 v[124:127], v0, s[8:11], s53 offen offset:3072 sc1
  s_waitcnt vmcnt(10)
  v_mfma_f32_32x32x16_bf16 v[224:239], a[20:23], v[88:91], v[224:239]
  v_mfma_f32_32x32x16_bf16 v[240:255], a[16:19], v[88:91], v[240:255]
  buffer_load_dword v5, v4, s[8:11], s50 offen sc1
  s_add_u32 s53, s52, 21504
  buffer_load_dwordx4 v[128:131], v0, s[8:11], s53 offen sc1
  s_waitcnt vmcnt(11)
  v_mfma_f32_32x32x16_bf16 v[224:239], a[28:31], v[92:95], v[224:239]
  v_mfma_f32_32x32x16_bf16 v[240:255], a[24:27], v[92:95], v[240:255]
  buffer_load_dwordx4 v[132:135], v0, s[8:11], s53 offen offset:1024 sc1
  s_waitcnt vmcnt(11)
  v_mfma_f32_32x32x16_bf16 v[224:239], a[60:63], v[96:99], v[224:239]
  v_mfma_f32_32x32x16_bf16 v[240:255], a[56:59], v[96:99], v[240:255]
  buffer_load_dwordx4 v[136:139], v0, s[8:11], s53 offen offset:2048 sc1
  s_waitcnt vmcnt(11)
  v_mfma_f32_32x32x16_bf16 v[224:239], a[68:71], v[100:103], v[224:239]
  v_mfma_f32_32x32x16_bf16 v[240:255], a[64:67], v[100:103], v[240:255]
  buffer_load_dwordx4 v[140:143], v0, s[8:11], s53 offen offset:3072 sc1
  s_waitcnt vmcnt(11)
  v_mfma_f32_32x32x16_bf16 v[224:239], a[76:79], v[104:107], v[224:239]
  v_mfma_f32_32x32x16_bf16 v[240:255], a[72:75], v[104:107], v[240:255]
  s_waitcnt vmcnt(9)
  v_mfma_f32_32x32x16_bf16 v[224:239], a[84:87], v[108:111], v[224:239]
  v_mfma_f32_32x32x16_bf16 v[240:255], a[80:83], v[108:111], v[240:255]
  s_waitcnt vmcnt(4)
  v_cmp_gt_u32 vcc, 4, v5
  s_nop 0
  s_cbranch_vccnz L_lslow_157
L_ljoin_158:
  s_cmp_lg_u32 s45, 0
  s_cbranch_scc1 L_slow_160
L_join_161:
  s_add_u32 s53, s51, 4096
  buffer_load_dwordx4 v[16:19], v0, s[8:11], s53 offen sc1
  buffer_load_dwordx4 v[20:23], v0, s[8:11], s53 offen offset:1024 sc1
  v_mfma_f32_32x32x16_bf16 v[224:239], a[116:119], v[112:115], v[224:239]
  v_mfma_f32_32x32x16_bf16 v[240:255], a[112:115], v[112:115], v[240:255]
  buffer_load_dwordx4 v[24:27], v0, s[8:11], s53 offen offset:2048 sc1
  v_mfma_f32_32x32x16_bf16 v[224:239], a[124:127], v[116:119], v[224:239]
  v_mfma_f32_32x32x16_bf16 v[240:255], a[120:123], v[116:119], v[240:255]
  s_add_u32 s53, s51, 11264
  buffer_load_dwordx4 v[28:31], v0, s[8:11], s53 offen sc1
  v_mfma_f32_32x32x16_bf16 v[224:239], a[132:135], v[120:123], v[224:239]
  v_mfma_f32_32x32x16_bf16 v[240:255], a[128:131], v[120:123], v[240:255]
  buffer_load_dwordx4 v[32:35], v0, s[8:11], s53 offen offset:1024 sc1
  v_mfma_f32_32x32x16_bf16 v[224:239], a[140:143], v[124:127], v[224:239]
  v_mfma_f32_32x32x16_bf16 v[240:255], a[136:139], v[124:127], v[240:255]
  buffer_load_dwordx4 v[36:39], v0, s[8:11], s53 offen offset:2048 sc1
  s_waitcnt vmcnt(9)
  v_mfma_f32_32x32x16_bf16 v[224:239], a[172:175], v[128:131], v[224:239]
  v_mfma_f32_32x32x16_bf16 v[240:255], a[168:171], v[128:131], v[240:255]
  s_add_u32 s53, s51, 18432
  buffer_load_dwordx4 v[40:43], v0, s[8:11], s53 offen sc1
  s_waitcnt vmcnt(9)
  v_mfma_f32_32x32x16_bf16 v[224:239], a[180:183], v[132:135], v[224:239]
  v_mfma_f32_32x32x16_bf16 v[240:255], a[176:179], v[132:135], v[240:255]
  buffer_load_dwordx4 v[44:47], v0, s[8:11], s53 offen offset:1024 sc1
  s_waitcnt vmcnt(9)
  v_mfma_f32_32x32x16_bf16 v[224:239], a[188:191], v[136:139], v[224:239]
  v_mfma_f32_32x32x16_bf16 v[240:255], a[184:187], v[136:139], v[240:255]
  buffer_load_dwordx4 v[48:51], v0, s[8:11], s53 offen offset:2048 sc1
  s_waitcnt vmcnt(9)
  v_mfma_f32_32x32x16_bf16 v[224:239], a[196:199], v[140:143], v[224:239]
  v_mfma_f32_32x32x16_bf16 v[240:255], a[192:195], v[140:143], v[240:255]
  s_add_u32 s53, s51, 25600
  buffer_load_dwordx4 v[52:55], v0, s[8:11], s53 offen sc1
  s_waitcnt vmcnt(9)
  v_mfma_f32_32x32x16_bf16 v[192:207], a[36:39], v[16:19], v[192:207]
  v_mfma_f32_32x32x16_bf16 v[208:223], a[32:35], v[16:19], v[208:223]
  buffer_load_dwordx4 v[56:59], v0, s[8:11], s53 offen offset:1024 sc1
  s_waitcnt vmcnt(9)
  v_mfma_f32_32x32x16_bf16 v[192:207], a[44:47], v[20:23], v[192:207]
  v_mfma_f32_32x32x16_bf16 v[208:223], a[40:43], v[20:23], v[208:223]
  buffer_load_dwordx4 v[60:63], v0, s[8:11], s53 offen offset:2048 sc1
  s_waitcnt vmcnt(9)
  v_mfma_f32_32x32x16_bf16 v[192:207], a[52:55], v[24:27], v[192:207]
  v_mfma_f32_32x32x16_bf16 v[208:223], a[48:51], v[24:27], v[208:223]
  s_add_u32 s53, s52, 4096
  buffer_load_dwordx4 v[64:67], v0, s[8:11], s53 offen sc1
  s_waitcnt vmcnt(9)
  v_mfma_f32_32x32x16_bf16 v[192:207], a[92:95], v[28:31], v[192:207]
  v_mfma_f32_32x32x16_bf16 v[208:223], a[88:91], v[28:31], v[208:223]
  buffer_load_dwordx4 v[68:71], v0, s[8:11], s53 offen offset:1024 sc1
  s_waitcnt vmcnt(9)
  v_mfma_f32_32x32x16_bf16 v[192:207], a[100:103], v[32:35], v[192:207]
  v_mfma_f32_32x32x16_bf16 v[208:223], a[96:99], v[32:35], v[208:223]
  buffer_load_dwordx4 v[72:75], v0, s[8:11], s53 offen offset:2048 sc1
  s_waitcnt vmcnt(9)
  v_mfma_f32_32x32x16_bf16 v[192:207], a[108:111], v[36:39], v[192:207]
  v_mfma_f32_32x32x16_bf16 v[208:223], a[104:107], v[36:39], v[208:223]
  s_add_u32 s53, s52, 11264
  buffer_load_dwordx4 v[76:79], v0, s[8:11], s53 offen sc1
  s_waitcnt vmcnt(9)
  v_mfma_f32_32x32x16_bf16 v[192:207], a[148:151], v[40:43], v[192:207]
  v_mfma_f32_32x32x16_bf16 v[208:223], a[144:147], v[40:43], v[208:223]
  buffer_load_dwordx4 v[80:83], v0, s[8:11], s53 offen offset:1024 sc1
  s_waitcnt vmcnt(9)
  v_mfma_f32_32x32x16_bf16 v[192:207], a[156:159], v[44:47], v[192:207]
  v_mfma_f32_32x32x16_bf16 v[208:223], a[152:155], v[44:47], v[208:223]
  buffer_load_dwordx4 v[84:87], v0, s[8:11], s53 offen offset:2048 sc1
  s_waitcnt vmcnt(9)
  v_mfma_f32_32x32x16_bf16 v[192:207], a[164:167], v[48:51], v[192:207]
  v_mfma_f32_32x32x16_bf16 v[208:223], a[160:163], v[48:51], v[208:223]
  s_add_u32 s53, s52, 18432
  buffer_load_dwordx4 v[88:91], v0, s[8:11], s53 offen sc1
  s_waitcnt vmcnt(9)
  v_mfma_f32_32x32x16_bf16 v[192:207], a[204:207], v[52:55], v[192:207]
  v_mfma_f32_32x32x16_bf16 v[208:223], a[200:203], v[52:55], v[208:223]
  buffer_load_dwordx4 v[92:95], v0, s[8:11], s53 offen offset:1024 sc1
  s_waitcnt vmcnt(9)
  v_mfma_f32_32x32x16_bf16 v[192:207], a[212:215], v[56:59], v[192:207]
  v_mfma_f32_32x32x16_bf16 v[208:223], a[208:211], v[56:59], v[208:223]
  buffer_load_dwordx4 v[96:99], v0, s[8:11], s53 offen offset:2048 sc1
  s_waitcnt vmcnt(9)
  v_mfma_f32_32x32x16_bf16 v[192:207], a[220:223], v[60:63], v[192:207]
  v_mfma_f32_32x32x16_bf16 v[208:223], a[216:219], v[60:63], v[208:223]
  s_add_u32 s53, s52, 25600
  buffer_load_dwordx4 v[100:103], v0, s[8:11], s53 offen sc1
  s_waitcnt vmcnt(9)
  v_mfma_f32_32x32x16_bf16 v[224:239], a[36:39], v[64:67], v[224:239]
  buffer_load_dwordx4 v[104:107], v0, s[8:11], s53 offen offset:1024 sc1
  s_xor_b32 s54, s38, 3
  s_mul_i32 s54, s54, 12288
  s_add_u32 s54, s54, 8192
  v_add_u32 v4, s54, v0
  s_waitcnt vmcnt(9)
  v_mfma_f32_32x32x16_bf16 v[224:239], a[44:47], v[68:71], v[224:239]
  buffer_load_dwordx4 v[108:111], v0, s[8:11], s53 offen offset:2048 sc1
  s_waitcnt vmcnt(9)
  v_mfma_f32_32x32x16_bf16 v[224:239], a[52:55], v[72:75], v[224:239]
  ds_write_b128 v4, v[192:195] offset:0
  ds_write_b128 v4, v[196:199] offset:1024
  s_waitcnt vmcnt(8)
  v_mfma_f32_32x32x16_bf16 v[224:239], a[92:95], v[76:79], v[224:239]
  ds_write_b128 v4, v[200:203] offset:2048
  ds_write_b128 v4, v[204:207] offset:3072
  s_waitcnt vmcnt(7)
  v_mfma_f32_32x32x16_bf16 v[224:239], a[100:103], v[80:83], v[224:239]
  s_xor_b32 s54, s38, 2
  s_mul_i32 s54, s54, 12288
  s_add_u32 s54, s54, 4096
  v_add_u32 v4, s54, v0
  s_waitcnt vmcnt(6)
  v_mfma_f32_32x32x16_bf16 v[224:239], a[108:111], v[84:87], v[224:239]
  ds_write_b128 v4, v[208:211] offset:0
  ds_write_b128 v4, v[212:215] offset:1024
  s_waitcnt vmcnt(5)
  v_mfma_f32_32x32x16_bf16 v[224:239], a[148:151], v[88:91], v[224:239]
  ds_write_b128 v4, v[216:219] offset:2048
  ds_write_b128 v4, v[220:223] offset:3072
  s_waitcnt vmcnt(4)
  v_mfma_f32_32x32x16_bf16 v[224:239], a[156:159], v[92:95], v[224:239]
  s_waitcnt lgkmcnt(0)
  s_barrier
  s_waitcnt vmcnt(3)
  v_mfma_f32_32x32x16_bf16 v[224:239], a[164:167], v[96:99], v[224:239]
  ds_read_b128 v[144:147], v6 offset:8192
  ds_read_b128 v[148:151], v6 offset:9216
  v_mfma_f32_32x32x16_bf16 v[240:255], a[32:35], v[64:67], v[240:255]
  ds_read_b128 v[152:155], v6 offset:10240
  ds_read_b128 v[156:159], v6 offset:11264
  s_waitcnt vmcnt(2)
  v_mfma_f32_32x32x16_bf16 v[224:239], a[204:207], v[100:103], v[224:239]
  ds_read_b128 v[160:163], v6 offset:4096
  ds_read_b128 v[164:167], v6 offset:5120
  v_mfma_f32_32x32x16_bf16 v[240:255], a[40:43], v[68:71], v[240:255]
  ds_read_b128 v[168:171], v6 offset:6144
  ds_read_b128 v[172:175], v6 offset:7168
  s_waitcnt vmcnt(1)
  v_mfma_f32_32x32x16_bf16 v[224:239], a[212:215], v[104:107], v[224:239]
  s_waitcnt lgkmcnt(7)
  v_add_f32 v176, v176, v144
  v_add_f32 v177, v177, v145
  v_add_f32 v178, v178, v146
  v_add_f32 v179, v179, v147
  s_waitcnt lgkmcnt(6)
  v_add_f32 v180, v180, v148
  v_add_f32 v181, v181, v149
  v_add_f32 v182, v182, v150
  v_add_f32 v183, v183, v151
  v_mfma_f32_32x32x16_bf16 v[240:255], a[48:51], v[72:75], v[240:255]
  s_waitcnt lgkmcnt(5)
  v_add_f32 v184, v184, v152
  v_add_f32 v185, v185, v153
  v_add_f32 v186, v186, v154
  v_add_f32 v187, v187, v155
  s_waitcnt lgkmcnt(4)
  v_add_f32 v188, v188, v156
  v_add_f32 v189, v189, v157
  v_add_f32 v190, v190, v158
  v_add_f32 v191, v191, v159
  s_waitcnt vmcnt(0)
  v_mfma_f32_32x32x16_bf16 v[224:239], a[220:223], v[108:111], v[224:239]
  s_waitcnt lgkmcnt(3)
  v_add_f32 v176, v176, v160
  v_add_f32 v177, v177, v161
  v_add_f32 v178, v178, v162
  v_add_f32 v179, v179, v163
  s_waitcnt lgkmcnt(2)
  v_add_f32 v180, v180, v164
  v_add_f32 v181, v181, v165
  v_add_f32 v182, v182, v166
  v_add_f32 v183, v183, v167
  v_mfma_f32_32x32x16_bf16 v[240:255], a[88:91], v[76:79], v[240:255]
  s_waitcnt lgkmcnt(1)
  v_add_f32 v184, v184, v168
  v_add_f32 v185, v185, v169
  v_add_f32 v186, v186, v170
  v_add_f32 v187, v187, v171
  s_waitcnt lgkmcnt(0)
  v_add_f32 v188, v188, v172
  v_add_f32 v189, v189, v173
  v_add_f32 v190, v190, v174
  v_add_f32 v191, v191, v175
  v_mfma_f32_32x32x16_bf16 v[240:255], a[96:99], v[80:83], v[240:255]
  s_xor_b32 s54, s38, 1
  s_mul_i32 s54, s54, 12288
  s_add_u32 s54, s54, 0
  v_add_u32 v4, s54, v0
  v_mfma_f32_32x32x16_bf16 v[240:255], a[104:107], v[84:87], v[240:255]
  v_mfma_f32_32x32x16_bf16 v[240:255], a[144:147], v[88:91], v[240:255]
  ds_write_b128 v4, v[224:227] offset:0
  v_mfma_f32_32x32x16_bf16 v[240:255], a[152:155], v[92:95], v[240:255]
  ds_write_b128 v4, v[228:231] offset:1024
  ds_write_b128 v4, v[232:235] offset:2048
  v_mfma_f32_32x32x16_bf16 v[240:255], a[160:163], v[96:99], v[240:255]
  ds_write_b128 v4, v[236:239] offset:3072
  s_waitcnt lgkmcnt(0)
  s_barrier
  v_mfma_f32_32x32x16_bf16 v[240:255], a[200:203], v[100:103], v[240:255]
  ds_read_b128 v[144:147], v6 offset:0
  ds_read_b128 v[148:151], v6 offset:1024
  v_mfma_f32_32x32x16_bf16 v[240:255], a[208:211], v[104:107], v[240:255]
  ds_read_b128 v[152:155], v6 offset:2048
  ds_read_b128 v[156:159], v6 offset:3072
  v_mfma_f32_32x32x16_bf16 v[240:255], a[216:219], v[108:111], v[240:255]
  s_waitcnt lgkmcnt(3)
  v_pk_add_f32 v[176:177], v[176:177], v[144:145]
  v_pk_add_f32 v[178:179], v[178:179], v[146:147]
  s_waitcnt lgkmcnt(2)
  v_pk_add_f32 v[180:181], v[180:181], v[148:149]
  v_pk_add_f32 v[182:183], v[182:183], v[150:151]
  s_waitcnt lgkmcnt(1)
  v_pk_add_f32 v[184:185], v[184:185], v[152:153]
  v_pk_add_f32 v[186:187], v[186:187], v[154:155]
  s_waitcnt lgkmcnt(0)
  v_pk_add_f32 v[188:189], v[188:189], v[156:157]
  v_pk_add_f32 v[190:191], v[190:191], v[158:159]
  v_pk_add_f32 v[240:241], v[240:241], v[176:177]
  v_pk_add_f32 v[242:243], v[242:243], v[178:179]
  v_pk_add_f32 v[244:245], v[244:245], v[180:181]
  v_pk_add_f32 v[246:247], v[246:247], v[182:183]
  v_cvt_pk_bf16_f32 v8, v240, v241
  v_cvt_pk_bf16_f32 v9, v242, v243
  v_cvt_pk_bf16_f32 v10, v244, v245
  v_cvt_pk_bf16_f32 v11, v246, v247
  buffer_store_dwordx4 v[8:11], v7, s[16:19], s55 offen
  v_pk_add_f32 v[248:249], v[248:249], v[184:185]
  v_pk_add_f32 v[250:251], v[250:251], v[186:187]
  v_pk_add_f32 v[252:253], v[252:253], v[188:189]
  v_pk_add_f32 v[254:255], v[254:255], v[190:191]
  v_cvt_pk_bf16_f32 v12, v248, v249
  v_cvt_pk_bf16_f32 v13, v250, v251
  v_cvt_pk_bf16_f32 v14, v252, v253
  v_cvt_pk_bf16_f32 v15, v254, v255
  buffer_store_dwordx4 v[12:15], v7, s[16:19], s55 offen offset:32
L_exit:
  s_endpgm
L_lslow_13:
  s_mov_b32 s46, 2097152
L_lp_15:
  s_sleep 8
  v_and_b32 v254, 0x7c, v1
  buffer_load_dword v5, v254, s[20:23], 0 offen sc1
  s_sub_u32 s46, s46, 1
  s_cbranch_scc1 L_exit
  s_waitcnt vmcnt(0)
  v_cmp_eq_u32 vcc, 0, v5
  s_nop 0
  s_cbranch_vccnz L_lp_15
  s_branch L_ljoin_14
L_gslow_21:
  s_mov_b32 s46, 2097152
L_gp_23:
  buffer_load_dword v249, v253, s[8:11], s7 offen sc1
  s_sub_u32 s46, s46, 1
  s_cbranch_scc1 L_exit
  s_waitcnt vmcnt(0)
  v_cmp_gt_u32 s[100:101], 1, v249
  s_nop 1
  s_and_b32 s4, s100, 12
  s_cbranch_scc0 L_gjoin_22
  s_sleep 2
  s_branch L_gp_23
L_gslow_25:
  s_mov_b32 s46, 2097152
L_gp_27:
  buffer_load_dword v249, v253, s[8:11], s7 offen sc1
  s_sub_u32 s46, s46, 1
  s_cbranch_scc1 L_exit
  s_waitcnt vmcnt(0)
  v_cmp_gt_u32 s[100:101], 1, v249
  s_nop 1
  s_and_b32 s4, s100, 48
  s_cbranch_scc0 L_gjoin_26
  s_sleep 2
  s_branch L_gp_27
L_lslow_29:
  s_mov_b32 s46, 2097152
L_lp_31:
  s_sleep 16
  buffer_load_dwordx4 v[244:247], v248, s[8:11], s58 offen sc1
  s_sub_u32 s46, s46, 1
  s_cbranch_scc1 L_exit
  s_waitcnt vmcnt(0)
  v_min_u32 v244, v244, v245
  v_min3_u32 v244, v244, v246, v247
  v_cmp_gt_u32 vcc, 1, v244
  s_nop 0
  s_cbranch_vccnz L_lp_31
  s_branch L_ljoin_30
L_gslow_32:
  s_mov_b32 s46, 2097152
L_gp_34:
  buffer_load_dword v249, v253, s[8:11], s7 offen sc1
  s_sub_u32 s46, s46, 1
  s_cbranch_scc1 L_exit
  s_waitcnt vmcnt(0)
  v_cmp_gt_u32 s[100:101], 1, v249
  s_nop 1
  s_and_b32 s4, s100, 192
  s_cbranch_scc0 L_gjoin_33
  s_sleep 2
  s_branch L_gp_34
L_gslow_35:
  s_mov_b32 s46, 2097152
L_gp_37:
  buffer_load_dword v249, v253, s[8:11], s7 offen sc1
  s_sub_u32 s46, s46, 1
  s_cbranch_scc1 L_exit
  s_waitcnt vmcnt(0)
  v_cmp_gt_u32 s[100:101], 1, v249
  s_nop 1
  s_and_b32 s4, s100, 768
  s_cbranch_scc0 L_gjoin_36
  s_sleep 2
  s_branch L_gp_37
L_gslow_38:
  s_mov_b32 s46, 2097152
L_gp_40:
  buffer_load_dword v249, v253, s[8:11], s7 offen sc1
  s_sub_u32 s46, s46, 1
  s_cbranch_scc1 L_exit
  s_waitcnt vmcnt(0)
  v_cmp_gt_u32 s[100:101], 1, v249
  s_nop 1
  s_and_b32 s4, s100, 3072
  s_cbranch_scc0 L_gjoin_39
  s_sleep 2
  s_branch L_gp_40
L_gslow_41:
  s_mov_b32 s46, 2097152
L_gp_43:
  buffer_load_dword v249, v253, s[8:11], s7 offen sc1
  s_sub_u32 s46, s46, 1
  s_cbranch_scc1 L_exit
  s_waitcnt vmcnt(0)
  v_cmp_gt_u32 s[100:101], 1, v249
  s_nop 1
  s_and_b32 s4, s100, 12288
  s_cbranch_scc0 L_gjoin_42
  s_sleep 2
  s_branch L_gp_43
L_gslow_44:
  s_mov_b32 s46, 2097152
L_gp_46:
  buffer_load_dword v249, v253, s[8:11], s7 offen sc1
  s_sub_u32 s46, s46, 1
  s_cbranch_scc1 L_exit
  s_waitcnt vmcnt(0)
  v_cmp_gt_u32 s[100:101], 1, v249
  s_nop 1
  s_and_b32 s4, s100, 49152
  s_cbranch_scc0 L_gjoin_45
  s_sleep 2
  s_branch L_gp_46
L_lslow_47:
  s_mov_b32 s46, 2097152
L_lp_49:
  s_sleep 8
  s_lshl_b32 s55, s36, 7
  s_add_u32 s55, s55, 90112
  buffer_load_dword v6, v7, s[8:11], s55 offen sc1
  s_sub_u32 s46, s46, 1
  s_cbranch_scc1 L_exit
  s_waitcnt vmcnt(0)
  v_cmp_eq_u32 vcc, 0, v6
  s_nop 0
  s_cbranch_vccnz L_lp_49
  s_branch L_ljoin_48
L_fb_51:
  s_lshl_b32 s50, s37, 17
  s_add_u32 s50, s50, 23068672
  s_mov_b32 s51, s50
  s_add_u32 s52, s50, 0x20000
  v_mov_b32 v16, 0xff800000
  v_mov_b32 v17, 0xff800000
L_fb1_53:
  buffer_load_dwordx4 v[208:211], v0, s[8:11], s51 offen sc1
  s_waitcnt vmcnt(0)
  v_mfma_f32_32x32x16_bf16 v[176:191], v[208:211], v[168:171], 0
  v_mfma_f32_32x32x16_bf16 v[192:207], v[208:211], v[172:175], 0
  s_nop 15
  v_max3_f32 v16, v176, v177, v16
  v_max3_f32 v16, v178, v179, v16
  v_max3_f32 v16, v180, v181, v16
  v_max3_f32 v16, v182, v183, v16
  v_max3_f32 v16, v184, v185, v16
  v_max3_f32 v16, v186, v187, v16
  v_max3_f32 v16, v188, v189, v16
  v_max3_f32 v16, v190, v191, v16
  v_max3_f32 v17, v192, v193, v17
  v_max3_f32 v17, v194, v195, v17
  v_max3_f32 v17, v196, v197, v17
  v_max3_f32 v17, v198, v199, v17
  v_max3_f32 v17, v200, v201, v17
  v_max3_f32 v17, v202, v203, v17
  v_max3_f32 v17, v204, v205, v17
  v_max3_f32 v17, v206, v207, v17
  s_add_u32 s51, s51, 2048
  s_cmp_lt_u32 s51, s52
  s_cbranch_scc1 L_fb1_53
  v_mov_b32 v18, v16
  s_nop 1
  v_permlane32_swap_b32 v16, v18
  v_max_f32 v16, v16, v18
  v_mov_b32 v18, v17
  s_nop 1
  v_permlane32_swap_b32 v17, v18
  v_max_f32 v17, v17, v18
  v_mov_b32 v112, 0
  v_mov_b32 v113, 0
  v_mov_b32 v114, 0
  v_mov_b32 v115, 0
  v_mov_b32 v116, 0
  v_mov_b32 v117, 0
  v_mov_b32 v118, 0
  v_mov_b32 v119, 0
  v_mov_b32 v120, 0
  v_mov_b32 v121, 0
  v_mov_b32 v122, 0
  v_mov_b32 v123, 0
  v_mov_b32 v124, 0
  v_mov_b32 v125, 0
  v_mov_b32 v126, 0
  v_mov_b32 v127, 0
  v_mov_b32 v128, 0
  v_mov_b32 v129, 0
  v_mov_b32 v130, 0
  v_mov_b32 v131, 0
  v_mov_b32 v132, 0
  v_mov_b32 v133, 0
  v_mov_b32 v134, 0
  v_mov_b32 v135, 0
  v_mov_b32 v136, 0
  v_mov_b32 v137, 0
  v_mov_b32 v138, 0
  v_mov_b32 v139, 0
  v_mov_b32 v140, 0
  v_mov_b32 v141, 0
  v_mov_b32 v142, 0
  v_mov_b32 v143, 0
  s_mov_b32 s51, s50
L_fb2_54:
  buffer_load_dwordx4 v[208:211], v0, s[8:11], s51 offen sc1
  s_mov_b64 exec, s[60:61]
  buffer_load_dwordx4 v[212:215], v252, s[8:11], s51 offen offset:1024 sc1
  buffer_load_dwordx4 v[216:219], v252, s[8:11], s51 offen offset:1536 sc1
  s_mov_b64 exec, -1
  s_waitcnt vmcnt(0)
  v_mfma_f32_32x32x16_bf16 v[176:191], v[208:211], v[168:171], 0
  v_mfma_f32_32x32x16_bf16 v[192:207], v[208:211], v[172:175], 0
  s_nop 15
  v_sub_f32 v176, v176, v16
  v_sub_f32 v177, v177, v16
  v_sub_f32 v178, v178, v16
  v_sub_f32 v179, v179, v16
  v_sub_f32 v180, v180, v16
  v_sub_f32 v181, v181, v16
  v_sub_f32 v182, v182, v16
  v_sub_f32 v183, v183, v16
  v_sub_f32 v184, v184, v16
  v_sub_f32 v185, v185, v16
  v_sub_f32 v186, v186, v16
  v_sub_f32 v187, v187, v16
  v_sub_f32 v188, v188, v16
  v_sub_f32 v189, v189, v16
  v_sub_f32 v190, v190, v16
  v_sub_f32 v191, v191, v16
  v_exp_f32 v176, v176
  v_exp_f32 v177, v177
  v_exp_f32 v178, v178
  v_exp_f32 v179, v179
  v_exp_f32 v180, v180
  v_exp_f32 v181, v181
  v_exp_f32 v182, v182
  v_exp_f32 v183, v183
  v_exp_f32 v184, v184
  v_exp_f32 v185, v185
  v_exp_f32 v186, v186
  v_exp_f32 v187, v187
  v_exp_f32 v188, v188
  v_exp_f32 v189, v189
  v_exp_f32 v190, v190
  v_exp_f32 v191, v191
  v_sub_f32 v192, v192, v17
  v_sub_f32 v193, v193, v17
  v_sub_f32 v194, v194, v17
  v_sub_f32 v195, v195, v17
  v_sub_f32 v196, v196, v17
  v_sub_f32 v197, v197, v17
  v_sub_f32 v198, v198, v17
  v_sub_f32 v199, v199, v17
  v_sub_f32 v200, v200, v17
  v_sub_f32 v201, v201, v17
  v_sub_f32 v202, v202, v17
  v_sub_f32 v203, v203, v17
  v_sub_f32 v204, v204, v17
  v_sub_f32 v205, v205, v17
  v_sub_f32 v206, v206, v17
  v_sub_f32 v207, v207, v17
  v_exp_f32 v192, v192
  v_exp_f32 v193, v193
  v_exp_f32 v194, v194
  v_exp_f32 v195, v195
  v_exp_f32 v196, v196
  v_exp_f32 v197, v197
  v_exp_f32 v198, v198
  v_exp_f32 v199, v199
  v_exp_f32 v200, v200
  v_exp_f32 v201, v201
  v_exp_f32 v202, v202
  v_exp_f32 v203, v203
  v_exp_f32 v204, v204
  v_exp_f32 v205, v205
  v_exp_f32 v206, v206
  v_exp_f32 v207, v207
  s_nop 1
  v_smfmac_f32_32x32x32_bf16 v[112:127], v[212:215], v[176:183], v2
  v_smfmac_f32_32x32x32_bf16 v[112:127], v[216:219], v[184:191], v2
  v_smfmac_f32_32x32x32_bf16 v[128:143], v[212:215], v[192:199], v2
  v_smfmac_f32_32x32x32_bf16 v[128:143], v[216:219], v[200:207], v2
  s_add_u32 s51, s51, 2048
  s_cmp_lt_u32 s51, s52
  s_nop 7
  s_cbranch_scc1 L_fb2_54
  s_nop 15
  v_rcp_f32 v122, v120
  s_nop 0
  v_pk_mul_f32 v[112:113], v[112:113], v[122:123] op_sel_hi:[1,0]
  v_pk_mul_f32 v[114:115], v[114:115], v[122:123] op_sel_hi:[1,0]
  v_pk_mul_f32 v[116:117], v[116:117], v[122:123] op_sel_hi:[1,0]
  v_pk_mul_f32 v[118:119], v[118:119], v[122:123] op_sel_hi:[1,0]
  v_cvt_pk_bf16_f32 v124, v112, v113
  v_cvt_pk_bf16_f32 v125, v114, v115
  v_cvt_pk_bf16_f32 v126, v116, v117
  v_cvt_pk_bf16_f32 v127, v118, v119
  buffer_store_dwordx4 v[124:127], v0, s[8:11], s48 offen
  v_rcp_f32 v138, v136
  s_nop 0
  v_pk_mul_f32 v[128:129], v[128:129], v[138:139] op_sel_hi:[1,0]
  v_pk_mul_f32 v[130:131], v[130:131], v[138:139] op_sel_hi:[1,0]
  v_pk_mul_f32 v[132:133], v[132:133], v[138:139] op_sel_hi:[1,0]
  v_pk_mul_f32 v[134:135], v[134:135], v[138:139] op_sel_hi:[1,0]
  v_cvt_pk_bf16_f32 v140, v128, v129
  v_cvt_pk_bf16_f32 v141, v130, v131
  v_cvt_pk_bf16_f32 v142, v132, v133
  v_cvt_pk_bf16_f32 v143, v134, v135
  buffer_store_dwordx4 v[140:143], v0, s[8:11], s49 offen
  s_branch L_fbj_52
L_slow_55:
  buffer_wbl2 sc1
  s_waitcnt vmcnt(0)
  s_mov_b64 exec, 4
  buffer_store_dword v5, v3, s[8:11], 0 offen sc1
  s_mov_b64 exec, -1
  s_branch L_join_56
L_slow_58:
  buffer_inv sc1
  s_waitcnt vmcnt(0)
  s_branch L_join_59
L_slow_61:
  buffer_store_dword v128, v0, s[8:11], s56 offen sc1
  s_branch L_join_62
L_slow_63:
  buffer_wbl2 sc1
  s_waitcnt vmcnt(0)
  s_mov_b64 exec, 8
  buffer_store_dword v5, v3, s[8:11], 0 offen sc1
  s_mov_b64 exec, -1
  s_branch L_join_64
L_slow_66:
  buffer_inv sc1
  s_waitcnt vmcnt(0)
  s_branch L_join_67
L_slow_74:
  buffer_wbl2 sc1
  s_waitcnt vmcnt(0)
  s_mov_b64 exec, 16
  buffer_store_dword v5, v3, s[8:11], 0 offen sc1
  s_mov_b64 exec, -1
  s_branch L_join_75
L_lslow_76:
  s_mov_b32 s46, 2097152
L_lp_78:
  buffer_load_dword v5, v4, s[8:11], s50 offen sc1
  s_sub_u32 s46, s46, 1
  s_cbranch_scc1 L_exit
  s_waitcnt vmcnt(0)
  v_cmp_gt_u32 vcc, 1, v5
  s_nop 0
  s_cbranch_vccnz L_lp_78
  s_branch L_ljoin_77
L_slow_79:
  buffer_inv sc1
  s_waitcnt vmcnt(0)
  s_branch L_join_80
L_slow_81:
  buffer_wbl2 sc1
  s_waitcnt vmcnt(0)
  s_mov_b64 exec, 16
  buffer_store_dword v5, v3, s[8:11], 0 offen sc1
  s_mov_b64 exec, -1
  s_branch L_join_82
L_lslow_83:
  s_mov_b32 s46, 2097152
L_lp_85:
  buffer_load_dword v5, v4, s[8:11], s50 offen sc1
  s_sub_u32 s46, s46, 1
  s_cbranch_scc1 L_exit
  s_waitcnt vmcnt(0)
  v_cmp_gt_u32 vcc, 2, v5
  s_nop 0
  s_cbranch_vccnz L_lp_85
  s_branch L_ljoin_84
L_slow_86:
  buffer_inv sc1
  s_waitcnt vmcnt(0)
  s_branch L_join_87
L_slow_88:
  buffer_store_dword v176, v0, s[8:11], s56 offen sc1
  s_branch L_join_89
L_slow_90:
  buffer_wbl2 sc1
  s_waitcnt vmcnt(0)
  s_mov_b64 exec, 32
  buffer_store_dword v5, v3, s[8:11], 0 offen sc1
  s_mov_b64 exec, -1
  s_branch L_join_91
L_slow_93:
  buffer_inv sc1
  s_waitcnt vmcnt(0)
  s_branch L_join_94
L_slow_95:
  buffer_wbl2 sc1
  s_waitcnt vmcnt(0)
  s_mov_b64 exec, 1
  buffer_store_dword v5, v3, s[8:11], 0 offen sc1
  s_mov_b64 exec, -1
  s_branch L_join_96
L_slow_100:
  buffer_inv sc1
  s_waitcnt vmcnt(0)
  s_branch L_join_101
L_gslow_103:
  s_mov_b32 s46, 2097152
L_gp_105:
  buffer_load_dword v249, v253, s[8:11], s7 offen sc1
  s_sub_u32 s46, s46, 1
  s_cbranch_scc1 L_exit
  s_waitcnt vmcnt(0)
  v_cmp_gt_u32 s[100:101], 2, v249
  s_nop 1
  s_and_b32 s4, s100, 12
  s_cbranch_scc0 L_gjoin_104
  s_sleep 2
  s_branch L_gp_105
L_gslow_107:
  s_mov_b32 s46, 2097152
L_gp_109:
  buffer_load_dword v249, v253, s[8:11], s7 offen sc1
  s_sub_u32 s46, s46, 1
  s_cbranch_scc1 L_exit
  s_waitcnt vmcnt(0)
  v_cmp_gt_u32 s[100:101], 2, v249
  s_nop 1
  s_and_b32 s4, s100, 48
  s_cbranch_scc0 L_gjoin_108
  s_sleep 2
  s_branch L_gp_109
L_gslow_110:
  s_mov_b32 s46, 2097152
L_gp_112:
  buffer_load_dword v249, v253, s[8:11], s7 offen sc1
  s_sub_u32 s46, s46, 1
  s_cbranch_scc1 L_exit
  s_waitcnt vmcnt(0)
  v_cmp_gt_u32 s[100:101], 2, v249
  s_nop 1
  s_and_b32 s4, s100, 192
  s_cbranch_scc0 L_gjoin_111
  s_sleep 2
  s_branch L_gp_112
L_gslow_113:
  s_mov_b32 s46, 2097152
L_gp_115:
  buffer_load_dword v249, v253, s[8:11], s7 offen sc1
  s_sub_u32 s46, s46, 1
  s_cbranch_scc1 L_exit
  s_waitcnt vmcnt(0)
  v_cmp_gt_u32 s[100:101], 2, v249
  s_nop 1
  s_and_b32 s4, s100, 768
  s_cbranch_scc0 L_gjoin_114
  s_sleep 2
  s_branch L_gp_115
L_gslow_116:
  s_mov_b32 s46, 2097152
L_gp_118:
  buffer_load_dword v249, v253, s[8:11], s7 offen sc1
  s_sub_u32 s46, s46, 1
  s_cbranch_scc1 L_exit
  s_waitcnt vmcnt(0)
  v_cmp_gt_u32 s[100:101], 2, v249
  s_nop 1
  s_and_b32 s4, s100, 3072
  s_cbranch_scc0 L_gjoin_117
  s_sleep 2
  s_branch L_gp_118
L_gslow_119:
  s_mov_b32 s46, 2097152
L_gp_121:
  buffer_load_dword v249, v253, s[8:11], s7 offen sc1
  s_sub_u32 s46, s46, 1
  s_cbranch_scc1 L_exit
  s_waitcnt vmcnt(0)
  v_cmp_gt_u32 s[100:101], 2, v249
  s_nop 1
  s_and_b32 s4, s100, 12288
  s_cbranch_scc0 L_gjoin_120
  s_sleep 2
  s_branch L_gp_121
L_gslow_122:
  s_mov_b32 s46, 2097152
L_gp_124:
  buffer_load_dword v249, v253, s[8:11], s7 offen sc1
  s_sub_u32 s46, s46, 1
  s_cbranch_scc1 L_exit
  s_waitcnt vmcnt(0)
  v_cmp_gt_u32 s[100:101], 2, v249
  s_nop 1
  s_and_b32 s4, s100, 49152
  s_cbranch_scc0 L_gjoin_123
  s_sleep 2
  s_branch L_gp_124
L_fb_126:
  s_lshl_b32 s50, s37, 17
  s_add_u32 s50, s50, 27262976
  s_mov_b32 s51, s50
  s_add_u32 s52, s50, 0x20000
  v_mov_b32 v16, 0xff800000
  v_mov_b32 v17, 0xff800000
L_fb1_128:
  buffer_load_dwordx4 v[208:211], v0, s[8:11], s51 offen sc1
  s_waitcnt vmcnt(0)
  v_mfma_f32_32x32x16_bf16 v[176:191], v[208:211], v[168:171], 0
  v_mfma_f32_32x32x16_bf16 v[192:207], v[208:211], v[172:175], 0
  s_nop 15
  v_max3_f32 v16, v176, v177, v16
  v_max3_f32 v16, v178, v179, v16
  v_max3_f32 v16, v180, v181, v16
  v_max3_f32 v16, v182, v183, v16
  v_max3_f32 v16, v184, v185, v16
  v_max3_f32 v16, v186, v187, v16
  v_max3_f32 v16, v188, v189, v16
  v_max3_f32 v16, v190, v191, v16
  v_max3_f32 v17, v192, v193, v17
  v_max3_f32 v17, v194, v195, v17
  v_max3_f32 v17, v196, v197, v17
  v_max3_f32 v17, v198, v199, v17
  v_max3_f32 v17, v200, v201, v17
  v_max3_f32 v17, v202, v203, v17
  v_max3_f32 v17, v204, v205, v17
  v_max3_f32 v17, v206, v207, v17
  s_add_u32 s51, s51, 2048
  s_cmp_lt_u32 s51, s52
  s_cbranch_scc1 L_fb1_128
  v_mov_b32 v18, v16
  s_nop 1
  v_permlane32_swap_b32 v16, v18
  v_max_f32 v16, v16, v18
  v_mov_b32 v18, v17
  s_nop 1
  v_permlane32_swap_b32 v17, v18
  v_max_f32 v17, v17, v18
  v_mov_b32 v112, 0
  v_mov_b32 v113, 0
  v_mov_b32 v114, 0
  v_mov_b32 v115, 0
  v_mov_b32 v116, 0
  v_mov_b32 v117, 0
  v_mov_b32 v118, 0
  v_mov_b32 v119, 0
  v_mov_b32 v120, 0
  v_mov_b32 v121, 0
  v_mov_b32 v122, 0
  v_mov_b32 v123, 0
  v_mov_b32 v124, 0
  v_mov_b32 v125, 0
  v_mov_b32 v126, 0
  v_mov_b32 v127, 0
  v_mov_b32 v128, 0
  v_mov_b32 v129, 0
  v_mov_b32 v130, 0
  v_mov_b32 v131, 0
  v_mov_b32 v132, 0
  v_mov_b32 v133, 0
  v_mov_b32 v134, 0
  v_mov_b32 v135, 0
  v_mov_b32 v136, 0
  v_mov_b32 v137, 0
  v_mov_b32 v138, 0
  v_mov_b32 v139, 0
  v_mov_b32 v140, 0
  v_mov_b32 v141, 0
  v_mov_b32 v142, 0
  v_mov_b32 v143, 0
  s_mov_b32 s51, s50
L_fb2_129:
  buffer_load_dwordx4 v[208:211], v0, s[8:11], s51 offen sc1
  s_mov_b64 exec, s[60:61]
  buffer_load_dwordx4 v[212:215], v252, s[8:11], s51 offen offset:1024 sc1
  buffer_load_dwordx4 v[216:219], v252, s[8:11], s51 offen offset:1536 sc1
  s_mov_b64 exec, -1
  s_waitcnt vmcnt(0)
  v_mfma_f32_32x32x16_bf16 v[176:191], v[208:211], v[168:171], 0
  v_mfma_f32_32x32x16_bf16 v[192:207], v[208:211], v[172:175], 0
  s_nop 15
  v_sub_f32 v176, v176, v16
  v_sub_f32 v177, v177, v16
  v_sub_f32 v178, v178, v16
  v_sub_f32 v179, v179, v16
  v_sub_f32 v180, v180, v16
  v_sub_f32 v181, v181, v16
  v_sub_f32 v182, v182, v16
  v_sub_f32 v183, v183, v16
  v_sub_f32 v184, v184, v16
  v_sub_f32 v185, v185, v16
  v_sub_f32 v186, v186, v16
  v_sub_f32 v187, v187, v16
  v_sub_f32 v188, v188, v16
  v_sub_f32 v189, v189, v16
  v_sub_f32 v190, v190, v16
  v_sub_f32 v191, v191, v16
  v_exp_f32 v176, v176
  v_exp_f32 v177, v177
  v_exp_f32 v178, v178
  v_exp_f32 v179, v179
  v_exp_f32 v180, v180
  v_exp_f32 v181, v181
  v_exp_f32 v182, v182
  v_exp_f32 v183, v183
  v_exp_f32 v184, v184
  v_exp_f32 v185, v185
  v_exp_f32 v186, v186
  v_exp_f32 v187, v187
  v_exp_f32 v188, v188
  v_exp_f32 v189, v189
  v_exp_f32 v190, v190
  v_exp_f32 v191, v191
  v_sub_f32 v192, v192, v17
  v_sub_f32 v193, v193, v17
  v_sub_f32 v194, v194, v17
  v_sub_f32 v195, v195, v17
  v_sub_f32 v196, v196, v17
  v_sub_f32 v197, v197, v17
  v_sub_f32 v198, v198, v17
  v_sub_f32 v199, v199, v17
  v_sub_f32 v200, v200, v17
  v_sub_f32 v201, v201, v17
  v_sub_f32 v202, v202, v17
  v_sub_f32 v203, v203, v17
  v_sub_f32 v204, v204, v17
  v_sub_f32 v205, v205, v17
  v_sub_f32 v206, v206, v17
  v_sub_f32 v207, v207, v17
  v_exp_f32 v192, v192
  v_exp_f32 v193, v193
  v_exp_f32 v194, v194
  v_exp_f32 v195, v195
  v_exp_f32 v196, v196
  v_exp_f32 v197, v197
  v_exp_f32 v198, v198
  v_exp_f32 v199, v199
  v_exp_f32 v200, v200
  v_exp_f32 v201, v201
  v_exp_f32 v202, v202
  v_exp_f32 v203, v203
  v_exp_f32 v204, v204
  v_exp_f32 v205, v205
  v_exp_f32 v206, v206
  v_exp_f32 v207, v207
  s_nop 1
  v_smfmac_f32_32x32x32_bf16 v[112:127], v[212:215], v[176:183], v2
  v_smfmac_f32_32x32x32_bf16 v[112:127], v[216:219], v[184:191], v2
  v_smfmac_f32_32x32x32_bf16 v[128:143], v[212:215], v[192:199], v2
  v_smfmac_f32_32x32x32_bf16 v[128:143], v[216:219], v[200:207], v2
  s_add_u32 s51, s51, 2048
  s_cmp_lt_u32 s51, s52
  s_nop 7
  s_cbranch_scc1 L_fb2_129
  s_nop 15
  v_rcp_f32 v122, v120
  s_nop 0
  v_pk_mul_f32 v[112:113], v[112:113], v[122:123] op_sel_hi:[1,0]
  v_pk_mul_f32 v[114:115], v[114:115], v[122:123] op_sel_hi:[1,0]
  v_pk_mul_f32 v[116:117], v[116:117], v[122:123] op_sel_hi:[1,0]
  v_pk_mul_f32 v[118:119], v[118:119], v[122:123] op_sel_hi:[1,0]
  v_cvt_pk_bf16_f32 v124, v112, v113
  v_cvt_pk_bf16_f32 v125, v114, v115
  v_cvt_pk_bf16_f32 v126, v116, v117
  v_cvt_pk_bf16_f32 v127, v118, v119
  buffer_store_dwordx4 v[124:127], v0, s[8:11], s48 offen
  v_rcp_f32 v138, v136
  s_nop 0
  v_pk_mul_f32 v[128:129], v[128:129], v[138:139] op_sel_hi:[1,0]
  v_pk_mul_f32 v[130:131], v[130:131], v[138:139] op_sel_hi:[1,0]
  v_pk_mul_f32 v[132:133], v[132:133], v[138:139] op_sel_hi:[1,0]
  v_pk_mul_f32 v[134:135], v[134:135], v[138:139] op_sel_hi:[1,0]
  v_cvt_pk_bf16_f32 v140, v128, v129
  v_cvt_pk_bf16_f32 v141, v130, v131
  v_cvt_pk_bf16_f32 v142, v132, v133
  v_cvt_pk_bf16_f32 v143, v134, v135
  buffer_store_dwordx4 v[140:143], v0, s[8:11], s49 offen
  s_branch L_fbj_127
L_slow_130:
  buffer_wbl2 sc1
  s_waitcnt vmcnt(0)
  s_mov_b64 exec, 4
  buffer_store_dword v5, v3, s[8:11], 0 offen sc1
  s_mov_b64 exec, -1
  s_branch L_join_131
L_slow_133:
  buffer_inv sc1
  s_waitcnt vmcnt(0)
  s_branch L_join_134
L_slow_136:
  buffer_store_dword v128, v0, s[8:11], s56 offen sc1
  s_branch L_join_137
L_slow_138:
  buffer_wbl2 sc1
  s_waitcnt vmcnt(0)
  s_mov_b64 exec, 8
  buffer_store_dword v5, v3, s[8:11], 0 offen sc1
  s_mov_b64 exec, -1
  s_branch L_join_139
L_slow_141:
  buffer_inv sc1
  s_waitcnt vmcnt(0)
  s_branch L_join_142
L_slow_148:
  buffer_wbl2 sc1
  s_waitcnt vmcnt(0)
  s_mov_b64 exec, 16
  buffer_store_dword v5, v3, s[8:11], 0 offen sc1
  s_mov_b64 exec, -1
  s_branch L_join_149
L_lslow_150:
  s_mov_b32 s46, 2097152
L_lp_152:
  buffer_load_dword v5, v4, s[8:11], s50 offen sc1
  s_sub_u32 s46, s46, 1
  s_cbranch_scc1 L_exit
  s_waitcnt vmcnt(0)
  v_cmp_gt_u32 vcc, 3, v5
  s_nop 0
  s_cbranch_vccnz L_lp_152
  s_branch L_ljoin_151
L_slow_153:
  buffer_inv sc1
  s_waitcnt vmcnt(0)
  s_branch L_join_154
L_slow_155:
  buffer_wbl2 sc1
  s_waitcnt vmcnt(0)
  s_mov_b64 exec, 16
  buffer_store_dword v5, v3, s[8:11], 0 offen sc1
  s_mov_b64 exec, -1
  s_branch L_join_156
L_lslow_157:
  s_mov_b32 s46, 2097152
L_lp_159:
  buffer_load_dword v5, v4, s[8:11], s50 offen sc1
  s_sub_u32 s46, s46, 1
  s_cbranch_scc1 L_exit
  s_waitcnt vmcnt(0)
  v_cmp_gt_u32 vcc, 4, v5
  s_nop 0
  s_cbranch_vccnz L_lp_159
  s_branch L_ljoin_158
L_slow_160:
  buffer_inv sc1
  s_waitcnt vmcnt(0)
  s_branch L_join_161
L_end:
.section .rodata,"a"
.p2align 6
.amdhsa_kernel interleave_layers__mha_block__glu_gated_swiglu__prompt_kernel
  .amdhsa_next_free_vgpr 512
  .amdhsa_next_free_sgpr 102
  .amdhsa_accum_offset 256
  .amdhsa_group_segment_fixed_size 0
  .amdhsa_kernarg_size 80
  .amdhsa_user_sgpr_count 2
  .amdhsa_user_sgpr_kernarg_segment_ptr 1
  .amdhsa_system_sgpr_workgroup_id_x 1
  .amdhsa_float_denorm_mode_32 3
.end_amdhsa_kernel
```
